```python
import torch

def _softmax(x, axis=-1):
    return torch.softmax(x, dim=axis)
def _gelu(x):
    return torch.nn.functional.gelu(x, approximate="tanh")
def _silu(x):
    return torch.nn.functional.silu(x)
def _sigmoid(x):
    return torch.sigmoid(x)
def _layernorm(x, axis=-1, eps=1e-5):
    m = x.mean(dim=axis, keepdim=True)
    v = x.var(dim=axis, keepdim=True, unbiased=False)
    return (x - m) / torch.sqrt(v + eps)
def _scatter_add(tgt, idx, src, axis=0):
    return tgt.clone().index_add_(axis, idx, src)
def _segment_sum(src, seg, n):
    out = torch.zeros((n,) + src.shape[1:], dtype=src.dtype)
    return out.index_add_(0, seg, src)
def _pad(x, pw):
    flat = tuple(v for pair in reversed(pw) for v in pair)
    return torch.nn.functional.pad(x, flat)

kernel_name = 'recurrent_scan__softmax_full_mha__glu_gated_glu__prompt'

def setup_inputs():

    _w = (lambda a: (lambda t: t.to(torch.bfloat16) if t.is_floating_point() else t)(torch.as_tensor(a)))
    def _A_setup():
        B, S, D = 1, 2048, 576
        return {
            "x": _w((lambda *s: torch.randn(*s, dtype=torch.bfloat16) * 0.05)(B, S, D)),
            "wqkv": _w((lambda *s: torch.randn(*s, dtype=torch.bfloat16) * 0.05)(D, 3 * D)),
            "wo": _w((lambda *s: torch.randn(*s, dtype=torch.bfloat16) * 0.05)(D, D)),
        }
    _A_in = _A_setup()

    def _B_setup():
        B, S, D, F = 1, 2048, 576, 4608
        return {
            "x": _w((lambda *s: torch.randn(*s, dtype=torch.bfloat16) * 0.05)(B, S, D)),
            "w_gate": _w((lambda *s: torch.randn(*s, dtype=torch.bfloat16) * 0.05)(D, F)),
            "w_up": _w((lambda *s: torch.randn(*s, dtype=torch.bfloat16) * 0.05)(D, F)),
            "w_down": _w((lambda *s: torch.randn(*s, dtype=torch.bfloat16) * 0.05)(F, D)),
        }
    _B_in = _B_setup()

    return {
        "A_x": _A_in["x"],
        "A_wqkv": _A_in["wqkv"],
        "A_wo": _A_in["wo"],
        "B_x": _B_in["x"],
        "B_w_gate": _B_in["w_gate"],
        "B_w_up": _B_in["w_up"],
        "B_w_down": _B_in["w_down"],
    }

def reference(A_x, A_wqkv, A_wo, B_x, B_w_gate, B_w_up, B_w_down):
    def _A_ref(x, wqkv, wo):
        B, S, D = x.shape
        H = 32; Dh = D // H
        qkv = (lambda x, *d: x.permute(*d))((x @ wqkv).reshape(B, S, 3, H, Dh), 2, 0, 3, 1, 4)
        q, k, v = qkv[0], qkv[1], qkv[2]
        scale = Dh ** -0.5
        scores = torch.einsum("bhqd,bhkd->bhqk", q, k) * scale
        p = _softmax(scores, axis=-1)
        o = torch.einsum("bhqk,bhkd->bhqd", p, v)
        return (lambda x, *d: x.permute(*d))(o, 0, 2, 1, 3).reshape(B, S, D) @ wo

    def _B_ref(x, w_gate, w_up, w_down):
        g = torch.einsum("bsd,df->bsf", x, w_gate)
        u = torch.einsum("bsd,df->bsf", x, w_up)
        h = _sigmoid(g) * u
        return torch.einsum("bsf,fd->bsd", h, w_down)

    x = A_x
    xn = _layernorm(x, axis=-1)
    s = _A_ref(xn, A_wqkv, A_wo)
    g = _silu(_B_ref(xn, B_w_gate, B_w_up, B_w_down))
    return x + s * g
```

```asm
; @launch grid=(256,1,1) block=(512,1,1) lds=157760
.amdgcn_target "amdgcn-amd-amdhsa--gfx950"
.text
.globl recurrent_scan__softmax_full_mha__glu_gated_glu__prompt_kernel
.p2align 8
.type recurrent_scan__softmax_full_mha__glu_gated_glu__prompt_kernel,@function
recurrent_scan__softmax_full_mha__glu_gated_glu__prompt_kernel:
    s_cmp_ge_u32 s2, 256
    s_cbranch_scc1 L_end
    s_load_dwordx2 s[6:7], s[0:1], 0
    s_load_dwordx2 s[4:5], s[0:1], 72
    s_load_dwordx4 s[8:11], s[0:1], 56
    s_load_dwordx4 s[36:39], s[0:1], 32
    s_load_dwordx2 s[100:101], s[0:1], 8
    s_load_dwordx2 s[64:65], s[0:1], 48
    v_and_b32 v247, 63, v0
    v_lshrrev_b32 v1, 6, v0
    v_lshlrev_b32 v245, 4, v247
    v_readfirstlane_b32 s3, v1
    s_and_b32 s41, s2, 7
    s_lshr_b32 s42, s2, 3
    s_mov_b32 s40, s3
    s_and_b32 s33, s42, 3
    s_lshl_b32 s33, s33, 3
    s_add_u32 s33, s33, s41
    s_and_b32 s34, s42, 28
    s_lshl_b32 s34, s34, 3
    s_add_u32 s34, s34, s33
    s_lshl_b32 s33, s34, 3
    s_add_u32 s33, s33, s3
    s_mul_i32 s33, s33, 1152
    v_lshlrev_b32 v1, 2, v247
    v_mov_b32 v12, 0
    s_mov_b32 s58, 2359296
    s_mov_b32 s59, 0x20000
    s_waitcnt lgkmcnt(0)
    s_mov_b32 s56, s6
    s_mov_b32 s57, s7
    buffer_load_dword v8, v1, s[56:59], s33 offen offset:0
    buffer_load_dword v9, v1, s[56:59], s33 offen offset:256
    buffer_load_dword v10, v1, s[56:59], s33 offen offset:512
    buffer_load_dword v11, v1, s[56:59], s33 offen offset:768
    s_mov_b32 exec_hi, 0
    buffer_load_dword v12, v1, s[56:59], s33 offen offset:1024
    s_mov_b32 exec_hi, -1
    s_mov_b32 s12, s4
    s_mov_b32 s13, s5
    s_mov_b32 s14, 0x3000000
    s_mov_b32 s15, 0x20000
    s_mov_b32 s52, s10
    s_mov_b32 s53, s11
    s_mov_b32 s54, 0x100
    s_mov_b32 s55, 0x20000
    s_lshl_b32 s33, s2, 3
    s_add_u32 s33, s33, s3
    s_cmp_lg_u32 s33, 2
    s_cbranch_scc1 L0_notag
    s_memrealtime s[32:33]
    s_waitcnt lgkmcnt(0)
    s_or_b32 s32, s32, 1
    v_mov_b32 v4, s32
    v_mov_b32 v5, s33
    v_mov_b32 v6, 0
    v_mov_b32 v7, 0
    s_mov_b64 exec, 1
    buffer_atomic_cmpswap_x2 v[4:7], v6, s[52:55], 0 offen
    s_mov_b64 exec, -1
    s_nop 1
L0_notag:
    s_lshr_b32 s33, s42, 2
    s_lshl_b32 s33, s33, 3
    s_add_u32 s33, s33, s3
    s_lshr_b32 s32, s33, 1
    s_mul_i32 s30, s32, 73728
    s_and_b32 s31, s3, 1
    s_lshl_b32 s31, s31, 11
    s_add_u32 s30, s30, s31
    s_add_u32 s30, s30, 0
    s_lshl_b32 s29, s3, 10
    s_mov_b32 s66, 5308416
    s_mov_b32 s67, 0x20000
    s_mov_b32 s51, 0
    s_and_b32 s43, s42, 3
    s_cmp_eq_u32 s43, 3
    s_cbranch_scc1 L0_sp
    s_mov_b32 s16, s36
    s_mov_b32 s17, s37
    s_mov_b32 s18, 0x510000
    s_mov_b32 s19, 0x20000
    s_mov_b32 s20, s38
    s_mov_b32 s21, s39
    s_mov_b32 s22, 0x510000
    s_mov_b32 s23, 0x20000
    s_mul_i32 s46, s41, 3
    s_add_u32 s46, s46, s43
    s_mul_i32 s25, s46, 384
    s_mov_b32 s26, 3
    s_mov_b32 s28, 0xbfb8aa3b
    s_mul_i32 s27, s32, 144
    s_mul_i32 s46, s46, 6
    s_add_u32 s27, s27, s46
    s_lshl_b32 s27, s27, 12
    s_add_u32 s27, s27, s31
    s_add_u32 s27, s27, 18874368
    s_movk_i32 s43, 9216
    s_mov_b32 s48, 32
    s_mov_b32 s49, 0
    s_mov_b32 s50, 0
    s_bitcmp1_b32 s3, 1
    s_cselect_b32 s60, s20, s16
    s_cselect_b32 s61, s21, s17
    s_lshr_b32 s47, s3, 2
    s_lshl_b32 s47, s47, 7
    s_add_u32 s47, s47, 128
    s_branch L0_par
L0_sp:
    s_mov_b32 s16, s100
    s_mov_b32 s17, s101
    s_mov_b32 s18, 0x1e6000
    s_mov_b32 s19, 0x20000
    s_mov_b32 s20, s100
    s_mov_b32 s21, s101
    s_mov_b32 s22, 0x1e6000
    s_mov_b32 s23, 0x20000
    s_movk_i32 s43, 3456
    s_mov_b32 s48, 36
    s_mov_b32 s49, 4
    s_movk_i32 s50, 144
    s_mov_b32 s60, s16
    s_mov_b32 s61, s17
    s_lshr_b32 s47, s3, 1
    s_lshl_b32 s47, s47, 7
    s_add_u32 s47, s47, 256
    s_min_u32 s47, s47, 572
    s_mul_i32 s25, s41, 576
    s_mov_b32 s26, 2
    s_cmp_lt_u32 s41, 2
    s_cselect_b32 s28, 0x3eae1a93, 1.0
    s_lshl_b32 s27, s41, 20
    s_lshl_b32 s46, s33, 10
    s_add_u32 s27, s27, s46
    s_add_u32 s27, s27, 10485760
    s_cmp_lt_u32 s41, 4
    s_cbranch_scc1 L0_par
    s_sub_u32 s46, s41, 4
    s_mul_i32 s27, s46, 1310720
    s_mul_i32 s46, s33, 1280
    s_add_u32 s27, s27, s46
    s_add_u32 s27, s27, 15728640
    s_cmp_lt_u32 s41, 6
    s_cbranch_scc1 L0_par
    s_add_u32 s16, s4, 0x26a0000
    s_addc_u32 s17, s5, 0
    s_mov_b32 s18, 0x36000
    s_mov_b32 s19, 0x20000
    s_add_u32 s20, s4, 0x26a0000
    s_addc_u32 s21, s5, 0
    s_mov_b32 s22, 0x36000
    s_mov_b32 s23, 0x20000
    s_movk_i32 s43, 384
    s_mov_b32 s48, 32
    s_mov_b32 s49, 0
    s_mov_b32 s51, 1
    s_mov_b32 s47, 0x40000000
    s_mov_b32 s25, 0
    s_mov_b32 s26, 1
    s_mov_b32 s28, 0x3eae1a93
    s_lshl_b32 s27, s33, 7
    s_add_u32 s27, s27, 14680064
    s_cmp_eq_u32 s41, 6
    s_cbranch_scc1 L0_par
    s_movk_i32 s25, 256
    s_add_u32 s27, s46, 15728640
L0_par:
    s_lshl_b32 s35, s43, 6
    s_mov_b32 s62, s18
    s_mov_b32 s63, 0x20000
    v_lshrrev_b32 v249, 3, v247
    s_lshl_b32 s46, s3, 3
    v_add_u32 v250, s46, v249
    v_mul_lo_u32 v244, v250, s43
    v_bfe_u32 v249, v250, 1, 1
    v_bfe_u32 v251, v250, 3, 1
    v_lshl_or_b32 v249, v251, 1, v249
    v_bfe_u32 v250, v247, 1, 2
    v_xor_b32 v249, v249, v250
    v_mad_u32_u24 v244, v249, s48, v244
    v_and_b32 v249, 1, v249
    v_mad_u32_u24 v244, v249, s49, v244
    v_and_b32 v249, 1, v247
    v_lshl_add_u32 v244, v249, 4, v244
    s_lshr_b32 s46, s42, 2
    s_lshl_b32 s46, s46, 1
    s_and_b32 s39, s3, 1
    s_add_u32 s46, s46, s39
    s_mul_i32 s46, s46, 36
    s_mul_i32 s46, s46, s43
    s_add_u32 s46, s46, s25
    s_add_u32 s47, s47, s46
    v_mul_lo_u32 v255, v247, s43
    v_cmp_gt_u32 vcc, 36, v247
    v_mov_b32 v99, 0x40000000
    s_lshl_b32 s33, s2, 3
    v_cndmask_b32 v255, v99, v255, vcc
    s_bitcmp1_b32 s3, 1
    s_cselect_b32 s36, s20, s16
    s_cselect_b32 s37, s21, s17
    s_cselect_b32 s39, s50, 0
    s_add_u32 s46, s46, s39
    s_cmp_ge_u32 s3, 4
    s_cselect_b32 s38, s18, 0
    s_cmp_lg_u32 s51, 0
    s_cselect_b32 s38, 0, s38
    s_mov_b32 s39, 0x20000
    v_mov_b32 v98, v255
    s_lshr_b32 s32, s50, 1
    s_cmp_lg_u32 s3, 1
    s_cbranch_scc1 L0_n1
    s_mul_i32 s46, s2, 10368
    v_mul_u32_u24 v98, 72, v247
    v_add_u32 v98, 32, v98
    v_cmp_gt_u32 vcc, 48, v247
    v_lshlrev_b32 v97, 3, v247
    s_mov_b32 s36, s100
    s_mov_b32 s37, s101
    s_mov_b32 s38, 1990656
    s_movk_i32 s32, 3456
    v_cndmask_b32 v98, v99, v98, vcc
    v_cndmask_b32 v99, v99, v97, vcc
L0_n1:
    s_cmp_lg_u32 s3, 3
    s_cbranch_scc1 L0_n3
    s_getpc_b64 s[36:37]
L0_pc:
    s_sub_u32 s36, s36, L0_pc-recurrent_scan__softmax_full_mha__glu_gated_glu__prompt_kernel
    s_subb_u32 s37, s37, 0
    s_mov_b32 s38, code_end-recurrent_scan__softmax_full_mha__glu_gated_glu__prompt_kernel
    s_lshl_b32 s46, s42, 12
    s_mov_b32 s32, 0x1000000
    v_and_b32 v98, 31, v247
    v_lshlrev_b32 v98, 7, v98
L0_n3:
    buffer_load_dwordx2 v[100:101], v98, s[36:39], s46 offen
    s_add_u32 s46, s46, s32
    buffer_load_dwordx2 v[102:103], v98, s[36:39], s46 offen
    s_add_u32 s46, s46, s32
    buffer_load_dwordx2 v[104:105], v98, s[36:39], s46 offen
    s_add_u32 s46, s46, s32
    s_add_u32 s33, s33, s3
    s_mul_i32 s33, s33, 21
    v_add_u32 v254, s33, v247
    v_cmp_gt_u32 vcc, 21, v247
    v_lshlrev_b32 v254, 7, v254
    v_mov_b32 v248, 0x40000000
    v_cndmask_b32 v254, v248, v254, vcc
    v_add_u32 v4, 157696, v1
    v_mov_b32 v5, 0
    s_mov_b64 exec, 0xffff
    ds_write_b32 v4, v5
    s_mov_b64 exec, -1
    v_lshrrev_b32 v18, 2, v247
    v_lshlrev_b32 v18, 7, v18
    v_and_b32 v3, 3, v247
    v_lshl_add_u32 v18, v3, 2, v18
    s_lshl_b32 s37, s3, 4
    s_add_u32 s37, s37, 147456
    v_add_u32 v18, s37, v18
    v_mov_b32 v46, 0
    s_mov_b32 s36, s25
    s_add_u32 s37, s25, s50
    s_waitcnt vmcnt(3)
    buffer_load_dwordx2 v[44:45], v46, s[52:55], 0 offen sc1
    v_lshlrev_b32 v20, 16, v8
    v_and_b32 v21, 0xffff0000, v8
    v_lshlrev_b32 v22, 16, v9
    v_and_b32 v23, 0xffff0000, v9
    v_lshlrev_b32 v24, 16, v10
    v_and_b32 v25, 0xffff0000, v10
    v_lshlrev_b32 v26, 16, v11
    v_and_b32 v27, 0xffff0000, v11
    v_lshlrev_b32 v28, 16, v12
    v_and_b32 v29, 0xffff0000, v12
    v_pk_add_f32 v[4:5], v[20:21], v[22:23]
    v_pk_add_f32 v[4:5], v[4:5], v[24:25]
    v_pk_add_f32 v[4:5], v[4:5], v[26:27]
    v_pk_add_f32 v[4:5], v[4:5], v[28:29]
    v_add_f32 v4, v4, v5
    s_nop 1
    v_add_f32_dpp v4, v4, v4 row_ror:8 row_mask:0xf bank_mask:0xf
    s_nop 1
    v_add_f32_dpp v4, v4, v4 row_ror:4 row_mask:0xf bank_mask:0xf
    s_nop 1
    v_add_f32_dpp v4, v4, v4 row_ror:2 row_mask:0xf bank_mask:0xf
    s_nop 1
    v_add_f32_dpp v4, v4, v4 row_ror:1 row_mask:0xf bank_mask:0xf
    v_mov_b32 v5, v4
    s_nop 1
    v_permlane16_swap_b32 v5, v4
    s_nop 1
    v_add_f32 v4, v4, v5
    v_mov_b32 v5, v4
    s_nop 1
    v_permlane32_swap_b32 v5, v4
    s_nop 1
    v_add_f32 v4, v4, v5
    v_mul_f32 v4, 0x3ae38e39, v4
    v_mov_b64 v[40:41], 0
    v_mov_b32 v5, v4
    v_pk_add_f32 v[42:43], v[20:21], v[4:5] neg_lo:[0,1] neg_hi:[0,1]
    v_pk_fma_f32 v[40:41], v[42:43], v[42:43], v[40:41]
    v_pk_add_f32 v[42:43], v[22:23], v[4:5] neg_lo:[0,1] neg_hi:[0,1]
    v_pk_fma_f32 v[40:41], v[42:43], v[42:43], v[40:41]
    v_pk_add_f32 v[42:43], v[24:25], v[4:5] neg_lo:[0,1] neg_hi:[0,1]
    v_pk_fma_f32 v[40:41], v[42:43], v[42:43], v[40:41]
    v_pk_add_f32 v[42:43], v[26:27], v[4:5] neg_lo:[0,1] neg_hi:[0,1]
    v_pk_fma_f32 v[40:41], v[42:43], v[42:43], v[40:41]
    s_mov_b32 exec_hi, 0
    v_pk_add_f32 v[42:43], v[28:29], v[4:5] neg_lo:[0,1] neg_hi:[0,1]
    v_pk_fma_f32 v[40:41], v[42:43], v[42:43], v[40:41]
    s_mov_b32 exec_hi, -1
    v_add_f32 v6, v40, v41
    s_nop 1
    v_add_f32_dpp v6, v6, v6 row_ror:8 row_mask:0xf bank_mask:0xf
    s_nop 1
    v_add_f32_dpp v6, v6, v6 row_ror:4 row_mask:0xf bank_mask:0xf
    s_nop 1
    v_add_f32_dpp v6, v6, v6 row_ror:2 row_mask:0xf bank_mask:0xf
    s_nop 1
    v_add_f32_dpp v6, v6, v6 row_ror:1 row_mask:0xf bank_mask:0xf
    v_mov_b32 v19, v6
    s_nop 1
    v_permlane16_swap_b32 v19, v6
    s_nop 1
    v_add_f32 v6, v6, v19
    v_mov_b32 v19, v6
    s_nop 1
    v_permlane32_swap_b32 v19, v6
    s_nop 1
    v_add_f32 v6, v6, v19
    v_mul_f32 v6, 0x3ae38e39, v6
    v_cvt_pk_bf16_f32 v4, v4, v4
    v_and_b32 v4, 0xffff0000, v4
    v_cvt_pk_bf16_f32 v6, v6, v6
    v_and_b32 v6, 0xffff0000, v6
    v_add_f32 v6, 0x3727c5ac, v6
    v_cvt_pk_bf16_f32 v6, v6, v6
    v_and_b32 v6, 0xffff0000, v6
    v_sqrt_f32 v6, v6
    v_mov_b32 v5, v4
    v_cvt_pk_bf16_f32 v6, v6, v6
    v_and_b32 v6, 0xffff0000, v6
    v_rcp_f32 v40, v6
    v_pk_add_f32 v[20:21], v[20:21], v[4:5] neg_lo:[0,1] neg_hi:[0,1]
    v_pk_add_f32 v[22:23], v[22:23], v[4:5] neg_lo:[0,1] neg_hi:[0,1]
    v_pk_add_f32 v[24:25], v[24:25], v[4:5] neg_lo:[0,1] neg_hi:[0,1]
    v_pk_add_f32 v[26:27], v[26:27], v[4:5] neg_lo:[0,1] neg_hi:[0,1]
    v_pk_add_f32 v[28:29], v[28:29], v[4:5] neg_lo:[0,1] neg_hi:[0,1]
    v_mov_b32 v41, v40
    v_cvt_pk_bf16_f32 v19, v20, v21
    v_lshlrev_b32 v20, 16, v19
    v_and_b32 v21, 0xffff0000, v19
    v_pk_mul_f32 v[20:21], v[20:21], v[40:41]
    v_cvt_pk_bf16_f32 v8, v20, v21
    ds_write_b32 v18, v8 offset:0
    v_cvt_pk_bf16_f32 v19, v22, v23
    v_lshlrev_b32 v22, 16, v19
    v_and_b32 v23, 0xffff0000, v19
    v_pk_mul_f32 v[22:23], v[22:23], v[40:41]
    v_cvt_pk_bf16_f32 v9, v22, v23
    ds_write_b32 v18, v9 offset:2048
    v_cvt_pk_bf16_f32 v19, v24, v25
    v_lshlrev_b32 v24, 16, v19
    v_and_b32 v25, 0xffff0000, v19
    v_pk_mul_f32 v[24:25], v[24:25], v[40:41]
    v_cvt_pk_bf16_f32 v10, v24, v25
    ds_write_b32 v18, v10 offset:4096
    v_cvt_pk_bf16_f32 v19, v26, v27
    v_lshlrev_b32 v26, 16, v19
    v_and_b32 v27, 0xffff0000, v19
    v_pk_mul_f32 v[26:27], v[26:27], v[40:41]
    v_cvt_pk_bf16_f32 v11, v26, v27
    ds_write_b32 v18, v11 offset:6144
    v_cvt_pk_bf16_f32 v19, v28, v29
    v_lshlrev_b32 v28, 16, v19
    v_and_b32 v29, 0xffff0000, v19
    v_pk_mul_f32 v[28:29], v[28:29], v[40:41]
    v_cvt_pk_bf16_f32 v12, v28, v29
    s_mov_b32 exec_hi, 0
    ds_write_b32 v18, v12 offset:8192
    s_mov_b32 exec_hi, -1
    s_waitcnt lgkmcnt(0)
    s_barrier
    s_cmp_lg_u32 s3, 0
    s_cbranch_scc1 L0_nw0
    v_add_u32 v2, 147456, v245
    ds_read_b128 v[48:51], v2 offset:0
    ds_read_b128 v[52:55], v2 offset:1024
    ds_read_b128 v[56:59], v2 offset:2048
    ds_read_b128 v[60:63], v2 offset:3072
    ds_read_b128 v[64:67], v2 offset:4096
    ds_read_b128 v[68:71], v2 offset:5120
    ds_read_b128 v[72:75], v2 offset:6144
    ds_read_b128 v[76:79], v2 offset:7168
    ds_read_b128 v[80:83], v2 offset:8192
    s_lshr_b32 s38, s34, 3
    s_mul_i32 s38, s38, 73728
    s_bfe_u32 s39, s34, 0x20001
    s_lshl_b32 s39, s39, 10
    s_add_u32 s38, s38, s39
    s_and_b32 s39, s34, 1
    s_lshl_b32 s39, s39, 7
    s_add_u32 s38, s38, s39
    s_add_u32 s38, s38, 0
    v_lshrrev_b32 v1, 5, v247
    v_lshlrev_b32 v1, 12, v1
    v_bfe_u32 v4, v247, 3, 2
    v_lshl_add_u32 v1, v4, 8, v1
    v_and_b32 v4, 7, v247
    v_lshl_add_u32 v1, v4, 4, v1
    s_waitcnt lgkmcnt(8)
    buffer_store_dwordx4 v[48:51], v1, s[12:15], s38 offen sc1
    s_add_u32 s38, s38, 8192
    s_waitcnt lgkmcnt(7)
    buffer_store_dwordx4 v[52:55], v1, s[12:15], s38 offen sc1
    s_add_u32 s38, s38, 8192
    s_waitcnt lgkmcnt(6)
    buffer_store_dwordx4 v[56:59], v1, s[12:15], s38 offen sc1
    s_add_u32 s38, s38, 8192
    s_waitcnt lgkmcnt(5)
    buffer_store_dwordx4 v[60:63], v1, s[12:15], s38 offen sc1
    s_add_u32 s38, s38, 8192
    s_waitcnt lgkmcnt(4)
    buffer_store_dwordx4 v[64:67], v1, s[12:15], s38 offen sc1
    s_add_u32 s38, s38, 8192
    s_waitcnt lgkmcnt(3)
    buffer_store_dwordx4 v[68:71], v1, s[12:15], s38 offen sc1
    s_add_u32 s38, s38, 8192
    s_waitcnt lgkmcnt(2)
    buffer_store_dwordx4 v[72:75], v1, s[12:15], s38 offen sc1
    s_add_u32 s38, s38, 8192
    s_waitcnt lgkmcnt(1)
    buffer_store_dwordx4 v[76:79], v1, s[12:15], s38 offen sc1
    s_add_u32 s38, s38, 8192
    s_waitcnt lgkmcnt(0)
    buffer_store_dwordx4 v[80:83], v1, s[12:15], s38 offen sc1
    s_add_u32 s38, s38, 8192
    s_lshr_b32 s38, s34, 2
    s_mul_i32 s38, s38, 1152
    s_and_b32 s39, s34, 3
    s_lshl_b32 s39, s39, 3
    s_add_u32 s38, s38, s39
    s_add_u32 s38, s38, 47185920
    s_barrier
    s_waitcnt vmcnt(0)
    v_readfirstlane_b32 s44, v44
    v_readfirstlane_b32 s45, v45
    s_cmp_lg_u32 s44, 0
    s_cbranch_scc1 L0_tag_ok
    s_mov_b32 s31, 400000
L0_tag:
    buffer_load_dwordx2 v[44:45], v46, s[52:55], 0 offen sc1
    s_waitcnt vmcnt(0)
    v_readfirstlane_b32 s44, v44
    v_readfirstlane_b32 s45, v45
    s_cmp_lg_u32 s44, 0
    s_cbranch_scc1 L0_tag_ok
    s_sleep 2
    s_sub_u32 s31, s31, 1
    s_cmp_lg_u32 s31, 0
    s_cbranch_scc1 L0_tag
L0_tag_ok:
    s_mov_b64 exec, 1
    buffer_store_dwordx2 v[44:45], v46, s[12:15], s38 offen sc1
    s_mov_b64 exec, -1
    v_mov_b32 v6, 157736
    ds_write_b64 v6, v[44:45]
    s_branch L0_b2
L0_nw0:
    s_barrier
    s_cmp_lg_u32 s3, 1
    s_cbranch_scc1 L0_b2
    s_cmp_ge_u32 s2, 192
    s_cbranch_scc1 L0_b2
    s_mul_i32 s38, s2, 1152
    s_add_u32 s38, s38, 40501248
    s_waitcnt vmcnt(0)
    buffer_store_dwordx2 v[100:101], v99, s[12:15], s38 offen offset:0 sc1
    buffer_store_dwordx2 v[102:103], v99, s[12:15], s38 offen offset:384 sc1
    buffer_store_dwordx2 v[104:105], v99, s[12:15], s38 offen offset:768 sc1
    s_lshl_b32 s38, s2, 3
    s_add_u32 s38, s38, 40431616
    s_waitcnt vmcnt(0)
    v_readfirstlane_b32 s44, v44
    v_readfirstlane_b32 s45, v45
    s_cmp_lg_u32 s44, 0
    s_cbranch_scc1 L0_tag1_ok
    s_mov_b32 s31, 400000
L0_tag1:
    buffer_load_dwordx2 v[44:45], v46, s[52:55], 0 offen sc1
    s_waitcnt vmcnt(0)
    v_readfirstlane_b32 s44, v44
    v_readfirstlane_b32 s45, v45
    s_cmp_lg_u32 s44, 0
    s_cbranch_scc1 L0_tag1_ok
    s_sleep 2
    s_sub_u32 s31, s31, 1
    s_cmp_lg_u32 s31, 0
    s_cbranch_scc1 L0_tag1
L0_tag1_ok:
    s_mov_b64 exec, 1
    buffer_store_dwordx2 v[44:45], v46, s[12:15], s38 offen sc1
    s_mov_b64 exec, -1
L0_b2:
    s_cmp_lg_u32 s51, 0
    s_cbranch_scc1 L0_nd1
    s_add_u32 m0, s29, 0
    s_nop 0
    buffer_load_dwordx4 v244, s[16:19], s36 offen lds
    s_add_u32 s36, s36, s35
    s_add_u32 m0, s29, 73728
    s_nop 0
    buffer_load_dwordx4 v244, s[20:23], s37 offen lds
    s_add_u32 s37, s37, s35
    s_add_u32 m0, s29, 8192
    s_nop 0
    buffer_load_dwordx4 v244, s[16:19], s36 offen lds
    s_add_u32 s36, s36, s35
    s_add_u32 m0, s29, 81920
    s_nop 0
    buffer_load_dwordx4 v244, s[20:23], s37 offen lds
    s_add_u32 s37, s37, s35
L0_nd1:
    s_cmp_lg_u32 s51, 0
    s_cbranch_scc1 L0_nd2
    s_add_u32 m0, s29, 16384
    s_nop 0
    buffer_load_dwordx4 v244, s[16:19], s36 offen lds
    s_add_u32 s36, s36, s35
    s_add_u32 m0, s29, 90112
    s_nop 0
    buffer_load_dwordx4 v244, s[20:23], s37 offen lds
    s_add_u32 s37, s37, s35
    s_add_u32 m0, s29, 24576
    s_nop 0
    buffer_load_dwordx4 v244, s[16:19], s36 offen lds
    s_add_u32 s36, s36, s35
    s_add_u32 m0, s29, 98304
    s_nop 0
    buffer_load_dwordx4 v244, s[20:23], s37 offen lds
    s_add_u32 s37, s37, s35
    s_add_u32 m0, s29, 32768
    s_nop 0
    buffer_load_dwordx4 v244, s[16:19], s36 offen lds
    s_add_u32 s36, s36, s35
    s_add_u32 m0, s29, 106496
    s_nop 0
    buffer_load_dwordx4 v244, s[20:23], s37 offen lds
    s_add_u32 s37, s37, s35
    s_add_u32 m0, s29, 40960
    s_nop 0
    buffer_load_dwordx4 v244, s[16:19], s36 offen lds
    s_add_u32 s36, s36, s35
    s_add_u32 m0, s29, 114688
    s_nop 0
    buffer_load_dwordx4 v244, s[20:23], s37 offen lds
    s_add_u32 s37, s37, s35
    s_add_u32 m0, s29, 49152
    s_nop 0
    buffer_load_dwordx4 v244, s[16:19], s36 offen lds
    s_add_u32 s36, s36, s35
    s_add_u32 m0, s29, 122880
    s_nop 0
    buffer_load_dwordx4 v244, s[20:23], s37 offen lds
    s_add_u32 s37, s37, s35
    s_add_u32 m0, s29, 57344
    s_nop 0
    buffer_load_dwordx4 v244, s[16:19], s36 offen lds
    s_add_u32 s36, s36, s35
    s_add_u32 m0, s29, 131072
    s_nop 0
    buffer_load_dwordx4 v244, s[20:23], s37 offen lds
    s_add_u32 s37, s37, s35
    s_add_u32 m0, s29, 65536
    s_nop 0
    buffer_load_dwordx4 v244, s[16:19], s36 offen lds
    s_add_u32 s36, s36, s35
    s_add_u32 m0, s29, 139264
    s_nop 0
    buffer_load_dwordx4 v244, s[20:23], s37 offen lds
    s_add_u32 s37, s37, s35
L0_nd2:
    s_cmp_lg_u32 s3, 0
    s_cbranch_scc1 L0_join
    v_and_b32 v2, 3, v247
    v_lshlrev_b32 v2, 3, v2
    v_bfe_u32 v3, v247, 2, 3
    s_movk_i32 s39, 1152
    v_mad_u32_u24 v2, v3, s39, v2
    s_lshr_b32 s38, s42, 2
    s_mul_i32 s38, s38, 9216
    s_add_u32 s38, s38, 47185920
    s_mov_b32 s31, 400000
L0_px:
    buffer_load_dwordx2 v[8:9], v2, s[12:15], s38 offen sc1
    s_waitcnt vmcnt(0)
    v_cmp_ne_u64 vcc, s[44:45], v[8:9]
    s_nop 1
    s_and_b64 vcc, vcc, exec
    s_cbranch_scc0 L0_px_ok
    s_sleep 1
    s_sub_u32 s31, s31, 1
    s_cmp_lg_u32 s31, 0
    s_cbranch_scc1 L0_px
L0_px_ok:
    s_cmp_eq_u32 s51, 0
    s_cbranch_scc1 L0_join
    v_lshlrev_b32 v2, 3, v247
    s_mov_b32 s38, 40431616
    s_mov_b32 s31, 400000
L0_pr0:
    buffer_load_dwordx2 v[8:9], v2, s[12:15], s38 offen sc1
    s_waitcnt vmcnt(0)
    v_cmp_ne_u64 vcc, s[44:45], v[8:9]
    s_nop 1
    s_and_b64 vcc, vcc, exec
    s_cbranch_scc0 L0_pr0_ok
    s_sleep 4
    s_sub_u32 s31, s31, 1
    s_cmp_lg_u32 s31, 0
    s_cbranch_scc1 L0_pr0
L0_pr0_ok:
    s_mov_b32 s38, 40432128
    s_mov_b32 s31, 400000
L0_pr1:
    buffer_load_dwordx2 v[8:9], v2, s[12:15], s38 offen sc1
    s_waitcnt vmcnt(0)
    v_cmp_ne_u64 vcc, s[44:45], v[8:9]
    s_nop 1
    s_and_b64 vcc, vcc, exec
    s_cbranch_scc0 L0_pr1_ok
    s_sleep 4
    s_sub_u32 s31, s31, 1
    s_cmp_lg_u32 s31, 0
    s_cbranch_scc1 L0_pr1
L0_pr1_ok:
    s_mov_b32 s38, 40432640
    s_mov_b32 s31, 400000
L0_pr2:
    buffer_load_dwordx2 v[8:9], v2, s[12:15], s38 offen sc1
    s_waitcnt vmcnt(0)
    v_cmp_ne_u64 vcc, s[44:45], v[8:9]
    s_nop 1
    s_and_b64 vcc, vcc, exec
    s_cbranch_scc0 L0_pr2_ok
    s_sleep 4
    s_sub_u32 s31, s31, 1
    s_cmp_lg_u32 s31, 0
    s_cbranch_scc1 L0_pr2
L0_pr2_ok:
L0_join:
    s_and_b32 s33, s42, 3
    s_cmp_eq_u32 s33, 3
    s_cbranch_scc0 L1_gu
    s_cmp_lt_u32 s41, 4
    s_cbranch_scc1 L1_qk
    s_cmp_lt_u32 s41, 6
    s_cbranch_scc1 L1_v
    s_cmp_eq_u32 s41, 6
    s_cbranch_scc1 L1_qkr
    s_branch L1_vr
L1_gu:
    v_lshrrev_b32 v249, 4, v247
    v_bfe_u32 v250, v247, 2, 2
    v_lshl_add_u32 v250, v249, 3, v250
    v_lshlrev_b32 v250, 7, v250
    v_and_b32 v251, 3, v247
    v_lshl_add_u32 v250, v251, 3, v250
    v_bfe_u32 v249, v247, 3, 2
    v_xor_b32 v251, 0, v249
    v_lshl_add_u32 v240, v251, 5, v250
    v_xor_b32 v251, 1, v249
    v_lshl_add_u32 v241, v251, 5, v250
    v_xor_b32 v251, 2, v249
    v_lshl_add_u32 v242, v251, 5, v250
    v_xor_b32 v251, 3, v249
    v_lshl_add_u32 v243, v251, 5, v250
    v_and_b32 v249, 15, v247
    v_lshrrev_b32 v250, 4, v247
    v_mov_b32 v246, v245
    s_mov_b32 s38, s28
    s_mov_b32 s39, s28
    s_lshr_b32 s33, s42, 2
    s_lshl_b32 s33, s33, 2
    s_lshr_b32 s34, s3, 1
    s_add_u32 s33, s33, s34
    s_lshl_b32 s33, s33, 3
    s_add_u32 s33, s33, s41
    s_lshl_b32 s33, s33, 3
    s_and_b32 s34, s42, 3
    s_lshl_b32 s34, s34, 1
    s_add_u32 s33, s33, s34
    s_and_b32 s34, s3, 1
    s_add_u32 s33, s33, s34
    s_lshl_b32 s33, s33, 3
    s_add_u32 s46, s33, 40398848
    s_waitcnt vmcnt(0) lgkmcnt(0)
    s_barrier
    s_add_u32 s25, s25, 0
    v_mov_b32 v248, 157736
    ds_read_b64 v[248:249], v248
    s_add_u32 s34, s30, 0
    buffer_load_dwordx4 v[0:3], v245, s[12:15], s34 offen offset:0 sc1
    buffer_load_dwordx4 v[4:7], v245, s[12:15], s34 offen offset:1024 sc1
    s_add_u32 s34, s30, 4096
    buffer_load_dwordx4 v[8:11], v245, s[12:15], s34 offen offset:0 sc1
    buffer_load_dwordx4 v[12:15], v245, s[12:15], s34 offen offset:1024 sc1
    s_add_u32 s34, s30, 8192
    buffer_load_dwordx4 v[16:19], v245, s[12:15], s34 offen offset:0 sc1
    buffer_load_dwordx4 v[20:23], v245, s[12:15], s34 offen offset:1024 sc1
    s_add_u32 s34, s30, 12288
    buffer_load_dwordx4 v[24:27], v245, s[12:15], s34 offen offset:0 sc1
    buffer_load_dwordx4 v[28:31], v245, s[12:15], s34 offen offset:1024 sc1
    s_waitcnt lgkmcnt(0)
    v_readfirstlane_b32 s44, v248
    v_readfirstlane_b32 s45, v249
    ds_read_b64_tr_b16 v[224:225], v240 offset:0
    ds_read_b64_tr_b16 v[226:227], v240 offset:512
    ds_read_b64_tr_b16 v[228:229], v241 offset:0
    ds_read_b64_tr_b16 v[230:231], v241 offset:512
    ds_read_b64_tr_b16 v[232:233], v242 offset:0
    ds_read_b64_tr_b16 v[234:235], v242 offset:512
    s_waitcnt lgkmcnt(4)
    s_cmp_lt_u32 s3, 4
    s_cselect_b64 vcc, -1, 0
    v_add_u32 v240, 0x12000, v240
    v_add_u32 v241, 0x12000, v241
    v_add_u32 v242, 0x12000, v242
    s_cbranch_vccnz Lp1
    s_setprio 1
Lp1:
    s_waitcnt vmcnt(6)
    v_mfma_f32_16x16x32_bf16 v[144:147], v[224:227], v[0:3], 0
    ds_read_b64_tr_b16 v[236:237], v243 offset:0
    s_add_u32 s34, s30, 16384
    buffer_load_dwordx4 v[32:35], v245, s[12:15], s34 offen offset:0 sc1
    v_mfma_f32_16x16x32_bf16 v[148:151], v[224:227], v[4:7], 0
    ds_read_b64_tr_b16 v[238:239], v243 offset:512
    s_waitcnt lgkmcnt(4)
    v_add_u32 v243, 0x12000, v243
    v_mfma_f32_16x16x32_bf16 v[156:159], v[228:231], v[4:7], 0
    ds_read_b64_tr_b16 v[224:225], v240 offset:0
    v_mfma_f32_16x16x32_bf16 v[152:155], v[228:231], v[0:3], 0
    ds_read_b64_tr_b16 v[226:227], v240 offset:512
    s_waitcnt lgkmcnt(4)
    v_add_u32 v240, 0xfffee000, v240
    v_mfma_f32_16x16x32_bf16 v[160:163], v[232:235], v[0:3], 0
    ds_read_b64_tr_b16 v[228:229], v241 offset:0
    v_mfma_f32_16x16x32_bf16 v[164:167], v[232:235], v[4:7], 0
    ds_read_b64_tr_b16 v[230:231], v241 offset:512
    s_waitcnt lgkmcnt(4)
    v_add_u32 v241, 0xfffee000, v241
    v_mfma_f32_16x16x32_bf16 v[172:175], v[236:239], v[4:7], 0
    ds_read_b64_tr_b16 v[232:233], v242 offset:0
    buffer_load_dwordx4 v[36:39], v245, s[12:15], s34 offen offset:1024 sc1
    v_mfma_f32_16x16x32_bf16 v[168:171], v[236:239], v[0:3], 0
    ds_read_b64_tr_b16 v[234:235], v242 offset:512
    s_waitcnt lgkmcnt(4)
    v_add_u32 v242, 0xfffee000, v242
    v_mfma_f32_16x16x32_bf16 v[176:179], v[224:227], v[0:3], 0
    ds_read_b64_tr_b16 v[236:237], v243 offset:0
    v_mfma_f32_16x16x32_bf16 v[180:183], v[224:227], v[4:7], 0
    ds_read_b64_tr_b16 v[238:239], v243 offset:512
    s_waitcnt lgkmcnt(4)
    v_add_u32 v243, 0xfffee000, v243
    v_mfma_f32_16x16x32_bf16 v[188:191], v[228:231], v[4:7], 0
    ds_read_b64_tr_b16 v[224:225], v240 offset:4096
    v_mfma_f32_16x16x32_bf16 v[184:187], v[228:231], v[0:3], 0
    ds_read_b64_tr_b16 v[226:227], v240 offset:4608
    s_waitcnt lgkmcnt(4)
    v_add_u32 v240, 0x12000, v240
    v_mfma_f32_16x16x32_bf16 v[192:195], v[232:235], v[0:3], 0
    ds_read_b64_tr_b16 v[228:229], v241 offset:4096
    s_add_u32 s34, s30, 20480
    buffer_load_dwordx4 v[40:43], v245, s[12:15], s34 offen offset:0 sc1
    v_mfma_f32_16x16x32_bf16 v[196:199], v[232:235], v[4:7], 0
    ds_read_b64_tr_b16 v[230:231], v241 offset:4608
    s_waitcnt lgkmcnt(4)
    v_add_u32 v241, 0x12000, v241
    v_mfma_f32_16x16x32_bf16 v[204:207], v[236:239], v[4:7], 0
    ds_read_b64_tr_b16 v[232:233], v242 offset:4096
    v_mfma_f32_16x16x32_bf16 v[200:203], v[236:239], v[0:3], 0
    ds_read_b64_tr_b16 v[234:235], v242 offset:4608
    s_waitcnt lgkmcnt(4)
    v_add_u32 v242, 0x12000, v242
    s_waitcnt vmcnt(7)
    v_mfma_f32_16x16x32_bf16 v[144:147], v[224:227], v[8:11], v[144:147]
    ds_read_b64_tr_b16 v[236:237], v243 offset:4096
    v_mfma_f32_16x16x32_bf16 v[148:151], v[224:227], v[12:15], v[148:151]
    ds_read_b64_tr_b16 v[238:239], v243 offset:4608
    s_waitcnt lgkmcnt(4)
    v_add_u32 v243, 0x12000, v243
    v_mfma_f32_16x16x32_bf16 v[156:159], v[228:231], v[12:15], v[156:159]
    ds_read_b64_tr_b16 v[224:225], v240 offset:4096
    buffer_load_dwordx4 v[44:47], v245, s[12:15], s34 offen offset:1024 sc1
    v_mfma_f32_16x16x32_bf16 v[152:155], v[228:231], v[8:11], v[152:155]
    ds_read_b64_tr_b16 v[226:227], v240 offset:4608
    s_waitcnt lgkmcnt(4)
    v_add_u32 v240, 0xfffee000, v240
    v_mfma_f32_16x16x32_bf16 v[160:163], v[232:235], v[8:11], v[160:163]
    ds_read_b64_tr_b16 v[228:229], v241 offset:4096
    v_mfma_f32_16x16x32_bf16 v[164:167], v[232:235], v[12:15], v[164:167]
    ds_read_b64_tr_b16 v[230:231], v241 offset:4608
    s_waitcnt lgkmcnt(4)
    v_add_u32 v241, 0xfffee000, v241
    v_mfma_f32_16x16x32_bf16 v[172:175], v[236:239], v[12:15], v[172:175]
    ds_read_b64_tr_b16 v[232:233], v242 offset:4096
    v_mfma_f32_16x16x32_bf16 v[168:171], v[236:239], v[8:11], v[168:171]
    ds_read_b64_tr_b16 v[234:235], v242 offset:4608
    s_waitcnt lgkmcnt(4)
    v_add_u32 v242, 0xfffee000, v242
    v_mfma_f32_16x16x32_bf16 v[176:179], v[224:227], v[8:11], v[176:179]
    ds_read_b64_tr_b16 v[236:237], v243 offset:4096
    s_add_u32 s34, s30, 24576
    buffer_load_dwordx4 v[48:51], v245, s[12:15], s34 offen offset:0 sc1
    v_mfma_f32_16x16x32_bf16 v[180:183], v[224:227], v[12:15], v[180:183]
    ds_read_b64_tr_b16 v[238:239], v243 offset:4608
    s_waitcnt lgkmcnt(4)
    v_add_u32 v243, 0xfffee000, v243
    v_mfma_f32_16x16x32_bf16 v[188:191], v[228:231], v[12:15], v[188:191]
    ds_read_b64_tr_b16 v[224:225], v240 offset:8192
    v_mfma_f32_16x16x32_bf16 v[184:187], v[228:231], v[8:11], v[184:187]
    ds_read_b64_tr_b16 v[226:227], v240 offset:8704
    s_waitcnt lgkmcnt(4)
    v_add_u32 v240, 0x12000, v240
    v_mfma_f32_16x16x32_bf16 v[192:195], v[232:235], v[8:11], v[192:195]
    ds_read_b64_tr_b16 v[228:229], v241 offset:8192
    v_mfma_f32_16x16x32_bf16 v[196:199], v[232:235], v[12:15], v[196:199]
    ds_read_b64_tr_b16 v[230:231], v241 offset:8704
    s_waitcnt lgkmcnt(4)
    v_add_u32 v241, 0x12000, v241
    v_mfma_f32_16x16x32_bf16 v[204:207], v[236:239], v[12:15], v[204:207]
    ds_read_b64_tr_b16 v[232:233], v242 offset:8192
    buffer_load_dwordx4 v[52:55], v245, s[12:15], s34 offen offset:1024 sc1
    v_mfma_f32_16x16x32_bf16 v[200:203], v[236:239], v[8:11], v[200:203]
    ds_read_b64_tr_b16 v[234:235], v242 offset:8704
    s_waitcnt lgkmcnt(4)
    v_add_u32 v242, 0x12000, v242
    s_waitcnt vmcnt(8)
    v_mfma_f32_16x16x32_bf16 v[144:147], v[224:227], v[16:19], v[144:147]
    ds_read_b64_tr_b16 v[236:237], v243 offset:8192
    v_mfma_f32_16x16x32_bf16 v[148:151], v[224:227], v[20:23], v[148:151]
    ds_read_b64_tr_b16 v[238:239], v243 offset:8704
    s_waitcnt lgkmcnt(4)
    v_add_u32 v243, 0x12000, v243
    v_mfma_f32_16x16x32_bf16 v[156:159], v[228:231], v[20:23], v[156:159]
    ds_read_b64_tr_b16 v[224:225], v240 offset:8192
    v_mfma_f32_16x16x32_bf16 v[152:155], v[228:231], v[16:19], v[152:155]
    ds_read_b64_tr_b16 v[226:227], v240 offset:8704
    s_waitcnt lgkmcnt(4)
    v_add_u32 v240, 0xfffee000, v240
    v_mfma_f32_16x16x32_bf16 v[160:163], v[232:235], v[16:19], v[160:163]
    ds_read_b64_tr_b16 v[228:229], v241 offset:8192
    s_add_u32 s34, s30, 28672
    buffer_load_dwordx4 v[56:59], v245, s[12:15], s34 offen offset:0 sc1
    v_mfma_f32_16x16x32_bf16 v[164:167], v[232:235], v[20:23], v[164:167]
    ds_read_b64_tr_b16 v[230:231], v241 offset:8704
    s_waitcnt lgkmcnt(4)
    v_add_u32 v241, 0xfffee000, v241
    v_mfma_f32_16x16x32_bf16 v[172:175], v[236:239], v[20:23], v[172:175]
    ds_read_b64_tr_b16 v[232:233], v242 offset:8192
    v_mfma_f32_16x16x32_bf16 v[168:171], v[236:239], v[16:19], v[168:171]
    ds_read_b64_tr_b16 v[234:235], v242 offset:8704
    s_waitcnt lgkmcnt(4)
    v_add_u32 v242, 0xfffee000, v242
    v_mfma_f32_16x16x32_bf16 v[176:179], v[224:227], v[16:19], v[176:179]
    ds_read_b64_tr_b16 v[236:237], v243 offset:8192
    v_mfma_f32_16x16x32_bf16 v[180:183], v[224:227], v[20:23], v[180:183]
    ds_read_b64_tr_b16 v[238:239], v243 offset:8704
    s_waitcnt lgkmcnt(4)
    v_add_u32 v243, 0xfffee000, v243
    v_mfma_f32_16x16x32_bf16 v[188:191], v[228:231], v[20:23], v[188:191]
    ds_read_b64_tr_b16 v[224:225], v240 offset:12288
    buffer_load_dwordx4 v[60:63], v245, s[12:15], s34 offen offset:1024 sc1
    v_mfma_f32_16x16x32_bf16 v[184:187], v[228:231], v[16:19], v[184:187]
    ds_read_b64_tr_b16 v[226:227], v240 offset:12800
    s_waitcnt lgkmcnt(4)
    v_add_u32 v240, 0x12000, v240
    v_mfma_f32_16x16x32_bf16 v[192:195], v[232:235], v[16:19], v[192:195]
    ds_read_b64_tr_b16 v[228:229], v241 offset:12288
    v_mfma_f32_16x16x32_bf16 v[196:199], v[232:235], v[20:23], v[196:199]
    ds_read_b64_tr_b16 v[230:231], v241 offset:12800
    s_waitcnt lgkmcnt(4)
    v_add_u32 v241, 0x12000, v241
    v_mfma_f32_16x16x32_bf16 v[204:207], v[236:239], v[20:23], v[204:207]
    ds_read_b64_tr_b16 v[232:233], v242 offset:12288
    v_mfma_f32_16x16x32_bf16 v[200:203], v[236:239], v[16:19], v[200:203]
    ds_read_b64_tr_b16 v[234:235], v242 offset:12800
    s_waitcnt lgkmcnt(4)
    v_add_u32 v242, 0x12000, v242
    s_waitcnt vmcnt(8)
    v_mfma_f32_16x16x32_bf16 v[144:147], v[224:227], v[24:27], v[144:147]
    ds_read_b64_tr_b16 v[236:237], v243 offset:12288
    s_add_u32 s34, s30, 32768
    buffer_load_dwordx4 v[64:67], v245, s[12:15], s34 offen offset:0 sc1
    v_mfma_f32_16x16x32_bf16 v[148:151], v[224:227], v[28:31], v[148:151]
    ds_read_b64_tr_b16 v[238:239], v243 offset:12800
    s_waitcnt lgkmcnt(4)
    v_add_u32 v243, 0x12000, v243
    v_mfma_f32_16x16x32_bf16 v[156:159], v[228:231], v[28:31], v[156:159]
    ds_read_b64_tr_b16 v[224:225], v240 offset:12288
    v_mfma_f32_16x16x32_bf16 v[152:155], v[228:231], v[24:27], v[152:155]
    ds_read_b64_tr_b16 v[226:227], v240 offset:12800
    s_waitcnt lgkmcnt(4)
    v_add_u32 v240, 0xfffee000, v240
    v_mfma_f32_16x16x32_bf16 v[160:163], v[232:235], v[24:27], v[160:163]
    ds_read_b64_tr_b16 v[228:229], v241 offset:12288
    v_mfma_f32_16x16x32_bf16 v[164:167], v[232:235], v[28:31], v[164:167]
    ds_read_b64_tr_b16 v[230:231], v241 offset:12800
    s_waitcnt lgkmcnt(4)
    v_add_u32 v241, 0xfffee000, v241
    v_mfma_f32_16x16x32_bf16 v[172:175], v[236:239], v[28:31], v[172:175]
    ds_read_b64_tr_b16 v[232:233], v242 offset:12288
    buffer_load_dwordx4 v[68:71], v245, s[12:15], s34 offen offset:1024 sc1
    v_mfma_f32_16x16x32_bf16 v[168:171], v[236:239], v[24:27], v[168:171]
    ds_read_b64_tr_b16 v[234:235], v242 offset:12800
    s_waitcnt lgkmcnt(4)
    v_add_u32 v242, 0xfffee000, v242
    v_mfma_f32_16x16x32_bf16 v[176:179], v[224:227], v[24:27], v[176:179]
    ds_read_b64_tr_b16 v[236:237], v243 offset:12288
    v_mfma_f32_16x16x32_bf16 v[180:183], v[224:227], v[28:31], v[180:183]
    ds_read_b64_tr_b16 v[238:239], v243 offset:12800
    s_waitcnt lgkmcnt(4)
    v_add_u32 v243, 0xfffee000, v243
    v_mfma_f32_16x16x32_bf16 v[188:191], v[228:231], v[28:31], v[188:191]
    ds_read_b64_tr_b16 v[224:225], v240 offset:16384
    v_mfma_f32_16x16x32_bf16 v[184:187], v[228:231], v[24:27], v[184:187]
    ds_read_b64_tr_b16 v[226:227], v240 offset:16896
    s_waitcnt lgkmcnt(4)
    v_add_u32 v240, 0x12000, v240
    v_mfma_f32_16x16x32_bf16 v[192:195], v[232:235], v[24:27], v[192:195]
    ds_read_b64_tr_b16 v[228:229], v241 offset:16384
    s_add_u32 s34, s30, 36864
    buffer_load_dwordx4 v[72:75], v245, s[12:15], s34 offen offset:0 sc1
    v_mfma_f32_16x16x32_bf16 v[196:199], v[232:235], v[28:31], v[196:199]
    ds_read_b64_tr_b16 v[230:231], v241 offset:16896
    s_waitcnt lgkmcnt(4)
    v_add_u32 v241, 0x12000, v241
    v_mfma_f32_16x16x32_bf16 v[204:207], v[236:239], v[28:31], v[204:207]
    ds_read_b64_tr_b16 v[232:233], v242 offset:16384
    v_mfma_f32_16x16x32_bf16 v[200:203], v[236:239], v[24:27], v[200:203]
    ds_read_b64_tr_b16 v[234:235], v242 offset:16896
    s_waitcnt lgkmcnt(4)
    v_add_u32 v242, 0x12000, v242
    s_waitcnt vmcnt(9)
    v_mfma_f32_16x16x32_bf16 v[144:147], v[224:227], v[32:35], v[144:147]
    ds_read_b64_tr_b16 v[236:237], v243 offset:16384
    v_mfma_f32_16x16x32_bf16 v[148:151], v[224:227], v[36:39], v[148:151]
    ds_read_b64_tr_b16 v[238:239], v243 offset:16896
    s_waitcnt lgkmcnt(4)
    v_add_u32 v243, 0x12000, v243
    v_mfma_f32_16x16x32_bf16 v[156:159], v[228:231], v[36:39], v[156:159]
    ds_read_b64_tr_b16 v[224:225], v240 offset:16384
    buffer_load_dwordx4 v[76:79], v245, s[12:15], s34 offen offset:1024 sc1
    v_mfma_f32_16x16x32_bf16 v[152:155], v[228:231], v[32:35], v[152:155]
    ds_read_b64_tr_b16 v[226:227], v240 offset:16896
    s_waitcnt lgkmcnt(4)
    v_add_u32 v240, 0xfffee000, v240
    v_mfma_f32_16x16x32_bf16 v[160:163], v[232:235], v[32:35], v[160:163]
    ds_read_b64_tr_b16 v[228:229], v241 offset:16384
    v_mfma_f32_16x16x32_bf16 v[164:167], v[232:235], v[36:39], v[164:167]
    ds_read_b64_tr_b16 v[230:231], v241 offset:16896
    s_waitcnt lgkmcnt(4)
    v_add_u32 v241, 0xfffee000, v241
    v_mfma_f32_16x16x32_bf16 v[172:175], v[236:239], v[36:39], v[172:175]
    ds_read_b64_tr_b16 v[232:233], v242 offset:16384
    v_mfma_f32_16x16x32_bf16 v[168:171], v[236:239], v[32:35], v[168:171]
    ds_read_b64_tr_b16 v[234:235], v242 offset:16896
    s_waitcnt lgkmcnt(4)
    v_add_u32 v242, 0xfffee000, v242
    v_mfma_f32_16x16x32_bf16 v[176:179], v[224:227], v[32:35], v[176:179]
    ds_read_b64_tr_b16 v[236:237], v243 offset:16384
    s_add_u32 s34, s30, 40960
    buffer_load_dwordx4 v[80:83], v245, s[12:15], s34 offen offset:0 sc1
    v_mfma_f32_16x16x32_bf16 v[180:183], v[224:227], v[36:39], v[180:183]
    ds_read_b64_tr_b16 v[238:239], v243 offset:16896
    s_waitcnt lgkmcnt(4)
    v_add_u32 v243, 0xfffee000, v243
    v_mfma_f32_16x16x32_bf16 v[188:191], v[228:231], v[36:39], v[188:191]
    ds_read_b64_tr_b16 v[224:225], v240 offset:20480
    v_mfma_f32_16x16x32_bf16 v[184:187], v[228:231], v[32:35], v[184:187]
    ds_read_b64_tr_b16 v[226:227], v240 offset:20992
    s_waitcnt lgkmcnt(4)
    v_add_u32 v240, 0x12000, v240
    v_mfma_f32_16x16x32_bf16 v[192:195], v[232:235], v[32:35], v[192:195]
    ds_read_b64_tr_b16 v[228:229], v241 offset:20480
    v_mfma_f32_16x16x32_bf16 v[196:199], v[232:235], v[36:39], v[196:199]
    ds_read_b64_tr_b16 v[230:231], v241 offset:20992
    s_waitcnt lgkmcnt(4)
    v_add_u32 v241, 0x12000, v241
    v_mfma_f32_16x16x32_bf16 v[204:207], v[236:239], v[36:39], v[204:207]
    ds_read_b64_tr_b16 v[232:233], v242 offset:20480
    buffer_load_dwordx4 v[84:87], v245, s[12:15], s34 offen offset:1024 sc1
    v_mfma_f32_16x16x32_bf16 v[200:203], v[236:239], v[32:35], v[200:203]
    ds_read_b64_tr_b16 v[234:235], v242 offset:20992
    s_waitcnt lgkmcnt(4)
    v_add_u32 v242, 0x12000, v242
    s_waitcnt vmcnt(10)
    v_mfma_f32_16x16x32_bf16 v[144:147], v[224:227], v[40:43], v[144:147]
    ds_read_b64_tr_b16 v[236:237], v243 offset:20480
    v_mfma_f32_16x16x32_bf16 v[148:151], v[224:227], v[44:47], v[148:151]
    ds_read_b64_tr_b16 v[238:239], v243 offset:20992
    s_waitcnt lgkmcnt(4)
    v_add_u32 v243, 0x12000, v243
    v_mfma_f32_16x16x32_bf16 v[156:159], v[228:231], v[44:47], v[156:159]
    ds_read_b64_tr_b16 v[224:225], v240 offset:20480
    v_mfma_f32_16x16x32_bf16 v[152:155], v[228:231], v[40:43], v[152:155]
    ds_read_b64_tr_b16 v[226:227], v240 offset:20992
    s_waitcnt lgkmcnt(4)
    v_add_u32 v240, 0xfffee000, v240
    v_mfma_f32_16x16x32_bf16 v[160:163], v[232:235], v[40:43], v[160:163]
    ds_read_b64_tr_b16 v[228:229], v241 offset:20480
    s_add_u32 s34, s30, 45056
    buffer_load_dwordx4 v[88:91], v245, s[12:15], s34 offen offset:0 sc1
    v_mfma_f32_16x16x32_bf16 v[164:167], v[232:235], v[44:47], v[164:167]
    ds_read_b64_tr_b16 v[230:231], v241 offset:20992
    s_waitcnt lgkmcnt(4)
    v_add_u32 v241, 0xfffee000, v241
    v_mfma_f32_16x16x32_bf16 v[172:175], v[236:239], v[44:47], v[172:175]
    ds_read_b64_tr_b16 v[232:233], v242 offset:20480
    v_mfma_f32_16x16x32_bf16 v[168:171], v[236:239], v[40:43], v[168:171]
    ds_read_b64_tr_b16 v[234:235], v242 offset:20992
    s_waitcnt lgkmcnt(4)
    v_add_u32 v242, 0xfffee000, v242
    v_mfma_f32_16x16x32_bf16 v[176:179], v[224:227], v[40:43], v[176:179]
    ds_read_b64_tr_b16 v[236:237], v243 offset:20480
    v_mfma_f32_16x16x32_bf16 v[180:183], v[224:227], v[44:47], v[180:183]
    ds_read_b64_tr_b16 v[238:239], v243 offset:20992
    s_waitcnt lgkmcnt(4)
    v_add_u32 v243, 0xfffee000, v243
    v_mfma_f32_16x16x32_bf16 v[188:191], v[228:231], v[44:47], v[188:191]
    ds_read_b64_tr_b16 v[224:225], v240 offset:24576
    buffer_load_dwordx4 v[92:95], v245, s[12:15], s34 offen offset:1024 sc1
    v_mfma_f32_16x16x32_bf16 v[184:187], v[228:231], v[40:43], v[184:187]
    ds_read_b64_tr_b16 v[226:227], v240 offset:25088
    s_waitcnt lgkmcnt(4)
    v_add_u32 v240, 0x12000, v240
    v_mfma_f32_16x16x32_bf16 v[192:195], v[232:235], v[40:43], v[192:195]
    ds_read_b64_tr_b16 v[228:229], v241 offset:24576
    v_mfma_f32_16x16x32_bf16 v[196:199], v[232:235], v[44:47], v[196:199]
    ds_read_b64_tr_b16 v[230:231], v241 offset:25088
    s_waitcnt lgkmcnt(4)
    v_add_u32 v241, 0x12000, v241
    v_mfma_f32_16x16x32_bf16 v[204:207], v[236:239], v[44:47], v[204:207]
    ds_read_b64_tr_b16 v[232:233], v242 offset:24576
    v_mfma_f32_16x16x32_bf16 v[200:203], v[236:239], v[40:43], v[200:203]
    ds_read_b64_tr_b16 v[234:235], v242 offset:25088
    s_waitcnt lgkmcnt(4)
    v_add_u32 v242, 0x12000, v242
    s_waitcnt vmcnt(10)
    v_mfma_f32_16x16x32_bf16 v[144:147], v[224:227], v[48:51], v[144:147]
    ds_read_b64_tr_b16 v[236:237], v243 offset:24576
    s_add_u32 s34, s30, 49152
    buffer_load_dwordx4 v[96:99], v245, s[12:15], s34 offen offset:0 sc1
    v_mfma_f32_16x16x32_bf16 v[148:151], v[224:227], v[52:55], v[148:151]
    ds_read_b64_tr_b16 v[238:239], v243 offset:25088
    s_waitcnt lgkmcnt(4)
    v_add_u32 v243, 0x12000, v243
    v_mfma_f32_16x16x32_bf16 v[156:159], v[228:231], v[52:55], v[156:159]
    ds_read_b64_tr_b16 v[224:225], v240 offset:24576
    v_mfma_f32_16x16x32_bf16 v[152:155], v[228:231], v[48:51], v[152:155]
    ds_read_b64_tr_b16 v[226:227], v240 offset:25088
    s_waitcnt lgkmcnt(4)
    v_add_u32 v240, 0xfffee000, v240
    v_mfma_f32_16x16x32_bf16 v[160:163], v[232:235], v[48:51], v[160:163]
    ds_read_b64_tr_b16 v[228:229], v241 offset:24576
    v_mfma_f32_16x16x32_bf16 v[164:167], v[232:235], v[52:55], v[164:167]
    ds_read_b64_tr_b16 v[230:231], v241 offset:25088
    s_waitcnt lgkmcnt(4)
    v_add_u32 v241, 0xfffee000, v241
    v_mfma_f32_16x16x32_bf16 v[172:175], v[236:239], v[52:55], v[172:175]
    ds_read_b64_tr_b16 v[232:233], v242 offset:24576
    buffer_load_dwordx4 v[100:103], v245, s[12:15], s34 offen offset:1024 sc1
    v_mfma_f32_16x16x32_bf16 v[168:171], v[236:239], v[48:51], v[168:171]
    ds_read_b64_tr_b16 v[234:235], v242 offset:25088
    s_waitcnt lgkmcnt(4)
    v_add_u32 v242, 0xfffee000, v242
    s_setprio 0
    v_mfma_f32_16x16x32_bf16 v[176:179], v[224:227], v[48:51], v[176:179]
    ds_read_b64_tr_b16 v[236:237], v243 offset:24576
    v_mfma_f32_16x16x32_bf16 v[180:183], v[224:227], v[52:55], v[180:183]
    ds_read_b64_tr_b16 v[238:239], v243 offset:25088
    s_waitcnt lgkmcnt(4)
    v_add_u32 v243, 0xfffee000, v243
    v_mfma_f32_16x16x32_bf16 v[188:191], v[228:231], v[52:55], v[188:191]
    ds_read_b64_tr_b16 v[224:225], v240 offset:28672
    v_mfma_f32_16x16x32_bf16 v[184:187], v[228:231], v[48:51], v[184:187]
    ds_read_b64_tr_b16 v[226:227], v240 offset:29184
    s_waitcnt lgkmcnt(4)
    v_add_u32 v240, 0x12000, v240
    v_mfma_f32_16x16x32_bf16 v[192:195], v[232:235], v[48:51], v[192:195]
    ds_read_b64_tr_b16 v[228:229], v241 offset:28672
    s_add_u32 s34, s30, 53248
    buffer_load_dwordx4 v[104:107], v245, s[12:15], s34 offen offset:0 sc1
    v_mfma_f32_16x16x32_bf16 v[196:199], v[232:235], v[52:55], v[196:199]
    ds_read_b64_tr_b16 v[230:231], v241 offset:29184
    s_waitcnt lgkmcnt(4)
    v_add_u32 v241, 0x12000, v241
    v_mfma_f32_16x16x32_bf16 v[204:207], v[236:239], v[52:55], v[204:207]
    ds_read_b64_tr_b16 v[232:233], v242 offset:28672
    v_mfma_f32_16x16x32_bf16 v[200:203], v[236:239], v[48:51], v[200:203]
    ds_read_b64_tr_b16 v[234:235], v242 offset:29184
    s_waitcnt lgkmcnt(4)
    v_add_u32 v242, 0x12000, v242
    s_waitcnt vmcnt(11)
    v_mfma_f32_16x16x32_bf16 v[144:147], v[224:227], v[56:59], v[144:147]
    ds_read_b64_tr_b16 v[236:237], v243 offset:28672
    v_mfma_f32_16x16x32_bf16 v[148:151], v[224:227], v[60:63], v[148:151]
    ds_read_b64_tr_b16 v[238:239], v243 offset:29184
    s_waitcnt lgkmcnt(4)
    v_add_u32 v243, 0x12000, v243
    v_mfma_f32_16x16x32_bf16 v[156:159], v[228:231], v[60:63], v[156:159]
    ds_read_b64_tr_b16 v[224:225], v240 offset:28672
    buffer_load_dwordx4 v[108:111], v245, s[12:15], s34 offen offset:1024 sc1
    v_mfma_f32_16x16x32_bf16 v[152:155], v[228:231], v[56:59], v[152:155]
    ds_read_b64_tr_b16 v[226:227], v240 offset:29184
    s_waitcnt lgkmcnt(4)
    v_add_u32 v240, 0xfffee000, v240
    v_mfma_f32_16x16x32_bf16 v[160:163], v[232:235], v[56:59], v[160:163]
    ds_read_b64_tr_b16 v[228:229], v241 offset:28672
    v_mfma_f32_16x16x32_bf16 v[164:167], v[232:235], v[60:63], v[164:167]
    ds_read_b64_tr_b16 v[230:231], v241 offset:29184
    s_waitcnt lgkmcnt(4)
    v_add_u32 v241, 0xfffee000, v241
    v_mfma_f32_16x16x32_bf16 v[172:175], v[236:239], v[60:63], v[172:175]
    ds_read_b64_tr_b16 v[232:233], v242 offset:28672
    v_mfma_f32_16x16x32_bf16 v[168:171], v[236:239], v[56:59], v[168:171]
    ds_read_b64_tr_b16 v[234:235], v242 offset:29184
    s_waitcnt lgkmcnt(4)
    v_add_u32 v242, 0xfffee000, v242
    v_mfma_f32_16x16x32_bf16 v[176:179], v[224:227], v[56:59], v[176:179]
    ds_read_b64_tr_b16 v[236:237], v243 offset:28672
    s_add_u32 s34, s30, 57344
    buffer_load_dwordx4 v[112:115], v245, s[12:15], s34 offen offset:0 sc1
    v_mfma_f32_16x16x32_bf16 v[180:183], v[224:227], v[60:63], v[180:183]
    ds_read_b64_tr_b16 v[238:239], v243 offset:29184
    s_waitcnt lgkmcnt(4)
    v_add_u32 v243, 0xfffee000, v243
    v_mfma_f32_16x16x32_bf16 v[188:191], v[228:231], v[60:63], v[188:191]
    ds_read_b64_tr_b16 v[224:225], v240 offset:32768
    v_mfma_f32_16x16x32_bf16 v[184:187], v[228:231], v[56:59], v[184:187]
    ds_read_b64_tr_b16 v[226:227], v240 offset:33280
    s_waitcnt lgkmcnt(4)
    v_add_u32 v240, 0x12000, v240
    v_mfma_f32_16x16x32_bf16 v[192:195], v[232:235], v[56:59], v[192:195]
    ds_read_b64_tr_b16 v[228:229], v241 offset:32768
    v_mfma_f32_16x16x32_bf16 v[196:199], v[232:235], v[60:63], v[196:199]
    ds_read_b64_tr_b16 v[230:231], v241 offset:33280
    s_waitcnt lgkmcnt(4)
    v_add_u32 v241, 0x12000, v241
    v_mfma_f32_16x16x32_bf16 v[204:207], v[236:239], v[60:63], v[204:207]
    ds_read_b64_tr_b16 v[232:233], v242 offset:32768
    buffer_load_dwordx4 v[116:119], v245, s[12:15], s34 offen offset:1024 sc1
    v_mfma_f32_16x16x32_bf16 v[200:203], v[236:239], v[56:59], v[200:203]
    ds_read_b64_tr_b16 v[234:235], v242 offset:33280
    s_waitcnt lgkmcnt(4)
    v_add_u32 v242, 0x12000, v242
    s_waitcnt vmcnt(12)
    v_mfma_f32_16x16x32_bf16 v[144:147], v[224:227], v[64:67], v[144:147]
    ds_read_b64_tr_b16 v[236:237], v243 offset:32768
    v_mfma_f32_16x16x32_bf16 v[148:151], v[224:227], v[68:71], v[148:151]
    ds_read_b64_tr_b16 v[238:239], v243 offset:33280
    s_waitcnt lgkmcnt(4)
    v_add_u32 v243, 0x12000, v243
    v_mfma_f32_16x16x32_bf16 v[156:159], v[228:231], v[68:71], v[156:159]
    ds_read_b64_tr_b16 v[224:225], v240 offset:32768
    v_mfma_f32_16x16x32_bf16 v[152:155], v[228:231], v[64:67], v[152:155]
    ds_read_b64_tr_b16 v[226:227], v240 offset:33280
    s_waitcnt lgkmcnt(4)
    v_add_u32 v240, 0xffff7000, v240
    v_mfma_f32_16x16x32_bf16 v[160:163], v[232:235], v[64:67], v[160:163]
    ds_read_b64_tr_b16 v[228:229], v241 offset:32768
    s_add_u32 s34, s30, 61440
    buffer_load_dwordx4 v[120:123], v245, s[12:15], s34 offen offset:0 sc1
    v_mfma_f32_16x16x32_bf16 v[164:167], v[232:235], v[68:71], v[164:167]
    ds_read_b64_tr_b16 v[230:231], v241 offset:33280
    s_waitcnt lgkmcnt(4)
    v_add_u32 v241, 0xffff7000, v241
    v_mfma_f32_16x16x32_bf16 v[172:175], v[236:239], v[68:71], v[172:175]
    ds_read_b64_tr_b16 v[232:233], v242 offset:32768
    v_mfma_f32_16x16x32_bf16 v[168:171], v[236:239], v[64:67], v[168:171]
    ds_read_b64_tr_b16 v[234:235], v242 offset:33280
    s_waitcnt lgkmcnt(4)
    v_add_u32 v242, 0xffff7000, v242
    v_mfma_f32_16x16x32_bf16 v[176:179], v[224:227], v[64:67], v[176:179]
    ds_read_b64_tr_b16 v[236:237], v243 offset:32768
    v_mfma_f32_16x16x32_bf16 v[180:183], v[224:227], v[68:71], v[180:183]
    ds_read_b64_tr_b16 v[238:239], v243 offset:33280
    s_waitcnt lgkmcnt(4)
    v_add_u32 v243, 0xffff7000, v243
    v_mfma_f32_16x16x32_bf16 v[188:191], v[228:231], v[68:71], v[188:191]
    ds_read_b64_tr_b16 v[224:225], v240 offset:0
    buffer_load_dwordx4 v[124:127], v245, s[12:15], s34 offen offset:1024 sc1
    v_mfma_f32_16x16x32_bf16 v[184:187], v[228:231], v[64:67], v[184:187]
    ds_read_b64_tr_b16 v[226:227], v240 offset:512
    s_waitcnt lgkmcnt(4)
    v_mfma_f32_16x16x32_bf16 v[192:195], v[232:235], v[64:67], v[192:195]
    ds_read_b64_tr_b16 v[228:229], v241 offset:0
    v_mfma_f32_16x16x32_bf16 v[196:199], v[232:235], v[68:71], v[196:199]
    ds_read_b64_tr_b16 v[230:231], v241 offset:512
    s_waitcnt lgkmcnt(4)
    v_mfma_f32_16x16x32_bf16 v[204:207], v[236:239], v[68:71], v[204:207]
    ds_read_b64_tr_b16 v[232:233], v242 offset:0
    v_mfma_f32_16x16x32_bf16 v[200:203], v[236:239], v[64:67], v[200:203]
    ds_read_b64_tr_b16 v[234:235], v242 offset:512
    s_waitcnt lgkmcnt(4)
    s_cbranch_vccnz Lp2
    s_setprio 1
Lp2:
    s_waitcnt vmcnt(12)
    v_mfma_f32_16x16x32_bf16 v[144:147], v[224:227], v[72:75], v[144:147]
    ds_read_b64_tr_b16 v[236:237], v243 offset:0
    s_add_u32 s34, s30, 65536
    buffer_load_dwordx4 v[128:131], v245, s[12:15], s34 offen offset:0 sc1
    v_mfma_f32_16x16x32_bf16 v[148:151], v[224:227], v[76:79], v[148:151]
    ds_read_b64_tr_b16 v[238:239], v243 offset:512
    s_waitcnt lgkmcnt(4)
    v_mfma_f32_16x16x32_bf16 v[156:159], v[228:231], v[76:79], v[156:159]
    ds_read_b64_tr_b16 v[224:225], v240 offset:4096
    v_mfma_f32_16x16x32_bf16 v[152:155], v[228:231], v[72:75], v[152:155]
    ds_read_b64_tr_b16 v[226:227], v240 offset:4608
    s_waitcnt lgkmcnt(4)
    v_mfma_f32_16x16x32_bf16 v[160:163], v[232:235], v[72:75], v[160:163]
    ds_read_b64_tr_b16 v[228:229], v241 offset:4096
    v_mfma_f32_16x16x32_bf16 v[164:167], v[232:235], v[76:79], v[164:167]
    ds_read_b64_tr_b16 v[230:231], v241 offset:4608
    s_waitcnt lgkmcnt(4)
    v_mfma_f32_16x16x32_bf16 v[172:175], v[236:239], v[76:79], v[172:175]
    ds_read_b64_tr_b16 v[232:233], v242 offset:4096
    buffer_load_dwordx4 v[132:135], v245, s[12:15], s34 offen offset:1024 sc1
    v_mfma_f32_16x16x32_bf16 v[168:171], v[236:239], v[72:75], v[168:171]
    ds_read_b64_tr_b16 v[234:235], v242 offset:4608
    s_waitcnt lgkmcnt(4)
    s_waitcnt vmcnt(12)
    v_mfma_f32_16x16x32_bf16 v[144:147], v[224:227], v[80:83], v[144:147]
    ds_read_b64_tr_b16 v[236:237], v243 offset:4096
    v_mfma_f32_16x16x32_bf16 v[148:151], v[224:227], v[84:87], v[148:151]
    ds_read_b64_tr_b16 v[238:239], v243 offset:4608
    s_waitcnt lgkmcnt(4)
    v_mfma_f32_16x16x32_bf16 v[156:159], v[228:231], v[84:87], v[156:159]
    ds_read_b64_tr_b16 v[224:225], v240 offset:8192
    v_mfma_f32_16x16x32_bf16 v[152:155], v[228:231], v[80:83], v[152:155]
    ds_read_b64_tr_b16 v[226:227], v240 offset:8704
    s_waitcnt lgkmcnt(4)
    v_mfma_f32_16x16x32_bf16 v[160:163], v[232:235], v[80:83], v[160:163]
    ds_read_b64_tr_b16 v[228:229], v241 offset:8192
    s_add_u32 s34, s30, 69632
    buffer_load_dwordx4 v[136:139], v245, s[12:15], s34 offen offset:0 sc1
    v_mfma_f32_16x16x32_bf16 v[164:167], v[232:235], v[84:87], v[164:167]
    ds_read_b64_tr_b16 v[230:231], v241 offset:8704
    s_waitcnt lgkmcnt(4)
    v_mfma_f32_16x16x32_bf16 v[172:175], v[236:239], v[84:87], v[172:175]
    ds_read_b64_tr_b16 v[232:233], v242 offset:8192
    v_mfma_f32_16x16x32_bf16 v[168:171], v[236:239], v[80:83], v[168:171]
    ds_read_b64_tr_b16 v[234:235], v242 offset:8704
    s_waitcnt lgkmcnt(4)
    s_waitcnt vmcnt(11)
    v_mfma_f32_16x16x32_bf16 v[144:147], v[224:227], v[88:91], v[144:147]
    ds_read_b64_tr_b16 v[236:237], v243 offset:8192
    v_mfma_f32_16x16x32_bf16 v[148:151], v[224:227], v[92:95], v[148:151]
    ds_read_b64_tr_b16 v[238:239], v243 offset:8704
    s_waitcnt lgkmcnt(4)
    v_mfma_f32_16x16x32_bf16 v[156:159], v[228:231], v[92:95], v[156:159]
    ds_read_b64_tr_b16 v[224:225], v240 offset:12288
    buffer_load_dwordx4 v[140:143], v245, s[12:15], s34 offen offset:1024 sc1
    v_mfma_f32_16x16x32_bf16 v[152:155], v[228:231], v[88:91], v[152:155]
    ds_read_b64_tr_b16 v[226:227], v240 offset:12800
    s_waitcnt lgkmcnt(4)
    v_mfma_f32_16x16x32_bf16 v[160:163], v[232:235], v[88:91], v[160:163]
    ds_read_b64_tr_b16 v[228:229], v241 offset:12288
    buffer_load_dword v255, v255, s[60:63], s47 offen
    v_mfma_f32_16x16x32_bf16 v[164:167], v[232:235], v[92:95], v[164:167]
    ds_read_b64_tr_b16 v[230:231], v241 offset:12800
    s_waitcnt lgkmcnt(4)
    v_mfma_f32_16x16x32_bf16 v[172:175], v[236:239], v[92:95], v[172:175]
    ds_read_b64_tr_b16 v[232:233], v242 offset:12288
    buffer_load_dword v254, v254, s[64:67], 0 offen
    v_mfma_f32_16x16x32_bf16 v[168:171], v[236:239], v[88:91], v[168:171]
    ds_read_b64_tr_b16 v[234:235], v242 offset:12800
    s_waitcnt lgkmcnt(4)
    s_waitcnt vmcnt(12)
    v_mfma_f32_16x16x32_bf16 v[144:147], v[224:227], v[96:99], v[144:147]
    ds_read_b64_tr_b16 v[236:237], v243 offset:12288
    v_mfma_f32_16x16x32_bf16 v[148:151], v[224:227], v[100:103], v[148:151]
    ds_read_b64_tr_b16 v[238:239], v243 offset:12800
    s_waitcnt lgkmcnt(4)
    v_mfma_f32_16x16x32_bf16 v[156:159], v[228:231], v[100:103], v[156:159]
    ds_read_b64_tr_b16 v[224:225], v240 offset:16384
    v_mfma_f32_16x16x32_bf16 v[152:155], v[228:231], v[96:99], v[152:155]
    ds_read_b64_tr_b16 v[226:227], v240 offset:16896
    s_waitcnt lgkmcnt(4)
    v_mfma_f32_16x16x32_bf16 v[160:163], v[232:235], v[96:99], v[160:163]
    ds_read_b64_tr_b16 v[228:229], v241 offset:16384
    v_mfma_f32_16x16x32_bf16 v[164:167], v[232:235], v[100:103], v[164:167]
    ds_read_b64_tr_b16 v[230:231], v241 offset:16896
    s_waitcnt lgkmcnt(4)
    v_mfma_f32_16x16x32_bf16 v[172:175], v[236:239], v[100:103], v[172:175]
    ds_read_b64_tr_b16 v[232:233], v242 offset:16384
    v_mfma_f32_16x16x32_bf16 v[168:171], v[236:239], v[96:99], v[168:171]
    ds_read_b64_tr_b16 v[234:235], v242 offset:16896
    s_waitcnt lgkmcnt(4)
    s_waitcnt vmcnt(10)
    v_mfma_f32_16x16x32_bf16 v[144:147], v[224:227], v[104:107], v[144:147]
    ds_read_b64_tr_b16 v[236:237], v243 offset:16384
    v_mfma_f32_16x16x32_bf16 v[148:151], v[224:227], v[108:111], v[148:151]
    ds_read_b64_tr_b16 v[238:239], v243 offset:16896
    s_waitcnt lgkmcnt(4)
    v_mfma_f32_16x16x32_bf16 v[156:159], v[228:231], v[108:111], v[156:159]
    ds_read_b64_tr_b16 v[224:225], v240 offset:20480
    v_mfma_f32_16x16x32_bf16 v[152:155], v[228:231], v[104:107], v[152:155]
    ds_read_b64_tr_b16 v[226:227], v240 offset:20992
    s_waitcnt lgkmcnt(4)
    v_mfma_f32_16x16x32_bf16 v[160:163], v[232:235], v[104:107], v[160:163]
    ds_read_b64_tr_b16 v[228:229], v241 offset:20480
    v_mfma_f32_16x16x32_bf16 v[164:167], v[232:235], v[108:111], v[164:167]
    ds_read_b64_tr_b16 v[230:231], v241 offset:20992
    s_waitcnt lgkmcnt(4)
    v_mfma_f32_16x16x32_bf16 v[172:175], v[236:239], v[108:111], v[172:175]
    ds_read_b64_tr_b16 v[232:233], v242 offset:20480
    v_mfma_f32_16x16x32_bf16 v[168:171], v[236:239], v[104:107], v[168:171]
    ds_read_b64_tr_b16 v[234:235], v242 offset:20992
    s_waitcnt lgkmcnt(4)
    s_waitcnt vmcnt(8)
    v_mfma_f32_16x16x32_bf16 v[144:147], v[224:227], v[112:115], v[144:147]
    ds_read_b64_tr_b16 v[236:237], v243 offset:20480
    v_mfma_f32_16x16x32_bf16 v[148:151], v[224:227], v[116:119], v[148:151]
    ds_read_b64_tr_b16 v[238:239], v243 offset:20992
    s_waitcnt lgkmcnt(4)
    v_mfma_f32_16x16x32_bf16 v[156:159], v[228:231], v[116:119], v[156:159]
    ds_read_b64_tr_b16 v[224:225], v240 offset:24576
    v_mfma_f32_16x16x32_bf16 v[152:155], v[228:231], v[112:115], v[152:155]
    ds_read_b64_tr_b16 v[226:227], v240 offset:25088
    s_waitcnt lgkmcnt(4)
    v_mfma_f32_16x16x32_bf16 v[160:163], v[232:235], v[112:115], v[160:163]
    ds_read_b64_tr_b16 v[228:229], v241 offset:24576
    v_mfma_f32_16x16x32_bf16 v[164:167], v[232:235], v[116:119], v[164:167]
    ds_read_b64_tr_b16 v[230:231], v241 offset:25088
    s_waitcnt lgkmcnt(4)
    v_mfma_f32_16x16x32_bf16 v[172:175], v[236:239], v[116:119], v[172:175]
    ds_read_b64_tr_b16 v[232:233], v242 offset:24576
    v_mfma_f32_16x16x32_bf16 v[168:171], v[236:239], v[112:115], v[168:171]
    ds_read_b64_tr_b16 v[234:235], v242 offset:25088
    s_waitcnt lgkmcnt(4)
    s_waitcnt vmcnt(6)
    v_mfma_f32_16x16x32_bf16 v[144:147], v[224:227], v[120:123], v[144:147]
    ds_read_b64_tr_b16 v[236:237], v243 offset:24576
    v_mfma_f32_16x16x32_bf16 v[148:151], v[224:227], v[124:127], v[148:151]
    ds_read_b64_tr_b16 v[238:239], v243 offset:25088
    s_waitcnt lgkmcnt(4)
    v_mfma_f32_16x16x32_bf16 v[156:159], v[228:231], v[124:127], v[156:159]
    ds_read_b64_tr_b16 v[224:225], v240 offset:28672
    v_mfma_f32_16x16x32_bf16 v[152:155], v[228:231], v[120:123], v[152:155]
    ds_read_b64_tr_b16 v[226:227], v240 offset:29184
    s_waitcnt lgkmcnt(4)
    v_mfma_f32_16x16x32_bf16 v[160:163], v[232:235], v[120:123], v[160:163]
    ds_read_b64_tr_b16 v[228:229], v241 offset:28672
    v_mfma_f32_16x16x32_bf16 v[164:167], v[232:235], v[124:127], v[164:167]
    ds_read_b64_tr_b16 v[230:231], v241 offset:29184
    s_waitcnt lgkmcnt(4)
    v_mfma_f32_16x16x32_bf16 v[172:175], v[236:239], v[124:127], v[172:175]
    ds_read_b64_tr_b16 v[232:233], v242 offset:28672
    v_mfma_f32_16x16x32_bf16 v[168:171], v[236:239], v[120:123], v[168:171]
    ds_read_b64_tr_b16 v[234:235], v242 offset:29184
    s_waitcnt lgkmcnt(4)
    s_waitcnt vmcnt(4)
    v_mfma_f32_16x16x32_bf16 v[144:147], v[224:227], v[128:131], v[144:147]
    ds_read_b64_tr_b16 v[236:237], v243 offset:28672
    v_mfma_f32_16x16x32_bf16 v[148:151], v[224:227], v[132:135], v[148:151]
    ds_read_b64_tr_b16 v[238:239], v243 offset:29184
    s_waitcnt lgkmcnt(4)
    v_mfma_f32_16x16x32_bf16 v[156:159], v[228:231], v[132:135], v[156:159]
    ds_read_b64_tr_b16 v[224:225], v240 offset:32768
    v_mfma_f32_16x16x32_bf16 v[152:155], v[228:231], v[128:131], v[152:155]
    ds_read_b64_tr_b16 v[226:227], v240 offset:33280
    s_waitcnt lgkmcnt(4)
    v_add_u32 v240, 0x12000, v240
    v_mfma_f32_16x16x32_bf16 v[160:163], v[232:235], v[128:131], v[160:163]
    ds_read_b64_tr_b16 v[228:229], v241 offset:32768
    v_mfma_f32_16x16x32_bf16 v[164:167], v[232:235], v[132:135], v[164:167]
    ds_read_b64_tr_b16 v[230:231], v241 offset:33280
    s_waitcnt lgkmcnt(4)
    v_add_u32 v241, 0x12000, v241
    v_mfma_f32_16x16x32_bf16 v[172:175], v[236:239], v[132:135], v[172:175]
    ds_read_b64_tr_b16 v[232:233], v242 offset:32768
    v_mfma_f32_16x16x32_bf16 v[168:171], v[236:239], v[128:131], v[168:171]
    ds_read_b64_tr_b16 v[234:235], v242 offset:33280
    s_waitcnt lgkmcnt(4)
    v_add_u32 v242, 0x12000, v242
    s_waitcnt vmcnt(2)
    v_mfma_f32_16x16x32_bf16 v[144:147], v[224:227], v[136:139], v[144:147]
    ds_read_b64_tr_b16 v[236:237], v243 offset:32768
    v_mfma_f32_16x16x32_bf16 v[148:151], v[224:227], v[140:143], v[148:151]
    ds_read_b64_tr_b16 v[238:239], v243 offset:33280
    s_waitcnt lgkmcnt(4)
    v_add_u32 v243, 0x12000, v243
    v_mfma_f32_16x16x32_bf16 v[156:159], v[228:231], v[140:143], v[156:159]
    ds_read_b64_tr_b16 v[224:225], v240 offset:0
    v_mfma_f32_16x16x32_bf16 v[152:155], v[228:231], v[136:139], v[152:155]
    ds_read_b64_tr_b16 v[226:227], v240 offset:512
    s_waitcnt lgkmcnt(4)
    v_mfma_f32_16x16x32_bf16 v[160:163], v[232:235], v[136:139], v[160:163]
    ds_read_b64_tr_b16 v[228:229], v241 offset:0
    v_mfma_f32_16x16x32_bf16 v[164:167], v[232:235], v[140:143], v[164:167]
    ds_read_b64_tr_b16 v[230:231], v241 offset:512
    s_waitcnt lgkmcnt(4)
    v_mfma_f32_16x16x32_bf16 v[172:175], v[236:239], v[140:143], v[172:175]
    ds_read_b64_tr_b16 v[232:233], v242 offset:0
    v_mfma_f32_16x16x32_bf16 v[168:171], v[236:239], v[136:139], v[168:171]
    ds_read_b64_tr_b16 v[234:235], v242 offset:512
    s_waitcnt lgkmcnt(4)
    s_barrier
    v_mfma_f32_16x16x32_bf16 v[176:179], v[224:227], v[72:75], v[176:179]
    ds_read_b64_tr_b16 v[236:237], v243 offset:0
    v_mfma_f32_16x16x32_bf16 v[180:183], v[224:227], v[76:79], v[180:183]
    ds_read_b64_tr_b16 v[238:239], v243 offset:512
    s_waitcnt lgkmcnt(4)
    v_mfma_f32_16x16x32_bf16 v[188:191], v[228:231], v[76:79], v[188:191]
    ds_read_b64_tr_b16 v[224:225], v240 offset:4096
    s_add_u32 s25, s25, 128
    s_sub_u32 s26, s26, 1
    s_cmp_eq_u32 s26, 0
    s_cselect_b32 s18, 0, s18
    s_add_u32 m0, s29, 0
    s_mov_b32 s24, s25
    buffer_load_dwordx4 v244, s[16:19], s24 offen lds
    v_mfma_f32_16x16x32_bf16 v[184:187], v[228:231], v[72:75], v[184:187]
    ds_read_b64_tr_b16 v[226:227], v240 offset:4608
    s_waitcnt lgkmcnt(4)
    v_mfma_f32_16x16x32_bf16 v[192:195], v[232:235], v[72:75], v[192:195]
    ds_read_b64_tr_b16 v[228:229], v241 offset:4096
    v_mul_f32 v144, s28, v144
    v_mul_f32 v145, s28, v145
    v_mul_f32 v146, s28, v146
    v_mfma_f32_16x16x32_bf16 v[196:199], v[232:235], v[76:79], v[196:199]
    ds_read_b64_tr_b16 v[230:231], v241 offset:4608
    s_waitcnt lgkmcnt(4)
    v_mul_f32 v147, s28, v147
    v_exp_f32 v144, v144
    v_mfma_f32_16x16x32_bf16 v[204:207], v[236:239], v[76:79], v[204:207]
    ds_read_b64_tr_b16 v[232:233], v242 offset:4096
    v_exp_f32 v145, v145
    v_mfma_f32_16x16x32_bf16 v[200:203], v[236:239], v[72:75], v[200:203]
    ds_read_b64_tr_b16 v[234:235], v242 offset:4608
    s_waitcnt lgkmcnt(4)
    v_mul_f32 v148, s28, v148
    v_mul_f32 v149, s28, v149
    v_mfma_f32_16x16x32_bf16 v[176:179], v[224:227], v[80:83], v[176:179]
    ds_read_b64_tr_b16 v[236:237], v243 offset:4096
    s_add_u32 m0, s29, 8192
    s_add_u32 s24, s24, s35
    buffer_load_dwordx4 v244, s[16:19], s24 offen lds
    v_exp_f32 v146, v146
    v_mfma_f32_16x16x32_bf16 v[180:183], v[224:227], v[84:87], v[180:183]
    ds_read_b64_tr_b16 v[238:239], v243 offset:4608
    s_waitcnt lgkmcnt(4)
    v_exp_f32 v147, v147
    v_add_f32 v144, 1.0, v144
    v_mfma_f32_16x16x32_bf16 v[188:191], v[228:231], v[84:87], v[188:191]
    ds_read_b64_tr_b16 v[224:225], v240 offset:8192
    v_add_f32 v145, 1.0, v145
    v_mul_f32 v150, s28, v150
    v_mfma_f32_16x16x32_bf16 v[184:187], v[228:231], v[80:83], v[184:187]
    ds_read_b64_tr_b16 v[226:227], v240 offset:8704
    s_waitcnt lgkmcnt(4)
    v_mul_f32 v151, s28, v151
    v_exp_f32 v148, v148
    v_mfma_f32_16x16x32_bf16 v[192:195], v[232:235], v[80:83], v[192:195]
    ds_read_b64_tr_b16 v[228:229], v241 offset:8192
    v_exp_f32 v149, v149
    v_mfma_f32_16x16x32_bf16 v[196:199], v[232:235], v[84:87], v[196:199]
    ds_read_b64_tr_b16 v[230:231], v241 offset:8704
    s_waitcnt lgkmcnt(4)
    v_add_f32 v146, 1.0, v146
    v_add_f32 v147, 1.0, v147
    v_mfma_f32_16x16x32_bf16 v[204:207], v[236:239], v[84:87], v[204:207]
    ds_read_b64_tr_b16 v[232:233], v242 offset:8192
    s_add_u32 m0, s29, 16384
    s_add_u32 s24, s24, s35
    buffer_load_dwordx4 v244, s[16:19], s24 offen lds
    v_cvt_pk_bf16_f32 v208, v144, v145
    v_mul_f32 v152, s28, v152
    v_mul_f32 v153, s28, v153
    v_mfma_f32_16x16x32_bf16 v[200:203], v[236:239], v[80:83], v[200:203]
    ds_read_b64_tr_b16 v[234:235], v242 offset:8704
    s_waitcnt lgkmcnt(4)
    v_exp_f32 v150, v150
    v_mfma_f32_16x16x32_bf16 v[176:179], v[224:227], v[88:91], v[176:179]
    ds_read_b64_tr_b16 v[236:237], v243 offset:8192
    v_exp_f32 v151, v151
    v_add_f32 v148, 1.0, v148
    v_mfma_f32_16x16x32_bf16 v[180:183], v[224:227], v[92:95], v[180:183]
    ds_read_b64_tr_b16 v[238:239], v243 offset:8704
    s_waitcnt lgkmcnt(4)
    v_add_f32 v149, 1.0, v149
    v_cvt_pk_bf16_f32 v209, v146, v147
    v_mfma_f32_16x16x32_bf16 v[188:191], v[228:231], v[92:95], v[188:191]
    ds_read_b64_tr_b16 v[224:225], v240 offset:12288
    v_mul_f32 v154, s28, v154
    v_mul_f32 v155, s28, v155
    v_mfma_f32_16x16x32_bf16 v[184:187], v[228:231], v[88:91], v[184:187]
    ds_read_b64_tr_b16 v[226:227], v240 offset:12800
    s_waitcnt lgkmcnt(4)
    v_exp_f32 v152, v152
    v_exp_f32 v153, v153
    v_mfma_f32_16x16x32_bf16 v[192:195], v[232:235], v[88:91], v[192:195]
    ds_read_b64_tr_b16 v[228:229], v241 offset:12288
    s_add_u32 m0, s29, 24576
    s_add_u32 s24, s24, s35
    buffer_load_dwordx4 v244, s[16:19], s24 offen lds
    v_add_f32 v150, 1.0, v150
    v_mfma_f32_16x16x32_bf16 v[196:199], v[232:235], v[92:95], v[196:199]
    ds_read_b64_tr_b16 v[230:231], v241 offset:12800
    s_waitcnt lgkmcnt(4)
    v_add_f32 v151, 1.0, v151
    v_cvt_pk_bf16_f32 v210, v148, v149
    v_mul_f32 v156, s28, v156
    v_mfma_f32_16x16x32_bf16 v[204:207], v[236:239], v[92:95], v[204:207]
    ds_read_b64_tr_b16 v[232:233], v242 offset:12288
    v_mul_f32 v157, s28, v157
    v_exp_f32 v154, v154
    v_mfma_f32_16x16x32_bf16 v[200:203], v[236:239], v[88:91], v[200:203]
    ds_read_b64_tr_b16 v[234:235], v242 offset:12800
    s_waitcnt lgkmcnt(4)
    v_exp_f32 v155, v155
    v_mfma_f32_16x16x32_bf16 v[176:179], v[224:227], v[96:99], v[176:179]
    ds_read_b64_tr_b16 v[236:237], v243 offset:12288
    v_add_f32 v152, 1.0, v152
    v_add_f32 v153, 1.0, v153
    v_mfma_f32_16x16x32_bf16 v[180:183], v[224:227], v[100:103], v[180:183]
    ds_read_b64_tr_b16 v[238:239], v243 offset:12800
    s_waitcnt lgkmcnt(4)
    v_cvt_pk_bf16_f32 v211, v150, v151
    v_mul_f32 v158, s28, v158
    v_mfma_f32_16x16x32_bf16 v[188:191], v[228:231], v[100:103], v[188:191]
    ds_read_b64_tr_b16 v[224:225], v240 offset:16384
    s_add_u32 m0, s29, 32768
    s_add_u32 s24, s24, s35
    buffer_load_dwordx4 v244, s[16:19], s24 offen lds
    v_mul_f32 v159, s28, v159
    v_exp_f32 v156, v156
    v_mfma_f32_16x16x32_bf16 v[184:187], v[228:231], v[96:99], v[184:187]
    ds_read_b64_tr_b16 v[226:227], v240 offset:16896
    s_waitcnt lgkmcnt(4)
    v_exp_f32 v157, v157
    v_mfma_f32_16x16x32_bf16 v[192:195], v[232:235], v[96:99], v[192:195]
    ds_read_b64_tr_b16 v[228:229], v241 offset:16384
    v_add_f32 v154, 1.0, v154
    v_add_f32 v155, 1.0, v155
    v_mfma_f32_16x16x32_bf16 v[196:199], v[232:235], v[100:103], v[196:199]
    ds_read_b64_tr_b16 v[230:231], v241 offset:16896
    s_waitcnt lgkmcnt(4)
    v_cvt_pk_bf16_f32 v212, v152, v153
    v_mul_f32 v160, s28, v160
    v_mul_f32 v161, s28, v161
    v_mfma_f32_16x16x32_bf16 v[204:207], v[236:239], v[100:103], v[204:207]
    ds_read_b64_tr_b16 v[232:233], v242 offset:16384
    v_exp_f32 v158, v158
    v_mfma_f32_16x16x32_bf16 v[200:203], v[236:239], v[96:99], v[200:203]
    ds_read_b64_tr_b16 v[234:235], v242 offset:16896
    s_waitcnt lgkmcnt(4)
    v_exp_f32 v159, v159
    v_add_f32 v156, 1.0, v156
    s_setprio 0
    v_mfma_f32_16x16x32_bf16 v[176:179], v[224:227], v[104:107], v[176:179]
    ds_read_b64_tr_b16 v[236:237], v243 offset:16384
    s_add_u32 m0, s29, 40960
    s_add_u32 s24, s24, s35
    buffer_load_dwordx4 v244, s[16:19], s24 offen lds
    v_add_f32 v157, 1.0, v157
    v_cvt_pk_bf16_f32 v213, v154, v155
    v_mfma_f32_16x16x32_bf16 v[180:183], v[224:227], v[108:111], v[180:183]
    ds_read_b64_tr_b16 v[238:239], v243 offset:16896
    s_waitcnt lgkmcnt(4)
    v_mul_f32 v162, s28, v162
    v_mul_f32 v163, s28, v163
    v_mfma_f32_16x16x32_bf16 v[188:191], v[228:231], v[108:111], v[188:191]
    ds_read_b64_tr_b16 v[224:225], v240 offset:20480
    v_exp_f32 v160, v160
    v_exp_f32 v161, v161
    v_mfma_f32_16x16x32_bf16 v[184:187], v[228:231], v[104:107], v[184:187]
    ds_read_b64_tr_b16 v[226:227], v240 offset:20992
    s_waitcnt lgkmcnt(4)
    v_add_f32 v158, 1.0, v158
    v_mfma_f32_16x16x32_bf16 v[192:195], v[232:235], v[104:107], v[192:195]
    ds_read_b64_tr_b16 v[228:229], v241 offset:20480
    v_add_f32 v159, 1.0, v159
    v_cvt_pk_bf16_f32 v214, v156, v157
    v_mul_f32 v164, s28, v164
    v_mfma_f32_16x16x32_bf16 v[196:199], v[232:235], v[108:111], v[196:199]
    ds_read_b64_tr_b16 v[230:231], v241 offset:20992
    s_waitcnt lgkmcnt(4)
    v_mul_f32 v165, s28, v165
    v_exp_f32 v162, v162
    v_mfma_f32_16x16x32_bf16 v[204:207], v[236:239], v[108:111], v[204:207]
    ds_read_b64_tr_b16 v[232:233], v242 offset:20480
    s_add_u32 m0, s29, 49152
    s_add_u32 s24, s24, s35
    buffer_load_dwordx4 v244, s[16:19], s24 offen lds
    v_exp_f32 v163, v163
    v_mfma_f32_16x16x32_bf16 v[200:203], v[236:239], v[104:107], v[200:203]
    ds_read_b64_tr_b16 v[234:235], v242 offset:20992
    s_waitcnt lgkmcnt(4)
    v_add_f32 v160, 1.0, v160
    v_add_f32 v161, 1.0, v161
    v_mfma_f32_16x16x32_bf16 v[176:179], v[224:227], v[112:115], v[176:179]
    ds_read_b64_tr_b16 v[236:237], v243 offset:20480
    v_cvt_pk_bf16_f32 v215, v158, v159
    v_mul_f32 v166, s28, v166
    v_mfma_f32_16x16x32_bf16 v[180:183], v[224:227], v[116:119], v[180:183]
    ds_read_b64_tr_b16 v[238:239], v243 offset:20992
    s_waitcnt lgkmcnt(4)
    v_mul_f32 v167, s28, v167
    v_exp_f32 v164, v164
    v_mfma_f32_16x16x32_bf16 v[188:191], v[228:231], v[116:119], v[188:191]
    ds_read_b64_tr_b16 v[224:225], v240 offset:24576
    v_exp_f32 v165, v165
    v_mfma_f32_16x16x32_bf16 v[184:187], v[228:231], v[112:115], v[184:187]
    ds_read_b64_tr_b16 v[226:227], v240 offset:25088
    s_waitcnt lgkmcnt(4)
    v_add_f32 v162, 1.0, v162
    v_add_f32 v163, 1.0, v163
    v_mfma_f32_16x16x32_bf16 v[192:195], v[232:235], v[112:115], v[192:195]
    ds_read_b64_tr_b16 v[228:229], v241 offset:24576
    s_add_u32 m0, s29, 57344
    s_add_u32 s24, s24, s35
    buffer_load_dwordx4 v244, s[16:19], s24 offen lds
    v_cvt_pk_bf16_f32 v216, v160, v161
    v_mul_f32 v168, s28, v168
    v_mul_f32 v169, s28, v169
    v_mfma_f32_16x16x32_bf16 v[196:199], v[232:235], v[116:119], v[196:199]
    ds_read_b64_tr_b16 v[230:231], v241 offset:25088
    s_waitcnt lgkmcnt(4)
    v_exp_f32 v166, v166
    v_mfma_f32_16x16x32_bf16 v[204:207], v[236:239], v[116:119], v[204:207]
    ds_read_b64_tr_b16 v[232:233], v242 offset:24576
    v_exp_f32 v167, v167
    v_add_f32 v164, 1.0, v164
    v_mfma_f32_16x16x32_bf16 v[200:203], v[236:239], v[112:115], v[200:203]
    ds_read_b64_tr_b16 v[234:235], v242 offset:25088
    s_waitcnt lgkmcnt(4)
    v_add_f32 v165, 1.0, v165
    v_cvt_pk_bf16_f32 v217, v162, v163
    v_mfma_f32_16x16x32_bf16 v[176:179], v[224:227], v[120:123], v[176:179]
    ds_read_b64_tr_b16 v[236:237], v243 offset:24576
    v_mul_f32 v170, s28, v170
    v_mul_f32 v171, s28, v171
    v_mfma_f32_16x16x32_bf16 v[180:183], v[224:227], v[124:127], v[180:183]
    ds_read_b64_tr_b16 v[238:239], v243 offset:25088
    s_waitcnt lgkmcnt(4)
    v_exp_f32 v168, v168
    v_exp_f32 v169, v169
    v_mfma_f32_16x16x32_bf16 v[188:191], v[228:231], v[124:127], v[188:191]
    ds_read_b64_tr_b16 v[224:225], v240 offset:28672
    s_add_u32 m0, s29, 65536
    s_add_u32 s24, s24, s35
    buffer_load_dwordx4 v244, s[16:19], s24 offen lds
    v_add_f32 v166, 1.0, v166
    v_mfma_f32_16x16x32_bf16 v[184:187], v[228:231], v[120:123], v[184:187]
    ds_read_b64_tr_b16 v[226:227], v240 offset:29184
    s_waitcnt lgkmcnt(4)
    v_add_f32 v167, 1.0, v167
    v_cvt_pk_bf16_f32 v218, v164, v165
    v_mul_f32 v172, s28, v172
    v_mfma_f32_16x16x32_bf16 v[192:195], v[232:235], v[120:123], v[192:195]
    ds_read_b64_tr_b16 v[228:229], v241 offset:28672
    v_mul_f32 v173, s28, v173
    v_exp_f32 v170, v170
    v_mfma_f32_16x16x32_bf16 v[196:199], v[232:235], v[124:127], v[196:199]
    ds_read_b64_tr_b16 v[230:231], v241 offset:29184
    s_waitcnt lgkmcnt(4)
    v_exp_f32 v171, v171
    v_mfma_f32_16x16x32_bf16 v[204:207], v[236:239], v[124:127], v[204:207]
    ds_read_b64_tr_b16 v[232:233], v242 offset:28672
    v_add_f32 v168, 1.0, v168
    v_add_f32 v169, 1.0, v169
    v_mfma_f32_16x16x32_bf16 v[200:203], v[236:239], v[120:123], v[200:203]
    ds_read_b64_tr_b16 v[234:235], v242 offset:29184
    s_waitcnt lgkmcnt(4)
    v_cvt_pk_bf16_f32 v219, v166, v167
    v_mul_f32 v174, s28, v174
    v_mfma_f32_16x16x32_bf16 v[176:179], v[224:227], v[128:131], v[176:179]
    ds_read_b64_tr_b16 v[236:237], v243 offset:28672
    v_mul_f32 v175, s28, v175
    v_exp_f32 v172, v172
    v_mfma_f32_16x16x32_bf16 v[180:183], v[224:227], v[132:135], v[180:183]
    ds_read_b64_tr_b16 v[238:239], v243 offset:29184
    s_waitcnt lgkmcnt(4)
    v_exp_f32 v173, v173
    v_mfma_f32_16x16x32_bf16 v[188:191], v[228:231], v[132:135], v[188:191]
    ds_read_b64_tr_b16 v[224:225], v240 offset:32768
    v_add_f32 v170, 1.0, v170
    v_add_f32 v171, 1.0, v171
    v_mfma_f32_16x16x32_bf16 v[184:187], v[228:231], v[128:131], v[184:187]
    ds_read_b64_tr_b16 v[226:227], v240 offset:33280
    s_waitcnt lgkmcnt(4)
    v_add_u32 v240, 0xfffe5000, v240
    v_cvt_pk_bf16_f32 v220, v168, v169
    v_exp_f32 v174, v174
    v_mfma_f32_16x16x32_bf16 v[192:195], v[232:235], v[128:131], v[192:195]
    ds_read_b64_tr_b16 v[228:229], v241 offset:32768
    v_exp_f32 v175, v175
    v_mfma_f32_16x16x32_bf16 v[196:199], v[232:235], v[132:135], v[196:199]
    ds_read_b64_tr_b16 v[230:231], v241 offset:33280
    s_waitcnt lgkmcnt(4)
    v_add_u32 v241, 0xfffe5000, v241
    v_add_f32 v172, 1.0, v172
    v_add_f32 v173, 1.0, v173
    v_cvt_pk_bf16_f32 v221, v170, v171
    v_mfma_f32_16x16x32_bf16 v[204:207], v[236:239], v[132:135], v[204:207]
    ds_read_b64_tr_b16 v[232:233], v242 offset:32768
    v_add_f32 v174, 1.0, v174
    v_add_f32 v175, 1.0, v175
    v_mfma_f32_16x16x32_bf16 v[200:203], v[236:239], v[128:131], v[200:203]
    ds_read_b64_tr_b16 v[234:235], v242 offset:33280
    s_waitcnt lgkmcnt(4)
    v_add_u32 v242, 0xfffe5000, v242
    v_cvt_pk_bf16_f32 v222, v172, v173
    v_cvt_pk_bf16_f32 v223, v174, v175
    v_mfma_f32_16x16x32_bf16 v[176:179], v[224:227], v[136:139], v[176:179]
    ds_read_b64_tr_b16 v[236:237], v243 offset:32768
    v_mfma_f32_16x16x32_bf16 v[180:183], v[224:227], v[140:143], v[180:183]
    ds_read_b64_tr_b16 v[238:239], v243 offset:33280
    s_waitcnt lgkmcnt(4)
    v_add_u32 v243, 0xfffe5000, v243
    s_waitcnt vmcnt(0)
    s_barrier
    v_mfma_f32_16x16x32_bf16 v[188:191], v[228:231], v[140:143], v[188:191]
    ds_read_b64_tr_b16 v[224:225], v240 offset:0
    v_mfma_f32_16x16x32_bf16 v[184:187], v[228:231], v[136:139], v[184:187]
    ds_read_b64_tr_b16 v[226:227], v240 offset:512
    s_waitcnt lgkmcnt(4)
    v_mfma_f32_16x16x32_bf16 v[192:195], v[232:235], v[136:139], v[192:195]
    ds_read_b64_tr_b16 v[228:229], v241 offset:0
    v_mfma_f32_16x16x32_bf16 v[196:199], v[232:235], v[140:143], v[196:199]
    ds_read_b64_tr_b16 v[230:231], v241 offset:512
    s_waitcnt lgkmcnt(4)
    v_mfma_f32_16x16x32_bf16 v[204:207], v[236:239], v[140:143], v[204:207]
    ds_read_b64_tr_b16 v[232:233], v242 offset:0
    v_mfma_f32_16x16x32_bf16 v[200:203], v[236:239], v[136:139], v[200:203]
    ds_read_b64_tr_b16 v[234:235], v242 offset:512
    s_waitcnt lgkmcnt(4)
    s_add_u32 s32, s27, 4096
.p2align 3
L1_gu_loop:
    s_add_u32 s25, s25, 0
    s_cbranch_vccnz Lp3
    s_setprio 1
Lp3:
    v_mfma_f32_16x16x32_bf16 v[144:147], v[224:227], v[0:3], 0
    ds_read_b64_tr_b16 v[236:237], v243 offset:0
    v_mfma_f32_16x16x32_bf16 v[148:151], v[224:227], v[4:7], 0
    ds_read_b64_tr_b16 v[238:239], v243 offset:512
    s_waitcnt lgkmcnt(4)
    v_mfma_f32_16x16x32_bf16 v[156:159], v[228:231], v[4:7], 0
    ds_read_b64_tr_b16 v[224:225], v240 offset:4096
    s_add_u32 m0, s29, 73728
    s_mov_b32 s24, s25
    buffer_load_dwordx4 v244, s[20:23], s24 offen lds
    v_mfma_f32_16x16x32_bf16 v[152:155], v[228:231], v[0:3], 0
    ds_read_b64_tr_b16 v[226:227], v240 offset:4608
    s_waitcnt lgkmcnt(4)
    v_mfma_f32_16x16x32_bf16 v[160:163], v[232:235], v[0:3], 0
    ds_read_b64_tr_b16 v[228:229], v241 offset:4096
    v_lshlrev_b32 v248, 16, v208
    v_and_b32 v249, 0xffff0000, v208
    v_mfma_f32_16x16x32_bf16 v[164:167], v[232:235], v[4:7], 0
    ds_read_b64_tr_b16 v[230:231], v241 offset:4608
    s_waitcnt lgkmcnt(4)
    v_lshlrev_b32 v250, 16, v209
    v_mfma_f32_16x16x32_bf16 v[172:175], v[236:239], v[4:7], 0
    ds_read_b64_tr_b16 v[232:233], v242 offset:4096
    v_and_b32 v251, 0xffff0000, v209
    v_mfma_f32_16x16x32_bf16 v[168:171], v[236:239], v[0:3], 0
    ds_read_b64_tr_b16 v[234:235], v242 offset:4608
    s_waitcnt lgkmcnt(4)
    v_rcp_f32 v248, v248
    v_mfma_f32_16x16x32_bf16 v[144:147], v[224:227], v[8:11], v[144:147]
    ds_read_b64_tr_b16 v[236:237], v243 offset:4096
    v_mfma_f32_16x16x32_bf16 v[148:151], v[224:227], v[12:15], v[148:151]
    ds_read_b64_tr_b16 v[238:239], v243 offset:4608
    s_waitcnt lgkmcnt(4)
    v_rcp_f32 v249, v249
    v_mfma_f32_16x16x32_bf16 v[156:159], v[228:231], v[12:15], v[156:159]
    ds_read_b64_tr_b16 v[224:225], v240 offset:8192
    v_mfma_f32_16x16x32_bf16 v[152:155], v[228:231], v[8:11], v[152:155]
    ds_read_b64_tr_b16 v[226:227], v240 offset:8704
    s_waitcnt lgkmcnt(4)
    v_lshlrev_b32 v252, 16, v212
    v_mfma_f32_16x16x32_bf16 v[160:163], v[232:235], v[8:11], v[160:163]
    ds_read_b64_tr_b16 v[228:229], v241 offset:8192
    s_add_u32 m0, s29, 81920
    s_add_u32 s24, s24, s35
    buffer_load_dwordx4 v244, s[20:23], s24 offen lds
    v_and_b32 v253, 0xffff0000, v212
    v_rcp_f32 v250, v250
    v_mfma_f32_16x16x32_bf16 v[164:167], v[232:235], v[12:15], v[164:167]
    ds_read_b64_tr_b16 v[230:231], v241 offset:8704
    s_waitcnt lgkmcnt(4)
    v_mfma_f32_16x16x32_bf16 v[172:175], v[236:239], v[12:15], v[172:175]
    ds_read_b64_tr_b16 v[232:233], v242 offset:8192
    v_rcp_f32 v251, v251
    v_mfma_f32_16x16x32_bf16 v[168:171], v[236:239], v[8:11], v[168:171]
    ds_read_b64_tr_b16 v[234:235], v242 offset:8704
    s_waitcnt lgkmcnt(4)
    v_mfma_f32_16x16x32_bf16 v[144:147], v[224:227], v[16:19], v[144:147]
    ds_read_b64_tr_b16 v[236:237], v243 offset:8192
    v_mul_f32 v176, v176, v248
    v_mfma_f32_16x16x32_bf16 v[148:151], v[224:227], v[20:23], v[148:151]
    ds_read_b64_tr_b16 v[238:239], v243 offset:8704
    s_waitcnt lgkmcnt(4)
    v_mul_f32 v177, v177, v249
    v_mfma_f32_16x16x32_bf16 v[156:159], v[228:231], v[20:23], v[156:159]
    ds_read_b64_tr_b16 v[224:225], v240 offset:12288
    v_lshlrev_b32 v254, 16, v213
    v_mfma_f32_16x16x32_bf16 v[152:155], v[228:231], v[16:19], v[152:155]
    ds_read_b64_tr_b16 v[226:227], v240 offset:12800
    s_waitcnt lgkmcnt(4)
    v_and_b32 v255, 0xffff0000, v213
    v_mfma_f32_16x16x32_bf16 v[160:163], v[232:235], v[16:19], v[160:163]
    ds_read_b64_tr_b16 v[228:229], v241 offset:12288
    v_rcp_f32 v252, v252
    v_mfma_f32_16x16x32_bf16 v[164:167], v[232:235], v[20:23], v[164:167]
    ds_read_b64_tr_b16 v[230:231], v241 offset:12800
    s_waitcnt lgkmcnt(4)
    v_rcp_f32 v253, v253
    v_mfma_f32_16x16x32_bf16 v[172:175], v[236:239], v[20:23], v[172:175]
    ds_read_b64_tr_b16 v[232:233], v242 offset:12288
    s_add_u32 m0, s29, 90112
    s_add_u32 s24, s24, s35
    buffer_load_dwordx4 v244, s[20:23], s24 offen lds
    v_mfma_f32_16x16x32_bf16 v[168:171], v[236:239], v[16:19], v[168:171]
    ds_read_b64_tr_b16 v[234:235], v242 offset:12800
    s_waitcnt lgkmcnt(4)
    v_mul_f32 v178, v178, v250
    v_mfma_f32_16x16x32_bf16 v[144:147], v[224:227], v[24:27], v[144:147]
    ds_read_b64_tr_b16 v[236:237], v243 offset:12288
    v_mul_f32 v179, v179, v251
    v_mfma_f32_16x16x32_bf16 v[148:151], v[224:227], v[28:31], v[148:151]
    ds_read_b64_tr_b16 v[238:239], v243 offset:12800
    s_waitcnt lgkmcnt(4)
    v_rcp_f32 v254, v254
    v_mfma_f32_16x16x32_bf16 v[156:159], v[228:231], v[28:31], v[156:159]
    ds_read_b64_tr_b16 v[224:225], v240 offset:16384
    v_mfma_f32_16x16x32_bf16 v[152:155], v[228:231], v[24:27], v[152:155]
    ds_read_b64_tr_b16 v[226:227], v240 offset:16896
    s_waitcnt lgkmcnt(4)
    v_rcp_f32 v255, v255
    v_mfma_f32_16x16x32_bf16 v[160:163], v[232:235], v[24:27], v[160:163]
    ds_read_b64_tr_b16 v[228:229], v241 offset:16384
    v_mul_f32 v184, v184, v252
    v_mfma_f32_16x16x32_bf16 v[164:167], v[232:235], v[28:31], v[164:167]
    ds_read_b64_tr_b16 v[230:231], v241 offset:16896
    s_waitcnt lgkmcnt(4)
    v_mul_f32 v185, v185, v253
    v_mfma_f32_16x16x32_bf16 v[172:175], v[236:239], v[28:31], v[172:175]
    ds_read_b64_tr_b16 v[232:233], v242 offset:16384
    v_mul_f32 v186, v186, v254
    v_mfma_f32_16x16x32_bf16 v[168:171], v[236:239], v[24:27], v[168:171]
    ds_read_b64_tr_b16 v[234:235], v242 offset:16896
    s_waitcnt lgkmcnt(4)
    v_mul_f32 v187, v187, v255
    v_mfma_f32_16x16x32_bf16 v[144:147], v[224:227], v[32:35], v[144:147]
    ds_read_b64_tr_b16 v[236:237], v243 offset:16384
    s_add_u32 m0, s29, 98304
    s_add_u32 s24, s24, s35
    buffer_load_dwordx4 v244, s[20:23], s24 offen lds
    v_cvt_pk_bf16_f32 v176, v176, v177
    v_mfma_f32_16x16x32_bf16 v[148:151], v[224:227], v[36:39], v[148:151]
    ds_read_b64_tr_b16 v[238:239], v243 offset:16896
    s_waitcnt lgkmcnt(4)
    v_cvt_pk_bf16_f32 v177, v178, v179
    v_mfma_f32_16x16x32_bf16 v[156:159], v[228:231], v[36:39], v[156:159]
    ds_read_b64_tr_b16 v[224:225], v240 offset:20480
    v_cvt_pk_bf16_f32 v178, v184, v185
    v_mfma_f32_16x16x32_bf16 v[152:155], v[228:231], v[32:35], v[152:155]
    ds_read_b64_tr_b16 v[226:227], v240 offset:20992
    s_waitcnt lgkmcnt(4)
    v_cvt_pk_bf16_f32 v179, v186, v187
    v_mfma_f32_16x16x32_bf16 v[160:163], v[232:235], v[32:35], v[160:163]
    ds_read_b64_tr_b16 v[228:229], v241 offset:20480
    buffer_store_dwordx4 v[176:179], v246, s[12:15], s27 offen offset:0 sc1
    v_mfma_f32_16x16x32_bf16 v[164:167], v[232:235], v[36:39], v[164:167]
    ds_read_b64_tr_b16 v[230:231], v241 offset:20992
    s_waitcnt lgkmcnt(4)
    v_lshlrev_b32 v248, 16, v210
    v_and_b32 v249, 0xffff0000, v210
    v_mfma_f32_16x16x32_bf16 v[172:175], v[236:239], v[36:39], v[172:175]
    ds_read_b64_tr_b16 v[232:233], v242 offset:20480
    v_lshlrev_b32 v250, 16, v211
    v_mfma_f32_16x16x32_bf16 v[168:171], v[236:239], v[32:35], v[168:171]
    ds_read_b64_tr_b16 v[234:235], v242 offset:20992
    s_waitcnt lgkmcnt(4)
    v_and_b32 v251, 0xffff0000, v211
    v_mfma_f32_16x16x32_bf16 v[144:147], v[224:227], v[40:43], v[144:147]
    ds_read_b64_tr_b16 v[236:237], v243 offset:20480
    v_rcp_f32 v248, v248
    v_mfma_f32_16x16x32_bf16 v[148:151], v[224:227], v[44:47], v[148:151]
    ds_read_b64_tr_b16 v[238:239], v243 offset:20992
    s_waitcnt lgkmcnt(4)
    v_mfma_f32_16x16x32_bf16 v[156:159], v[228:231], v[44:47], v[156:159]
    ds_read_b64_tr_b16 v[224:225], v240 offset:24576
    s_add_u32 m0, s29, 106496
    s_add_u32 s24, s24, s35
    buffer_load_dwordx4 v244, s[20:23], s24 offen lds
    v_rcp_f32 v249, v249
    v_mfma_f32_16x16x32_bf16 v[152:155], v[228:231], v[40:43], v[152:155]
    ds_read_b64_tr_b16 v[226:227], v240 offset:25088
    s_waitcnt lgkmcnt(4)
    v_mfma_f32_16x16x32_bf16 v[160:163], v[232:235], v[40:43], v[160:163]
    ds_read_b64_tr_b16 v[228:229], v241 offset:24576
    v_lshlrev_b32 v252, 16, v214
    v_mfma_f32_16x16x32_bf16 v[164:167], v[232:235], v[44:47], v[164:167]
    ds_read_b64_tr_b16 v[230:231], v241 offset:25088
    s_waitcnt lgkmcnt(4)
    v_and_b32 v253, 0xffff0000, v214
    v_rcp_f32 v250, v250
    v_mfma_f32_16x16x32_bf16 v[172:175], v[236:239], v[44:47], v[172:175]
    ds_read_b64_tr_b16 v[232:233], v242 offset:24576
    v_mfma_f32_16x16x32_bf16 v[168:171], v[236:239], v[40:43], v[168:171]
    ds_read_b64_tr_b16 v[234:235], v242 offset:25088
    s_waitcnt lgkmcnt(4)
    v_rcp_f32 v251, v251
    v_mfma_f32_16x16x32_bf16 v[144:147], v[224:227], v[48:51], v[144:147]
    ds_read_b64_tr_b16 v[236:237], v243 offset:24576
    v_mfma_f32_16x16x32_bf16 v[148:151], v[224:227], v[52:55], v[148:151]
    ds_read_b64_tr_b16 v[238:239], v243 offset:25088
    s_waitcnt lgkmcnt(4)
    v_mul_f32 v180, v180, v248
    v_mfma_f32_16x16x32_bf16 v[156:159], v[228:231], v[52:55], v[156:159]
    ds_read_b64_tr_b16 v[224:225], v240 offset:28672
    v_mul_f32 v181, v181, v249
    v_mfma_f32_16x16x32_bf16 v[152:155], v[228:231], v[48:51], v[152:155]
    ds_read_b64_tr_b16 v[226:227], v240 offset:29184
    s_waitcnt lgkmcnt(4)
    v_lshlrev_b32 v254, 16, v215
    v_mfma_f32_16x16x32_bf16 v[160:163], v[232:235], v[48:51], v[160:163]
    ds_read_b64_tr_b16 v[228:229], v241 offset:28672
    s_add_u32 m0, s29, 114688
    s_add_u32 s24, s24, s35
    buffer_load_dwordx4 v244, s[20:23], s24 offen lds
    v_and_b32 v255, 0xffff0000, v215
    v_mfma_f32_16x16x32_bf16 v[164:167], v[232:235], v[52:55], v[164:167]
    ds_read_b64_tr_b16 v[230:231], v241 offset:29184
    s_waitcnt lgkmcnt(4)
    v_rcp_f32 v252, v252
    v_mfma_f32_16x16x32_bf16 v[172:175], v[236:239], v[52:55], v[172:175]
    ds_read_b64_tr_b16 v[232:233], v242 offset:28672
    v_rcp_f32 v253, v253
    v_mfma_f32_16x16x32_bf16 v[168:171], v[236:239], v[48:51], v[168:171]
    ds_read_b64_tr_b16 v[234:235], v242 offset:29184
    s_waitcnt lgkmcnt(4)
    v_mfma_f32_16x16x32_bf16 v[144:147], v[224:227], v[56:59], v[144:147]
    ds_read_b64_tr_b16 v[236:237], v243 offset:28672
    v_mul_f32 v182, v182, v250
    v_mfma_f32_16x16x32_bf16 v[148:151], v[224:227], v[60:63], v[148:151]
    ds_read_b64_tr_b16 v[238:239], v243 offset:29184
    s_waitcnt lgkmcnt(4)
    v_mul_f32 v183, v183, v251
    v_mfma_f32_16x16x32_bf16 v[156:159], v[228:231], v[60:63], v[156:159]
    ds_read_b64_tr_b16 v[224:225], v240 offset:32768
    v_rcp_f32 v254, v254
    v_mfma_f32_16x16x32_bf16 v[152:155], v[228:231], v[56:59], v[152:155]
    ds_read_b64_tr_b16 v[226:227], v240 offset:33280
    s_waitcnt lgkmcnt(4)
    v_add_u32 v240, 0x9000, v240
    v_mfma_f32_16x16x32_bf16 v[160:163], v[232:235], v[56:59], v[160:163]
    ds_read_b64_tr_b16 v[228:229], v241 offset:32768
    v_rcp_f32 v255, v255
    v_mfma_f32_16x16x32_bf16 v[164:167], v[232:235], v[60:63], v[164:167]
    ds_read_b64_tr_b16 v[230:231], v241 offset:33280
    s_waitcnt lgkmcnt(4)
    v_add_u32 v241, 0x9000, v241
    v_mul_f32 v188, v188, v252
    v_mfma_f32_16x16x32_bf16 v[172:175], v[236:239], v[60:63], v[172:175]
    ds_read_b64_tr_b16 v[232:233], v242 offset:32768
    s_add_u32 m0, s29, 122880
    s_add_u32 s24, s24, s35
    buffer_load_dwordx4 v244, s[20:23], s24 offen lds
    v_mul_f32 v189, v189, v253
    v_mfma_f32_16x16x32_bf16 v[168:171], v[236:239], v[56:59], v[168:171]
    ds_read_b64_tr_b16 v[234:235], v242 offset:33280
    s_waitcnt lgkmcnt(4)
    v_add_u32 v242, 0x9000, v242
    v_mul_f32 v190, v190, v254
    v_mfma_f32_16x16x32_bf16 v[144:147], v[224:227], v[64:67], v[144:147]
    ds_read_b64_tr_b16 v[236:237], v243 offset:32768
    v_mul_f32 v191, v191, v255
    v_mfma_f32_16x16x32_bf16 v[148:151], v[224:227], v[68:71], v[148:151]
    ds_read_b64_tr_b16 v[238:239], v243 offset:33280
    s_waitcnt lgkmcnt(4)
    v_add_u32 v243, 0x9000, v243
    v_cvt_pk_bf16_f32 v180, v180, v181
    v_mfma_f32_16x16x32_bf16 v[156:159], v[228:231], v[68:71], v[156:159]
    ds_read_b64_tr_b16 v[224:225], v240 offset:0
    v_cvt_pk_bf16_f32 v181, v182, v183
    v_mfma_f32_16x16x32_bf16 v[152:155], v[228:231], v[64:67], v[152:155]
    ds_read_b64_tr_b16 v[226:227], v240 offset:512
    s_waitcnt lgkmcnt(4)
    v_cvt_pk_bf16_f32 v182, v188, v189
    v_mfma_f32_16x16x32_bf16 v[160:163], v[232:235], v[64:67], v[160:163]
    ds_read_b64_tr_b16 v[228:229], v241 offset:0
    v_cvt_pk_bf16_f32 v183, v190, v191
    v_mfma_f32_16x16x32_bf16 v[164:167], v[232:235], v[68:71], v[164:167]
    ds_read_b64_tr_b16 v[230:231], v241 offset:512
    s_waitcnt lgkmcnt(4)
    buffer_store_dwordx4 v[180:183], v246, s[12:15], s27 offen offset:1024 sc1
    v_mfma_f32_16x16x32_bf16 v[172:175], v[236:239], v[68:71], v[172:175]
    ds_read_b64_tr_b16 v[232:233], v242 offset:0
    v_lshlrev_b32 v248, 16, v216
    v_and_b32 v249, 0xffff0000, v216
    v_mfma_f32_16x16x32_bf16 v[168:171], v[236:239], v[64:67], v[168:171]
    ds_read_b64_tr_b16 v[234:235], v242 offset:512
    s_waitcnt lgkmcnt(4)
    v_lshlrev_b32 v250, 16, v217
    v_mfma_f32_16x16x32_bf16 v[144:147], v[224:227], v[72:75], v[144:147]
    ds_read_b64_tr_b16 v[236:237], v243 offset:0
    s_add_u32 m0, s29, 131072
    s_add_u32 s24, s24, s35
    buffer_load_dwordx4 v244, s[20:23], s24 offen lds
    v_and_b32 v251, 0xffff0000, v217
    v_mfma_f32_16x16x32_bf16 v[148:151], v[224:227], v[76:79], v[148:151]
    ds_read_b64_tr_b16 v[238:239], v243 offset:512
    s_waitcnt lgkmcnt(4)
    v_rcp_f32 v248, v248
    v_mfma_f32_16x16x32_bf16 v[156:159], v[228:231], v[76:79], v[156:159]
    ds_read_b64_tr_b16 v[224:225], v240 offset:4096
    v_mfma_f32_16x16x32_bf16 v[152:155], v[228:231], v[72:75], v[152:155]
    ds_read_b64_tr_b16 v[226:227], v240 offset:4608
    s_waitcnt lgkmcnt(4)
    v_rcp_f32 v249, v249
    v_mfma_f32_16x16x32_bf16 v[160:163], v[232:235], v[72:75], v[160:163]
    ds_read_b64_tr_b16 v[228:229], v241 offset:4096
    v_mfma_f32_16x16x32_bf16 v[164:167], v[232:235], v[76:79], v[164:167]
    ds_read_b64_tr_b16 v[230:231], v241 offset:4608
    s_waitcnt lgkmcnt(4)
    v_lshlrev_b32 v252, 16, v220
    v_mfma_f32_16x16x32_bf16 v[172:175], v[236:239], v[76:79], v[172:175]
    ds_read_b64_tr_b16 v[232:233], v242 offset:4096
    v_and_b32 v253, 0xffff0000, v220
    v_rcp_f32 v250, v250
    v_mfma_f32_16x16x32_bf16 v[168:171], v[236:239], v[72:75], v[168:171]
    ds_read_b64_tr_b16 v[234:235], v242 offset:4608
    s_waitcnt lgkmcnt(4)
    v_mfma_f32_16x16x32_bf16 v[144:147], v[224:227], v[80:83], v[144:147]
    ds_read_b64_tr_b16 v[236:237], v243 offset:4096
    v_rcp_f32 v251, v251
    v_mfma_f32_16x16x32_bf16 v[148:151], v[224:227], v[84:87], v[148:151]
    ds_read_b64_tr_b16 v[238:239], v243 offset:4608
    s_waitcnt lgkmcnt(4)
    v_mfma_f32_16x16x32_bf16 v[156:159], v[228:231], v[84:87], v[156:159]
    ds_read_b64_tr_b16 v[224:225], v240 offset:8192
    s_add_u32 m0, s29, 139264
    s_add_u32 s24, s24, s35
    buffer_load_dwordx4 v244, s[20:23], s24 offen lds
    v_mul_f32 v192, v192, v248
    v_mfma_f32_16x16x32_bf16 v[152:155], v[228:231], v[80:83], v[152:155]
    ds_read_b64_tr_b16 v[226:227], v240 offset:8704
    s_waitcnt lgkmcnt(4)
    v_mul_f32 v193, v193, v249
    v_mfma_f32_16x16x32_bf16 v[160:163], v[232:235], v[80:83], v[160:163]
    ds_read_b64_tr_b16 v[228:229], v241 offset:8192
    v_lshlrev_b32 v254, 16, v221
    v_mfma_f32_16x16x32_bf16 v[164:167], v[232:235], v[84:87], v[164:167]
    ds_read_b64_tr_b16 v[230:231], v241 offset:8704
    s_waitcnt lgkmcnt(4)
    v_and_b32 v255, 0xffff0000, v221
    v_mfma_f32_16x16x32_bf16 v[172:175], v[236:239], v[84:87], v[172:175]
    ds_read_b64_tr_b16 v[232:233], v242 offset:8192
    v_rcp_f32 v252, v252
    v_mfma_f32_16x16x32_bf16 v[168:171], v[236:239], v[80:83], v[168:171]
    ds_read_b64_tr_b16 v[234:235], v242 offset:8704
    s_waitcnt lgkmcnt(4)
    v_rcp_f32 v253, v253
    v_mfma_f32_16x16x32_bf16 v[144:147], v[224:227], v[88:91], v[144:147]
    ds_read_b64_tr_b16 v[236:237], v243 offset:8192
    v_mfma_f32_16x16x32_bf16 v[148:151], v[224:227], v[92:95], v[148:151]
    ds_read_b64_tr_b16 v[238:239], v243 offset:8704
    s_waitcnt lgkmcnt(4)
    v_mul_f32 v194, v194, v250
    v_mfma_f32_16x16x32_bf16 v[156:159], v[228:231], v[92:95], v[156:159]
    ds_read_b64_tr_b16 v[224:225], v240 offset:12288
    v_mul_f32 v195, v195, v251
    v_mfma_f32_16x16x32_bf16 v[152:155], v[228:231], v[88:91], v[152:155]
    ds_read_b64_tr_b16 v[226:227], v240 offset:12800
    s_waitcnt lgkmcnt(4)
    v_rcp_f32 v254, v254
    v_mfma_f32_16x16x32_bf16 v[160:163], v[232:235], v[88:91], v[160:163]
    ds_read_b64_tr_b16 v[228:229], v241 offset:12288
    v_mfma_f32_16x16x32_bf16 v[164:167], v[232:235], v[92:95], v[164:167]
    ds_read_b64_tr_b16 v[230:231], v241 offset:12800
    s_waitcnt lgkmcnt(4)
    v_rcp_f32 v255, v255
    v_mfma_f32_16x16x32_bf16 v[172:175], v[236:239], v[92:95], v[172:175]
    ds_read_b64_tr_b16 v[232:233], v242 offset:12288
    v_mul_f32 v200, v200, v252
    v_mfma_f32_16x16x32_bf16 v[168:171], v[236:239], v[88:91], v[168:171]
    ds_read_b64_tr_b16 v[234:235], v242 offset:12800
    s_waitcnt lgkmcnt(4)
    v_mul_f32 v201, v201, v253
    v_mfma_f32_16x16x32_bf16 v[144:147], v[224:227], v[96:99], v[144:147]
    ds_read_b64_tr_b16 v[236:237], v243 offset:12288
    v_mul_f32 v202, v202, v254
    v_mfma_f32_16x16x32_bf16 v[148:151], v[224:227], v[100:103], v[148:151]
    ds_read_b64_tr_b16 v[238:239], v243 offset:12800
    s_waitcnt lgkmcnt(4)
    v_mul_f32 v203, v203, v255
    v_mfma_f32_16x16x32_bf16 v[156:159], v[228:231], v[100:103], v[156:159]
    ds_read_b64_tr_b16 v[224:225], v240 offset:16384
    v_cvt_pk_bf16_f32 v192, v192, v193
    v_mfma_f32_16x16x32_bf16 v[152:155], v[228:231], v[96:99], v[152:155]
    ds_read_b64_tr_b16 v[226:227], v240 offset:16896
    s_waitcnt lgkmcnt(4)
    v_cvt_pk_bf16_f32 v193, v194, v195
    v_mfma_f32_16x16x32_bf16 v[160:163], v[232:235], v[96:99], v[160:163]
    ds_read_b64_tr_b16 v[228:229], v241 offset:16384
    v_cvt_pk_bf16_f32 v194, v200, v201
    v_mfma_f32_16x16x32_bf16 v[164:167], v[232:235], v[100:103], v[164:167]
    ds_read_b64_tr_b16 v[230:231], v241 offset:16896
    s_waitcnt lgkmcnt(4)
    v_cvt_pk_bf16_f32 v195, v202, v203
    v_mfma_f32_16x16x32_bf16 v[172:175], v[236:239], v[100:103], v[172:175]
    ds_read_b64_tr_b16 v[232:233], v242 offset:16384
    buffer_store_dwordx4 v[192:195], v246, s[12:15], s32 offen offset:0 sc1
    v_mfma_f32_16x16x32_bf16 v[168:171], v[236:239], v[96:99], v[168:171]
    ds_read_b64_tr_b16 v[234:235], v242 offset:16896
    s_waitcnt lgkmcnt(4)
    v_lshlrev_b32 v248, 16, v218
    v_and_b32 v249, 0xffff0000, v218
    s_setprio 0
    v_mfma_f32_16x16x32_bf16 v[144:147], v[224:227], v[104:107], v[144:147]
    ds_read_b64_tr_b16 v[236:237], v243 offset:16384
    v_lshlrev_b32 v250, 16, v219
    v_mfma_f32_16x16x32_bf16 v[148:151], v[224:227], v[108:111], v[148:151]
    ds_read_b64_tr_b16 v[238:239], v243 offset:16896
    s_waitcnt lgkmcnt(4)
    v_and_b32 v251, 0xffff0000, v219
    v_mfma_f32_16x16x32_bf16 v[156:159], v[228:231], v[108:111], v[156:159]
    ds_read_b64_tr_b16 v[224:225], v240 offset:20480
    v_rcp_f32 v248, v248
    v_mfma_f32_16x16x32_bf16 v[152:155], v[228:231], v[104:107], v[152:155]
    ds_read_b64_tr_b16 v[226:227], v240 offset:20992
    s_waitcnt lgkmcnt(4)
    v_mfma_f32_16x16x32_bf16 v[160:163], v[232:235], v[104:107], v[160:163]
    ds_read_b64_tr_b16 v[228:229], v241 offset:20480
    v_rcp_f32 v249, v249
    v_mfma_f32_16x16x32_bf16 v[164:167], v[232:235], v[108:111], v[164:167]
    ds_read_b64_tr_b16 v[230:231], v241 offset:20992
    s_waitcnt lgkmcnt(4)
    v_mfma_f32_16x16x32_bf16 v[172:175], v[236:239], v[108:111], v[172:175]
    ds_read_b64_tr_b16 v[232:233], v242 offset:20480
    v_lshlrev_b32 v252, 16, v222
    v_mfma_f32_16x16x32_bf16 v[168:171], v[236:239], v[104:107], v[168:171]
    ds_read_b64_tr_b16 v[234:235], v242 offset:20992
    s_waitcnt lgkmcnt(4)
    v_and_b32 v253, 0xffff0000, v222
    v_rcp_f32 v250, v250
    v_mfma_f32_16x16x32_bf16 v[144:147], v[224:227], v[112:115], v[144:147]
    ds_read_b64_tr_b16 v[236:237], v243 offset:20480
    v_mfma_f32_16x16x32_bf16 v[148:151], v[224:227], v[116:119], v[148:151]
    ds_read_b64_tr_b16 v[238:239], v243 offset:20992
    s_waitcnt lgkmcnt(4)
    v_rcp_f32 v251, v251
    v_mfma_f32_16x16x32_bf16 v[156:159], v[228:231], v[116:119], v[156:159]
    ds_read_b64_tr_b16 v[224:225], v240 offset:24576
    v_mfma_f32_16x16x32_bf16 v[152:155], v[228:231], v[112:115], v[152:155]
    ds_read_b64_tr_b16 v[226:227], v240 offset:25088
    s_waitcnt lgkmcnt(4)
    v_mul_f32 v196, v196, v248
    v_mfma_f32_16x16x32_bf16 v[160:163], v[232:235], v[112:115], v[160:163]
    ds_read_b64_tr_b16 v[228:229], v241 offset:24576
    v_mul_f32 v197, v197, v249
    v_mfma_f32_16x16x32_bf16 v[164:167], v[232:235], v[116:119], v[164:167]
    ds_read_b64_tr_b16 v[230:231], v241 offset:25088
    s_waitcnt lgkmcnt(4)
    v_lshlrev_b32 v254, 16, v223
    v_mfma_f32_16x16x32_bf16 v[172:175], v[236:239], v[116:119], v[172:175]
    ds_read_b64_tr_b16 v[232:233], v242 offset:24576
    v_and_b32 v255, 0xffff0000, v223
    v_mfma_f32_16x16x32_bf16 v[168:171], v[236:239], v[112:115], v[168:171]
    ds_read_b64_tr_b16 v[234:235], v242 offset:25088
    s_waitcnt lgkmcnt(4)
    v_rcp_f32 v252, v252
    v_mfma_f32_16x16x32_bf16 v[144:147], v[224:227], v[120:123], v[144:147]
    ds_read_b64_tr_b16 v[236:237], v243 offset:24576
    v_rcp_f32 v253, v253
    v_mfma_f32_16x16x32_bf16 v[148:151], v[224:227], v[124:127], v[148:151]
    ds_read_b64_tr_b16 v[238:239], v243 offset:25088
    s_waitcnt lgkmcnt(4)
    v_mfma_f32_16x16x32_bf16 v[156:159], v[228:231], v[124:127], v[156:159]
    ds_read_b64_tr_b16 v[224:225], v240 offset:28672
    v_mul_f32 v198, v198, v250
    v_mfma_f32_16x16x32_bf16 v[152:155], v[228:231], v[120:123], v[152:155]
    ds_read_b64_tr_b16 v[226:227], v240 offset:29184
    s_waitcnt lgkmcnt(4)
    v_mul_f32 v199, v199, v251
    v_mfma_f32_16x16x32_bf16 v[160:163], v[232:235], v[120:123], v[160:163]
    ds_read_b64_tr_b16 v[228:229], v241 offset:28672
    v_rcp_f32 v254, v254
    v_mfma_f32_16x16x32_bf16 v[164:167], v[232:235], v[124:127], v[164:167]
    ds_read_b64_tr_b16 v[230:231], v241 offset:29184
    s_waitcnt lgkmcnt(4)
    v_mfma_f32_16x16x32_bf16 v[172:175], v[236:239], v[124:127], v[172:175]
    ds_read_b64_tr_b16 v[232:233], v242 offset:28672
    v_rcp_f32 v255, v255
    v_mfma_f32_16x16x32_bf16 v[168:171], v[236:239], v[120:123], v[168:171]
    ds_read_b64_tr_b16 v[234:235], v242 offset:29184
    s_waitcnt lgkmcnt(4)
    v_mul_f32 v204, v204, v252
    v_mfma_f32_16x16x32_bf16 v[144:147], v[224:227], v[128:131], v[144:147]
    ds_read_b64_tr_b16 v[236:237], v243 offset:28672
    v_mul_f32 v205, v205, v253
    v_mfma_f32_16x16x32_bf16 v[148:151], v[224:227], v[132:135], v[148:151]
    ds_read_b64_tr_b16 v[238:239], v243 offset:29184
    s_waitcnt lgkmcnt(4)
    v_mul_f32 v206, v206, v254
    v_mfma_f32_16x16x32_bf16 v[156:159], v[228:231], v[132:135], v[156:159]
    ds_read_b64_tr_b16 v[224:225], v240 offset:32768
    v_mul_f32 v207, v207, v255
    v_mfma_f32_16x16x32_bf16 v[152:155], v[228:231], v[128:131], v[152:155]
    ds_read_b64_tr_b16 v[226:227], v240 offset:33280
    s_waitcnt lgkmcnt(4)
    v_add_u32 v240, 0x9000, v240
    v_cvt_pk_bf16_f32 v196, v196, v197
    v_mfma_f32_16x16x32_bf16 v[160:163], v[232:235], v[128:131], v[160:163]
    ds_read_b64_tr_b16 v[228:229], v241 offset:32768
    v_cvt_pk_bf16_f32 v197, v198, v199
    v_mfma_f32_16x16x32_bf16 v[164:167], v[232:235], v[132:135], v[164:167]
    ds_read_b64_tr_b16 v[230:231], v241 offset:33280
    s_waitcnt lgkmcnt(4)
    v_add_u32 v241, 0x9000, v241
    v_cvt_pk_bf16_f32 v198, v204, v205
    v_mfma_f32_16x16x32_bf16 v[172:175], v[236:239], v[132:135], v[172:175]
    ds_read_b64_tr_b16 v[232:233], v242 offset:32768
    v_cvt_pk_bf16_f32 v199, v206, v207
    v_mfma_f32_16x16x32_bf16 v[168:171], v[236:239], v[128:131], v[168:171]
    ds_read_b64_tr_b16 v[234:235], v242 offset:33280
    s_waitcnt lgkmcnt(4)
    v_add_u32 v242, 0x9000, v242
    buffer_store_dwordx4 v[196:199], v246, s[12:15], s32 offen offset:1024 sc1
    v_mfma_f32_16x16x32_bf16 v[144:147], v[224:227], v[136:139], v[144:147]
    ds_read_b64_tr_b16 v[236:237], v243 offset:32768
    v_mfma_f32_16x16x32_bf16 v[148:151], v[224:227], v[140:143], v[148:151]
    ds_read_b64_tr_b16 v[238:239], v243 offset:33280
    s_waitcnt lgkmcnt(4)
    v_add_u32 v243, 0x9000, v243
    s_waitcnt vmcnt(2)
    s_barrier
    v_mfma_f32_16x16x32_bf16 v[156:159], v[228:231], v[140:143], v[156:159]
    ds_read_b64_tr_b16 v[224:225], v240 offset:0
    v_mfma_f32_16x16x32_bf16 v[152:155], v[228:231], v[136:139], v[152:155]
    ds_read_b64_tr_b16 v[226:227], v240 offset:512
    s_waitcnt lgkmcnt(4)
    v_mfma_f32_16x16x32_bf16 v[160:163], v[232:235], v[136:139], v[160:163]
    ds_read_b64_tr_b16 v[228:229], v241 offset:0
    v_mfma_f32_16x16x32_bf16 v[164:167], v[232:235], v[140:143], v[164:167]
    ds_read_b64_tr_b16 v[230:231], v241 offset:512
    s_waitcnt lgkmcnt(4)
    v_mfma_f32_16x16x32_bf16 v[172:175], v[236:239], v[140:143], v[172:175]
    ds_read_b64_tr_b16 v[232:233], v242 offset:0
    v_mfma_f32_16x16x32_bf16 v[168:171], v[236:239], v[136:139], v[168:171]
    ds_read_b64_tr_b16 v[234:235], v242 offset:512
    s_waitcnt lgkmcnt(4)
    s_add_u32 s27, s27, 8192
    s_add_u32 s25, s25, 128
    s_sub_u32 s26, s26, 1
    s_cmp_eq_u32 s26, 0
    s_cselect_b32 s18, 0, s18
    s_cselect_b32 s37, s46, 0x40000000
    s_add_u32 s37, s37, 16384
    s_cbranch_vccnz Lp4
    s_setprio 1
Lp4:
    v_mfma_f32_16x16x32_bf16 v[176:179], v[224:227], v[0:3], 0
    ds_read_b64_tr_b16 v[236:237], v243 offset:0
    v_mfma_f32_16x16x32_bf16 v[180:183], v[224:227], v[4:7], 0
    ds_read_b64_tr_b16 v[238:239], v243 offset:512
    s_waitcnt lgkmcnt(4)
    v_mfma_f32_16x16x32_bf16 v[188:191], v[228:231], v[4:7], 0
    ds_read_b64_tr_b16 v[224:225], v240 offset:4096
    s_add_u32 m0, s29, 0
    s_mov_b32 s24, s25
    buffer_load_dwordx4 v244, s[16:19], s24 offen lds
    v_mfma_f32_16x16x32_bf16 v[184:187], v[228:231], v[0:3], 0
    ds_read_b64_tr_b16 v[226:227], v240 offset:4608
    s_waitcnt lgkmcnt(4)
    v_mfma_f32_16x16x32_bf16 v[192:195], v[232:235], v[0:3], 0
    ds_read_b64_tr_b16 v[228:229], v241 offset:4096
    v_mul_f32 v144, s28, v144
    v_mul_f32 v145, s28, v145
    v_mfma_f32_16x16x32_bf16 v[196:199], v[232:235], v[4:7], 0
    ds_read_b64_tr_b16 v[230:231], v241 offset:4608
    s_waitcnt lgkmcnt(4)
    v_mul_f32 v146, s28, v146
    v_mfma_f32_16x16x32_bf16 v[204:207], v[236:239], v[4:7], 0
    ds_read_b64_tr_b16 v[232:233], v242 offset:4096
    v_mul_f32 v147, s28, v147
    v_mfma_f32_16x16x32_bf16 v[200:203], v[236:239], v[0:3], 0
    ds_read_b64_tr_b16 v[234:235], v242 offset:4608
    s_waitcnt lgkmcnt(4)
    v_exp_f32 v144, v144
    v_mfma_f32_16x16x32_bf16 v[176:179], v[224:227], v[8:11], v[176:179]
    ds_read_b64_tr_b16 v[236:237], v243 offset:4096
    v_mfma_f32_16x16x32_bf16 v[180:183], v[224:227], v[12:15], v[180:183]
    ds_read_b64_tr_b16 v[238:239], v243 offset:4608
    s_waitcnt lgkmcnt(4)
    v_exp_f32 v145, v145
    v_mfma_f32_16x16x32_bf16 v[188:191], v[228:231], v[12:15], v[188:191]
    ds_read_b64_tr_b16 v[224:225], v240 offset:8192
    v_mfma_f32_16x16x32_bf16 v[184:187], v[228:231], v[8:11], v[184:187]
    ds_read_b64_tr_b16 v[226:227], v240 offset:8704
    s_waitcnt lgkmcnt(4)
    v_mul_f32 v148, s28, v148
    v_mfma_f32_16x16x32_bf16 v[192:195], v[232:235], v[8:11], v[192:195]
    ds_read_b64_tr_b16 v[228:229], v241 offset:8192
    s_add_u32 m0, s29, 8192
    s_add_u32 s24, s24, s35
    buffer_load_dwordx4 v244, s[16:19], s24 offen lds
    v_mul_f32 v149, s28, v149
    v_mfma_f32_16x16x32_bf16 v[196:199], v[232:235], v[12:15], v[196:199]
    ds_read_b64_tr_b16 v[230:231], v241 offset:8704
    s_waitcnt lgkmcnt(4)
    v_exp_f32 v146, v146
    v_mfma_f32_16x16x32_bf16 v[204:207], v[236:239], v[12:15], v[204:207]
    ds_read_b64_tr_b16 v[232:233], v242 offset:8192
    v_mfma_f32_16x16x32_bf16 v[200:203], v[236:239], v[8:11], v[200:203]
    ds_read_b64_tr_b16 v[234:235], v242 offset:8704
    s_waitcnt lgkmcnt(4)
    v_exp_f32 v147, v147
    v_mfma_f32_16x16x32_bf16 v[176:179], v[224:227], v[16:19], v[176:179]
    ds_read_b64_tr_b16 v[236:237], v243 offset:8192
    v_add_f32 v144, 1.0, v144
    v_mfma_f32_16x16x32_bf16 v[180:183], v[224:227], v[20:23], v[180:183]
    ds_read_b64_tr_b16 v[238:239], v243 offset:8704
    s_waitcnt lgkmcnt(4)
    v_add_f32 v145, 1.0, v145
    v_mfma_f32_16x16x32_bf16 v[188:191], v[228:231], v[20:23], v[188:191]
    ds_read_b64_tr_b16 v[224:225], v240 offset:12288
    v_mul_f32 v150, s28, v150
    v_mfma_f32_16x16x32_bf16 v[184:187], v[228:231], v[16:19], v[184:187]
    ds_read_b64_tr_b16 v[226:227], v240 offset:12800
    s_waitcnt lgkmcnt(4)
    v_mul_f32 v151, s28, v151
    v_mfma_f32_16x16x32_bf16 v[192:195], v[232:235], v[16:19], v[192:195]
    ds_read_b64_tr_b16 v[228:229], v241 offset:12288
    v_exp_f32 v148, v148
    v_mfma_f32_16x16x32_bf16 v[196:199], v[232:235], v[20:23], v[196:199]
    ds_read_b64_tr_b16 v[230:231], v241 offset:12800
    s_waitcnt lgkmcnt(4)
    v_mfma_f32_16x16x32_bf16 v[204:207], v[236:239], v[20:23], v[204:207]
    ds_read_b64_tr_b16 v[232:233], v242 offset:12288
    s_add_u32 m0, s29, 16384
    s_add_u32 s24, s24, s35
    buffer_load_dwordx4 v244, s[16:19], s24 offen lds
    v_exp_f32 v149, v149
    v_mfma_f32_16x16x32_bf16 v[200:203], v[236:239], v[16:19], v[200:203]
    ds_read_b64_tr_b16 v[234:235], v242 offset:12800
    s_waitcnt lgkmcnt(4)
    v_mfma_f32_16x16x32_bf16 v[176:179], v[224:227], v[24:27], v[176:179]
    ds_read_b64_tr_b16 v[236:237], v243 offset:12288
    v_add_f32 v146, 1.0, v146
    v_mfma_f32_16x16x32_bf16 v[180:183], v[224:227], v[28:31], v[180:183]
    ds_read_b64_tr_b16 v[238:239], v243 offset:12800
    s_waitcnt lgkmcnt(4)
    v_add_f32 v147, 1.0, v147
    v_mfma_f32_16x16x32_bf16 v[188:191], v[228:231], v[28:31], v[188:191]
    ds_read_b64_tr_b16 v[224:225], v240 offset:16384
    v_cvt_pk_bf16_f32 v208, v144, v145
    v_mul_f32 v152, s28, v152
    v_mfma_f32_16x16x32_bf16 v[184:187], v[228:231], v[24:27], v[184:187]
    ds_read_b64_tr_b16 v[226:227], v240 offset:16896
    s_waitcnt lgkmcnt(4)
    v_mul_f32 v153, s28, v153
    v_mfma_f32_16x16x32_bf16 v[192:195], v[232:235], v[24:27], v[192:195]
    ds_read_b64_tr_b16 v[228:229], v241 offset:16384
    v_mov_b32 v248, s44
    v_mov_b32 v249, s45
    v_mov_b32 v250, 0
    s_waitcnt vmcnt(3)
    s_mov_b64 exec, 1
    buffer_store_dwordx2 v[248:249], v250, s[12:15], s37 offen sc1
    s_mov_b64 exec, -1
    v_exp_f32 v150, v150
    v_mfma_f32_16x16x32_bf16 v[196:199], v[232:235], v[28:31], v[196:199]
    ds_read_b64_tr_b16 v[230:231], v241 offset:16896
    s_waitcnt lgkmcnt(4)
    v_mfma_f32_16x16x32_bf16 v[204:207], v[236:239], v[28:31], v[204:207]
    ds_read_b64_tr_b16 v[232:233], v242 offset:16384
    v_exp_f32 v151, v151
    v_mfma_f32_16x16x32_bf16 v[200:203], v[236:239], v[24:27], v[200:203]
    ds_read_b64_tr_b16 v[234:235], v242 offset:16896
    s_waitcnt lgkmcnt(4)
    v_mfma_f32_16x16x32_bf16 v[176:179], v[224:227], v[32:35], v[176:179]
    ds_read_b64_tr_b16 v[236:237], v243 offset:16384
    s_add_u32 m0, s29, 24576
    s_add_u32 s24, s24, s35
    buffer_load_dwordx4 v244, s[16:19], s24 offen lds
    v_add_f32 v148, 1.0, v148
    v_mfma_f32_16x16x32_bf16 v[180:183], v[224:227], v[36:39], v[180:183]
    ds_read_b64_tr_b16 v[238:239], v243 offset:16896
    s_waitcnt lgkmcnt(4)
    v_add_f32 v149, 1.0, v149
    v_mfma_f32_16x16x32_bf16 v[188:191], v[228:231], v[36:39], v[188:191]
    ds_read_b64_tr_b16 v[224:225], v240 offset:20480
    v_cvt_pk_bf16_f32 v209, v146, v147
    v_mfma_f32_16x16x32_bf16 v[184:187], v[228:231], v[32:35], v[184:187]
    ds_read_b64_tr_b16 v[226:227], v240 offset:20992
    s_waitcnt lgkmcnt(4)
    v_mul_f32 v154, s28, v154
    v_mfma_f32_16x16x32_bf16 v[192:195], v[232:235], v[32:35], v[192:195]
    ds_read_b64_tr_b16 v[228:229], v241 offset:20480
    v_mul_f32 v155, s28, v155
    v_mfma_f32_16x16x32_bf16 v[196:199], v[232:235], v[36:39], v[196:199]
    ds_read_b64_tr_b16 v[230:231], v241 offset:20992
    s_waitcnt lgkmcnt(4)
    v_exp_f32 v152, v152
    v_mfma_f32_16x16x32_bf16 v[204:207], v[236:239], v[36:39], v[204:207]
    ds_read_b64_tr_b16 v[232:233], v242 offset:20480
    v_exp_f32 v153, v153
    v_mfma_f32_16x16x32_bf16 v[200:203], v[236:239], v[32:35], v[200:203]
    ds_read_b64_tr_b16 v[234:235], v242 offset:20992
    s_waitcnt lgkmcnt(4)
    v_mfma_f32_16x16x32_bf16 v[176:179], v[224:227], v[40:43], v[176:179]
    ds_read_b64_tr_b16 v[236:237], v243 offset:20480
    v_add_f32 v150, 1.0, v150
    v_mfma_f32_16x16x32_bf16 v[180:183], v[224:227], v[44:47], v[180:183]
    ds_read_b64_tr_b16 v[238:239], v243 offset:20992
    s_waitcnt lgkmcnt(4)
    v_add_f32 v151, 1.0, v151
    v_mfma_f32_16x16x32_bf16 v[188:191], v[228:231], v[44:47], v[188:191]
    ds_read_b64_tr_b16 v[224:225], v240 offset:24576
    s_add_u32 m0, s29, 32768
    s_add_u32 s24, s24, s35
    buffer_load_dwordx4 v244, s[16:19], s24 offen lds
    v_cvt_pk_bf16_f32 v210, v148, v149
    v_mfma_f32_16x16x32_bf16 v[184:187], v[228:231], v[40:43], v[184:187]
    ds_read_b64_tr_b16 v[226:227], v240 offset:25088
    s_waitcnt lgkmcnt(4)
    v_mul_f32 v156, s28, v156
    v_mfma_f32_16x16x32_bf16 v[192:195], v[232:235], v[40:43], v[192:195]
    ds_read_b64_tr_b16 v[228:229], v241 offset:24576
    v_mul_f32 v157, s28, v157
    v_mfma_f32_16x16x32_bf16 v[196:199], v[232:235], v[44:47], v[196:199]
    ds_read_b64_tr_b16 v[230:231], v241 offset:25088
    s_waitcnt lgkmcnt(4)
    v_exp_f32 v154, v154
    v_mfma_f32_16x16x32_bf16 v[204:207], v[236:239], v[44:47], v[204:207]
    ds_read_b64_tr_b16 v[232:233], v242 offset:24576
    v_mfma_f32_16x16x32_bf16 v[200:203], v[236:239], v[40:43], v[200:203]
    ds_read_b64_tr_b16 v[234:235], v242 offset:25088
    s_waitcnt lgkmcnt(4)
    v_exp_f32 v155, v155
    v_mfma_f32_16x16x32_bf16 v[176:179], v[224:227], v[48:51], v[176:179]
    ds_read_b64_tr_b16 v[236:237], v243 offset:24576
    v_add_f32 v152, 1.0, v152
    v_mfma_f32_16x16x32_bf16 v[180:183], v[224:227], v[52:55], v[180:183]
    ds_read_b64_tr_b16 v[238:239], v243 offset:25088
    s_waitcnt lgkmcnt(4)
    v_add_f32 v153, 1.0, v153
    v_mfma_f32_16x16x32_bf16 v[188:191], v[228:231], v[52:55], v[188:191]
    ds_read_b64_tr_b16 v[224:225], v240 offset:28672
    v_cvt_pk_bf16_f32 v211, v150, v151
    v_mfma_f32_16x16x32_bf16 v[184:187], v[228:231], v[48:51], v[184:187]
    ds_read_b64_tr_b16 v[226:227], v240 offset:29184
    s_waitcnt lgkmcnt(4)
    v_mul_f32 v158, s28, v158
    v_mfma_f32_16x16x32_bf16 v[192:195], v[232:235], v[48:51], v[192:195]
    ds_read_b64_tr_b16 v[228:229], v241 offset:28672
    s_add_u32 m0, s29, 40960
    s_add_u32 s24, s24, s35
    buffer_load_dwordx4 v244, s[16:19], s24 offen lds
    v_mul_f32 v159, s28, v159
    v_mfma_f32_16x16x32_bf16 v[196:199], v[232:235], v[52:55], v[196:199]
    ds_read_b64_tr_b16 v[230:231], v241 offset:29184
    s_waitcnt lgkmcnt(4)
    v_exp_f32 v156, v156
    v_mfma_f32_16x16x32_bf16 v[204:207], v[236:239], v[52:55], v[204:207]
    ds_read_b64_tr_b16 v[232:233], v242 offset:28672
    v_mfma_f32_16x16x32_bf16 v[200:203], v[236:239], v[48:51], v[200:203]
    ds_read_b64_tr_b16 v[234:235], v242 offset:29184
    s_waitcnt lgkmcnt(4)
    v_exp_f32 v157, v157
    v_mfma_f32_16x16x32_bf16 v[176:179], v[224:227], v[56:59], v[176:179]
    ds_read_b64_tr_b16 v[236:237], v243 offset:28672
    v_mfma_f32_16x16x32_bf16 v[180:183], v[224:227], v[60:63], v[180:183]
    ds_read_b64_tr_b16 v[238:239], v243 offset:29184
    s_waitcnt lgkmcnt(4)
    v_add_f32 v154, 1.0, v154
    v_mfma_f32_16x16x32_bf16 v[188:191], v[228:231], v[60:63], v[188:191]
    ds_read_b64_tr_b16 v[224:225], v240 offset:32768
    v_add_f32 v155, 1.0, v155
    v_mfma_f32_16x16x32_bf16 v[184:187], v[228:231], v[56:59], v[184:187]
    ds_read_b64_tr_b16 v[226:227], v240 offset:33280
    s_waitcnt lgkmcnt(4)
    v_add_u32 v240, 0x9000, v240
    v_cvt_pk_bf16_f32 v212, v152, v153
    v_mul_f32 v160, s28, v160
    v_mfma_f32_16x16x32_bf16 v[192:195], v[232:235], v[56:59], v[192:195]
    ds_read_b64_tr_b16 v[228:229], v241 offset:32768
    v_mul_f32 v161, s28, v161
    v_mfma_f32_16x16x32_bf16 v[196:199], v[232:235], v[60:63], v[196:199]
    ds_read_b64_tr_b16 v[230:231], v241 offset:33280
    s_waitcnt lgkmcnt(4)
    v_add_u32 v241, 0x9000, v241
    v_exp_f32 v158, v158
    v_mfma_f32_16x16x32_bf16 v[204:207], v[236:239], v[60:63], v[204:207]
    ds_read_b64_tr_b16 v[232:233], v242 offset:32768
    s_add_u32 m0, s29, 49152
    s_add_u32 s24, s24, s35
    buffer_load_dwordx4 v244, s[16:19], s24 offen lds
    v_mfma_f32_16x16x32_bf16 v[200:203], v[236:239], v[56:59], v[200:203]
    ds_read_b64_tr_b16 v[234:235], v242 offset:33280
    s_waitcnt lgkmcnt(4)
    v_add_u32 v242, 0x9000, v242
    v_exp_f32 v159, v159
    v_mfma_f32_16x16x32_bf16 v[176:179], v[224:227], v[64:67], v[176:179]
    ds_read_b64_tr_b16 v[236:237], v243 offset:32768
    v_mfma_f32_16x16x32_bf16 v[180:183], v[224:227], v[68:71], v[180:183]
    ds_read_b64_tr_b16 v[238:239], v243 offset:33280
    s_waitcnt lgkmcnt(4)
    v_add_u32 v243, 0x9000, v243
    v_add_f32 v156, 1.0, v156
    v_mfma_f32_16x16x32_bf16 v[188:191], v[228:231], v[68:71], v[188:191]
    ds_read_b64_tr_b16 v[224:225], v240 offset:0
    v_add_f32 v157, 1.0, v157
    v_mfma_f32_16x16x32_bf16 v[184:187], v[228:231], v[64:67], v[184:187]
    ds_read_b64_tr_b16 v[226:227], v240 offset:512
    s_waitcnt lgkmcnt(4)
    v_cvt_pk_bf16_f32 v213, v154, v155
    v_mfma_f32_16x16x32_bf16 v[192:195], v[232:235], v[64:67], v[192:195]
    ds_read_b64_tr_b16 v[228:229], v241 offset:0
    v_mul_f32 v162, s28, v162
    v_mfma_f32_16x16x32_bf16 v[196:199], v[232:235], v[68:71], v[196:199]
    ds_read_b64_tr_b16 v[230:231], v241 offset:512
    s_waitcnt lgkmcnt(4)
    v_mul_f32 v163, s28, v163
    v_mfma_f32_16x16x32_bf16 v[204:207], v[236:239], v[68:71], v[204:207]
    ds_read_b64_tr_b16 v[232:233], v242 offset:0
    v_exp_f32 v160, v160
    v_mfma_f32_16x16x32_bf16 v[200:203], v[236:239], v[64:67], v[200:203]
    ds_read_b64_tr_b16 v[234:235], v242 offset:512
    s_waitcnt lgkmcnt(4)
    v_exp_f32 v161, v161
    v_mfma_f32_16x16x32_bf16 v[176:179], v[224:227], v[72:75], v[176:179]
    ds_read_b64_tr_b16 v[236:237], v243 offset:0
    s_add_u32 m0, s29, 57344
    s_add_u32 s24, s24, s35
    buffer_load_dwordx4 v244, s[16:19], s24 offen lds
    v_mfma_f32_16x16x32_bf16 v[180:183], v[224:227], v[76:79], v[180:183]
    ds_read_b64_tr_b16 v[238:239], v243 offset:512
    s_waitcnt lgkmcnt(4)
    v_add_f32 v158, 1.0, v158
    v_mfma_f32_16x16x32_bf16 v[188:191], v[228:231], v[76:79], v[188:191]
    ds_read_b64_tr_b16 v[224:225], v240 offset:4096
    v_add_f32 v159, 1.0, v159
    v_mfma_f32_16x16x32_bf16 v[184:187], v[228:231], v[72:75], v[184:187]
    ds_read_b64_tr_b16 v[226:227], v240 offset:4608
    s_waitcnt lgkmcnt(4)
    v_cvt_pk_bf16_f32 v214, v156, v157
    v_mfma_f32_16x16x32_bf16 v[192:195], v[232:235], v[72:75], v[192:195]
    ds_read_b64_tr_b16 v[228:229], v241 offset:4096
    v_mul_f32 v164, s28, v164
    v_mfma_f32_16x16x32_bf16 v[196:199], v[232:235], v[76:79], v[196:199]
    ds_read_b64_tr_b16 v[230:231], v241 offset:4608
    s_waitcnt lgkmcnt(4)
    v_mul_f32 v165, s28, v165
    v_mfma_f32_16x16x32_bf16 v[204:207], v[236:239], v[76:79], v[204:207]
    ds_read_b64_tr_b16 v[232:233], v242 offset:4096
    s_mov_b32 s47, 40396800
    buffer_load_dwordx2 v[252:253], v245, s[12:15], s47 offen sc1
    s_lshr_b32 s47, s3, 2
    s_or_b32 s47, s47, s26
    v_exp_f32 v162, v162
    v_mfma_f32_16x16x32_bf16 v[200:203], v[236:239], v[72:75], v[200:203]
    ds_read_b64_tr_b16 v[234:235], v242 offset:4608
    s_waitcnt lgkmcnt(4)
    v_mfma_f32_16x16x32_bf16 v[176:179], v[224:227], v[80:83], v[176:179]
    ds_read_b64_tr_b16 v[236:237], v243 offset:4096
    v_exp_f32 v163, v163
    v_mfma_f32_16x16x32_bf16 v[180:183], v[224:227], v[84:87], v[180:183]
    ds_read_b64_tr_b16 v[238:239], v243 offset:4608
    s_waitcnt lgkmcnt(4)
    v_add_f32 v160, 1.0, v160
    v_mfma_f32_16x16x32_bf16 v[188:191], v[228:231], v[84:87], v[188:191]
    ds_read_b64_tr_b16 v[224:225], v240 offset:8192
    s_add_u32 m0, s29, 65536
    s_add_u32 s24, s24, s35
    buffer_load_dwordx4 v244, s[16:19], s24 offen lds
    v_add_f32 v161, 1.0, v161
    v_mfma_f32_16x16x32_bf16 v[184:187], v[228:231], v[80:83], v[184:187]
    ds_read_b64_tr_b16 v[226:227], v240 offset:8704
    s_waitcnt lgkmcnt(4)
    v_cvt_pk_bf16_f32 v215, v158, v159
    v_mfma_f32_16x16x32_bf16 v[192:195], v[232:235], v[80:83], v[192:195]
    ds_read_b64_tr_b16 v[228:229], v241 offset:8192
    v_mul_f32 v166, s28, v166
    v_mfma_f32_16x16x32_bf16 v[196:199], v[232:235], v[84:87], v[196:199]
    ds_read_b64_tr_b16 v[230:231], v241 offset:8704
    s_waitcnt lgkmcnt(4)
    v_mul_f32 v167, s28, v167
    v_mfma_f32_16x16x32_bf16 v[204:207], v[236:239], v[84:87], v[204:207]
    ds_read_b64_tr_b16 v[232:233], v242 offset:8192
    v_exp_f32 v164, v164
    v_mfma_f32_16x16x32_bf16 v[200:203], v[236:239], v[80:83], v[200:203]
    ds_read_b64_tr_b16 v[234:235], v242 offset:8704
    s_waitcnt lgkmcnt(4)
    v_mfma_f32_16x16x32_bf16 v[176:179], v[224:227], v[88:91], v[176:179]
    ds_read_b64_tr_b16 v[236:237], v243 offset:8192
    v_exp_f32 v165, v165
    v_mfma_f32_16x16x32_bf16 v[180:183], v[224:227], v[92:95], v[180:183]
    ds_read_b64_tr_b16 v[238:239], v243 offset:8704
    s_waitcnt lgkmcnt(4)
    v_mfma_f32_16x16x32_bf16 v[188:191], v[228:231], v[92:95], v[188:191]
    ds_read_b64_tr_b16 v[224:225], v240 offset:12288
    v_add_f32 v162, 1.0, v162
    v_mfma_f32_16x16x32_bf16 v[184:187], v[228:231], v[88:91], v[184:187]
    ds_read_b64_tr_b16 v[226:227], v240 offset:12800
    s_waitcnt lgkmcnt(4)
    v_add_f32 v163, 1.0, v163
    v_mfma_f32_16x16x32_bf16 v[192:195], v[232:235], v[88:91], v[192:195]
    ds_read_b64_tr_b16 v[228:229], v241 offset:12288
    v_cvt_pk_bf16_f32 v216, v160, v161
    v_mul_f32 v168, s28, v168
    v_mfma_f32_16x16x32_bf16 v[196:199], v[232:235], v[92:95], v[196:199]
    ds_read_b64_tr_b16 v[230:231], v241 offset:12800
    s_waitcnt lgkmcnt(4)
    v_mul_f32 v169, s28, v169
    v_mfma_f32_16x16x32_bf16 v[204:207], v[236:239], v[92:95], v[204:207]
    ds_read_b64_tr_b16 v[232:233], v242 offset:12288
    v_exp_f32 v166, v166
    v_mfma_f32_16x16x32_bf16 v[200:203], v[236:239], v[88:91], v[200:203]
    ds_read_b64_tr_b16 v[234:235], v242 offset:12800
    s_waitcnt lgkmcnt(4)
    v_mfma_f32_16x16x32_bf16 v[176:179], v[224:227], v[96:99], v[176:179]
    ds_read_b64_tr_b16 v[236:237], v243 offset:12288
    v_exp_f32 v167, v167
    v_mfma_f32_16x16x32_bf16 v[180:183], v[224:227], v[100:103], v[180:183]
    ds_read_b64_tr_b16 v[238:239], v243 offset:12800
    s_waitcnt lgkmcnt(4)
    v_mfma_f32_16x16x32_bf16 v[188:191], v[228:231], v[100:103], v[188:191]
    ds_read_b64_tr_b16 v[224:225], v240 offset:16384
    v_add_f32 v164, 1.0, v164
    v_mfma_f32_16x16x32_bf16 v[184:187], v[228:231], v[96:99], v[184:187]
    ds_read_b64_tr_b16 v[226:227], v240 offset:16896
    s_waitcnt lgkmcnt(4)
    v_add_f32 v165, 1.0, v165
    v_mfma_f32_16x16x32_bf16 v[192:195], v[232:235], v[96:99], v[192:195]
    ds_read_b64_tr_b16 v[228:229], v241 offset:16384
    v_cvt_pk_bf16_f32 v217, v162, v163
    v_mfma_f32_16x16x32_bf16 v[196:199], v[232:235], v[100:103], v[196:199]
    ds_read_b64_tr_b16 v[230:231], v241 offset:16896
    s_waitcnt lgkmcnt(4)
    v_mul_f32 v170, s28, v170
    v_mfma_f32_16x16x32_bf16 v[204:207], v[236:239], v[100:103], v[204:207]
    ds_read_b64_tr_b16 v[232:233], v242 offset:16384
    v_mul_f32 v171, s28, v171
    v_mfma_f32_16x16x32_bf16 v[200:203], v[236:239], v[96:99], v[200:203]
    ds_read_b64_tr_b16 v[234:235], v242 offset:16896
    s_waitcnt lgkmcnt(4)
    v_exp_f32 v168, v168
    s_setprio 0
    v_mfma_f32_16x16x32_bf16 v[176:179], v[224:227], v[104:107], v[176:179]
    ds_read_b64_tr_b16 v[236:237], v243 offset:16384
    v_exp_f32 v169, v169
    v_mfma_f32_16x16x32_bf16 v[180:183], v[224:227], v[108:111], v[180:183]
    ds_read_b64_tr_b16 v[238:239], v243 offset:16896
    s_waitcnt lgkmcnt(4)
    s_cmp_eq_u32 s47, 0
    s_cbranch_scc1 L2_side
L1_side_back:
    v_mfma_f32_16x16x32_bf16 v[188:191], v[228:231], v[108:111], v[188:191]
    ds_read_b64_tr_b16 v[224:225], v240 offset:20480
    v_add_f32 v166, 1.0, v166
    v_mfma_f32_16x16x32_bf16 v[184:187], v[228:231], v[104:107], v[184:187]
    ds_read_b64_tr_b16 v[226:227], v240 offset:20992
    s_waitcnt lgkmcnt(4)
    v_add_f32 v167, 1.0, v167
    v_mfma_f32_16x16x32_bf16 v[192:195], v[232:235], v[104:107], v[192:195]
    ds_read_b64_tr_b16 v[228:229], v241 offset:20480
    v_cvt_pk_bf16_f32 v218, v164, v165
    v_mfma_f32_16x16x32_bf16 v[196:199], v[232:235], v[108:111], v[196:199]
    ds_read_b64_tr_b16 v[230:231], v241 offset:20992
    s_waitcnt lgkmcnt(4)
    v_mul_f32 v172, s28, v172
    v_mfma_f32_16x16x32_bf16 v[204:207], v[236:239], v[108:111], v[204:207]
    ds_read_b64_tr_b16 v[232:233], v242 offset:20480
    v_mul_f32 v173, s28, v173
    v_mfma_f32_16x16x32_bf16 v[200:203], v[236:239], v[104:107], v[200:203]
    ds_read_b64_tr_b16 v[234:235], v242 offset:20992
    s_waitcnt lgkmcnt(4)
    v_exp_f32 v170, v170
    v_mfma_f32_16x16x32_bf16 v[176:179], v[224:227], v[112:115], v[176:179]
    ds_read_b64_tr_b16 v[236:237], v243 offset:20480
    v_mfma_f32_16x16x32_bf16 v[180:183], v[224:227], v[116:119], v[180:183]
    ds_read_b64_tr_b16 v[238:239], v243 offset:20992
    s_waitcnt lgkmcnt(4)
    v_exp_f32 v171, v171
    v_mfma_f32_16x16x32_bf16 v[188:191], v[228:231], v[116:119], v[188:191]
    ds_read_b64_tr_b16 v[224:225], v240 offset:24576
    v_add_f32 v168, 1.0, v168
    v_mfma_f32_16x16x32_bf16 v[184:187], v[228:231], v[112:115], v[184:187]
    ds_read_b64_tr_b16 v[226:227], v240 offset:25088
    s_waitcnt lgkmcnt(4)
    v_add_f32 v169, 1.0, v169
    v_mfma_f32_16x16x32_bf16 v[192:195], v[232:235], v[112:115], v[192:195]
    ds_read_b64_tr_b16 v[228:229], v241 offset:24576
    v_cvt_pk_bf16_f32 v219, v166, v167
    v_mfma_f32_16x16x32_bf16 v[196:199], v[232:235], v[116:119], v[196:199]
    ds_read_b64_tr_b16 v[230:231], v241 offset:25088
    s_waitcnt lgkmcnt(4)
    v_mul_f32 v174, s28, v174
    v_mfma_f32_16x16x32_bf16 v[204:207], v[236:239], v[116:119], v[204:207]
    ds_read_b64_tr_b16 v[232:233], v242 offset:24576
    v_mul_f32 v175, s28, v175
    v_mfma_f32_16x16x32_bf16 v[200:203], v[236:239], v[112:115], v[200:203]
    ds_read_b64_tr_b16 v[234:235], v242 offset:25088
    s_waitcnt lgkmcnt(4)
    v_exp_f32 v172, v172
    v_mfma_f32_16x16x32_bf16 v[176:179], v[224:227], v[120:123], v[176:179]
    ds_read_b64_tr_b16 v[236:237], v243 offset:24576
    v_mfma_f32_16x16x32_bf16 v[180:183], v[224:227], v[124:127], v[180:183]
    ds_read_b64_tr_b16 v[238:239], v243 offset:25088
    s_waitcnt lgkmcnt(4)
    v_exp_f32 v173, v173
    v_mfma_f32_16x16x32_bf16 v[188:191], v[228:231], v[124:127], v[188:191]
    ds_read_b64_tr_b16 v[224:225], v240 offset:28672
    v_mfma_f32_16x16x32_bf16 v[184:187], v[228:231], v[120:123], v[184:187]
    ds_read_b64_tr_b16 v[226:227], v240 offset:29184
    s_waitcnt lgkmcnt(4)
    v_add_f32 v170, 1.0, v170
    v_mfma_f32_16x16x32_bf16 v[192:195], v[232:235], v[120:123], v[192:195]
    ds_read_b64_tr_b16 v[228:229], v241 offset:28672
    v_add_f32 v171, 1.0, v171
    v_mfma_f32_16x16x32_bf16 v[196:199], v[232:235], v[124:127], v[196:199]
    ds_read_b64_tr_b16 v[230:231], v241 offset:29184
    s_waitcnt lgkmcnt(4)
    v_cvt_pk_bf16_f32 v220, v168, v169
    v_exp_f32 v174, v174
    v_mfma_f32_16x16x32_bf16 v[204:207], v[236:239], v[124:127], v[204:207]
    ds_read_b64_tr_b16 v[232:233], v242 offset:28672
    v_mfma_f32_16x16x32_bf16 v[200:203], v[236:239], v[120:123], v[200:203]
    ds_read_b64_tr_b16 v[234:235], v242 offset:29184
    s_waitcnt lgkmcnt(4)
    v_exp_f32 v175, v175
    v_mfma_f32_16x16x32_bf16 v[176:179], v[224:227], v[128:131], v[176:179]
    ds_read_b64_tr_b16 v[236:237], v243 offset:28672
    v_mfma_f32_16x16x32_bf16 v[180:183], v[224:227], v[132:135], v[180:183]
    ds_read_b64_tr_b16 v[238:239], v243 offset:29184
    s_waitcnt lgkmcnt(4)
    v_add_f32 v172, 1.0, v172
    v_mfma_f32_16x16x32_bf16 v[188:191], v[228:231], v[132:135], v[188:191]
    ds_read_b64_tr_b16 v[224:225], v240 offset:32768
    v_add_f32 v173, 1.0, v173
    v_mfma_f32_16x16x32_bf16 v[184:187], v[228:231], v[128:131], v[184:187]
    ds_read_b64_tr_b16 v[226:227], v240 offset:33280
    s_waitcnt lgkmcnt(4)
    v_add_u32 v240, 0xfffe5000, v240
    v_cvt_pk_bf16_f32 v221, v170, v171
    v_mfma_f32_16x16x32_bf16 v[192:195], v[232:235], v[128:131], v[192:195]
    ds_read_b64_tr_b16 v[228:229], v241 offset:32768
    v_add_f32 v174, 1.0, v174
    v_mfma_f32_16x16x32_bf16 v[196:199], v[232:235], v[132:135], v[196:199]
    ds_read_b64_tr_b16 v[230:231], v241 offset:33280
    s_waitcnt lgkmcnt(4)
    v_add_u32 v241, 0xfffe5000, v241
    v_add_f32 v175, 1.0, v175
    v_mfma_f32_16x16x32_bf16 v[204:207], v[236:239], v[132:135], v[204:207]
    ds_read_b64_tr_b16 v[232:233], v242 offset:32768
    v_cvt_pk_bf16_f32 v222, v172, v173
    v_mfma_f32_16x16x32_bf16 v[200:203], v[236:239], v[128:131], v[200:203]
    ds_read_b64_tr_b16 v[234:235], v242 offset:33280
    s_waitcnt lgkmcnt(4)
    v_add_u32 v242, 0xfffe5000, v242
    v_cvt_pk_bf16_f32 v223, v174, v175
    v_mfma_f32_16x16x32_bf16 v[176:179], v[224:227], v[136:139], v[176:179]
    ds_read_b64_tr_b16 v[236:237], v243 offset:32768
    v_mfma_f32_16x16x32_bf16 v[180:183], v[224:227], v[140:143], v[180:183]
    ds_read_b64_tr_b16 v[238:239], v243 offset:33280
    s_waitcnt lgkmcnt(4)
    v_add_u32 v243, 0xfffe5000, v243
    s_waitcnt vmcnt(0)
    s_barrier
    v_mfma_f32_16x16x32_bf16 v[188:191], v[228:231], v[140:143], v[188:191]
    ds_read_b64_tr_b16 v[224:225], v240 offset:0
    v_mfma_f32_16x16x32_bf16 v[184:187], v[228:231], v[136:139], v[184:187]
    ds_read_b64_tr_b16 v[226:227], v240 offset:512
    s_waitcnt lgkmcnt(4)
    v_mfma_f32_16x16x32_bf16 v[192:195], v[232:235], v[136:139], v[192:195]
    ds_read_b64_tr_b16 v[228:229], v241 offset:0
    v_mfma_f32_16x16x32_bf16 v[196:199], v[232:235], v[140:143], v[196:199]
    ds_read_b64_tr_b16 v[230:231], v241 offset:512
    s_waitcnt lgkmcnt(4)
    v_mfma_f32_16x16x32_bf16 v[204:207], v[236:239], v[140:143], v[204:207]
    ds_read_b64_tr_b16 v[232:233], v242 offset:0
    v_mfma_f32_16x16x32_bf16 v[200:203], v[236:239], v[136:139], v[200:203]
    ds_read_b64_tr_b16 v[234:235], v242 offset:512
    s_waitcnt lgkmcnt(4)
    s_add_u32 s32, s27, 4096
    s_cmp_lg_u32 s26, 0
    s_cbranch_scc1 L1_gu_loop
L1_gu_tail:
    s_setprio 0
    s_cmp_ge_u32 s3, 4
    s_cbranch_scc1 L2e_gu_g
    s_mov_b32 s47, 40396800
    v_lshlrev_b32 v8, 4, v247
    s_mov_b32 s31, 400000
L2e_gu_pq:
    buffer_load_dwordx2 v[0:1], v8, s[12:15], s47 offen sc1
    s_waitcnt vmcnt(0)
    v_cmp_ne_u64 vcc, s[44:45], v[0:1]
    s_nop 1
    s_and_b64 vcc, vcc, exec
    s_cbranch_scc0 L2e_gu_pq_ok
    s_sleep 4
    s_sub_u32 s31, s31, 1
    s_cmp_lg_u32 s31, 0
    s_cbranch_scc1 L2e_gu_pq
L2e_gu_pq_ok:
    v_mov_b32 v7, v247
    v_lshlrev_b32 v8, 4, v247
    s_lshl_b32 s63, s41, 2
    s_lshr_b32 s30, s42, 3
    s_add_u32 s63, s63, s30
    s_and_b32 s62, s42, 7
    v_and_b32 v1, 31, v7
    v_lshrrev_b32 v2, 5, v7
    v_lshlrev_b32 v10, 2, v1
    v_lshl_add_u32 v10, v2, 30, v10
    s_lshl_b32 s48, s63, 16
    s_lshl_b32 s50, s62, 13
    s_add_u32 s50, s50, s48
    s_add_u32 s50, s50, 10485760
    s_lshl_b32 s49, s63, 13
    s_lshl_b32 s51, s62, 10
    s_add_u32 s51, s51, s49
    s_add_u32 s51, s51, 14680064
    s_add_u32 s20, s48, 12582912
    s_add_u32 s21, s49, 14942208
    buffer_load_dwordx4 v[40:43], v8, s[12:15], s20 offen sc1
    buffer_load_dword v44, v10, s[12:15], s21 offen sc1
    buffer_load_dwordx4 v[48:51], v8, s[12:15], s50 offen offset:0 sc1
    buffer_load_dword v80, v10, s[12:15], s51 offen offset:0 sc1
    buffer_load_dwordx4 v[52:55], v8, s[12:15], s50 offen offset:1024 sc1
    buffer_load_dword v82, v10, s[12:15], s51 offen offset:128 sc1
    buffer_load_dwordx4 v[56:59], v8, s[12:15], s50 offen offset:2048 sc1
    buffer_load_dword v84, v10, s[12:15], s51 offen offset:256 sc1
    buffer_load_dwordx4 v[60:63], v8, s[12:15], s50 offen offset:3072 sc1
    buffer_load_dword v86, v10, s[12:15], s51 offen offset:384 sc1
    s_add_u32 s50, s50, 4096
    buffer_load_dwordx4 v[64:67], v8, s[12:15], s50 offen offset:0 sc1
    buffer_load_dword v88, v10, s[12:15], s51 offen offset:512 sc1
    buffer_load_dwordx4 v[68:71], v8, s[12:15], s50 offen offset:1024 sc1
    buffer_load_dword v90, v10, s[12:15], s51 offen offset:640 sc1
    buffer_load_dwordx4 v[72:75], v8, s[12:15], s50 offen offset:2048 sc1
    buffer_load_dword v92, v10, s[12:15], s51 offen offset:768 sc1
    buffer_load_dwordx4 v[76:79], v8, s[12:15], s50 offen offset:3072 sc1
    buffer_load_dword v94, v10, s[12:15], s51 offen offset:896 sc1
    s_lshl_b32 s36, s3, 14
    s_add_u32 s20, s48, s36
    s_add_u32 s20, s20, 12582912
    s_lshl_b32 s36, s3, 11
    s_add_u32 s21, s49, s36
    s_add_u32 s21, s21, 14942208
    s_mul_i32 s22, s63, 81920
    s_mul_i32 s36, s3, 20480
    s_add_u32 s22, s22, s36
    s_add_u32 s22, s22, 15728640
    buffer_load_dwordx4 v[12:15], v8, s[12:15], s20 offen sc1
    buffer_load_dword v24, v10, s[12:15], s21 offen sc1
    s_add_u32 s20, s20, 1024
    s_add_u32 s21, s21, 128
    v_mul_u32_u24 v9, 320, v2
    v_lshl_add_u32 v9, v1, 4, v9
    s_mov_b32 s60, 0x3ffff
    s_mov_b32 s61, 0x3ffff
    v_cmp_eq_u32 vcc, 18, v1
    v_mov_b32 v3, 0x3f803f80
    s_mov_b32 s24, 0
    s_mov_b32 s25, 0
    v_cndmask_b32 v16, 0, v3, vcc
    v_cndmask_b32 v17, 0, v3, vcc
    v_cndmask_b32 v18, 0, v3, vcc
    v_cndmask_b32 v19, 0, v3, vcc
    v_cndmask_b32 v20, 0, v3, vcc
    v_cndmask_b32 v21, 0, v3, vcc
    v_cndmask_b32 v22, 0, v3, vcc
    v_cndmask_b32 v23, 0, v3, vcc
    v_cndmask_b32 v30, 0, v3, vcc
    v_cndmask_b32 v31, 0, v3, vcc
    v_cndmask_b32 v32, 0, v3, vcc
    v_cndmask_b32 v33, 0, v3, vcc
    v_cndmask_b32 v34, 0, v3, vcc
    v_cndmask_b32 v35, 0, v3, vcc
    v_cndmask_b32 v36, 0, v3, vcc
    v_cndmask_b32 v37, 0, v3, vcc
    s_mov_b64 exec, s[60:61]
    buffer_load_dwordx4 v[16:19], v9, s[12:15], s22 offen sc1
    buffer_load_dwordx4 v[20:23], v9, s[12:15], s22 offen offset:640 sc1
    s_mov_b64 exec, -1
    s_add_u32 s22, s22, 1280
    buffer_load_dwordx4 v[26:29], v8, s[12:15], s20 offen sc1
    buffer_load_dword v38, v10, s[12:15], s21 offen sc1
    s_add_u32 s20, s20, 1024
    s_add_u32 s21, s21, 128
    v_cmp_gt_u32 vcc, 32, v7
    v_mov_b32 v4, 0
    v_mov_b32 v5, 0
    v_mov_b32 v45, 0
    v_cndmask_b32 v25, 0, v3, vcc
    v_cndmask_b32 v39, 0, v3, vcc
    v_mov_b32 v81, 0
    v_mov_b32 v83, 0
    v_mov_b32 v85, 0
    v_mov_b32 v87, 0
    v_mov_b32 v89, 0
    v_mov_b32 v91, 0
    v_mov_b32 v93, 0
    v_mov_b32 v95, 0
    v_mov_b32 v0, s44
    v_mov_b32 v1, s45
    v_mov_b32 v2, 0
    s_branch L2e_gu_done
L2e_gu_g:
    s_setprio 2
    v_mov_b32 v7, v247
    v_lshlrev_b32 v4, 4, v247
L2e_gu_done:
    s_nop 3
    v_lshlrev_b32 v248, 16, v208
    v_and_b32 v249, 0xffff0000, v208
    v_lshlrev_b32 v250, 16, v209
    v_and_b32 v251, 0xffff0000, v209
    v_rcp_f32 v248, v248
    v_rcp_f32 v249, v249
    v_lshlrev_b32 v252, 16, v212
    v_and_b32 v253, 0xffff0000, v212
    v_rcp_f32 v250, v250
    v_rcp_f32 v251, v251
    v_pk_mul_f32 v[176:177], v[176:177], v[248:249]
    v_lshlrev_b32 v254, 16, v213
    v_and_b32 v255, 0xffff0000, v213
    v_rcp_f32 v252, v252
    v_rcp_f32 v253, v253
    v_pk_mul_f32 v[178:179], v[178:179], v[250:251]
    v_rcp_f32 v254, v254
    v_rcp_f32 v255, v255
    v_pk_mul_f32 v[184:185], v[184:185], v[252:253]
    v_pk_mul_f32 v[186:187], v[186:187], v[254:255]
    v_cvt_pk_bf16_f32 v176, v176, v177
    v_cvt_pk_bf16_f32 v177, v178, v179
    v_cvt_pk_bf16_f32 v178, v184, v185
    v_cvt_pk_bf16_f32 v179, v186, v187
    buffer_store_dwordx4 v[176:179], v246, s[12:15], s27 offen offset:0 sc1
    v_lshlrev_b32 v248, 16, v210
    v_and_b32 v249, 0xffff0000, v210
    v_lshlrev_b32 v250, 16, v211
    v_and_b32 v251, 0xffff0000, v211
    v_rcp_f32 v248, v248
    v_rcp_f32 v249, v249
    v_lshlrev_b32 v252, 16, v214
    v_and_b32 v253, 0xffff0000, v214
    v_rcp_f32 v250, v250
    v_rcp_f32 v251, v251
    v_pk_mul_f32 v[180:181], v[180:181], v[248:249]
    v_lshlrev_b32 v254, 16, v215
    v_and_b32 v255, 0xffff0000, v215
    v_rcp_f32 v252, v252
    v_rcp_f32 v253, v253
    v_pk_mul_f32 v[182:183], v[182:183], v[250:251]
    v_rcp_f32 v254, v254
    v_rcp_f32 v255, v255
    v_pk_mul_f32 v[188:189], v[188:189], v[252:253]
    v_pk_mul_f32 v[190:191], v[190:191], v[254:255]
    v_cvt_pk_bf16_f32 v180, v180, v181
    v_cvt_pk_bf16_f32 v181, v182, v183
    v_cvt_pk_bf16_f32 v182, v188, v189
    v_cvt_pk_bf16_f32 v183, v190, v191
    buffer_store_dwordx4 v[180:183], v246, s[12:15], s27 offen offset:1024 sc1
    v_lshlrev_b32 v248, 16, v216
    v_and_b32 v249, 0xffff0000, v216
    v_lshlrev_b32 v250, 16, v217
    v_and_b32 v251, 0xffff0000, v217
    v_rcp_f32 v248, v248
    v_rcp_f32 v249, v249
    v_lshlrev_b32 v252, 16, v220
    v_and_b32 v253, 0xffff0000, v220
    v_rcp_f32 v250, v250
    v_rcp_f32 v251, v251
    v_pk_mul_f32 v[192:193], v[192:193], v[248:249]
    v_lshlrev_b32 v254, 16, v221
    v_and_b32 v255, 0xffff0000, v221
    v_rcp_f32 v252, v252
    v_rcp_f32 v253, v253
    v_pk_mul_f32 v[194:195], v[194:195], v[250:251]
    v_rcp_f32 v254, v254
    v_rcp_f32 v255, v255
    v_pk_mul_f32 v[200:201], v[200:201], v[252:253]
    v_pk_mul_f32 v[202:203], v[202:203], v[254:255]
    v_cvt_pk_bf16_f32 v192, v192, v193
    v_cvt_pk_bf16_f32 v193, v194, v195
    v_cvt_pk_bf16_f32 v194, v200, v201
    v_cvt_pk_bf16_f32 v195, v202, v203
    buffer_store_dwordx4 v[192:195], v246, s[12:15], s32 offen offset:0 sc1
    v_lshlrev_b32 v248, 16, v218
    v_and_b32 v249, 0xffff0000, v218
    v_lshlrev_b32 v250, 16, v219
    v_and_b32 v251, 0xffff0000, v219
    v_rcp_f32 v248, v248
    v_rcp_f32 v249, v249
    v_lshlrev_b32 v252, 16, v222
    v_and_b32 v253, 0xffff0000, v222
    v_rcp_f32 v250, v250
    v_rcp_f32 v251, v251
    v_pk_mul_f32 v[196:197], v[196:197], v[248:249]
    v_lshlrev_b32 v254, 16, v223
    v_and_b32 v255, 0xffff0000, v223
    v_rcp_f32 v252, v252
    v_rcp_f32 v253, v253
    v_pk_mul_f32 v[198:199], v[198:199], v[250:251]
    v_rcp_f32 v254, v254
    v_rcp_f32 v255, v255
    v_pk_mul_f32 v[204:205], v[204:205], v[252:253]
    v_pk_mul_f32 v[206:207], v[206:207], v[254:255]
    v_cvt_pk_bf16_f32 v196, v196, v197
    v_cvt_pk_bf16_f32 v197, v198, v199
    v_cvt_pk_bf16_f32 v198, v204, v205
    v_cvt_pk_bf16_f32 v199, v206, v207
    buffer_store_dwordx4 v[196:199], v246, s[12:15], s32 offen offset:1024 sc1
    s_waitcnt lgkmcnt(0)
    s_cmp_ge_u32 s3, 4
    s_cbranch_scc1 L2_gemm
    s_branch L2_att
L2_side:
    s_waitcnt vmcnt(1)
    v_cmp_ne_u64 vcc, s[44:45], v[252:253]
    s_nop 1
    s_and_b64 vcc, vcc, exec
    s_cbranch_scc1 L1_side_back
    v_mfma_f32_16x16x32_bf16 v[188:191], v[228:231], v[108:111], v[188:191]
    ds_read_b64_tr_b16 v[224:225], v240 offset:20480
    v_mov_b32 v7, v247
    v_lshlrev_b32 v8, 4, v247
    s_lshl_b32 s63, s41, 2
    v_add_f32 v166, 1.0, v166
    v_mfma_f32_16x16x32_bf16 v[184:187], v[228:231], v[104:107], v[184:187]
    ds_read_b64_tr_b16 v[226:227], v240 offset:20992
    s_lshr_b32 s30, s42, 3
    s_add_u32 s63, s63, s30
    s_and_b32 s62, s42, 7
    s_waitcnt lgkmcnt(4)
    v_add_f32 v167, 1.0, v167
    v_mfma_f32_16x16x32_bf16 v[192:195], v[232:235], v[104:107], v[192:195]
    ds_read_b64_tr_b16 v[228:229], v241 offset:20480
    v_and_b32 v1, 31, v7
    v_lshrrev_b32 v2, 5, v7
    v_lshlrev_b32 v10, 2, v1
    v_cvt_pk_bf16_f32 v218, v164, v165
    v_mfma_f32_16x16x32_bf16 v[196:199], v[232:235], v[108:111], v[196:199]
    ds_read_b64_tr_b16 v[230:231], v241 offset:20992
    v_lshl_add_u32 v10, v2, 30, v10
    s_lshl_b32 s48, s63, 16
    s_lshl_b32 s50, s62, 13
    s_waitcnt lgkmcnt(4)
    v_mul_f32 v172, s28, v172
    v_mfma_f32_16x16x32_bf16 v[204:207], v[236:239], v[108:111], v[204:207]
    ds_read_b64_tr_b16 v[232:233], v242 offset:20480
    s_add_u32 s50, s50, s48
    s_add_u32 s50, s50, 10485760
    s_lshl_b32 s49, s63, 13
    v_mul_f32 v173, s28, v173
    v_mfma_f32_16x16x32_bf16 v[200:203], v[236:239], v[104:107], v[200:203]
    ds_read_b64_tr_b16 v[234:235], v242 offset:20992
    s_lshl_b32 s51, s62, 10
    s_add_u32 s51, s51, s49
    s_add_u32 s51, s51, 14680064
    s_waitcnt lgkmcnt(4)
    v_exp_f32 v170, v170
    v_mfma_f32_16x16x32_bf16 v[176:179], v[224:227], v[112:115], v[176:179]
    ds_read_b64_tr_b16 v[236:237], v243 offset:20480
    s_add_u32 s20, s48, 12582912
    s_add_u32 s21, s49, 14942208
    buffer_load_dwordx4 v[40:43], v8, s[12:15], s20 offen sc1
    v_mfma_f32_16x16x32_bf16 v[180:183], v[224:227], v[116:119], v[180:183]
    ds_read_b64_tr_b16 v[238:239], v243 offset:20992
    buffer_load_dword v44, v10, s[12:15], s21 offen sc1
    s_waitcnt lgkmcnt(4)
    v_exp_f32 v171, v171
    v_mfma_f32_16x16x32_bf16 v[188:191], v[228:231], v[116:119], v[188:191]
    ds_read_b64_tr_b16 v[224:225], v240 offset:24576
    buffer_load_dwordx4 v[48:51], v8, s[12:15], s50 offen offset:0 sc1
    v_add_f32 v168, 1.0, v168
    v_mfma_f32_16x16x32_bf16 v[184:187], v[228:231], v[112:115], v[184:187]
    ds_read_b64_tr_b16 v[226:227], v240 offset:25088
    buffer_load_dword v80, v10, s[12:15], s51 offen offset:0 sc1
    s_waitcnt lgkmcnt(4)
    v_add_f32 v169, 1.0, v169
    v_mfma_f32_16x16x32_bf16 v[192:195], v[232:235], v[112:115], v[192:195]
    ds_read_b64_tr_b16 v[228:229], v241 offset:24576
    buffer_load_dwordx4 v[52:55], v8, s[12:15], s50 offen offset:1024 sc1
    v_cvt_pk_bf16_f32 v219, v166, v167
    v_mfma_f32_16x16x32_bf16 v[196:199], v[232:235], v[116:119], v[196:199]
    ds_read_b64_tr_b16 v[230:231], v241 offset:25088
    buffer_load_dword v82, v10, s[12:15], s51 offen offset:128 sc1
    s_waitcnt lgkmcnt(4)
    v_mul_f32 v174, s28, v174
    v_mfma_f32_16x16x32_bf16 v[204:207], v[236:239], v[116:119], v[204:207]
    ds_read_b64_tr_b16 v[232:233], v242 offset:24576
    buffer_load_dwordx4 v[56:59], v8, s[12:15], s50 offen offset:2048 sc1
    v_mul_f32 v175, s28, v175
    v_mfma_f32_16x16x32_bf16 v[200:203], v[236:239], v[112:115], v[200:203]
    ds_read_b64_tr_b16 v[234:235], v242 offset:25088
    buffer_load_dword v84, v10, s[12:15], s51 offen offset:256 sc1
    s_waitcnt lgkmcnt(4)
    v_exp_f32 v172, v172
    v_mfma_f32_16x16x32_bf16 v[176:179], v[224:227], v[120:123], v[176:179]
    ds_read_b64_tr_b16 v[236:237], v243 offset:24576
    buffer_load_dwordx4 v[60:63], v8, s[12:15], s50 offen offset:3072 sc1
    v_mfma_f32_16x16x32_bf16 v[180:183], v[224:227], v[124:127], v[180:183]
    ds_read_b64_tr_b16 v[238:239], v243 offset:25088
    buffer_load_dword v86, v10, s[12:15], s51 offen offset:384 sc1
    s_waitcnt lgkmcnt(4)
    v_exp_f32 v173, v173
    v_mfma_f32_16x16x32_bf16 v[188:191], v[228:231], v[124:127], v[188:191]
    ds_read_b64_tr_b16 v[224:225], v240 offset:28672
    s_add_u32 s50, s50, 4096
    buffer_load_dwordx4 v[64:67], v8, s[12:15], s50 offen offset:0 sc1
    v_mfma_f32_16x16x32_bf16 v[184:187], v[228:231], v[120:123], v[184:187]
    ds_read_b64_tr_b16 v[226:227], v240 offset:29184
    buffer_load_dword v88, v10, s[12:15], s51 offen offset:512 sc1
    s_waitcnt lgkmcnt(4)
    v_add_f32 v170, 1.0, v170
    v_mfma_f32_16x16x32_bf16 v[192:195], v[232:235], v[120:123], v[192:195]
    ds_read_b64_tr_b16 v[228:229], v241 offset:28672
    buffer_load_dwordx4 v[68:71], v8, s[12:15], s50 offen offset:1024 sc1
    v_add_f32 v171, 1.0, v171
    v_mfma_f32_16x16x32_bf16 v[196:199], v[232:235], v[124:127], v[196:199]
    ds_read_b64_tr_b16 v[230:231], v241 offset:29184
    buffer_load_dword v90, v10, s[12:15], s51 offen offset:640 sc1
    s_waitcnt lgkmcnt(4)
    v_cvt_pk_bf16_f32 v220, v168, v169
    v_exp_f32 v174, v174
    v_mfma_f32_16x16x32_bf16 v[204:207], v[236:239], v[124:127], v[204:207]
    ds_read_b64_tr_b16 v[232:233], v242 offset:28672
    buffer_load_dwordx4 v[72:75], v8, s[12:15], s50 offen offset:2048 sc1
    v_mfma_f32_16x16x32_bf16 v[200:203], v[236:239], v[120:123], v[200:203]
    ds_read_b64_tr_b16 v[234:235], v242 offset:29184
    buffer_load_dword v92, v10, s[12:15], s51 offen offset:768 sc1
    s_waitcnt lgkmcnt(4)
    v_exp_f32 v175, v175
    v_mfma_f32_16x16x32_bf16 v[176:179], v[224:227], v[128:131], v[176:179]
    ds_read_b64_tr_b16 v[236:237], v243 offset:28672
    buffer_load_dwordx4 v[76:79], v8, s[12:15], s50 offen offset:3072 sc1
    v_mfma_f32_16x16x32_bf16 v[180:183], v[224:227], v[132:135], v[180:183]
    ds_read_b64_tr_b16 v[238:239], v243 offset:29184
    buffer_load_dword v94, v10, s[12:15], s51 offen offset:896 sc1
    s_waitcnt lgkmcnt(4)
    v_add_f32 v172, 1.0, v172
    v_mfma_f32_16x16x32_bf16 v[188:191], v[228:231], v[132:135], v[188:191]
    ds_read_b64_tr_b16 v[224:225], v240 offset:32768
    s_lshl_b32 s36, s3, 14
    s_add_u32 s20, s48, s36
    s_add_u32 s20, s20, 12582912
    v_add_f32 v173, 1.0, v173
    v_mfma_f32_16x16x32_bf16 v[184:187], v[228:231], v[128:131], v[184:187]
    ds_read_b64_tr_b16 v[226:227], v240 offset:33280
    s_lshl_b32 s36, s3, 11
    s_add_u32 s21, s49, s36
    s_add_u32 s21, s21, 14942208
    s_waitcnt lgkmcnt(4)
    v_add_u32 v240, 0xfffe5000, v240
    v_cvt_pk_bf16_f32 v221, v170, v171
    v_mfma_f32_16x16x32_bf16 v[192:195], v[232:235], v[128:131], v[192:195]
    ds_read_b64_tr_b16 v[228:229], v241 offset:32768
    s_mul_i32 s22, s63, 81920
    s_mul_i32 s36, s3, 20480
    s_add_u32 s22, s22, s36
    v_add_f32 v174, 1.0, v174
    v_mfma_f32_16x16x32_bf16 v[196:199], v[232:235], v[132:135], v[196:199]
    ds_read_b64_tr_b16 v[230:231], v241 offset:33280
    s_add_u32 s22, s22, 15728640
    buffer_load_dwordx4 v[12:15], v8, s[12:15], s20 offen sc1
    s_waitcnt lgkmcnt(4)
    v_add_u32 v241, 0xfffe5000, v241
    v_add_f32 v175, 1.0, v175
    v_mfma_f32_16x16x32_bf16 v[204:207], v[236:239], v[132:135], v[204:207]
    ds_read_b64_tr_b16 v[232:233], v242 offset:32768
    buffer_load_dword v24, v10, s[12:15], s21 offen sc1
    v_cvt_pk_bf16_f32 v222, v172, v173
    v_mfma_f32_16x16x32_bf16 v[200:203], v[236:239], v[128:131], v[200:203]
    ds_read_b64_tr_b16 v[234:235], v242 offset:33280
    s_add_u32 s20, s20, 1024
    s_add_u32 s21, s21, 128
    v_mul_u32_u24 v9, 320, v2
    s_waitcnt lgkmcnt(4)
    v_add_u32 v242, 0xfffe5000, v242
    v_cvt_pk_bf16_f32 v223, v174, v175
    v_mfma_f32_16x16x32_bf16 v[176:179], v[224:227], v[136:139], v[176:179]
    ds_read_b64_tr_b16 v[236:237], v243 offset:32768
    v_lshl_add_u32 v9, v1, 4, v9
    s_mov_b32 s60, 0x3ffff
    s_mov_b32 s61, 0x3ffff
    v_mfma_f32_16x16x32_bf16 v[180:183], v[224:227], v[140:143], v[180:183]
    ds_read_b64_tr_b16 v[238:239], v243 offset:33280
    v_cmp_eq_u32 vcc, 18, v1
    v_mov_b32 v3, 0x3f803f80
    s_mov_b32 s24, 0
    s_waitcnt lgkmcnt(4)
    v_add_u32 v243, 0xfffe5000, v243
    s_barrier
    v_mfma_f32_16x16x32_bf16 v[188:191], v[228:231], v[140:143], v[188:191]
    ds_read_b64_tr_b16 v[224:225], v240 offset:0
    s_mov_b32 s25, 0
    v_cndmask_b32 v16, 0, v3, vcc
    v_cndmask_b32 v17, 0, v3, vcc
    v_mfma_f32_16x16x32_bf16 v[184:187], v[228:231], v[136:139], v[184:187]
    ds_read_b64_tr_b16 v[226:227], v240 offset:512
    v_cndmask_b32 v18, 0, v3, vcc
    v_cndmask_b32 v19, 0, v3, vcc
    v_cndmask_b32 v20, 0, v3, vcc
    s_waitcnt lgkmcnt(4)
    v_mfma_f32_16x16x32_bf16 v[192:195], v[232:235], v[136:139], v[192:195]
    ds_read_b64_tr_b16 v[228:229], v241 offset:0
    v_cndmask_b32 v21, 0, v3, vcc
    v_cndmask_b32 v22, 0, v3, vcc
    v_cndmask_b32 v23, 0, v3, vcc
    v_mfma_f32_16x16x32_bf16 v[196:199], v[232:235], v[140:143], v[196:199]
    ds_read_b64_tr_b16 v[230:231], v241 offset:512
    v_cndmask_b32 v30, 0, v3, vcc
    v_cndmask_b32 v31, 0, v3, vcc
    v_cndmask_b32 v32, 0, v3, vcc
    s_waitcnt lgkmcnt(4)
    v_mfma_f32_16x16x32_bf16 v[204:207], v[236:239], v[140:143], v[204:207]
    ds_read_b64_tr_b16 v[232:233], v242 offset:0
    v_cndmask_b32 v33, 0, v3, vcc
    v_cndmask_b32 v34, 0, v3, vcc
    v_cndmask_b32 v35, 0, v3, vcc
    v_mfma_f32_16x16x32_bf16 v[200:203], v[236:239], v[136:139], v[200:203]
    ds_read_b64_tr_b16 v[234:235], v242 offset:512
    v_cndmask_b32 v36, 0, v3, vcc
    v_cndmask_b32 v37, 0, v3, vcc
    s_mov_b64 exec, s[60:61]
    buffer_load_dwordx4 v[16:19], v9, s[12:15], s22 offen sc1
    buffer_load_dwordx4 v[20:23], v9, s[12:15], s22 offen offset:640 sc1
    s_mov_b64 exec, -1
    s_waitcnt lgkmcnt(4)
    s_add_u32 s32, s27, 4096
    s_setprio 0
    s_add_u32 s22, s22, 1280
    buffer_load_dwordx4 v[26:29], v8, s[12:15], s20 offen sc1
    buffer_load_dword v38, v10, s[12:15], s21 offen sc1
    s_add_u32 s20, s20, 1024
    s_add_u32 s21, s21, 128
    v_cmp_gt_u32 vcc, 32, v7
    v_mov_b32 v4, 0
    v_mov_b32 v5, 0
    v_mov_b32 v45, 0
    v_cndmask_b32 v25, 0, v3, vcc
    v_cndmask_b32 v39, 0, v3, vcc
    v_mov_b32 v81, 0
    v_mov_b32 v83, 0
    v_mov_b32 v85, 0
    v_mov_b32 v87, 0
    v_mov_b32 v89, 0
    v_mov_b32 v91, 0
    v_mov_b32 v93, 0
    v_mov_b32 v95, 0
    v_mov_b32 v0, s44
    v_mov_b32 v1, s45
    v_mov_b32 v2, 0
    s_branch L2e_gu_done
L2_att:
    s_waitcnt vmcnt(6)
    v_mfma_f32_32x32x16_bf16 v[96:111], v[40:43], v[48:51], 0
    s_and_b32 s32, s41, 1
    s_lshr_b32 s33, s41, 1
    s_lshl_b32 s33, s33, 3
    v_mfma_f32_32x32x8_bf16 v[96:111], v[44:45], v[80:81], v[96:111]
    s_lshr_b32 s34, s42, 2
    s_add_u32 s33, s33, s34
    s_and_b32 s34, s42, 3
    v_mfma_f32_32x32x8_bf16 v[128:143], v[4:5], v[4:5], 0
    s_lshl_b32 s35, s33, 2
    s_add_u32 s35, s35, s34
    s_lshl_b32 s35, s35, 1
    v_mfma_f32_32x32x16_bf16 v[112:127], v[40:43], v[52:55], 0
    s_add_u32 s35, s35, s32
    s_lshl_b32 s36, s3, 10
    s_mul_i32 s27, s35, 20480
    v_mfma_f32_32x32x8_bf16 v[112:127], v[44:45], v[82:83], v[112:127]
    s_add_u32 s27, s27, s36
    s_add_u32 s27, s27, 40894464
    s_lshl_b32 s35, s35, 2
    v_mfma_f32_32x32x8_bf16 v[144:159], v[4:5], v[4:5], 0
    s_add_u32 s35, s35, s3
    s_lshl_b32 s35, s35, 3
    s_add_u32 s28, s35, 40386560
    v_max_f32 v6, v96, v97
    v_max3_f32 v6, v6, v98, v99
    v_max3_f32 v6, v6, v100, v101
    v_max3_f32 v6, v6, v102, v103
    v_max3_f32 v6, v6, v104, v105
    v_max3_f32 v6, v6, v106, v107
    v_max3_f32 v6, v6, v108, v109
    v_max3_f32 v6, v6, v110, v111
    v_cvt_pk_bf16_f32 v6, -v6, 0
    v_cndmask_b32 v81, 0, v6, vcc
    v_mfma_f32_32x32x16_bf16 v[96:111], v[40:43], v[56:59], 0
    s_lshl_b32 s35, s33, 1
    v_mfma_f32_32x32x8_bf16 v[96:111], v[44:45], v[84:85], v[96:111]
    s_add_u32 s35, s35, s32
    v_mfma_f32_32x32x8_bf16 v[160:175], v[4:5], v[4:5], 0
    s_mul_i32 s35, s35, 36864
    v_max_f32 v6, v112, v113
    v_max3_f32 v6, v6, v114, v115
    v_max3_f32 v6, v6, v116, v117
    v_max3_f32 v6, v6, v118, v119
    v_max3_f32 v6, v6, v120, v121
    v_max3_f32 v6, v6, v122, v123
    v_max3_f32 v6, v6, v124, v125
    v_max3_f32 v6, v6, v126, v127
    v_cvt_pk_bf16_f32 v6, -v6, 0
    v_cndmask_b32 v83, 0, v6, vcc
    v_mfma_f32_32x32x16_bf16 v[112:127], v[40:43], v[60:63], 0
    s_mul_i32 s36, s34, 288
    v_mfma_f32_32x32x8_bf16 v[112:127], v[44:45], v[86:87], v[112:127]
    s_add_u32 s35, s35, s36
    v_mfma_f32_32x32x8_bf16 v[176:191], v[4:5], v[4:5], 0
    s_lshl_b32 s36, s3, 5
    v_max_f32 v6, v96, v97
    v_max3_f32 v6, v6, v98, v99
    v_max3_f32 v6, v6, v100, v101
    v_max3_f32 v6, v6, v102, v103
    v_max3_f32 v6, v6, v104, v105
    v_max3_f32 v6, v6, v106, v107
    v_max3_f32 v6, v6, v108, v109
    v_max3_f32 v6, v6, v110, v111
    v_cvt_pk_bf16_f32 v6, -v6, 0
    v_cndmask_b32 v85, 0, v6, vcc
    v_mfma_f32_32x32x16_bf16 v[96:111], v[40:43], v[64:67], 0
    s_add_u32 s50, s35, s36
    v_mfma_f32_32x32x8_bf16 v[96:111], v[44:45], v[88:89], v[96:111]
    s_add_u32 s51, s50, 128
    v_mfma_f32_32x32x8_bf16 v[192:207], v[4:5], v[4:5], 0
    s_min_u32 s36, s3, 1
    v_max_f32 v6, v112, v113
    v_max3_f32 v6, v6, v114, v115
    v_max3_f32 v6, v6, v116, v117
    v_max3_f32 v6, v6, v118, v119
    v_max3_f32 v6, v6, v120, v121
    v_max3_f32 v6, v6, v122, v123
    v_max3_f32 v6, v6, v124, v125
    v_max3_f32 v6, v6, v126, v127
    v_cvt_pk_bf16_f32 v6, -v6, 0
    v_cndmask_b32 v87, 0, v6, vcc
    v_mfma_f32_32x32x16_bf16 v[112:127], v[40:43], v[68:71], 0
    s_mul_i32 s36, s36, 18144
    v_mfma_f32_32x32x8_bf16 v[112:127], v[44:45], v[90:91], v[112:127]
    s_add_u32 s47, s50, s36
    v_mfma_f32_32x32x8_bf16 v[208:223], v[4:5], v[4:5], 0
    s_add_u32 s47, s47, 256
    v_max_f32 v6, v96, v97
    v_max3_f32 v6, v6, v98, v99
    v_max3_f32 v6, v6, v100, v101
    v_max3_f32 v6, v6, v102, v103
    v_max3_f32 v6, v6, v104, v105
    v_max3_f32 v6, v6, v106, v107
    v_max3_f32 v6, v6, v108, v109
    v_max3_f32 v6, v6, v110, v111
    v_cvt_pk_bf16_f32 v6, -v6, 0
    v_cndmask_b32 v89, 0, v6, vcc
    v_mfma_f32_32x32x16_bf16 v[96:111], v[40:43], v[72:75], 0
    s_add_u32 s64, s50, 18528
    v_mfma_f32_32x32x8_bf16 v[96:111], v[44:45], v[92:93], v[96:111]
    s_lshr_b32 s36, s3, 1
    v_mfma_f32_32x32x8_bf16 v[224:239], v[4:5], v[4:5], 0
    s_lshl_b32 s36, s36, 30
    v_max_f32 v6, v112, v113
    v_max3_f32 v6, v6, v114, v115
    v_max3_f32 v6, v6, v116, v117
    v_max3_f32 v6, v6, v118, v119
    v_max3_f32 v6, v6, v120, v121
    v_max3_f32 v6, v6, v122, v123
    v_max3_f32 v6, v6, v124, v125
    v_max3_f32 v6, v6, v126, v127
    v_cvt_pk_bf16_f32 v6, -v6, 0
    v_cndmask_b32 v91, 0, v6, vcc
    v_mfma_f32_32x32x16_bf16 v[112:127], v[40:43], v[76:79], 0
    s_add_u32 s65, s64, s36
    v_mfma_f32_32x32x8_bf16 v[112:127], v[44:45], v[94:95], v[112:127]
    s_add_u32 s65, s65, 128
    v_mfma_f32_32x32x8_bf16 v[240:255], v[4:5], v[4:5], 0
    v_max_f32 v6, v96, v97
    v_max3_f32 v6, v6, v98, v99
    v_max3_f32 v6, v6, v100, v101
    v_max3_f32 v6, v6, v102, v103
    v_max3_f32 v6, v6, v104, v105
    v_max3_f32 v6, v6, v106, v107
    v_max3_f32 v6, v6, v108, v109
    v_max3_f32 v6, v6, v110, v111
    v_cvt_pk_bf16_f32 v6, -v6, 0
    v_cndmask_b32 v93, 0, v6, vcc
    s_nop 0
    v_max_f32 v6, v112, v113
    v_max3_f32 v6, v6, v114, v115
    v_max3_f32 v6, v6, v116, v117
    v_max3_f32 v6, v6, v118, v119
    v_max3_f32 v6, v6, v120, v121
    v_max3_f32 v6, v6, v122, v123
    v_max3_f32 v6, v6, v124, v125
    v_max3_f32 v6, v6, v126, v127
    v_cvt_pk_bf16_f32 v6, -v6, 0
    v_cndmask_b32 v95, 0, v6, vcc
L2_att_go:
    v_mov_b64 v[40:41], 0
    v_mov_b64 v[42:43], 0
    v_mov_b64 v[44:45], 0
    v_mov_b64 v[46:47], 0
    v_mov_b64 v[124:125], 0
    v_mov_b64 v[126:127], 0
    v_mfma_f32_32x32x16_bf16 v[96:111], v[12:15], v[48:51], 0
    v_mfma_f32_32x32x8_bf16 v[96:111], v[24:25], v[80:81], v[96:111]
    v_lshrrev_b32 v6, 2, v7
    v_mul_u32_u24 v6, 1152, v6
    v_and_b32 v3, 3, v7
    v_lshl_add_u32 v6, v3, 3, v6
    s_mov_b32 s23, 8
    s_setprio 0
    s_nop 5
.p2align 3
L2_att_loop:
    v_mfma_f32_32x32x16_bf16 v[240:255], v[30:33], v[40:43], v[240:255]
    v_exp_f32 v96, v96
    v_cvt_pk_bf16_f32 v46, v124, v125
    v_cvt_pk_bf16_f32 v47, v126, v127
    v_exp_f32 v97, v97
    v_exp_f32 v98, v98
    v_exp_f32 v99, v99
    v_mfma_f32_32x32x16_bf16 v[112:127], v[12:15], v[52:55], 0
    v_exp_f32 v100, v100
    v_cvt_pk_bf16_f32 v40, v96, v97
    v_cvt_pk_bf16_f32 v41, v98, v99
    v_exp_f32 v101, v101
    v_exp_f32 v102, v102
    v_exp_f32 v103, v103
    v_mfma_f32_32x32x8_bf16 v[112:127], v[24:25], v[82:83], v[112:127]
    v_exp_f32 v104, v104
    v_cvt_pk_bf16_f32 v42, v100, v101
    v_cvt_pk_bf16_f32 v43, v102, v103
    v_exp_f32 v105, v105
    v_exp_f32 v106, v106
    v_exp_f32 v107, v107
    v_mfma_f32_32x32x16_bf16 v[240:255], v[34:37], v[44:47], v[240:255]
    v_exp_f32 v108, v108
    v_cvt_pk_bf16_f32 v44, v104, v105
    v_cvt_pk_bf16_f32 v45, v106, v107
    v_exp_f32 v109, v109
    v_exp_f32 v110, v110
    v_exp_f32 v111, v111
    s_cbranch_vccnz L2_att_nw
    s_waitcnt vmcnt(2)
L2_att_nw:
    v_mfma_f32_32x32x16_bf16 v[128:143], v[16:19], v[40:43], v[128:143]
    v_exp_f32 v112, v112
    v_cvt_pk_bf16_f32 v46, v108, v109
    v_cvt_pk_bf16_f32 v47, v110, v111
    v_exp_f32 v113, v113
    v_exp_f32 v114, v114
    v_exp_f32 v115, v115
    v_mfma_f32_32x32x16_bf16 v[96:111], v[12:15], v[56:59], 0
    s_mov_b64 exec, s[60:61]
    buffer_load_dwordx4 v[30:33], v9, s[12:15], s22 offen sc1
    buffer_load_dwordx4 v[34:37], v9, s[12:15], s22 offen offset:640 sc1
    s_mov_b64 exec, -1
    s_add_u32 s22, s22, 1280
    v_exp_f32 v116, v116
    v_cvt_pk_bf16_f32 v40, v112, v113
    v_cvt_pk_bf16_f32 v41, v114, v115
    v_exp_f32 v117, v117
    v_exp_f32 v118, v118
    v_exp_f32 v119, v119
    v_mfma_f32_32x32x8_bf16 v[96:111], v[24:25], v[84:85], v[96:111]
    v_exp_f32 v120, v120
    v_cvt_pk_bf16_f32 v42, v116, v117
    v_cvt_pk_bf16_f32 v43, v118, v119
    v_exp_f32 v121, v121
    v_exp_f32 v122, v122
    v_exp_f32 v123, v123
    v_mfma_f32_32x32x16_bf16 v[128:143], v[20:23], v[44:47], v[128:143]
    v_exp_f32 v124, v124
    v_cvt_pk_bf16_f32 v44, v120, v121
    v_cvt_pk_bf16_f32 v45, v122, v123
    v_exp_f32 v125, v125
    v_exp_f32 v126, v126
    v_exp_f32 v127, v127
    v_mfma_f32_32x32x16_bf16 v[144:159], v[16:19], v[40:43], v[144:159]
    v_exp_f32 v96, v96
    v_cvt_pk_bf16_f32 v46, v124, v125
    v_cvt_pk_bf16_f32 v47, v126, v127
    v_exp_f32 v97, v97
    v_exp_f32 v98, v98
    v_exp_f32 v99, v99
    v_mfma_f32_32x32x16_bf16 v[112:127], v[12:15], v[60:63], 0
    v_exp_f32 v100, v100
    v_cvt_pk_bf16_f32 v40, v96, v97
    v_cvt_pk_bf16_f32 v41, v98, v99
    v_exp_f32 v101, v101
    v_exp_f32 v102, v102
    v_exp_f32 v103, v103
    v_mfma_f32_32x32x8_bf16 v[112:127], v[24:25], v[86:87], v[112:127]
    v_exp_f32 v104, v104
    v_cvt_pk_bf16_f32 v42, v100, v101
    v_cvt_pk_bf16_f32 v43, v102, v103
    v_exp_f32 v105, v105
    v_exp_f32 v106, v106
    v_exp_f32 v107, v107
    v_mfma_f32_32x32x16_bf16 v[144:159], v[20:23], v[44:47], v[144:159]
    v_exp_f32 v108, v108
    v_cvt_pk_bf16_f32 v44, v104, v105
    v_cvt_pk_bf16_f32 v45, v106, v107
    v_exp_f32 v109, v109
    v_exp_f32 v110, v110
    v_exp_f32 v111, v111
    v_mfma_f32_32x32x16_bf16 v[160:175], v[16:19], v[40:43], v[160:175]
    v_exp_f32 v112, v112
    v_cvt_pk_bf16_f32 v46, v108, v109
    v_cvt_pk_bf16_f32 v47, v110, v111
    v_exp_f32 v113, v113
    v_exp_f32 v114, v114
    v_exp_f32 v115, v115
    v_mfma_f32_32x32x16_bf16 v[96:111], v[12:15], v[64:67], 0
    v_exp_f32 v116, v116
    v_cvt_pk_bf16_f32 v40, v112, v113
    v_cvt_pk_bf16_f32 v41, v114, v115
    v_exp_f32 v117, v117
    v_exp_f32 v118, v118
    v_exp_f32 v119, v119
    v_mfma_f32_32x32x8_bf16 v[96:111], v[24:25], v[88:89], v[96:111]
    v_exp_f32 v120, v120
    v_cvt_pk_bf16_f32 v42, v116, v117
    v_cvt_pk_bf16_f32 v43, v118, v119
    v_exp_f32 v121, v121
    v_exp_f32 v122, v122
    v_exp_f32 v123, v123
    v_mfma_f32_32x32x16_bf16 v[160:175], v[20:23], v[44:47], v[160:175]
    v_exp_f32 v124, v124
    v_cvt_pk_bf16_f32 v44, v120, v121
    v_cvt_pk_bf16_f32 v45, v122, v123
    v_exp_f32 v125, v125
    v_exp_f32 v126, v126
    v_exp_f32 v127, v127
    v_mfma_f32_32x32x16_bf16 v[176:191], v[16:19], v[40:43], v[176:191]
    v_exp_f32 v96, v96
    v_cvt_pk_bf16_f32 v46, v124, v125
    v_cvt_pk_bf16_f32 v47, v126, v127
    v_exp_f32 v97, v97
    v_exp_f32 v98, v98
    v_exp_f32 v99, v99
    v_mfma_f32_32x32x16_bf16 v[112:127], v[12:15], v[68:71], 0
    v_exp_f32 v100, v100
    v_cvt_pk_bf16_f32 v40, v96, v97
    v_cvt_pk_bf16_f32 v41, v98, v99
    v_exp_f32 v101, v101
    v_exp_f32 v102, v102
    v_exp_f32 v103, v103
    v_mfma_f32_32x32x8_bf16 v[112:127], v[24:25], v[90:91], v[112:127]
    v_exp_f32 v104, v104
    v_cvt_pk_bf16_f32 v42, v100, v101
    v_cvt_pk_bf16_f32 v43, v102, v103
    v_exp_f32 v105, v105
    v_exp_f32 v106, v106
    v_exp_f32 v107, v107
    v_mfma_f32_32x32x16_bf16 v[176:191], v[20:23], v[44:47], v[176:191]
    v_exp_f32 v108, v108
    v_cvt_pk_bf16_f32 v44, v104, v105
    v_cvt_pk_bf16_f32 v45, v106, v107
    v_exp_f32 v109, v109
    v_exp_f32 v110, v110
    v_exp_f32 v111, v111
    v_mfma_f32_32x32x16_bf16 v[192:207], v[16:19], v[40:43], v[192:207]
    v_exp_f32 v112, v112
    v_cvt_pk_bf16_f32 v46, v108, v109
    v_cvt_pk_bf16_f32 v47, v110, v111
    v_exp_f32 v113, v113
    v_exp_f32 v114, v114
    v_exp_f32 v115, v115
    v_mfma_f32_32x32x16_bf16 v[96:111], v[12:15], v[72:75], 0
    v_exp_f32 v116, v116
    v_cvt_pk_bf16_f32 v40, v112, v113
    v_cvt_pk_bf16_f32 v41, v114, v115
    v_exp_f32 v117, v117
    v_exp_f32 v118, v118
    v_exp_f32 v119, v119
    v_mfma_f32_32x32x8_bf16 v[96:111], v[24:25], v[92:93], v[96:111]
    v_exp_f32 v120, v120
    v_cvt_pk_bf16_f32 v42, v116, v117
    v_cvt_pk_bf16_f32 v43, v118, v119
    v_exp_f32 v121, v121
    v_exp_f32 v122, v122
    v_exp_f32 v123, v123
    v_mfma_f32_32x32x16_bf16 v[192:207], v[20:23], v[44:47], v[192:207]
    v_exp_f32 v124, v124
    v_cvt_pk_bf16_f32 v44, v120, v121
    v_cvt_pk_bf16_f32 v45, v122, v123
    v_exp_f32 v125, v125
    v_exp_f32 v126, v126
    v_exp_f32 v127, v127
    v_mfma_f32_32x32x16_bf16 v[208:223], v[16:19], v[40:43], v[208:223]
    v_exp_f32 v96, v96
    v_cvt_pk_bf16_f32 v46, v124, v125
    v_cvt_pk_bf16_f32 v47, v126, v127
    v_exp_f32 v97, v97
    v_exp_f32 v98, v98
    v_exp_f32 v99, v99
    v_mfma_f32_32x32x16_bf16 v[112:127], v[12:15], v[76:79], 0
    v_exp_f32 v100, v100
    v_cvt_pk_bf16_f32 v40, v96, v97
    v_cvt_pk_bf16_f32 v41, v98, v99
    v_exp_f32 v101, v101
    v_exp_f32 v102, v102
    v_exp_f32 v103, v103
    v_mfma_f32_32x32x8_bf16 v[112:127], v[24:25], v[94:95], v[112:127]
    v_exp_f32 v104, v104
    v_cvt_pk_bf16_f32 v42, v100, v101
    v_cvt_pk_bf16_f32 v43, v102, v103
    v_exp_f32 v105, v105
    v_exp_f32 v106, v106
    v_exp_f32 v107, v107
    v_mfma_f32_32x32x16_bf16 v[208:223], v[20:23], v[44:47], v[208:223]
    v_exp_f32 v108, v108
    v_cvt_pk_bf16_f32 v44, v104, v105
    v_cvt_pk_bf16_f32 v45, v106, v107
    v_exp_f32 v109, v109
    v_exp_f32 v110, v110
    v_exp_f32 v111, v111
    v_mfma_f32_32x32x16_bf16 v[224:239], v[16:19], v[40:43], v[224:239]
    s_waitcnt vmcnt(2)
    v_exp_f32 v112, v112
    v_cvt_pk_bf16_f32 v46, v108, v109
    v_cvt_pk_bf16_f32 v47, v110, v111
    v_exp_f32 v113, v113
    v_exp_f32 v114, v114
    v_exp_f32 v115, v115
    v_mfma_f32_32x32x16_bf16 v[96:111], v[26:29], v[48:51], 0
    v_exp_f32 v116, v116
    v_cvt_pk_bf16_f32 v40, v112, v113
    v_cvt_pk_bf16_f32 v41, v114, v115
    v_exp_f32 v117, v117
    v_exp_f32 v118, v118
    v_exp_f32 v119, v119
    v_mfma_f32_32x32x8_bf16 v[96:111], v[38:39], v[80:81], v[96:111]
    buffer_load_dwordx4 v[12:15], v8, s[12:15], s20 offen sc1
    buffer_load_dword v24, v10, s[12:15], s21 offen sc1
    s_add_u32 s20, s20, 1024
    s_add_u32 s21, s21, 128
    s_mov_b64 exec, 1
    buffer_store_dwordx2 v[0:1], v2, s[12:15], s46 offen sc1
    s_mov_b64 exec, -1
    s_mov_b32 s46, 0x40000000
    s_mov_b64 vcc, 0
    v_exp_f32 v120, v120
    v_cvt_pk_bf16_f32 v42, v116, v117
    v_cvt_pk_bf16_f32 v43, v118, v119
    v_exp_f32 v121, v121
    v_exp_f32 v122, v122
    v_exp_f32 v123, v123
    v_mfma_f32_32x32x16_bf16 v[224:239], v[20:23], v[44:47], v[224:239]
    v_exp_f32 v124, v124
    v_cvt_pk_bf16_f32 v44, v120, v121
    v_cvt_pk_bf16_f32 v45, v122, v123
    v_exp_f32 v125, v125
    v_exp_f32 v126, v126
    v_exp_f32 v127, v127
    v_mfma_f32_32x32x16_bf16 v[240:255], v[16:19], v[40:43], v[240:255]
    v_exp_f32 v96, v96
    v_cvt_pk_bf16_f32 v46, v124, v125
    v_cvt_pk_bf16_f32 v47, v126, v127
    v_exp_f32 v97, v97
    v_exp_f32 v98, v98
    v_exp_f32 v99, v99
    v_mfma_f32_32x32x16_bf16 v[112:127], v[26:29], v[52:55], 0
    v_exp_f32 v100, v100
    v_cvt_pk_bf16_f32 v40, v96, v97
    v_cvt_pk_bf16_f32 v41, v98, v99
    v_exp_f32 v101, v101
    v_exp_f32 v102, v102
    v_exp_f32 v103, v103
    v_mfma_f32_32x32x8_bf16 v[112:127], v[38:39], v[82:83], v[112:127]
    v_exp_f32 v104, v104
    v_cvt_pk_bf16_f32 v42, v100, v101
    v_cvt_pk_bf16_f32 v43, v102, v103
    v_exp_f32 v105, v105
    v_exp_f32 v106, v106
    v_exp_f32 v107, v107
    v_mfma_f32_32x32x16_bf16 v[240:255], v[20:23], v[44:47], v[240:255]
    v_exp_f32 v108, v108
    v_cvt_pk_bf16_f32 v44, v104, v105
    v_cvt_pk_bf16_f32 v45, v106, v107
    v_exp_f32 v109, v109
    v_exp_f32 v110, v110
    v_exp_f32 v111, v111
    s_waitcnt vmcnt(3)
    v_mfma_f32_32x32x16_bf16 v[128:143], v[30:33], v[40:43], v[128:143]
    v_exp_f32 v112, v112
    v_cvt_pk_bf16_f32 v46, v108, v109
    v_cvt_pk_bf16_f32 v47, v110, v111
    v_exp_f32 v113, v113
    v_exp_f32 v114, v114
    v_exp_f32 v115, v115
    v_mfma_f32_32x32x16_bf16 v[96:111], v[26:29], v[56:59], 0
    s_mov_b64 exec, s[60:61]
    buffer_load_dwordx4 v[16:19], v9, s[12:15], s22 offen sc1
    buffer_load_dwordx4 v[20:23], v9, s[12:15], s22 offen offset:640 sc1
    s_mov_b64 exec, -1
    s_add_u32 s22, s22, 1280
    v_exp_f32 v116, v116
    v_cvt_pk_bf16_f32 v40, v112, v113
    v_cvt_pk_bf16_f32 v41, v114, v115
    v_exp_f32 v117, v117
    v_exp_f32 v118, v118
    v_exp_f32 v119, v119
    v_mfma_f32_32x32x8_bf16 v[96:111], v[38:39], v[84:85], v[96:111]
    v_exp_f32 v120, v120
    v_cvt_pk_bf16_f32 v42, v116, v117
    v_cvt_pk_bf16_f32 v43, v118, v119
    v_exp_f32 v121, v121
    v_exp_f32 v122, v122
    v_exp_f32 v123, v123
    v_mfma_f32_32x32x16_bf16 v[128:143], v[34:37], v[44:47], v[128:143]
    v_exp_f32 v124, v124
    v_cvt_pk_bf16_f32 v44, v120, v121
    v_cvt_pk_bf16_f32 v45, v122, v123
    v_exp_f32 v125, v125
    v_exp_f32 v126, v126
    v_exp_f32 v127, v127
    v_mfma_f32_32x32x16_bf16 v[144:159], v[30:33], v[40:43], v[144:159]
    v_exp_f32 v96, v96
    v_cvt_pk_bf16_f32 v46, v124, v125
    v_cvt_pk_bf16_f32 v47, v126, v127
    v_exp_f32 v97, v97
    v_exp_f32 v98, v98
    v_exp_f32 v99, v99
    v_mfma_f32_32x32x16_bf16 v[112:127], v[26:29], v[60:63], 0
    v_exp_f32 v100, v100
    v_cvt_pk_bf16_f32 v40, v96, v97
    v_cvt_pk_bf16_f32 v41, v98, v99
    v_exp_f32 v101, v101
    v_exp_f32 v102, v102
    v_exp_f32 v103, v103
    v_mfma_f32_32x32x8_bf16 v[112:127], v[38:39], v[86:87], v[112:127]
    v_exp_f32 v104, v104
    v_cvt_pk_bf16_f32 v42, v100, v101
    v_cvt_pk_bf16_f32 v43, v102, v103
    v_exp_f32 v105, v105
    v_exp_f32 v106, v106
    v_exp_f32 v107, v107
    v_mfma_f32_32x32x16_bf16 v[144:159], v[34:37], v[44:47], v[144:159]
    v_exp_f32 v108, v108
    v_cvt_pk_bf16_f32 v44, v104, v105
    v_cvt_pk_bf16_f32 v45, v106, v107
    v_exp_f32 v109, v109
    v_exp_f32 v110, v110
    v_exp_f32 v111, v111
    v_mfma_f32_32x32x16_bf16 v[160:175], v[30:33], v[40:43], v[160:175]
    v_exp_f32 v112, v112
    v_cvt_pk_bf16_f32 v46, v108, v109
    v_cvt_pk_bf16_f32 v47, v110, v111
    v_exp_f32 v113, v113
    v_exp_f32 v114, v114
    v_exp_f32 v115, v115
    v_mfma_f32_32x32x16_bf16 v[96:111], v[26:29], v[64:67], 0
    v_exp_f32 v116, v116
    v_cvt_pk_bf16_f32 v40, v112, v113
    v_cvt_pk_bf16_f32 v41, v114, v115
    v_exp_f32 v117, v117
    v_exp_f32 v118, v118
    v_exp_f32 v119, v119
    v_mfma_f32_32x32x8_bf16 v[96:111], v[38:39], v[88:89], v[96:111]
    s_sub_u32 s23, s23, 1
    v_exp_f32 v120, v120
    v_cvt_pk_bf16_f32 v42, v116, v117
    v_cvt_pk_bf16_f32 v43, v118, v119
    v_exp_f32 v121, v121
    v_exp_f32 v122, v122
    v_exp_f32 v123, v123
    v_mfma_f32_32x32x16_bf16 v[160:175], v[34:37], v[44:47], v[160:175]
    v_exp_f32 v124, v124
    v_cvt_pk_bf16_f32 v44, v120, v121
    v_cvt_pk_bf16_f32 v45, v122, v123
    v_exp_f32 v125, v125
    v_exp_f32 v126, v126
    v_exp_f32 v127, v127
    v_mfma_f32_32x32x16_bf16 v[176:191], v[30:33], v[40:43], v[176:191]
    v_exp_f32 v96, v96
    v_cvt_pk_bf16_f32 v46, v124, v125
    v_cvt_pk_bf16_f32 v47, v126, v127
    v_exp_f32 v97, v97
    v_exp_f32 v98, v98
    v_exp_f32 v99, v99
    v_mfma_f32_32x32x16_bf16 v[112:127], v[26:29], v[68:71], 0
    v_exp_f32 v100, v100
    v_cvt_pk_bf16_f32 v40, v96, v97
    v_cvt_pk_bf16_f32 v41, v98, v99
    v_exp_f32 v101, v101
    v_exp_f32 v102, v102
    v_exp_f32 v103, v103
    v_mfma_f32_32x32x8_bf16 v[112:127], v[38:39], v[90:91], v[112:127]
    v_exp_f32 v104, v104
    v_cvt_pk_bf16_f32 v42, v100, v101
    v_cvt_pk_bf16_f32 v43, v102, v103
    v_exp_f32 v105, v105
    v_exp_f32 v106, v106
    v_exp_f32 v107, v107
    v_mfma_f32_32x32x16_bf16 v[176:191], v[34:37], v[44:47], v[176:191]
    v_exp_f32 v108, v108
    v_cvt_pk_bf16_f32 v44, v104, v105
    v_cvt_pk_bf16_f32 v45, v106, v107
    v_exp_f32 v109, v109
    v_exp_f32 v110, v110
    v_exp_f32 v111, v111
    v_mfma_f32_32x32x16_bf16 v[192:207], v[30:33], v[40:43], v[192:207]
    v_exp_f32 v112, v112
    v_cvt_pk_bf16_f32 v46, v108, v109
    v_cvt_pk_bf16_f32 v47, v110, v111
    v_exp_f32 v113, v113
    v_exp_f32 v114, v114
    v_exp_f32 v115, v115
    v_mfma_f32_32x32x16_bf16 v[96:111], v[26:29], v[72:75], 0
    v_exp_f32 v116, v116
    v_cvt_pk_bf16_f32 v40, v112, v113
    v_cvt_pk_bf16_f32 v41, v114, v115
    v_exp_f32 v117, v117
    v_exp_f32 v118, v118
    v_exp_f32 v119, v119
    v_mfma_f32_32x32x8_bf16 v[96:111], v[38:39], v[92:93], v[96:111]
    v_exp_f32 v120, v120
    v_cvt_pk_bf16_f32 v42, v116, v117
    v_cvt_pk_bf16_f32 v43, v118, v119
    v_exp_f32 v121, v121
    v_exp_f32 v122, v122
    v_exp_f32 v123, v123
    v_mfma_f32_32x32x16_bf16 v[192:207], v[34:37], v[44:47], v[192:207]
    v_exp_f32 v124, v124
    v_cvt_pk_bf16_f32 v44, v120, v121
    v_cvt_pk_bf16_f32 v45, v122, v123
    v_exp_f32 v125, v125
    v_exp_f32 v126, v126
    v_exp_f32 v127, v127
    v_mfma_f32_32x32x16_bf16 v[208:223], v[30:33], v[40:43], v[208:223]
    v_exp_f32 v96, v96
    v_cvt_pk_bf16_f32 v46, v124, v125
    v_cvt_pk_bf16_f32 v47, v126, v127
    v_exp_f32 v97, v97
    v_exp_f32 v98, v98
    v_exp_f32 v99, v99
    v_mfma_f32_32x32x16_bf16 v[112:127], v[26:29], v[76:79], 0
    v_exp_f32 v100, v100
    v_cvt_pk_bf16_f32 v40, v96, v97
    v_cvt_pk_bf16_f32 v41, v98, v99
    v_exp_f32 v101, v101
    v_exp_f32 v102, v102
    v_exp_f32 v103, v103
    v_mfma_f32_32x32x8_bf16 v[112:127], v[38:39], v[94:95], v[112:127]
    v_exp_f32 v104, v104
    v_cvt_pk_bf16_f32 v42, v100, v101
    v_cvt_pk_bf16_f32 v43, v102, v103
    v_exp_f32 v105, v105
    v_exp_f32 v106, v106
    v_exp_f32 v107, v107
    v_mfma_f32_32x32x16_bf16 v[208:223], v[34:37], v[44:47], v[208:223]
    v_exp_f32 v108, v108
    v_cvt_pk_bf16_f32 v44, v104, v105
    v_cvt_pk_bf16_f32 v45, v106, v107
    v_exp_f32 v109, v109
    v_exp_f32 v110, v110
    v_exp_f32 v111, v111
    v_mfma_f32_32x32x16_bf16 v[224:239], v[30:33], v[40:43], v[224:239]
    s_waitcnt vmcnt(2)
    v_exp_f32 v112, v112
    v_cvt_pk_bf16_f32 v46, v108, v109
    v_cvt_pk_bf16_f32 v47, v110, v111
    v_exp_f32 v113, v113
    v_exp_f32 v114, v114
    v_exp_f32 v115, v115
    v_mfma_f32_32x32x16_bf16 v[96:111], v[12:15], v[48:51], 0
    v_exp_f32 v116, v116
    v_cvt_pk_bf16_f32 v40, v112, v113
    v_cvt_pk_bf16_f32 v41, v114, v115
    v_exp_f32 v117, v117
    v_exp_f32 v118, v118
    v_exp_f32 v119, v119
    v_mfma_f32_32x32x8_bf16 v[96:111], v[24:25], v[80:81], v[96:111]
    buffer_load_dwordx4 v[26:29], v8, s[12:15], s20 offen sc1
    buffer_load_dword v38, v10, s[12:15], s21 offen sc1
    s_add_u32 s20, s20, 1024
    s_add_u32 s21, s21, 128
    v_exp_f32 v120, v120
    v_cvt_pk_bf16_f32 v42, v116, v117
    v_cvt_pk_bf16_f32 v43, v118, v119
    v_exp_f32 v121, v121
    v_exp_f32 v122, v122
    v_exp_f32 v123, v123
    v_mfma_f32_32x32x16_bf16 v[224:239], v[34:37], v[44:47], v[224:239]
    s_cmp_lg_u32 s23, 0
    v_exp_f32 v124, v124
    v_cvt_pk_bf16_f32 v44, v120, v121
    v_cvt_pk_bf16_f32 v45, v122, v123
    v_exp_f32 v125, v125
    v_exp_f32 v126, v126
    v_exp_f32 v127, v127
    s_cbranch_scc1 L2_att_loop
    v_mfma_f32_32x32x16_bf16 v[240:255], v[30:33], v[40:43], v[240:255]
    v_cvt_pk_bf16_f32 v46, v124, v125
    v_cvt_pk_bf16_f32 v47, v126, v127
    s_nop 1
    v_mfma_f32_32x32x16_bf16 v[240:255], v[34:37], v[44:47], v[240:255]
    buffer_load_dwordx2 v[126:127], v2, s[12:15], s28 offen sc1
    buffer_load_dwordx2 v[116:117], v6, s[56:59], s50 offen
    buffer_load_dwordx2 v[118:119], v6, s[56:59], s51 offen
    buffer_load_dwordx2 v[120:121], v6, s[56:59], s47 offen
    buffer_load_dwordx2 v[122:123], v6, s[56:59], s64 offen
    buffer_load_dwordx2 v[124:125], v6, s[56:59], s65 offen
    s_mul_i32 s36, s3, 20480
    v_add_u32 v2, s36, v8
    ds_write_b128 v2, v[128:131] offset:0
    ds_write_b128 v2, v[132:135] offset:1024
    ds_write_b128 v2, v[144:147] offset:2560
    ds_write_b128 v2, v[148:151] offset:3584
    ds_write_b128 v2, v[160:163] offset:5120
    ds_write_b128 v2, v[164:167] offset:6144
    ds_write_b128 v2, v[176:179] offset:7680
    ds_write_b128 v2, v[180:183] offset:8704
    ds_write_b128 v2, v[192:195] offset:10240
    ds_write_b128 v2, v[196:199] offset:11264
    ds_write_b128 v2, v[208:211] offset:12800
    ds_write_b128 v2, v[212:215] offset:13824
    ds_write_b128 v2, v[224:227] offset:15360
    ds_write_b128 v2, v[228:231] offset:16384
    ds_write_b128 v2, v[240:243] offset:17920
    ds_write_b128 v2, v[244:247] offset:18944
    s_mov_b32 exec_hi, 0
    ds_write_b128 v2, v[136:139] offset:2048
    ds_write_b128 v2, v[152:155] offset:4608
    ds_write_b128 v2, v[168:171] offset:7168
    ds_write_b128 v2, v[184:187] offset:9728
    ds_write_b128 v2, v[200:203] offset:12288
    ds_write_b128 v2, v[216:219] offset:14848
    ds_write_b128 v2, v[232:235] offset:17408
    ds_write_b128 v2, v[248:251] offset:19968
    v_maximum3_f32 v3, v138, v154, v170
    v_maximum3_f32 v3, v3, v186, v202
    v_maximum3_f32 v3, v3, v218, v234
    v_maximum3_f32 v3, v3, v250, v3
    v_min3_f32 v5, v138, v154, v170
    v_min3_f32 v5, v5, v186, v202
    v_min3_f32 v5, v5, v218, v234
    v_min_f32 v5, v5, v250
    s_cmp_eq_u32 s3, 0
    s_cselect_b32 s30, 0x2b800000, 0
    v_cmp_gt_f32 s[36:37], s30, v5
    v_mov_b32 v4, 0x53800000
    v_cmp_nlt_f32 vcc, v3, v4
    v_mov_b32 v4, 157720
    v_mov_b32 v5, 1
    s_or_b64 vcc, vcc, s[36:37]
    s_and_saveexec_b64 s[30:31], vcc
    s_cbranch_execz L2_att_noflag
    ds_write_b32 v4, v5
L2_att_noflag:
    s_mov_b64 exec, -1
    s_add_u32 s25, s25, 4
    v_mov_b32 v0, 157696
    v_mov_b32 v1, 1
    s_waitcnt lgkmcnt(0)
    s_mov_b64 exec, 1
    ds_add_u32 v0, v1
    s_mov_b64 exec, -1
L2_att_w1:
    ds_read_b32 v1, v0
    s_waitcnt lgkmcnt(0)
    v_readfirstlane_b32 s30, v1
    s_cmp_ge_u32 s30, s25
    s_cbranch_scc1 L2_att_w1_ok
    s_branch L2_att_w1
L2_att_w1_ok:
    v_mov_b32 v4, 157720
    ds_read_b32 v5, v4
    s_mul_i32 s36, s3, 5120
    v_add_u32 v2, s36, v8
    v_and_b32 v3, 0x1f0, v8
    v_add_u32 v3, s36, v3
    v_add_u32 v0, 40960, v2
    v_add_u32 v1, 40960, v3
    s_waitcnt lgkmcnt(0)
    v_readfirstlane_b32 s30, v5
    s_cmp_gt_u32 s30, s24
    s_cbranch_scc1 L2_att_fallback
    ds_read_b128 v[128:131], v2 offset:0
    ds_read_b128 v[132:135], v2 offset:1024
    ds_read_b128 v[136:139], v3 offset:2048
    ds_read_b128 v[140:143], v2 offset:20480
    ds_read_b128 v[144:147], v2 offset:21504
    ds_read_b128 v[148:151], v3 offset:22528
    ds_read_b128 v[152:155], v0 offset:0
    ds_read_b128 v[156:159], v0 offset:1024
    ds_read_b128 v[160:163], v1 offset:2048
    ds_read_b128 v[164:167], v0 offset:20480
    ds_read_b128 v[168:171], v0 offset:21504
    ds_read_b128 v[172:175], v1 offset:22528
    ds_read_b128 v[176:179], v2 offset:2560
    ds_read_b128 v[180:183], v2 offset:3584
    ds_read_b128 v[184:187], v3 offset:4608
    ds_read_b128 v[188:191], v2 offset:23040
    ds_read_b128 v[192:195], v2 offset:24064
    ds_read_b128 v[196:199], v3 offset:25088
    ds_read_b128 v[200:203], v0 offset:2560
    ds_read_b128 v[204:207], v0 offset:3584
    ds_read_b128 v[208:211], v1 offset:4608
    ds_read_b128 v[212:215], v0 offset:23040
    ds_read_b128 v[216:219], v0 offset:24064
    ds_read_b128 v[220:223], v1 offset:25088
    s_waitcnt vmcnt(0)
    v_cmp_ne_u64 vcc, s[44:45], v[126:127]
    s_nop 1
    s_and_b64 vcc, vcc, exec
    s_cselect_b32 s29, 0, 1
    s_cselect_b32 s30, 0x40000000, s27
    s_lshl_b32 s36, s62, 2
    s_add_u32 s36, s36, s3
    s_lshl_b32 s37, s36, 16
    s_lshr_b32 s38, s63, 1
    s_lshl_b32 s38, s38, 11
    s_add_u32 s37, s37, s38
    s_and_b32 s38, s63, 1
    s_lshl_b32 s38, s38, 9
    s_add_u32 s37, s37, s38
    s_add_u32 s37, s37, 37748736
    s_add_u32 s43, s37, 32768
    s_lshl_b32 s38, s36, 13
    s_lshl_b32 s39, s63, 7
    s_add_u32 s38, s38, s39
    s_add_u32 s38, s38, 39845888
    s_add_u32 s46, s38, 4096
    s_lshl_b32 s39, s36, 2
    s_lshr_b32 s35, s63, 3
    s_add_u32 s39, s39, s35
    s_mul_i32 s39, s39, 384
    s_and_b32 s35, s63, 7
    s_lshl_b32 s35, s35, 3
    s_add_u32 s39, s39, s35
    s_add_u32 s39, s39, 48234496
    v_and_b32 v4, 15, v7
    v_lshlrev_b32 v4, 4, v4
    v_bfe_u32 v5, v7, 4, 1
    v_lshl_add_u32 v4, v5, 10, v4
    v_lshrrev_b32 v5, 5, v7
    v_lshl_add_u32 v4, v5, 8, v4
    s_waitcnt lgkmcnt(12)
    v_pk_add_f32 v[138:139], v[138:139], v[150:151]
    v_pk_add_f32 v[162:163], v[162:163], v[174:175]
    v_pk_add_f32 v[128:129], v[128:129], v[140:141]
    v_pk_add_f32 v[152:153], v[152:153], v[164:165]
    v_pk_add_f32 v[130:131], v[130:131], v[142:143]
    v_pk_add_f32 v[154:155], v[154:155], v[166:167]
    v_pk_add_f32 v[132:133], v[132:133], v[144:145]
    v_pk_add_f32 v[156:157], v[156:157], v[168:169]
    v_pk_add_f32 v[134:135], v[134:135], v[146:147]
    v_pk_add_f32 v[158:159], v[158:159], v[170:171]
    v_pk_add_f32 v[136:137], v[136:137], v[148:149]
    v_pk_add_f32 v[160:161], v[160:161], v[172:173]
    v_add_f32 v138, v138, v162
    v_rcp_f32 v138, v138
    v_pk_add_f32 v[128:129], v[128:129], v[152:153]
    v_pk_add_f32 v[130:131], v[130:131], v[154:155]
    v_pk_add_f32 v[132:133], v[132:133], v[156:157]
    v_pk_add_f32 v[134:135], v[134:135], v[158:159]
    v_pk_add_f32 v[136:137], v[136:137], v[160:161]
    v_pk_mul_f32 v[128:129], v[128:129], v[138:139] op_sel_hi:[1,0]
    v_pk_mul_f32 v[130:131], v[130:131], v[138:139] op_sel_hi:[1,0]
    v_pk_mul_f32 v[132:133], v[132:133], v[138:139] op_sel_hi:[1,0]
    v_pk_mul_f32 v[134:135], v[134:135], v[138:139] op_sel_hi:[1,0]
    v_pk_mul_f32 v[136:137], v[136:137], v[138:139] op_sel_hi:[1,0]
    v_cvt_pk_bf16_f32 v140, v128, v129
    v_cvt_pk_bf16_f32 v141, v130, v131
    v_cvt_pk_bf16_f32 v142, v132, v133
    v_cvt_pk_bf16_f32 v143, v134, v135
    v_cvt_pk_bf16_f32 v144, v136, v137
    buffer_store_dwordx4 v[140:143], v4, s[12:15], s37 offen sc1
    buffer_store_dword v144, v10, s[12:15], s38 offen sc1
    s_waitcnt lgkmcnt(0)
    v_mov_b32 v2, 157752
    v_mov_b32 v3, 1
    s_mov_b64 exec, 1
    ds_add_u32 v2, v3
    s_mov_b64 exec, -1
    v_pk_add_f32 v[186:187], v[186:187], v[198:199]
    v_pk_add_f32 v[210:211], v[210:211], v[222:223]
    v_pk_add_f32 v[176:177], v[176:177], v[188:189]
    v_pk_add_f32 v[200:201], v[200:201], v[212:213]
    v_pk_add_f32 v[178:179], v[178:179], v[190:191]
    v_pk_add_f32 v[202:203], v[202:203], v[214:215]
    v_pk_add_f32 v[180:181], v[180:181], v[192:193]
    v_pk_add_f32 v[204:205], v[204:205], v[216:217]
    v_pk_add_f32 v[182:183], v[182:183], v[194:195]
    v_pk_add_f32 v[206:207], v[206:207], v[218:219]
    v_pk_add_f32 v[184:185], v[184:185], v[196:197]
    v_pk_add_f32 v[208:209], v[208:209], v[220:221]
    v_add_f32 v186, v186, v210
    v_rcp_f32 v186, v186
    v_pk_add_f32 v[176:177], v[176:177], v[200:201]
    v_pk_add_f32 v[178:179], v[178:179], v[202:203]
    v_pk_add_f32 v[180:181], v[180:181], v[204:205]
    v_pk_add_f32 v[182:183], v[182:183], v[206:207]
    v_pk_add_f32 v[184:185], v[184:185], v[208:209]
    v_pk_mul_f32 v[176:177], v[176:177], v[186:187] op_sel_hi:[1,0]
    v_pk_mul_f32 v[178:179], v[178:179], v[186:187] op_sel_hi:[1,0]
    v_pk_mul_f32 v[180:181], v[180:181], v[186:187] op_sel_hi:[1,0]
    v_pk_mul_f32 v[182:183], v[182:183], v[186:187] op_sel_hi:[1,0]
    v_pk_mul_f32 v[184:185], v[184:185], v[186:187] op_sel_hi:[1,0]
    v_cvt_pk_bf16_f32 v188, v176, v177
    v_cvt_pk_bf16_f32 v189, v178, v179
    v_cvt_pk_bf16_f32 v190, v180, v181
    v_cvt_pk_bf16_f32 v191, v182, v183
    v_cvt_pk_bf16_f32 v192, v184, v185
    buffer_store_dwordx4 v[188:191], v4, s[12:15], s43 offen sc1
    buffer_store_dword v192, v10, s[12:15], s46 offen sc1
    buffer_load_dwordx4 v[96:99], v8, s[12:15], s30 offen sc1
    s_add_u32 s30, s30, 4096
    buffer_load_dwordx4 v[100:103], v8, s[12:15], s30 offen sc1
    s_add_u32 s30, s30, 4096
    buffer_load_dwordx4 v[104:107], v8, s[12:15], s30 offen sc1
    s_add_u32 s30, s30, 4096
    buffer_load_dwordx4 v[108:111], v8, s[12:15], s30 offen sc1
    s_add_u32 s30, s30, 4096
    buffer_load_dwordx4 v[112:115], v8, s[12:15], s30 offen sc1
    s_add_u32 s30, s30, 4096
    v_mov_b32 v0, s44
    v_mov_b32 v1, s45
    v_mov_b32 v2, 0
    s_waitcnt vmcnt(5)
    s_mov_b64 exec, 1
    buffer_store_dwordx2 v[0:1], v2, s[12:15], s39 offen sc1
    s_mov_b64 exec, -1
    s_mov_b32 s16, s8
    s_mov_b32 s17, s9
    s_mov_b32 s18, 0x240000
    s_mov_b32 s19, 0x20000
    v_bfe_u32 v4, v7, 3, 2
    v_xor_b32 v4, v4, v7
    v_lshlrev_b32 v4, 4, v4
    s_lshl_b32 s36, s3, 10
    v_add_u32 v4, s36, v4
    v_add_u32 v0, 81920, v4
    v_add_u32 v1, 36864, v0
    v_add_u32 v5, 36864, v4
    v_mov_b32 v9, 0
    s_cmp_lg_u32 s29, 0
    s_cbranch_scc1 L2_haved
    s_mov_b32 s31, 400000
L2_pd:
    buffer_load_dwordx2 v[2:3], v9, s[12:15], s28 offen sc1
    s_waitcnt vmcnt(0)
    v_cmp_ne_u64 vcc, s[44:45], v[2:3]
    s_nop 1
    s_and_b64 vcc, vcc, exec
    s_cbranch_scc0 L2_pd_ok
    s_sleep 1
    s_sub_u32 s31, s31, 1
    s_cmp_lg_u32 s31, 0
    s_cbranch_scc1 L2_pd
L2_pd_ok:
    buffer_load_dwordx4 v[96:99], v8, s[12:15], s27 offen sc1
    s_add_u32 s27, s27, 4096
    buffer_load_dwordx4 v[100:103], v8, s[12:15], s27 offen sc1
    s_add_u32 s27, s27, 4096
    buffer_load_dwordx4 v[104:107], v8, s[12:15], s27 offen sc1
    s_add_u32 s27, s27, 4096
    buffer_load_dwordx4 v[108:111], v8, s[12:15], s27 offen sc1
    s_add_u32 s27, s27, 4096
    buffer_load_dwordx4 v[112:115], v8, s[12:15], s27 offen sc1
    s_add_u32 s27, s27, 4096
L2_haved:
    v_mov_b32 v2, 157712
L2_fg:
    ds_read_b32 v3, v2
    s_waitcnt lgkmcnt(0)
    v_readfirstlane_b32 s30, v3
    s_cmp_ge_u32 s30, 4
    s_cbranch_scc1 L2_fg_ok
    s_sleep 1
    s_branch L2_fg
L2_fg_ok:
    ds_read_b128 v[128:131], v0 offset:0
    ds_read_b128 v[132:135], v0 offset:18432
    ds_read_b128 v[136:139], v1 offset:0
    ds_read_b128 v[140:143], v1 offset:18432
    ds_read_b128 v[144:147], v0 offset:4096
    ds_read_b128 v[148:151], v0 offset:22528
    ds_read_b128 v[152:155], v1 offset:4096
    ds_read_b128 v[156:159], v1 offset:22528
    ds_read_b128 v[160:163], v0 offset:8192
    ds_read_b128 v[164:167], v0 offset:26624
    ds_read_b128 v[168:171], v1 offset:8192
    ds_read_b128 v[172:175], v1 offset:26624
    ds_read_b128 v[176:179], v0 offset:12288
    ds_read_b128 v[180:183], v0 offset:30720
    ds_read_b128 v[184:187], v1 offset:12288
    ds_read_b128 v[188:191], v1 offset:30720
    ds_read_b128 v[192:195], v0 offset:16384
    ds_read_b128 v[196:199], v0 offset:34816
    ds_read_b128 v[200:203], v1 offset:16384
    ds_read_b128 v[204:207], v1 offset:34816
    v_lshlrev_b32 v48, 16, v116
    v_and_b32 v49, 0xffff0000, v116
    v_lshlrev_b32 v50, 16, v117
    v_and_b32 v51, 0xffff0000, v117
    v_lshlrev_b32 v52, 16, v118
    v_and_b32 v53, 0xffff0000, v118
    v_lshlrev_b32 v54, 16, v119
    v_and_b32 v55, 0xffff0000, v119
    v_lshlrev_b32 v56, 16, v120
    v_and_b32 v57, 0xffff0000, v120
    v_lshlrev_b32 v58, 16, v121
    v_and_b32 v59, 0xffff0000, v121
    v_lshlrev_b32 v60, 16, v122
    v_and_b32 v61, 0xffff0000, v122
    v_lshlrev_b32 v62, 16, v123
    v_and_b32 v63, 0xffff0000, v123
    v_lshlrev_b32 v64, 16, v124
    v_and_b32 v65, 0xffff0000, v124
    v_lshlrev_b32 v66, 16, v125
    v_and_b32 v67, 0xffff0000, v125
    s_waitcnt lgkmcnt(15)
    v_pk_add_f32 v[128:129], v[128:129], v[132:133]
    v_pk_add_f32 v[130:131], v[130:131], v[134:135]
    v_pk_add_f32 v[136:137], v[136:137], v[140:141]
    v_pk_add_f32 v[138:139], v[138:139], v[142:143]
    v_pk_add_f32 v[24:25], v[128:129], v[136:137]
    v_pk_add_f32 v[26:27], v[130:131], v[138:139]
    s_waitcnt lgkmcnt(12)
    v_pk_add_f32 v[144:145], v[144:145], v[148:149]
    v_pk_add_f32 v[146:147], v[146:147], v[150:151]
    v_pk_add_f32 v[152:153], v[152:153], v[156:157]
    v_pk_add_f32 v[154:155], v[154:155], v[158:159]
    v_pk_add_f32 v[28:29], v[144:145], v[152:153]
    v_pk_add_f32 v[30:31], v[146:147], v[154:155]
    s_waitcnt lgkmcnt(8)
    v_pk_add_f32 v[160:161], v[160:161], v[164:165]
    v_pk_add_f32 v[162:163], v[162:163], v[166:167]
    v_pk_add_f32 v[168:169], v[168:169], v[172:173]
    v_pk_add_f32 v[170:171], v[170:171], v[174:175]
    v_pk_add_f32 v[32:33], v[160:161], v[168:169]
    v_pk_add_f32 v[34:35], v[162:163], v[170:171]
    s_waitcnt lgkmcnt(4)
    v_pk_add_f32 v[176:177], v[176:177], v[180:181]
    v_pk_add_f32 v[178:179], v[178:179], v[182:183]
    v_pk_add_f32 v[184:185], v[184:185], v[188:189]
    v_pk_add_f32 v[186:187], v[186:187], v[190:191]
    v_pk_add_f32 v[36:37], v[176:177], v[184:185]
    v_pk_add_f32 v[38:39], v[178:179], v[186:187]
    s_waitcnt lgkmcnt(0)
    v_pk_add_f32 v[192:193], v[192:193], v[196:197]
    v_pk_add_f32 v[194:195], v[194:195], v[198:199]
    v_pk_add_f32 v[200:201], v[200:201], v[204:205]
    v_pk_add_f32 v[202:203], v[202:203], v[206:207]
    v_pk_add_f32 v[40:41], v[192:193], v[200:201]
    v_pk_add_f32 v[42:43], v[194:195], v[202:203]
    s_mov_b32 s26, 0xbfb8aa3b
    s_mov_b32 s27, s26
    s_waitcnt vmcnt(0)
    v_pk_add_f32 v[24:25], v[24:25], v[96:97]
    v_pk_add_f32 v[26:27], v[26:27], v[98:99]
    v_pk_add_f32 v[28:29], v[28:29], v[100:101]
    v_pk_add_f32 v[30:31], v[30:31], v[102:103]
    v_pk_add_f32 v[32:33], v[32:33], v[104:105]
    v_pk_add_f32 v[34:35], v[34:35], v[106:107]
    v_pk_add_f32 v[36:37], v[36:37], v[108:109]
    v_pk_add_f32 v[38:39], v[38:39], v[110:111]
    v_pk_add_f32 v[40:41], v[40:41], v[112:113]
    v_pk_add_f32 v[42:43], v[42:43], v[114:115]
    v_pk_mul_f32 v[96:97], v[24:25], s[26:27]
    v_pk_mul_f32 v[98:99], v[26:27], s[26:27]
    v_pk_mul_f32 v[100:101], v[28:29], s[26:27]
    v_pk_mul_f32 v[102:103], v[30:31], s[26:27]
    v_pk_mul_f32 v[104:105], v[32:33], s[26:27]
    v_pk_mul_f32 v[106:107], v[34:35], s[26:27]
    v_pk_mul_f32 v[108:109], v[36:37], s[26:27]
    v_pk_mul_f32 v[110:111], v[38:39], s[26:27]
    v_pk_mul_f32 v[112:113], v[40:41], s[26:27]
    v_pk_mul_f32 v[114:115], v[42:43], s[26:27]
    v_exp_f32 v96, v96
    v_exp_f32 v97, v97
    v_exp_f32 v98, v98
    v_exp_f32 v99, v99
    v_exp_f32 v100, v100
    v_exp_f32 v101, v101
    v_exp_f32 v102, v102
    v_exp_f32 v103, v103
    v_exp_f32 v104, v104
    v_exp_f32 v105, v105
    v_exp_f32 v106, v106
    v_exp_f32 v107, v107
    v_exp_f32 v108, v108
    v_exp_f32 v109, v109
    v_exp_f32 v110, v110
    v_exp_f32 v111, v111
    v_exp_f32 v112, v112
    v_exp_f32 v113, v113
    v_exp_f32 v114, v114
    v_exp_f32 v115, v115
    v_pk_add_f32 v[96:97], v[96:97], 1.0 op_sel_hi:[1,0]
    v_pk_add_f32 v[98:99], v[98:99], 1.0 op_sel_hi:[1,0]
    v_pk_add_f32 v[100:101], v[100:101], 1.0 op_sel_hi:[1,0]
    v_pk_add_f32 v[102:103], v[102:103], 1.0 op_sel_hi:[1,0]
    v_pk_add_f32 v[104:105], v[104:105], 1.0 op_sel_hi:[1,0]
    v_pk_add_f32 v[106:107], v[106:107], 1.0 op_sel_hi:[1,0]
    v_pk_add_f32 v[108:109], v[108:109], 1.0 op_sel_hi:[1,0]
    v_pk_add_f32 v[110:111], v[110:111], 1.0 op_sel_hi:[1,0]
    v_pk_add_f32 v[112:113], v[112:113], 1.0 op_sel_hi:[1,0]
    v_pk_add_f32 v[114:115], v[114:115], 1.0 op_sel_hi:[1,0]
    v_rcp_f32 v96, v96
    v_rcp_f32 v97, v97
    v_rcp_f32 v98, v98
    v_rcp_f32 v99, v99
    v_rcp_f32 v100, v100
    v_rcp_f32 v101, v101
    v_rcp_f32 v102, v102
    v_rcp_f32 v103, v103
    v_rcp_f32 v104, v104
    v_rcp_f32 v105, v105
    v_rcp_f32 v106, v106
    v_rcp_f32 v107, v107
    v_rcp_f32 v108, v108
    v_rcp_f32 v109, v109
    v_rcp_f32 v110, v110
    v_rcp_f32 v111, v111
    v_rcp_f32 v112, v112
    v_rcp_f32 v113, v113
    v_rcp_f32 v114, v114
    v_rcp_f32 v115, v115
    v_pk_mul_f32 v[24:25], v[24:25], v[96:97]
    v_pk_mul_f32 v[26:27], v[26:27], v[98:99]
    v_pk_mul_f32 v[28:29], v[28:29], v[100:101]
    v_pk_mul_f32 v[30:31], v[30:31], v[102:103]
    v_pk_mul_f32 v[32:33], v[32:33], v[104:105]
    v_pk_mul_f32 v[34:35], v[34:35], v[106:107]
    v_pk_mul_f32 v[36:37], v[36:37], v[108:109]
    v_pk_mul_f32 v[38:39], v[38:39], v[110:111]
    v_pk_mul_f32 v[40:41], v[40:41], v[112:113]
    v_pk_mul_f32 v[42:43], v[42:43], v[114:115]
    v_mov_b32 v2, 157728
L2_p3w:
    ds_read_b32 v3, v2
    s_waitcnt lgkmcnt(0)
    v_readfirstlane_b32 s30, v3
    s_cmp_ge_u32 s30, 4
    s_cbranch_scc1 L2_p3w_ok
    s_sleep 1
    s_branch L2_p3w
L2_p3w_ok:
    ds_read_b128 v[128:131], v4 offset:0
    ds_read_b128 v[132:135], v4 offset:18432
    ds_read_b128 v[136:139], v5 offset:0
    ds_read_b128 v[140:143], v5 offset:18432
    ds_read_b128 v[144:147], v4 offset:4096
    ds_read_b128 v[148:151], v4 offset:22528
    ds_read_b128 v[152:155], v5 offset:4096
    ds_read_b128 v[156:159], v5 offset:22528
    ds_read_b128 v[160:163], v4 offset:8192
    ds_read_b128 v[164:167], v4 offset:26624
    ds_read_b128 v[168:171], v5 offset:8192
    ds_read_b128 v[172:175], v5 offset:26624
    ds_read_b128 v[176:179], v4 offset:12288
    ds_read_b128 v[180:183], v4 offset:30720
    ds_read_b128 v[184:187], v5 offset:12288
    ds_read_b128 v[188:191], v5 offset:30720
    ds_read_b128 v[192:195], v4 offset:16384
    ds_read_b128 v[196:199], v4 offset:34816
    ds_read_b128 v[200:203], v5 offset:16384
    ds_read_b128 v[204:207], v5 offset:34816
    s_waitcnt lgkmcnt(15)
    v_pk_add_f32 v[128:129], v[128:129], v[132:133]
    v_pk_add_f32 v[130:131], v[130:131], v[134:135]
    v_pk_add_f32 v[136:137], v[136:137], v[140:141]
    v_pk_add_f32 v[138:139], v[138:139], v[142:143]
    v_pk_add_f32 v[128:129], v[128:129], v[136:137]
    v_pk_add_f32 v[130:131], v[130:131], v[138:139]
    v_pk_fma_f32 v[128:129], v[128:129], v[24:25], v[48:49]
    v_pk_fma_f32 v[130:131], v[130:131], v[26:27], v[50:51]
    v_cvt_pk_bf16_f32 v136, v128, v129
    v_cvt_pk_bf16_f32 v137, v130, v131
    buffer_store_dwordx2 v[136:137], v6, s[16:19], s50 offen
    s_waitcnt lgkmcnt(12)
    v_pk_add_f32 v[144:145], v[144:145], v[148:149]
    v_pk_add_f32 v[146:147], v[146:147], v[150:151]
    v_pk_add_f32 v[152:153], v[152:153], v[156:157]
    v_pk_add_f32 v[154:155], v[154:155], v[158:159]
    v_pk_add_f32 v[144:145], v[144:145], v[152:153]
    v_pk_add_f32 v[146:147], v[146:147], v[154:155]
    v_pk_fma_f32 v[144:145], v[144:145], v[28:29], v[52:53]
    v_pk_fma_f32 v[146:147], v[146:147], v[30:31], v[54:55]
    v_cvt_pk_bf16_f32 v152, v144, v145
    v_cvt_pk_bf16_f32 v153, v146, v147
    buffer_store_dwordx2 v[152:153], v6, s[16:19], s51 offen
    s_waitcnt lgkmcnt(8)
    v_pk_add_f32 v[160:161], v[160:161], v[164:165]
    v_pk_add_f32 v[162:163], v[162:163], v[166:167]
    v_pk_add_f32 v[168:169], v[168:169], v[172:173]
    v_pk_add_f32 v[170:171], v[170:171], v[174:175]
    v_pk_add_f32 v[160:161], v[160:161], v[168:169]
    v_pk_add_f32 v[162:163], v[162:163], v[170:171]
    v_pk_fma_f32 v[160:161], v[160:161], v[32:33], v[56:57]
    v_pk_fma_f32 v[162:163], v[162:163], v[34:35], v[58:59]
    v_cvt_pk_bf16_f32 v168, v160, v161
    v_cvt_pk_bf16_f32 v169, v162, v163
    buffer_store_dwordx2 v[168:169], v6, s[16:19], s47 offen
    s_waitcnt lgkmcnt(4)
    v_pk_add_f32 v[176:177], v[176:177], v[180:181]
    v_pk_add_f32 v[178:179], v[178:179], v[182:183]
    v_pk_add_f32 v[184:185], v[184:185], v[188:189]
    v_pk_add_f32 v[186:187], v[186:187], v[190:191]
    v_pk_add_f32 v[176:177], v[176:177], v[184:185]
    v_pk_add_f32 v[178:179], v[178:179], v[186:187]
    v_pk_fma_f32 v[176:177], v[176:177], v[36:37], v[60:61]
    v_pk_fma_f32 v[178:179], v[178:179], v[38:39], v[62:63]
    v_cvt_pk_bf16_f32 v184, v176, v177
    v_cvt_pk_bf16_f32 v185, v178, v179
    buffer_store_dwordx2 v[184:185], v6, s[16:19], s64 offen
    s_waitcnt lgkmcnt(0)
    v_pk_add_f32 v[192:193], v[192:193], v[196:197]
    v_pk_add_f32 v[194:195], v[194:195], v[198:199]
    v_pk_add_f32 v[200:201], v[200:201], v[204:205]
    v_pk_add_f32 v[202:203], v[202:203], v[206:207]
    v_pk_add_f32 v[192:193], v[192:193], v[200:201]
    v_pk_add_f32 v[194:195], v[194:195], v[202:203]
    v_pk_fma_f32 v[192:193], v[192:193], v[40:41], v[64:65]
    v_pk_fma_f32 v[194:195], v[194:195], v[42:43], v[66:67]
    v_cvt_pk_bf16_f32 v200, v192, v193
    v_cvt_pk_bf16_f32 v201, v194, v195
    buffer_store_dwordx2 v[200:201], v6, s[16:19], s65 offen
    s_endpgm
L2_att_fallback:
    s_mov_b32 s24, 1
    s_mov_b32 s23, 16
    s_waitcnt vmcnt(0)
    s_lshl_b32 s36, s3, 14
    s_add_u32 s20, s48, s36
    s_add_u32 s20, s20, 12582912
    s_lshl_b32 s36, s3, 11
    s_add_u32 s21, s49, s36
    s_add_u32 s21, s21, 14942208
    s_mul_i32 s22, s63, 81920
    s_mul_i32 s36, s3, 20480
    s_add_u32 s22, s22, s36
    s_add_u32 s22, s22, 15728640
    v_mov_b32 v81, 0
    v_mov_b32 v40, 0xff800000
    v_mov_b32 v83, 0
    v_mov_b32 v41, 0xff800000
    v_mov_b32 v85, 0
    v_mov_b32 v42, 0xff800000
    v_mov_b32 v87, 0
    v_mov_b32 v43, 0xff800000
    v_mov_b32 v89, 0
    v_mov_b32 v44, 0xff800000
    v_mov_b32 v91, 0
    v_mov_b32 v45, 0xff800000
    v_mov_b32 v93, 0
    v_mov_b32 v46, 0xff800000
    v_mov_b32 v95, 0
    v_mov_b32 v47, 0xff800000
L2_att_fb_loop:
    buffer_load_dwordx4 v[12:15], v8, s[12:15], s20 offen sc1
    buffer_load_dword v24, v10, s[12:15], s21 offen sc1
    s_add_u32 s20, s20, 1024
    s_add_u32 s21, s21, 128
    s_waitcnt vmcnt(0)
    v_mfma_f32_32x32x16_bf16 v[96:111], v[12:15], v[48:51], 0
    v_mfma_f32_32x32x8_bf16 v[96:111], v[24:25], v[80:81], v[96:111]
    s_nop 7
    s_nop 3
    v_max3_f32 v40, v40, v96, v97
    v_max3_f32 v40, v40, v98, v99
    v_max3_f32 v40, v40, v100, v101
    v_max3_f32 v40, v40, v102, v103
    v_max3_f32 v40, v40, v104, v105
    v_max3_f32 v40, v40, v106, v107
    v_max3_f32 v40, v40, v108, v109
    v_max3_f32 v40, v40, v110, v111
    v_mfma_f32_32x32x16_bf16 v[96:111], v[12:15], v[52:55], 0
    v_mfma_f32_32x32x8_bf16 v[96:111], v[24:25], v[82:83], v[96:111]
    s_nop 7
    s_nop 3
    v_max3_f32 v41, v41, v96, v97
    v_max3_f32 v41, v41, v98, v99
    v_max3_f32 v41, v41, v100, v101
    v_max3_f32 v41, v41, v102, v103
    v_max3_f32 v41, v41, v104, v105
    v_max3_f32 v41, v41, v106, v107
    v_max3_f32 v41, v41, v108, v109
    v_max3_f32 v41, v41, v110, v111
    v_mfma_f32_32x32x16_bf16 v[96:111], v[12:15], v[56:59], 0
    v_mfma_f32_32x32x8_bf16 v[96:111], v[24:25], v[84:85], v[96:111]
    s_nop 7
    s_nop 3
    v_max3_f32 v42, v42, v96, v97
    v_max3_f32 v42, v42, v98, v99
    v_max3_f32 v42, v42, v100, v101
    v_max3_f32 v42, v42, v102, v103
    v_max3_f32 v42, v42, v104, v105
    v_max3_f32 v42, v42, v106, v107
    v_max3_f32 v42, v42, v108, v109
    v_max3_f32 v42, v42, v110, v111
    v_mfma_f32_32x32x16_bf16 v[96:111], v[12:15], v[60:63], 0
    v_mfma_f32_32x32x8_bf16 v[96:111], v[24:25], v[86:87], v[96:111]
    s_nop 7
    s_nop 3
    v_max3_f32 v43, v43, v96, v97
    v_max3_f32 v43, v43, v98, v99
    v_max3_f32 v43, v43, v100, v101
    v_max3_f32 v43, v43, v102, v103
    v_max3_f32 v43, v43, v104, v105
    v_max3_f32 v43, v43, v106, v107
    v_max3_f32 v43, v43, v108, v109
    v_max3_f32 v43, v43, v110, v111
    v_mfma_f32_32x32x16_bf16 v[96:111], v[12:15], v[64:67], 0
    v_mfma_f32_32x32x8_bf16 v[96:111], v[24:25], v[88:89], v[96:111]
    s_nop 7
    s_nop 3
    v_max3_f32 v44, v44, v96, v97
    v_max3_f32 v44, v44, v98, v99
    v_max3_f32 v44, v44, v100, v101
    v_max3_f32 v44, v44, v102, v103
    v_max3_f32 v44, v44, v104, v105
    v_max3_f32 v44, v44, v106, v107
    v_max3_f32 v44, v44, v108, v109
    v_max3_f32 v44, v44, v110, v111
    v_mfma_f32_32x32x16_bf16 v[96:111], v[12:15], v[68:71], 0
    v_mfma_f32_32x32x8_bf16 v[96:111], v[24:25], v[90:91], v[96:111]
    s_nop 7
    s_nop 3
    v_max3_f32 v45, v45, v96, v97
    v_max3_f32 v45, v45, v98, v99
    v_max3_f32 v45, v45, v100, v101
    v_max3_f32 v45, v45, v102, v103
    v_max3_f32 v45, v45, v104, v105
    v_max3_f32 v45, v45, v106, v107
    v_max3_f32 v45, v45, v108, v109
    v_max3_f32 v45, v45, v110, v111
    v_mfma_f32_32x32x16_bf16 v[96:111], v[12:15], v[72:75], 0
    v_mfma_f32_32x32x8_bf16 v[96:111], v[24:25], v[92:93], v[96:111]
    s_nop 7
    s_nop 3
    v_max3_f32 v46, v46, v96, v97
    v_max3_f32 v46, v46, v98, v99
    v_max3_f32 v46, v46, v100, v101
    v_max3_f32 v46, v46, v102, v103
    v_max3_f32 v46, v46, v104, v105
    v_max3_f32 v46, v46, v106, v107
    v_max3_f32 v46, v46, v108, v109
    v_max3_f32 v46, v46, v110, v111
    v_mfma_f32_32x32x16_bf16 v[96:111], v[12:15], v[76:79], 0
    v_mfma_f32_32x32x8_bf16 v[96:111], v[24:25], v[94:95], v[96:111]
    s_nop 7
    s_nop 3
    v_max3_f32 v47, v47, v96, v97
    v_max3_f32 v47, v47, v98, v99
    v_max3_f32 v47, v47, v100, v101
    v_max3_f32 v47, v47, v102, v103
    v_max3_f32 v47, v47, v104, v105
    v_max3_f32 v47, v47, v106, v107
    v_max3_f32 v47, v47, v108, v109
    v_max3_f32 v47, v47, v110, v111
    s_sub_u32 s23, s23, 1
    s_cmp_lg_u32 s23, 0
    s_cbranch_scc1 L2_att_fb_loop
    v_mov_b32 v2, v40
    s_nop 1
    v_permlane32_swap_b32 v2, v40
    s_nop 1
    v_max_f32 v40, v40, v2
    v_mov_b32 v2, v41
    s_nop 1
    v_permlane32_swap_b32 v2, v41
    s_nop 1
    v_max_f32 v41, v41, v2
    v_mov_b32 v2, v42
    s_nop 1
    v_permlane32_swap_b32 v2, v42
    s_nop 1
    v_max_f32 v42, v42, v2
    v_mov_b32 v2, v43
    s_nop 1
    v_permlane32_swap_b32 v2, v43
    s_nop 1
    v_max_f32 v43, v43, v2
    v_mov_b32 v2, v44
    s_nop 1
    v_permlane32_swap_b32 v2, v44
    s_nop 1
    v_max_f32 v44, v44, v2
    v_mov_b32 v2, v45
    s_nop 1
    v_permlane32_swap_b32 v2, v45
    s_nop 1
    v_max_f32 v45, v45, v2
    v_mov_b32 v2, v46
    s_nop 1
    v_permlane32_swap_b32 v2, v46
    s_nop 1
    v_max_f32 v46, v46, v2
    v_mov_b32 v2, v47
    s_nop 1
    v_permlane32_swap_b32 v2, v47
    s_nop 1
    v_max_f32 v47, v47, v2
    s_lshl_b32 s36, s3, 11
    v_add_u32 v2, s36, v8
    ds_write_b128 v2, v[40:43]
    ds_write_b128 v2, v[44:47] offset:1024
    s_add_u32 s25, s25, 4
    v_mov_b32 v0, 157696
    v_mov_b32 v1, 1
    s_waitcnt lgkmcnt(0)
    s_mov_b64 exec, 1
    ds_add_u32 v0, v1
    s_mov_b64 exec, -1
L2_att_w2:
    ds_read_b32 v1, v0
    s_waitcnt lgkmcnt(0)
    v_readfirstlane_b32 s30, v1
    s_cmp_ge_u32 s30, s25
    s_cbranch_scc1 L2_att_w2_ok
    s_sleep 1
    s_branch L2_att_w2
L2_att_w2_ok:
    v_mov_b32 v2, v8
    ds_read_b128 v[96:99], v2 offset:0
    ds_read_b128 v[100:103], v2 offset:1024
    ds_read_b128 v[104:107], v2 offset:2048
    ds_read_b128 v[108:111], v2 offset:3072
    ds_read_b128 v[112:115], v2 offset:4096
    ds_read_b128 v[116:119], v2 offset:5120
    ds_read_b128 v[120:123], v2 offset:6144
    ds_read_b128 v[124:127], v2 offset:7168
    s_waitcnt lgkmcnt(0)
    v_max3_f32 v40, v96, v104, v112
    v_max_f32 v40, v40, v120
    v_max3_f32 v41, v97, v105, v113
    v_max_f32 v41, v41, v121
    v_max3_f32 v42, v98, v106, v114
    v_max_f32 v42, v42, v122
    v_max3_f32 v43, v99, v107, v115
    v_max_f32 v43, v43, v123
    v_max3_f32 v44, v100, v108, v116
    v_max_f32 v44, v44, v124
    v_max3_f32 v45, v101, v109, v117
    v_max_f32 v45, v45, v125
    v_max3_f32 v46, v102, v110, v118
    v_max_f32 v46, v46, v126
    v_max3_f32 v47, v103, v111, v119
    v_max_f32 v47, v47, v127
    s_add_u32 s25, s25, 4
    v_mov_b32 v0, 157696
    v_mov_b32 v1, 1
    s_waitcnt lgkmcnt(0)
    s_mov_b64 exec, 1
    ds_add_u32 v0, v1
    s_mov_b64 exec, -1
L2_att_w3:
    ds_read_b32 v1, v0
    s_waitcnt lgkmcnt(0)
    v_readfirstlane_b32 s30, v1
    s_cmp_ge_u32 s30, s25
    s_cbranch_scc1 L2_att_w3_ok
    s_sleep 1
    s_branch L2_att_w3
L2_att_w3_ok:
    s_mov_b64 exec, s[60:61]
    v_mov_b32 v30, 0
    v_mov_b32 v31, 0
    v_mov_b32 v32, 0
    v_mov_b32 v33, 0
    v_mov_b32 v34, 0
    v_mov_b32 v35, 0
    v_mov_b32 v36, 0
    v_mov_b32 v37, 0
    s_mov_b64 exec, -1
    s_lshl_b32 s36, s3, 14
    s_add_u32 s20, s48, s36
    s_add_u32 s20, s20, 12582912
    s_lshl_b32 s36, s3, 11
    s_add_u32 s21, s49, s36
    s_add_u32 s21, s21, 14942208
    s_mul_i32 s22, s63, 81920
    s_mul_i32 s36, s3, 20480
    s_add_u32 s22, s22, s36
    s_add_u32 s22, s22, 15728640
    buffer_load_dwordx4 v[12:15], v8, s[12:15], s20 offen sc1
    buffer_load_dword v24, v10, s[12:15], s21 offen sc1
    s_add_u32 s20, s20, 1024
    s_add_u32 s21, s21, 128
    s_mov_b64 exec, s[60:61]
    buffer_load_dwordx4 v[16:19], v9, s[12:15], s22 offen sc1
    buffer_load_dwordx4 v[20:23], v9, s[12:15], s22 offen offset:640 sc1
    s_mov_b64 exec, -1
    s_add_u32 s22, s22, 1280
    buffer_load_dwordx4 v[26:29], v8, s[12:15], s20 offen sc1
    buffer_load_dword v38, v10, s[12:15], s21 offen sc1
    s_add_u32 s20, s20, 1024
    s_add_u32 s21, s21, 128
    v_cmp_gt_u32 vcc, 32, v7
    s_nop 1
    v_cvt_pk_bf16_f32 v0, -v40, -v40
    v_and_b32 v1, 0xffff0000, v0
    v_sub_f32 v1, -v40, v1
    v_cvt_pk_bf16_f32 v0, -v40, v1
    v_cndmask_b32 v81, 0, v0, vcc
    v_cvt_pk_bf16_f32 v0, -v41, -v41
    v_and_b32 v1, 0xffff0000, v0
    v_sub_f32 v1, -v41, v1
    v_cvt_pk_bf16_f32 v0, -v41, v1
    v_cndmask_b32 v83, 0, v0, vcc
    v_cvt_pk_bf16_f32 v0, -v42, -v42
    v_and_b32 v1, 0xffff0000, v0
    v_sub_f32 v1, -v42, v1
    v_cvt_pk_bf16_f32 v0, -v42, v1
    v_cndmask_b32 v85, 0, v0, vcc
    v_cvt_pk_bf16_f32 v0, -v43, -v43
    v_and_b32 v1, 0xffff0000, v0
    v_sub_f32 v1, -v43, v1
    v_cvt_pk_bf16_f32 v0, -v43, v1
    v_cndmask_b32 v87, 0, v0, vcc
    v_cvt_pk_bf16_f32 v0, -v44, -v44
    v_and_b32 v1, 0xffff0000, v0
    v_sub_f32 v1, -v44, v1
    v_cvt_pk_bf16_f32 v0, -v44, v1
    v_cndmask_b32 v89, 0, v0, vcc
    v_cvt_pk_bf16_f32 v0, -v45, -v45
    v_and_b32 v1, 0xffff0000, v0
    v_sub_f32 v1, -v45, v1
    v_cvt_pk_bf16_f32 v0, -v45, v1
    v_cndmask_b32 v91, 0, v0, vcc
    v_cvt_pk_bf16_f32 v0, -v46, -v46
    v_and_b32 v1, 0xffff0000, v0
    v_sub_f32 v1, -v46, v1
    v_cvt_pk_bf16_f32 v0, -v46, v1
    v_cndmask_b32 v93, 0, v0, vcc
    v_cvt_pk_bf16_f32 v0, -v47, -v47
    v_and_b32 v1, 0xffff0000, v0
    v_sub_f32 v1, -v47, v1
    v_cvt_pk_bf16_f32 v0, -v47, v1
    v_cndmask_b32 v95, 0, v0, vcc
    v_mov_b64 v[4:5], 0
    v_mov_b32 v2, 0
    s_nop 1
    v_mfma_f32_32x32x8_bf16 v[128:143], v[4:5], v[4:5], 0
    v_mfma_f32_32x32x8_bf16 v[144:159], v[4:5], v[4:5], 0
    v_mfma_f32_32x32x8_bf16 v[160:175], v[4:5], v[4:5], 0
    v_mfma_f32_32x32x8_bf16 v[176:191], v[4:5], v[4:5], 0
    v_mfma_f32_32x32x8_bf16 v[192:207], v[4:5], v[4:5], 0
    v_mfma_f32_32x32x8_bf16 v[208:223], v[4:5], v[4:5], 0
    v_mfma_f32_32x32x8_bf16 v[224:239], v[4:5], v[4:5], 0
    v_mfma_f32_32x32x8_bf16 v[240:255], v[4:5], v[4:5], 0
    s_waitcnt vmcnt(2)
    s_branch L2_att_go
L2_gemm:
    s_sub_u32 s3, s3, 4
    v_mov_b32 v2, 0
    v_mov_b32 v3, 0
    s_and_b32 s32, s41, 1
    s_lshr_b32 s33, s41, 1
    s_lshl_b32 s33, s33, 3
    s_lshr_b32 s34, s42, 2
    s_add_u32 s33, s33, s34
    s_and_b32 s34, s42, 3
    s_mul_i32 s35, s32, 72
    s_mul_i32 s36, s3, 18
    s_add_u32 s35, s35, s36
    s_mul_i32 s36, s34, 144
    s_add_u32 s36, s36, s35
    s_mul_i32 s20, s36, 9216
    s_add_u32 s20, s20, 3145728
    s_mul_i32 s36, s33, 144
    s_add_u32 s36, s36, s35
    s_lshl_b32 s21, s36, 12
    s_add_u32 s21, s21, 18874368
    v_and_b32 v6, 7, v7
    v_min_u32 v6, 5, v6
    v_lshlrev_b32 v6, 3, v6
    s_lshl_b32 s36, s33, 3
    s_lshl_b32 s37, s32, 2
    s_add_u32 s36, s36, s37
    s_add_u32 s36, s36, s3
    s_lshl_b32 s36, s36, 6
    s_add_u32 s36, s36, 40398848
    s_lshl_b32 s24, s34, 2
    s_add_u32 s24, s24, s3
    s_mul_i32 s25, s24, 5120
    s_add_u32 s25, s25, 10027008
    s_mul_i32 s24, s24, 36864
    s_add_u32 s24, s24, 9437184
    v_mfma_f32_32x32x8_bf16 v[112:127], v[2:3], v[2:3], 0
    v_mfma_f32_32x32x8_bf16 v[128:143], v[2:3], v[2:3], 0
    v_mfma_f32_32x32x8_bf16 v[144:159], v[2:3], v[2:3], 0
    v_mfma_f32_32x32x8_bf16 v[160:175], v[2:3], v[2:3], 0
    v_mfma_f32_32x32x8_bf16 v[176:191], v[2:3], v[2:3], 0
    v_mfma_f32_32x32x8_bf16 v[192:207], v[2:3], v[2:3], 0
    v_mfma_f32_32x32x8_bf16 v[208:223], v[2:3], v[2:3], 0
    v_mfma_f32_32x32x8_bf16 v[224:239], v[2:3], v[2:3], 0
    v_mfma_f32_32x32x8_bf16 v[240:255], v[2:3], v[2:3], 0
    s_add_u32 s37, s36, 16384
    s_mov_b32 s38, 40396808
    buffer_load_dwordx2 v[8:9], v4, s[12:15], s38 offen sc1
    s_mov_b32 s31, 400000
L2_ph1:
    buffer_load_dwordx2 v[0:1], v6, s[12:15], s37 offen sc1
    s_waitcnt vmcnt(0)
    v_cmp_ne_u64 vcc, s[44:45], v[0:1]
    s_nop 1
    s_and_b64 vcc, vcc, exec
    s_cbranch_scc0 L2_ph1_ok
    s_sleep 4
    s_sub_u32 s31, s31, 1
    s_cmp_lg_u32 s31, 0
    s_cbranch_scc1 L2_ph1
L2_ph1_ok:
    v_mov_b32 v0, s44
    v_mov_b32 v1, s45
    v_mov_b32 v2, 0
    s_waitcnt vmcnt(0)
    s_mov_b64 exec, 1
    buffer_store_dwordx2 v[0:1], v2, s[12:15], s46 offen sc1
    s_mov_b64 exec, -1
    v_cmp_ne_u64 vcc, s[44:45], v[8:9]
    s_nop 1
    s_and_b64 vcc, vcc, exec
    s_cbranch_scc0 L2_pw_ok
    s_mov_b32 s31, 400000
L2_pw:
    buffer_load_dwordx2 v[8:9], v4, s[12:15], s38 offen sc1
    s_waitcnt vmcnt(0)
    v_cmp_ne_u64 vcc, s[44:45], v[8:9]
    s_nop 1
    s_and_b64 vcc, vcc, exec
    s_cbranch_scc0 L2_pw_ok
    s_sleep 4
    s_sub_u32 s31, s31, 1
    s_cmp_lg_u32 s31, 0
    s_cbranch_scc1 L2_pw
L2_pw_ok:
    s_lshl_b32 s29, s32, 11
    v_add_u32 v5, s29, v4
    v_xor_b32 v3, 0x800, v5
    buffer_load_dwordx4 v[24:27], v4, s[12:15], s20 offen offset:0 sc1
    buffer_load_dwordx4 v[28:31], v4, s[12:15], s20 offen offset:1024 sc1
    buffer_load_dwordx4 v[32:35], v4, s[12:15], s20 offen offset:2048 sc1
    s_add_u32 s20, s20, 3072
    s_waitcnt vmcnt(4)
    buffer_load_dwordx4 v[36:39], v4, s[12:15], s20 offen offset:0 sc1
    buffer_load_dwordx4 v[40:43], v4, s[12:15], s20 offen offset:1024 sc1
    buffer_load_dwordx4 v[44:47], v4, s[12:15], s20 offen offset:2048 sc1
    s_add_u32 s20, s20, 3072
    s_waitcnt vmcnt(4)
    buffer_load_dwordx4 v[48:51], v4, s[12:15], s20 offen offset:0 sc1
    buffer_load_dwordx4 v[52:55], v4, s[12:15], s20 offen offset:1024 sc1
    buffer_load_dwordx4 v[56:59], v4, s[12:15], s20 offen offset:2048 sc1
    s_add_u32 s20, s20, 3072
    s_waitcnt vmcnt(4)
    buffer_load_dwordx4 v[8:11], v5, s[12:15], s21 offen offset:0 sc1
    buffer_load_dwordx4 v[12:15], v5, s[12:15], s21 offen offset:1024 sc1
    buffer_load_dwordx4 v[16:19], v3, s[12:15], s21 offen offset:0 sc1
    buffer_load_dwordx4 v[20:23], v3, s[12:15], s21 offen offset:1024 sc1
    s_add_u32 s21, s21, 4096
    s_waitcnt vmcnt(4)
    buffer_load_dwordx4 v[76:79], v4, s[12:15], s20 offen offset:0 sc1
    buffer_load_dwordx4 v[80:83], v4, s[12:15], s20 offen offset:1024 sc1
    buffer_load_dwordx4 v[84:87], v4, s[12:15], s20 offen offset:2048 sc1
    s_add_u32 s20, s20, 3072
    s_waitcnt vmcnt(4)
    buffer_load_dwordx4 v[88:91], v4, s[12:15], s20 offen offset:0 sc1
    buffer_load_dwordx4 v[92:95], v4, s[12:15], s20 offen offset:1024 sc1
    buffer_load_dwordx4 v[96:99], v4, s[12:15], s20 offen offset:2048 sc1
    s_add_u32 s20, s20, 3072
    s_waitcnt vmcnt(4)
    buffer_load_dwordx4 v[100:103], v4, s[12:15], s20 offen offset:0 sc1
    buffer_load_dwordx4 v[104:107], v4, s[12:15], s20 offen offset:1024 sc1
    buffer_load_dwordx4 v[108:111], v4, s[12:15], s20 offen offset:2048 sc1
    s_add_u32 s20, s20, 3072
    s_waitcnt vmcnt(4)
    buffer_load_dwordx4 v[60:63], v5, s[12:15], s21 offen offset:0 sc1
    buffer_load_dwordx4 v[64:67], v5, s[12:15], s21 offen offset:1024 sc1
    buffer_load_dwordx4 v[68:71], v3, s[12:15], s21 offen offset:0 sc1
    buffer_load_dwordx4 v[72:75], v3, s[12:15], s21 offen offset:1024 sc1
    s_add_u32 s21, s21, 4096
    s_mov_b32 s23, 9
    s_mov_b32 s26, 0x22a01010
    s_setprio 0
.p2align 3
L2_gemm_loop:
    s_cmp_lg_u32 s23, 4
    s_cbranch_scc1 L2_ph_ok
    s_setprio 3
    s_mov_b32 s31, 400000
L2_ph:
    buffer_load_dwordx2 v[0:1], v6, s[12:15], s36 offen sc1
    s_waitcnt vmcnt(0)
    v_cmp_ne_u64 vcc, s[44:45], v[0:1]
    s_nop 1
    s_and_b64 vcc, vcc, exec
    s_cbranch_scc0 L2_ph_ok
    s_sleep 4
    s_sub_u32 s31, s31, 1
    s_cmp_lg_u32 s31, 0
    s_cbranch_scc1 L2_ph
L2_ph_ok:
    s_setprio 0
    s_bfe_i32 s27, s26, 0x40000
    s_lshr_b32 s26, s26, 4
    s_mul_i32 s28, s27, 18432
    s_add_u32 s20, s20, s28
    s_lshl_b32 s28, s27, 13
    s_add_u32 s21, s21, s28
    s_sub_u32 s23, s23, 1
    s_cmp_eq_u32 s23, 0
    s_cbranch_scc0 L2_gnl
    s_mov_b32 s20, s24
    s_mov_b32 s21, s25
    s_setprio 3
    v_mov_b32 v5, v4
    v_xor_b32 v3, 0x800, v5
    s_setprio 0
L2_gnl:
    s_waitcnt vmcnt(13)
    v_mfma_f32_16x16x32_bf16 v[112:115], v[24:27], v[8:11], v[112:115]
    v_mfma_f32_16x16x32_bf16 v[148:151], v[24:27], v[12:15], v[148:151]
    v_mfma_f32_16x16x32_bf16 v[184:187], v[24:27], v[16:19], v[184:187]
    v_mfma_f32_16x16x32_bf16 v[220:223], v[24:27], v[20:23], v[220:223]
    v_mfma_f32_16x16x32_bf16 v[224:227], v[28:31], v[20:23], v[224:227]
    buffer_load_dwordx4 v[24:27], v4, s[12:15], s20 offen offset:0 sc1
    v_mfma_f32_16x16x32_bf16 v[188:191], v[28:31], v[16:19], v[188:191]
    v_mfma_f32_16x16x32_bf16 v[152:155], v[28:31], v[12:15], v[152:155]
    v_mfma_f32_16x16x32_bf16 v[116:119], v[28:31], v[8:11], v[116:119]
    v_mfma_f32_16x16x32_bf16 v[120:123], v[32:35], v[8:11], v[120:123]
    buffer_load_dwordx4 v[28:31], v4, s[12:15], s20 offen offset:1024 sc1
    v_mfma_f32_16x16x32_bf16 v[156:159], v[32:35], v[12:15], v[156:159]
    v_mfma_f32_16x16x32_bf16 v[192:195], v[32:35], v[16:19], v[192:195]
    v_mfma_f32_16x16x32_bf16 v[228:231], v[32:35], v[20:23], v[228:231]
    v_mfma_f32_16x16x32_bf16 v[232:235], v[36:39], v[20:23], v[232:235]
    buffer_load_dwordx4 v[32:35], v4, s[12:15], s20 offen offset:2048 sc1
    s_add_u32 s20, s20, 3072
    v_mfma_f32_16x16x32_bf16 v[196:199], v[36:39], v[16:19], v[196:199]
    v_mfma_f32_16x16x32_bf16 v[160:163], v[36:39], v[12:15], v[160:163]
    v_mfma_f32_16x16x32_bf16 v[124:127], v[36:39], v[8:11], v[124:127]
    v_mfma_f32_16x16x32_bf16 v[128:131], v[40:43], v[8:11], v[128:131]
    buffer_load_dwordx4 v[36:39], v4, s[12:15], s20 offen offset:0 sc1
    v_mfma_f32_16x16x32_bf16 v[164:167], v[40:43], v[12:15], v[164:167]
    v_mfma_f32_16x16x32_bf16 v[200:203], v[40:43], v[16:19], v[200:203]
    v_mfma_f32_16x16x32_bf16 v[236:239], v[40:43], v[20:23], v[236:239]
    v_mfma_f32_16x16x32_bf16 v[240:243], v[44:47], v[20:23], v[240:243]
    buffer_load_dwordx4 v[40:43], v4, s[12:15], s20 offen offset:1024 sc1
    v_mfma_f32_16x16x32_bf16 v[204:207], v[44:47], v[16:19], v[204:207]
    v_mfma_f32_16x16x32_bf16 v[168:171], v[44:47], v[12:15], v[168:171]
    v_mfma_f32_16x16x32_bf16 v[132:135], v[44:47], v[8:11], v[132:135]
    v_mfma_f32_16x16x32_bf16 v[136:139], v[48:51], v[8:11], v[136:139]
    buffer_load_dwordx4 v[44:47], v4, s[12:15], s20 offen offset:2048 sc1
    s_add_u32 s20, s20, 3072
    v_mfma_f32_16x16x32_bf16 v[172:175], v[48:51], v[12:15], v[172:175]
    v_mfma_f32_16x16x32_bf16 v[208:211], v[48:51], v[16:19], v[208:211]
    v_mfma_f32_16x16x32_bf16 v[244:247], v[48:51], v[20:23], v[244:247]
    v_mfma_f32_16x16x32_bf16 v[248:251], v[52:55], v[20:23], v[248:251]
    buffer_load_dwordx4 v[48:51], v4, s[12:15], s20 offen offset:0 sc1
    v_mfma_f32_16x16x32_bf16 v[212:215], v[52:55], v[16:19], v[212:215]
    v_mfma_f32_16x16x32_bf16 v[176:179], v[52:55], v[12:15], v[176:179]
    v_mfma_f32_16x16x32_bf16 v[140:143], v[52:55], v[8:11], v[140:143]
    v_mfma_f32_16x16x32_bf16 v[144:147], v[56:59], v[8:11], v[144:147]
    buffer_load_dwordx4 v[52:55], v4, s[12:15], s20 offen offset:1024 sc1
    v_mfma_f32_16x16x32_bf16 v[180:183], v[56:59], v[12:15], v[180:183]
    v_mfma_f32_16x16x32_bf16 v[216:219], v[56:59], v[16:19], v[216:219]
    v_mfma_f32_16x16x32_bf16 v[252:255], v[56:59], v[20:23], v[252:255]
    buffer_load_dwordx4 v[56:59], v4, s[12:15], s20 offen offset:2048 sc1
    s_add_u32 s20, s20, 3072
    buffer_load_dwordx4 v[8:11], v5, s[12:15], s21 offen offset:0 sc1
    buffer_load_dwordx4 v[12:15], v5, s[12:15], s21 offen offset:1024 sc1
    buffer_load_dwordx4 v[16:19], v3, s[12:15], s21 offen offset:0 sc1
    buffer_load_dwordx4 v[20:23], v3, s[12:15], s21 offen offset:1024 sc1
    s_add_u32 s21, s21, 4096
    s_waitcnt vmcnt(13)
    v_mfma_f32_16x16x32_bf16 v[112:115], v[76:79], v[60:63], v[112:115]
    v_mfma_f32_16x16x32_bf16 v[148:151], v[76:79], v[64:67], v[148:151]
    v_mfma_f32_16x16x32_bf16 v[184:187], v[76:79], v[68:71], v[184:187]
    v_mfma_f32_16x16x32_bf16 v[220:223], v[76:79], v[72:75], v[220:223]
    v_mfma_f32_16x16x32_bf16 v[224:227], v[80:83], v[72:75], v[224:227]
    buffer_load_dwordx4 v[76:79], v4, s[12:15], s20 offen offset:0 sc1
    v_mfma_f32_16x16x32_bf16 v[188:191], v[80:83], v[68:71], v[188:191]
    v_mfma_f32_16x16x32_bf16 v[152:155], v[80:83], v[64:67], v[152:155]
    v_mfma_f32_16x16x32_bf16 v[116:119], v[80:83], v[60:63], v[116:119]
    v_mfma_f32_16x16x32_bf16 v[120:123], v[84:87], v[60:63], v[120:123]
    buffer_load_dwordx4 v[80:83], v4, s[12:15], s20 offen offset:1024 sc1
    v_mfma_f32_16x16x32_bf16 v[156:159], v[84:87], v[64:67], v[156:159]
    v_mfma_f32_16x16x32_bf16 v[192:195], v[84:87], v[68:71], v[192:195]
    v_mfma_f32_16x16x32_bf16 v[228:231], v[84:87], v[72:75], v[228:231]
    v_mfma_f32_16x16x32_bf16 v[232:235], v[88:91], v[72:75], v[232:235]
    buffer_load_dwordx4 v[84:87], v4, s[12:15], s20 offen offset:2048 sc1
    s_add_u32 s20, s20, 3072
    v_mfma_f32_16x16x32_bf16 v[196:199], v[88:91], v[68:71], v[196:199]
    v_mfma_f32_16x16x32_bf16 v[160:163], v[88:91], v[64:67], v[160:163]
    v_mfma_f32_16x16x32_bf16 v[124:127], v[88:91], v[60:63], v[124:127]
    v_mfma_f32_16x16x32_bf16 v[128:131], v[92:95], v[60:63], v[128:131]
    buffer_load_dwordx4 v[88:91], v4, s[12:15], s20 offen offset:0 sc1
    v_mfma_f32_16x16x32_bf16 v[164:167], v[92:95], v[64:67], v[164:167]
    v_mfma_f32_16x16x32_bf16 v[200:203], v[92:95], v[68:71], v[200:203]
    v_mfma_f32_16x16x32_bf16 v[236:239], v[92:95], v[72:75], v[236:239]
    v_mfma_f32_16x16x32_bf16 v[240:243], v[96:99], v[72:75], v[240:243]
    buffer_load_dwordx4 v[92:95], v4, s[12:15], s20 offen offset:1024 sc1
    v_mfma_f32_16x16x32_bf16 v[204:207], v[96:99], v[68:71], v[204:207]
    v_mfma_f32_16x16x32_bf16 v[168:171], v[96:99], v[64:67], v[168:171]
    v_mfma_f32_16x16x32_bf16 v[132:135], v[96:99], v[60:63], v[132:135]
    v_mfma_f32_16x16x32_bf16 v[136:139], v[100:103], v[60:63], v[136:139]
    buffer_load_dwordx4 v[96:99], v4, s[12:15], s20 offen offset:2048 sc1
    s_add_u32 s20, s20, 3072
    v_mfma_f32_16x16x32_bf16 v[172:175], v[100:103], v[64:67], v[172:175]
    v_mfma_f32_16x16x32_bf16 v[208:211], v[100:103], v[68:71], v[208:211]
    v_mfma_f32_16x16x32_bf16 v[244:247], v[100:103], v[72:75], v[244:247]
    v_mfma_f32_16x16x32_bf16 v[248:251], v[104:107], v[72:75], v[248:251]
    buffer_load_dwordx4 v[100:103], v4, s[12:15], s20 offen offset:0 sc1
    v_mfma_f32_16x16x32_bf16 v[212:215], v[104:107], v[68:71], v[212:215]
    v_mfma_f32_16x16x32_bf16 v[176:179], v[104:107], v[64:67], v[176:179]
    v_mfma_f32_16x16x32_bf16 v[140:143], v[104:107], v[60:63], v[140:143]
    v_mfma_f32_16x16x32_bf16 v[144:147], v[108:111], v[60:63], v[144:147]
    buffer_load_dwordx4 v[104:107], v4, s[12:15], s20 offen offset:1024 sc1
    v_mfma_f32_16x16x32_bf16 v[180:183], v[108:111], v[64:67], v[180:183]
    v_mfma_f32_16x16x32_bf16 v[216:219], v[108:111], v[68:71], v[216:219]
    v_mfma_f32_16x16x32_bf16 v[252:255], v[108:111], v[72:75], v[252:255]
    buffer_load_dwordx4 v[108:111], v4, s[12:15], s20 offen offset:2048 sc1
    s_add_u32 s20, s20, 3072
    buffer_load_dwordx4 v[60:63], v5, s[12:15], s21 offen offset:0 sc1
    buffer_load_dwordx4 v[64:67], v5, s[12:15], s21 offen offset:1024 sc1
    buffer_load_dwordx4 v[68:71], v3, s[12:15], s21 offen offset:0 sc1
    buffer_load_dwordx4 v[72:75], v3, s[12:15], s21 offen offset:1024 sc1
    s_add_u32 s21, s21, 4096
    s_cmp_lg_u32 s23, 0
    s_cbranch_scc1 L2_gemm_loop
    s_setprio 3
    v_bfe_u32 v6, v7, 1, 2
    v_lshrrev_b32 v1, 4, v7
    v_xor_b32 v6, v6, v1
    v_and_b32 v1, 15, v7
    v_lshl_add_u32 v6, v1, 2, v6
    v_lshlrev_b32 v6, 4, v6
    s_mul_i32 s36, s3, 18432
    v_add_u32 v6, s36, v6
    v_add_u32 v5, 81920, v6
    ds_write_b128 v5, v[184:187] offset:0
    ds_write_b128 v5, v[220:223] offset:9216
    ds_write_b128 v5, v[188:191] offset:1024
    ds_write_b128 v5, v[224:227] offset:10240
    ds_write_b128 v5, v[192:195] offset:2048
    ds_write_b128 v5, v[228:231] offset:11264
    ds_write_b128 v5, v[196:199] offset:3072
    ds_write_b128 v5, v[232:235] offset:12288
    ds_write_b128 v5, v[200:203] offset:4096
    ds_write_b128 v5, v[236:239] offset:13312
    ds_write_b128 v5, v[204:207] offset:5120
    ds_write_b128 v5, v[240:243] offset:14336
    ds_write_b128 v5, v[208:211] offset:6144
    ds_write_b128 v5, v[244:247] offset:15360
    ds_write_b128 v5, v[212:215] offset:7168
    ds_write_b128 v5, v[248:251] offset:16384
    ds_write_b128 v5, v[216:219] offset:8192
    ds_write_b128 v5, v[252:255] offset:17408
    v_bfe_u32 v0, v7, 3, 2
    v_xor_b32 v0, v0, v7
    v_lshlrev_b32 v0, 4, v0
    s_lshl_b32 s36, s3, 10
    v_add_u32 v0, s36, v0
    v_add_u32 v0, 81920, v0
    v_add_u32 v1, 36864, v0
    s_xor_b32 s37, s32, 1
    s_lshl_b32 s35, s33, 2
    s_add_u32 s35, s35, s34
    s_lshl_b32 s35, s35, 1
    s_add_u32 s35, s35, s37
    s_lshl_b32 s36, s3, 10
    s_mul_i32 s26, s35, 20480
    s_add_u32 s26, s26, s36
    s_add_u32 s26, s26, 40894464
    s_lshl_b32 s35, s35, 2
    s_add_u32 s35, s35, s3
    s_lshl_b32 s35, s35, 3
    s_add_u32 s28, s35, 40386560
    v_mov_b32 v2, 157704
    v_mov_b32 v3, 1
    s_waitcnt lgkmcnt(0)
    s_mov_b64 exec, 1
    ds_add_u32 v2, v3
    s_mov_b64 exec, -1
L2_gemm_w1:
    ds_read_b32 v3, v2
    s_waitcnt lgkmcnt(0)
    v_readfirstlane_b32 s30, v3
    s_cmp_ge_u32 s30, 4
    s_cbranch_scc1 L2_gemm_w1_ok
    s_sleep 1
    s_branch L2_gemm_w1
L2_gemm_w1_ok:
    ds_read_b128 v[184:187], v0 offset:0
    ds_read_b128 v[188:191], v0 offset:18432
    ds_read_b128 v[192:195], v1 offset:0
    ds_read_b128 v[196:199], v1 offset:18432
    ds_read_b128 v[200:203], v0 offset:4096
    ds_read_b128 v[204:207], v0 offset:22528
    ds_read_b128 v[208:211], v1 offset:4096
    ds_read_b128 v[212:215], v1 offset:22528
    ds_read_b128 v[216:219], v0 offset:8192
    ds_read_b128 v[220:223], v0 offset:26624
    ds_read_b128 v[224:227], v1 offset:8192
    ds_read_b128 v[228:231], v1 offset:26624
    s_waitcnt lgkmcnt(8)
    v_add_f32 v184, v184, v188
    v_add_f32 v192, v192, v196
    v_add_f32 v185, v185, v189
    v_add_f32 v193, v193, v197
    v_add_f32 v186, v186, v190
    v_add_f32 v194, v194, v198
    v_add_f32 v187, v187, v191
    v_add_f32 v195, v195, v199
    v_add_f32 v184, v184, v192
    v_add_f32 v185, v185, v193
    v_add_f32 v186, v186, v194
    v_add_f32 v187, v187, v195
    buffer_store_dwordx4 v[184:187], v4, s[12:15], s26 offen sc1
    s_add_u32 s26, s26, 4096
    ds_read_b128 v[232:235], v0 offset:12288
    ds_read_b128 v[236:239], v0 offset:30720
    ds_read_b128 v[240:243], v1 offset:12288
    ds_read_b128 v[244:247], v1 offset:30720
    s_waitcnt lgkmcnt(8)
    v_add_f32 v200, v200, v204
    v_add_f32 v208, v208, v212
    v_add_f32 v201, v201, v205
    v_add_f32 v209, v209, v213
    v_add_f32 v202, v202, v206
    v_add_f32 v210, v210, v214
    v_add_f32 v203, v203, v207
    v_add_f32 v211, v211, v215
    v_add_f32 v200, v200, v208
    v_add_f32 v201, v201, v209
    v_add_f32 v202, v202, v210
    v_add_f32 v203, v203, v211
    buffer_store_dwordx4 v[200:203], v4, s[12:15], s26 offen sc1
    s_add_u32 s26, s26, 4096
    ds_read_b128 v[184:187], v0 offset:16384
    ds_read_b128 v[188:191], v0 offset:34816
    ds_read_b128 v[192:195], v1 offset:16384
    ds_read_b128 v[196:199], v1 offset:34816
    s_waitcnt lgkmcnt(8)
    v_add_f32 v216, v216, v220
    v_add_f32 v224, v224, v228
    v_add_f32 v217, v217, v221
    v_add_f32 v225, v225, v229
    v_add_f32 v218, v218, v222
    v_add_f32 v226, v226, v230
    v_add_f32 v219, v219, v223
    v_add_f32 v227, v227, v231
    v_add_f32 v216, v216, v224
    v_add_f32 v217, v217, v225
    v_add_f32 v218, v218, v226
    v_add_f32 v219, v219, v227
    buffer_store_dwordx4 v[216:219], v4, s[12:15], s26 offen sc1
    s_add_u32 s26, s26, 4096
    s_waitcnt lgkmcnt(4)
    v_add_f32 v232, v232, v236
    v_add_f32 v240, v240, v244
    v_add_f32 v233, v233, v237
    v_add_f32 v241, v241, v245
    v_add_f32 v234, v234, v238
    v_add_f32 v242, v242, v246
    v_add_f32 v235, v235, v239
    v_add_f32 v243, v243, v247
    v_add_f32 v232, v232, v240
    v_add_f32 v233, v233, v241
    v_add_f32 v234, v234, v242
    v_add_f32 v235, v235, v243
    buffer_store_dwordx4 v[232:235], v4, s[12:15], s26 offen sc1
    s_add_u32 s26, s26, 4096
    s_waitcnt lgkmcnt(0)
    v_add_f32 v184, v184, v188
    v_add_f32 v192, v192, v196
    v_add_f32 v185, v185, v189
    v_add_f32 v193, v193, v197
    v_add_f32 v186, v186, v190
    v_add_f32 v194, v194, v198
    v_add_f32 v187, v187, v191
    v_add_f32 v195, v195, v199
    v_add_f32 v184, v184, v192
    v_add_f32 v185, v185, v193
    v_add_f32 v186, v186, v194
    v_add_f32 v187, v187, v195
    buffer_store_dwordx4 v[184:187], v4, s[12:15], s26 offen sc1
    s_add_u32 s26, s26, 4096
    v_mov_b32 v2, 157704
    v_mov_b32 v3, 1
    s_waitcnt lgkmcnt(0)
    s_mov_b64 exec, 1
    ds_add_u32 v2, v3
    s_mov_b64 exec, -1
    v_mov_b32 v0, s44
    v_mov_b32 v1, s45
    v_mov_b32 v2, 0
    s_waitcnt vmcnt(0)
    s_mov_b64 exec, 1
    buffer_store_dwordx2 v[0:1], v2, s[12:15], s28 offen sc1
    s_mov_b64 exec, -1
    s_add_u32 s38, s24, 18432
    buffer_load_dwordx4 v[184:187], v4, s[12:15], s38 offen offset:0 sc1
    buffer_load_dwordx4 v[188:191], v4, s[12:15], s38 offen offset:1024 sc1
    buffer_load_dwordx4 v[192:195], v4, s[12:15], s38 offen offset:2048 sc1
    s_waitcnt vmcnt(3)
    s_add_u32 s38, s24, 21504
    buffer_load_dwordx4 v[196:199], v4, s[12:15], s38 offen offset:0 sc1
    buffer_load_dwordx4 v[200:203], v4, s[12:15], s38 offen offset:1024 sc1
    buffer_load_dwordx4 v[204:207], v4, s[12:15], s38 offen offset:2048 sc1
    s_waitcnt vmcnt(3)
    s_add_u32 s38, s24, 24576
    buffer_load_dwordx4 v[208:211], v4, s[12:15], s38 offen offset:0 sc1
    buffer_load_dwordx4 v[212:215], v4, s[12:15], s38 offen offset:1024 sc1
    buffer_load_dwordx4 v[216:219], v4, s[12:15], s38 offen offset:2048 sc1
    s_waitcnt vmcnt(3)
    s_add_u32 s38, s24, 27648
    buffer_load_dwordx4 v[220:223], v4, s[12:15], s38 offen offset:0 sc1
    buffer_load_dwordx4 v[224:227], v4, s[12:15], s38 offen offset:1024 sc1
    buffer_load_dwordx4 v[228:231], v4, s[12:15], s38 offen offset:2048 sc1
    s_waitcnt vmcnt(3)
    s_add_u32 s38, s24, 30720
    buffer_load_dwordx4 v[232:235], v4, s[12:15], s38 offen offset:0 sc1
    buffer_load_dwordx4 v[236:239], v4, s[12:15], s38 offen offset:1024 sc1
    buffer_load_dwordx4 v[240:243], v4, s[12:15], s38 offen offset:2048 sc1
    s_waitcnt vmcnt(3)
    s_add_u32 s38, s24, 33792
    buffer_load_dwordx4 v[244:247], v4, s[12:15], s38 offen offset:0 sc1
    buffer_load_dwordx4 v[248:251], v4, s[12:15], s38 offen offset:1024 sc1
    buffer_load_dwordx4 v[252:255], v4, s[12:15], s38 offen offset:2048 sc1
    s_waitcnt vmcnt(3)
    s_lshl_b32 s37, s33, 1
    s_add_u32 s37, s37, s32
    s_lshl_b32 s43, s37, 2
    s_add_u32 s43, s43, s3
    s_lshl_b32 s46, s43, 10
    s_add_u32 s46, s46, 39845888
    s_lshl_b32 s43, s43, 13
    s_add_u32 s43, s43, 37748736
    s_add_u32 s39, s43, 4096
    v_and_b32 v2, 15, v7
    v_lshlrev_b32 v2, 2, v2
    v_lshrrev_b32 v3, 4, v7
    v_lshl_add_u32 v2, v3, 8, v2
    s_lshl_b32 s35, s33, 2
    s_add_u32 s35, s35, s3
    s_mul_i32 s35, s35, 384
    s_add_u32 s35, s35, 48234496
    v_and_b32 v3, 7, v7
    v_lshlrev_b32 v3, 3, v3
    v_mov_b32 v0, 157704
L2_gemm_w2:
    ds_read_b32 v1, v0
    s_waitcnt lgkmcnt(0)
    v_readfirstlane_b32 s30, v1
    s_cmp_ge_u32 s30, 8
    s_cbranch_scc1 L2_gemm_w2_ok
    s_sleep 4
    s_branch L2_gemm_w2
L2_gemm_w2_ok:
    v_mov_b32 v0, 157752
L2_p3k:
    ds_read_b32 v1, v0
    s_waitcnt lgkmcnt(0)
    v_readfirstlane_b32 s30, v1
    s_cmp_ge_u32 s30, 4
    s_cbranch_scc1 L2_p3k_ok
    s_sleep 6
    s_branch L2_p3k
L2_p3k_ok:
    ds_write_b128 v5, v[112:115] offset:0
    ds_write_b128 v5, v[116:119] offset:1024
    ds_write_b128 v5, v[120:123] offset:2048
    ds_write_b128 v5, v[124:127] offset:3072
    ds_write_b128 v5, v[128:131] offset:4096
    ds_write_b128 v5, v[132:135] offset:5120
    ds_write_b128 v5, v[136:139] offset:6144
    ds_write_b128 v5, v[140:143] offset:7168
    ds_write_b128 v5, v[144:147] offset:8192
    ds_write_b128 v5, v[148:151] offset:9216
    ds_write_b128 v5, v[152:155] offset:10240
    ds_write_b128 v5, v[156:159] offset:11264
    ds_write_b128 v5, v[160:163] offset:12288
    ds_write_b128 v5, v[164:167] offset:13312
    ds_write_b128 v5, v[168:171] offset:14336
    ds_write_b128 v5, v[172:175] offset:15360
    ds_write_b128 v5, v[176:179] offset:16384
    ds_write_b128 v5, v[180:183] offset:17408
    v_mov_b32 v0, 157712
    v_mov_b32 v1, 1
    s_waitcnt lgkmcnt(0)
    s_mov_b64 exec, 1
    ds_add_u32 v0, v1
    s_mov_b64 exec, -1
    s_mov_b32 s31, 400000
L2_po:
    buffer_load_dwordx2 v[0:1], v3, s[12:15], s35 offen sc1
    s_waitcnt vmcnt(0)
    v_cmp_ne_u64 vcc, s[44:45], v[0:1]
    s_nop 1
    s_and_b64 vcc, vcc, exec
    s_cbranch_scc0 L2_po_ok
    s_sleep 4
    s_sub_u32 s31, s31, 1
    s_cmp_lg_u32 s31, 0
    s_cbranch_scc1 L2_po
L2_po_ok:
    buffer_load_dwordx4 v[220:223], v4, s[12:15], s43 offen offset:0 sc1
    buffer_load_dwordx4 v[224:227], v4, s[12:15], s43 offen offset:1024 sc1
    buffer_load_dwordx4 v[228:231], v4, s[12:15], s43 offen offset:2048 sc1
    buffer_load_dwordx4 v[232:235], v4, s[12:15], s43 offen offset:3072 sc1
    buffer_load_dword v252, v2, s[12:15], s46 offen offset:0 sc1
    buffer_load_dword v253, v2, s[12:15], s46 offen offset:128 sc1
    buffer_load_dword v254, v2, s[12:15], s46 offen offset:64 sc1
    buffer_load_dword v255, v2, s[12:15], s46 offen offset:192 sc1
    buffer_load_dwordx4 v[236:239], v4, s[12:15], s39 offen offset:0 sc1
    buffer_load_dwordx4 v[240:243], v4, s[12:15], s39 offen offset:1024 sc1
    buffer_load_dwordx4 v[244:247], v4, s[12:15], s39 offen offset:2048 sc1
    buffer_load_dwordx4 v[248:251], v4, s[12:15], s39 offen offset:3072 sc1
    s_waitcnt vmcnt(10)
    v_mfma_f32_16x16x32_bf16 v[112:115], v[24:27], v[220:223], 0
    v_mfma_f32_16x16x32_bf16 v[148:151], v[24:27], v[224:227], 0
    v_mfma_f32_16x16x32_bf16 v[116:119], v[28:31], v[220:223], 0
    v_mfma_f32_16x16x32_bf16 v[152:155], v[28:31], v[224:227], 0
    v_mfma_f32_16x16x32_bf16 v[120:123], v[32:35], v[220:223], 0
    v_mfma_f32_16x16x32_bf16 v[156:159], v[32:35], v[224:227], 0
    v_mfma_f32_16x16x32_bf16 v[124:127], v[36:39], v[220:223], 0
    v_mfma_f32_16x16x32_bf16 v[160:163], v[36:39], v[224:227], 0
    v_mfma_f32_16x16x32_bf16 v[128:131], v[40:43], v[220:223], 0
    v_mfma_f32_16x16x32_bf16 v[164:167], v[40:43], v[224:227], 0
    v_mfma_f32_16x16x32_bf16 v[132:135], v[44:47], v[220:223], 0
    v_mfma_f32_16x16x32_bf16 v[168:171], v[44:47], v[224:227], 0
    v_mfma_f32_16x16x32_bf16 v[136:139], v[48:51], v[220:223], 0
    v_mfma_f32_16x16x32_bf16 v[172:175], v[48:51], v[224:227], 0
    v_mfma_f32_16x16x32_bf16 v[140:143], v[52:55], v[220:223], 0
    v_mfma_f32_16x16x32_bf16 v[176:179], v[52:55], v[224:227], 0
    v_mfma_f32_16x16x32_bf16 v[144:147], v[56:59], v[220:223], 0
    v_mfma_f32_16x16x32_bf16 v[180:183], v[56:59], v[224:227], 0
    s_add_u32 s38, s24, 27648
    buffer_load_dwordx4 v[24:27], v4, s[12:15], s38 offen offset:0 sc1
    buffer_load_dwordx4 v[28:31], v4, s[12:15], s38 offen offset:1024 sc1
    buffer_load_dwordx4 v[32:35], v4, s[12:15], s38 offen offset:2048 sc1
    s_add_u32 s38, s24, 30720
    buffer_load_dwordx4 v[36:39], v4, s[12:15], s38 offen offset:0 sc1
    buffer_load_dwordx4 v[40:43], v4, s[12:15], s38 offen offset:1024 sc1
    buffer_load_dwordx4 v[44:47], v4, s[12:15], s38 offen offset:2048 sc1
    s_add_u32 s38, s24, 33792
    buffer_load_dwordx4 v[48:51], v4, s[12:15], s38 offen offset:0 sc1
    buffer_load_dwordx4 v[52:55], v4, s[12:15], s38 offen offset:1024 sc1
    buffer_load_dwordx4 v[56:59], v4, s[12:15], s38 offen offset:2048 sc1
    s_waitcnt vmcnt(17)
    v_mfma_f32_16x16x32_bf16 v[112:115], v[76:79], v[228:231], v[112:115]
    v_mfma_f32_16x16x32_bf16 v[148:151], v[76:79], v[232:235], v[148:151]
    v_mfma_f32_16x16x32_bf16 v[116:119], v[80:83], v[228:231], v[116:119]
    v_mfma_f32_16x16x32_bf16 v[152:155], v[80:83], v[232:235], v[152:155]
    v_mfma_f32_16x16x32_bf16 v[120:123], v[84:87], v[228:231], v[120:123]
    v_mfma_f32_16x16x32_bf16 v[156:159], v[84:87], v[232:235], v[156:159]
    v_mfma_f32_16x16x32_bf16 v[124:127], v[88:91], v[228:231], v[124:127]
    v_mfma_f32_16x16x32_bf16 v[160:163], v[88:91], v[232:235], v[160:163]
    v_mfma_f32_16x16x32_bf16 v[128:131], v[92:95], v[228:231], v[128:131]
    v_mfma_f32_16x16x32_bf16 v[164:167], v[92:95], v[232:235], v[164:167]
    v_mfma_f32_16x16x32_bf16 v[132:135], v[96:99], v[228:231], v[132:135]
    v_mfma_f32_16x16x32_bf16 v[168:171], v[96:99], v[232:235], v[168:171]
    v_mfma_f32_16x16x32_bf16 v[136:139], v[100:103], v[228:231], v[136:139]
    v_mfma_f32_16x16x32_bf16 v[172:175], v[100:103], v[232:235], v[172:175]
    v_mfma_f32_16x16x32_bf16 v[140:143], v[104:107], v[228:231], v[140:143]
    v_mfma_f32_16x16x32_bf16 v[176:179], v[104:107], v[232:235], v[176:179]
    v_mfma_f32_16x16x32_bf16 v[144:147], v[108:111], v[228:231], v[144:147]
    v_mfma_f32_16x16x32_bf16 v[180:183], v[108:111], v[232:235], v[180:183]
    s_waitcnt vmcnt(13)
    v_mfma_f32_16x16x16_bf16 v[112:115], v[8:9], v[252:253], v[112:115]
    v_mfma_f32_16x16x16_bf16 v[148:151], v[8:9], v[254:255], v[148:151]
    v_mfma_f32_16x16x16_bf16 v[116:119], v[10:11], v[252:253], v[116:119]
    v_mfma_f32_16x16x16_bf16 v[152:155], v[10:11], v[254:255], v[152:155]
    v_mfma_f32_16x16x16_bf16 v[120:123], v[12:13], v[252:253], v[120:123]
    v_mfma_f32_16x16x16_bf16 v[156:159], v[12:13], v[254:255], v[156:159]
    v_mfma_f32_16x16x16_bf16 v[124:127], v[14:15], v[252:253], v[124:127]
    v_mfma_f32_16x16x16_bf16 v[160:163], v[14:15], v[254:255], v[160:163]
    v_mfma_f32_16x16x16_bf16 v[128:131], v[16:17], v[252:253], v[128:131]
    v_mfma_f32_16x16x16_bf16 v[164:167], v[16:17], v[254:255], v[164:167]
    v_mfma_f32_16x16x16_bf16 v[132:135], v[18:19], v[252:253], v[132:135]
    v_mfma_f32_16x16x16_bf16 v[168:171], v[18:19], v[254:255], v[168:171]
    v_mfma_f32_16x16x16_bf16 v[136:139], v[20:21], v[252:253], v[136:139]
    v_mfma_f32_16x16x16_bf16 v[172:175], v[20:21], v[254:255], v[172:175]
    v_mfma_f32_16x16x16_bf16 v[140:143], v[22:23], v[252:253], v[140:143]
    v_mfma_f32_16x16x16_bf16 v[176:179], v[22:23], v[254:255], v[176:179]
    v_mfma_f32_16x16x16_bf16 v[144:147], v[60:61], v[252:253], v[144:147]
    v_mfma_f32_16x16x16_bf16 v[180:183], v[60:61], v[254:255], v[180:183]
    s_waitcnt vmcnt(11)
    v_mfma_f32_16x16x32_bf16 v[112:115], v[184:187], v[236:239], v[112:115]
    v_mfma_f32_16x16x32_bf16 v[148:151], v[184:187], v[240:243], v[148:151]
    v_mfma_f32_16x16x32_bf16 v[116:119], v[188:191], v[236:239], v[116:119]
    v_mfma_f32_16x16x32_bf16 v[152:155], v[188:191], v[240:243], v[152:155]
    v_mfma_f32_16x16x32_bf16 v[120:123], v[192:195], v[236:239], v[120:123]
    v_mfma_f32_16x16x32_bf16 v[156:159], v[192:195], v[240:243], v[156:159]
    v_mfma_f32_16x16x32_bf16 v[124:127], v[196:199], v[236:239], v[124:127]
    v_mfma_f32_16x16x32_bf16 v[160:163], v[196:199], v[240:243], v[160:163]
    v_mfma_f32_16x16x32_bf16 v[128:131], v[200:203], v[236:239], v[128:131]
    v_mfma_f32_16x16x32_bf16 v[164:167], v[200:203], v[240:243], v[164:167]
    v_mfma_f32_16x16x32_bf16 v[132:135], v[204:207], v[236:239], v[132:135]
    v_mfma_f32_16x16x32_bf16 v[168:171], v[204:207], v[240:243], v[168:171]
    v_mfma_f32_16x16x32_bf16 v[136:139], v[208:211], v[236:239], v[136:139]
    v_mfma_f32_16x16x32_bf16 v[172:175], v[208:211], v[240:243], v[172:175]
    v_mfma_f32_16x16x32_bf16 v[140:143], v[212:215], v[236:239], v[140:143]
    v_mfma_f32_16x16x32_bf16 v[176:179], v[212:215], v[240:243], v[176:179]
    v_mfma_f32_16x16x32_bf16 v[144:147], v[216:219], v[236:239], v[144:147]
    v_mfma_f32_16x16x32_bf16 v[180:183], v[216:219], v[240:243], v[180:183]
    s_waitcnt vmcnt(0)
    v_mfma_f32_16x16x32_bf16 v[112:115], v[24:27], v[244:247], v[112:115]
    v_mfma_f32_16x16x32_bf16 v[148:151], v[24:27], v[248:251], v[148:151]
    v_mfma_f32_16x16x32_bf16 v[116:119], v[28:31], v[244:247], v[116:119]
    v_mfma_f32_16x16x32_bf16 v[152:155], v[28:31], v[248:251], v[152:155]
    v_mfma_f32_16x16x32_bf16 v[120:123], v[32:35], v[244:247], v[120:123]
    v_mfma_f32_16x16x32_bf16 v[156:159], v[32:35], v[248:251], v[156:159]
    v_mfma_f32_16x16x32_bf16 v[124:127], v[36:39], v[244:247], v[124:127]
    v_mfma_f32_16x16x32_bf16 v[160:163], v[36:39], v[248:251], v[160:163]
    v_mfma_f32_16x16x32_bf16 v[128:131], v[40:43], v[244:247], v[128:131]
    ds_write_b128 v6, v[112:115] offset:0
    v_mfma_f32_16x16x32_bf16 v[164:167], v[40:43], v[248:251], v[164:167]
    ds_write_b128 v6, v[148:151] offset:9216
    v_mfma_f32_16x16x32_bf16 v[132:135], v[44:47], v[244:247], v[132:135]
    ds_write_b128 v6, v[116:119] offset:1024
    v_mfma_f32_16x16x32_bf16 v[168:171], v[44:47], v[248:251], v[168:171]
    ds_write_b128 v6, v[152:155] offset:10240
    v_mfma_f32_16x16x32_bf16 v[136:139], v[48:51], v[244:247], v[136:139]
    ds_write_b128 v6, v[120:123] offset:2048
    v_mfma_f32_16x16x32_bf16 v[172:175], v[48:51], v[248:251], v[172:175]
    ds_write_b128 v6, v[156:159] offset:11264
    v_mfma_f32_16x16x32_bf16 v[140:143], v[52:55], v[244:247], v[140:143]
    ds_write_b128 v6, v[124:127] offset:3072
    v_mfma_f32_16x16x32_bf16 v[176:179], v[52:55], v[248:251], v[176:179]
    ds_write_b128 v6, v[160:163] offset:12288
    v_mfma_f32_16x16x32_bf16 v[144:147], v[56:59], v[244:247], v[144:147]
    ds_write_b128 v6, v[128:131] offset:4096
    v_mfma_f32_16x16x32_bf16 v[180:183], v[56:59], v[248:251], v[180:183]
    ds_write_b128 v6, v[164:167] offset:13312
    ds_write_b128 v6, v[132:135] offset:5120
    ds_write_b128 v6, v[168:171] offset:14336
    ds_write_b128 v6, v[136:139] offset:6144
    ds_write_b128 v6, v[172:175] offset:15360
    ds_write_b128 v6, v[140:143] offset:7168
    ds_write_b128 v6, v[176:179] offset:16384
    ds_write_b128 v6, v[144:147] offset:8192
    ds_write_b128 v6, v[180:183] offset:17408
    v_mov_b32 v2, 157728
    v_mov_b32 v3, 1
    s_waitcnt lgkmcnt(0)
    s_mov_b64 exec, 1
    ds_add_u32 v2, v3
    s_mov_b64 exec, -1
    s_endpgm
L1_qk:
    v_lshrrev_b32 v249, 4, v247
    v_bfe_u32 v250, v247, 2, 2
    v_lshl_add_u32 v250, v249, 3, v250
    v_lshlrev_b32 v250, 7, v250
    v_and_b32 v251, 3, v247
    v_lshl_add_u32 v250, v251, 3, v250
    v_bfe_u32 v249, v247, 3, 2
    v_xor_b32 v251, 0, v249
    v_lshl_add_u32 v240, v251, 5, v250
    v_xor_b32 v251, 1, v249
    v_lshl_add_u32 v241, v251, 5, v250
    v_xor_b32 v251, 2, v249
    v_lshl_add_u32 v242, v251, 5, v250
    v_xor_b32 v251, 3, v249
    v_lshl_add_u32 v243, v251, 5, v250
    v_and_b32 v249, 15, v247
    v_lshrrev_b32 v250, 4, v247
    v_lshrrev_b32 v251, 1, v250
    v_lshlrev_b32 v246, 9, v251
    v_lshl_add_u32 v246, v249, 4, v246
    v_and_b32 v251, 1, v250
    v_lshl_add_u32 v246, v251, 3, v246
    s_mov_b32 s38, s28
    s_mov_b32 s39, s28
    s_lshr_b32 s33, s42, 2
    s_mul_i32 s33, s33, 6
    s_add_u32 s33, s33, s41
    s_mul_i32 s36, s33, 73728
    s_waitcnt vmcnt(0) lgkmcnt(0)
    s_barrier
    s_add_u32 s25, s25, 144
    v_mov_b32 v248, 157736
    ds_read_b64 v[248:249], v248
    s_add_u32 s34, s30, 0
    buffer_load_dwordx4 v[0:3], v245, s[12:15], s34 offen offset:0 sc1
    buffer_load_dwordx4 v[4:7], v245, s[12:15], s34 offen offset:1024 sc1
    s_add_u32 s34, s30, 4096
    buffer_load_dwordx4 v[8:11], v245, s[12:15], s34 offen offset:0 sc1
    buffer_load_dwordx4 v[12:15], v245, s[12:15], s34 offen offset:1024 sc1
    s_add_u32 s34, s30, 8192
    buffer_load_dwordx4 v[16:19], v245, s[12:15], s34 offen offset:0 sc1
    buffer_load_dwordx4 v[20:23], v245, s[12:15], s34 offen offset:1024 sc1
    s_add_u32 s34, s30, 12288
    buffer_load_dwordx4 v[24:27], v245, s[12:15], s34 offen offset:0 sc1
    buffer_load_dwordx4 v[28:31], v245, s[12:15], s34 offen offset:1024 sc1
    s_waitcnt lgkmcnt(0)
    v_readfirstlane_b32 s44, v248
    v_readfirstlane_b32 s45, v249
    ds_read_b64_tr_b16 v[224:225], v240 offset:0
    ds_read_b64_tr_b16 v[226:227], v240 offset:512
    ds_read_b64_tr_b16 v[228:229], v241 offset:0
    ds_read_b64_tr_b16 v[230:231], v241 offset:512
    ds_read_b64_tr_b16 v[232:233], v242 offset:0
    ds_read_b64_tr_b16 v[234:235], v242 offset:512
    s_waitcnt lgkmcnt(4)
    s_cmp_lt_u32 s3, 4
    s_cselect_b64 vcc, -1, 0
    v_add_u32 v240, 0x12000, v240
    v_add_u32 v241, 0x12000, v241
    v_add_u32 v242, 0x12000, v242
    s_cbranch_vccnz Lp5
    s_setprio 1
Lp5:
    s_waitcnt vmcnt(6)
    v_mfma_f32_16x16x32_bf16 v[144:147], v[224:227], v[0:3], 0
    ds_read_b64_tr_b16 v[236:237], v243 offset:0
    s_add_u32 s34, s30, 16384
    buffer_load_dwordx4 v[32:35], v245, s[12:15], s34 offen offset:0 sc1
    v_mfma_f32_16x16x32_bf16 v[148:151], v[224:227], v[4:7], 0
    ds_read_b64_tr_b16 v[238:239], v243 offset:512
    s_waitcnt lgkmcnt(4)
    v_add_u32 v243, 0x12000, v243
    v_mfma_f32_16x16x32_bf16 v[156:159], v[228:231], v[4:7], 0
    ds_read_b64_tr_b16 v[224:225], v240 offset:0
    v_mfma_f32_16x16x32_bf16 v[152:155], v[228:231], v[0:3], 0
    ds_read_b64_tr_b16 v[226:227], v240 offset:512
    s_waitcnt lgkmcnt(4)
    v_add_u32 v240, 0xfffee000, v240
    v_mfma_f32_16x16x32_bf16 v[160:163], v[232:235], v[0:3], 0
    ds_read_b64_tr_b16 v[228:229], v241 offset:0
    v_mfma_f32_16x16x32_bf16 v[164:167], v[232:235], v[4:7], 0
    ds_read_b64_tr_b16 v[230:231], v241 offset:512
    s_waitcnt lgkmcnt(4)
    v_add_u32 v241, 0xfffee000, v241
    v_mfma_f32_16x16x32_bf16 v[172:175], v[236:239], v[4:7], 0
    ds_read_b64_tr_b16 v[232:233], v242 offset:0
    buffer_load_dwordx4 v[36:39], v245, s[12:15], s34 offen offset:1024 sc1
    v_mfma_f32_16x16x32_bf16 v[168:171], v[236:239], v[0:3], 0
    ds_read_b64_tr_b16 v[234:235], v242 offset:512
    s_waitcnt lgkmcnt(4)
    v_add_u32 v242, 0xfffee000, v242
    v_mfma_f32_16x16x32_bf16 v[176:179], v[224:227], v[0:3], 0
    ds_read_b64_tr_b16 v[236:237], v243 offset:0
    v_mfma_f32_16x16x32_bf16 v[180:183], v[224:227], v[4:7], 0
    ds_read_b64_tr_b16 v[238:239], v243 offset:512
    s_waitcnt lgkmcnt(4)
    v_add_u32 v243, 0xfffee000, v243
    v_mfma_f32_16x16x32_bf16 v[188:191], v[228:231], v[4:7], 0
    ds_read_b64_tr_b16 v[224:225], v240 offset:4096
    v_mfma_f32_16x16x32_bf16 v[184:187], v[228:231], v[0:3], 0
    ds_read_b64_tr_b16 v[226:227], v240 offset:4608
    s_waitcnt lgkmcnt(4)
    v_add_u32 v240, 0x12000, v240
    v_mfma_f32_16x16x32_bf16 v[192:195], v[232:235], v[0:3], 0
    ds_read_b64_tr_b16 v[228:229], v241 offset:4096
    s_add_u32 s34, s30, 20480
    buffer_load_dwordx4 v[40:43], v245, s[12:15], s34 offen offset:0 sc1
    v_mfma_f32_16x16x32_bf16 v[196:199], v[232:235], v[4:7], 0
    ds_read_b64_tr_b16 v[230:231], v241 offset:4608
    s_waitcnt lgkmcnt(4)
    v_add_u32 v241, 0x12000, v241
    v_mfma_f32_16x16x32_bf16 v[204:207], v[236:239], v[4:7], 0
    ds_read_b64_tr_b16 v[232:233], v242 offset:4096
    v_mfma_f32_16x16x32_bf16 v[200:203], v[236:239], v[0:3], 0
    ds_read_b64_tr_b16 v[234:235], v242 offset:4608
    s_waitcnt lgkmcnt(4)
    v_add_u32 v242, 0x12000, v242
    s_waitcnt vmcnt(7)
    v_mfma_f32_16x16x32_bf16 v[144:147], v[224:227], v[8:11], v[144:147]
    ds_read_b64_tr_b16 v[236:237], v243 offset:4096
    v_mfma_f32_16x16x32_bf16 v[148:151], v[224:227], v[12:15], v[148:151]
    ds_read_b64_tr_b16 v[238:239], v243 offset:4608
    s_waitcnt lgkmcnt(4)
    v_add_u32 v243, 0x12000, v243
    v_mfma_f32_16x16x32_bf16 v[156:159], v[228:231], v[12:15], v[156:159]
    ds_read_b64_tr_b16 v[224:225], v240 offset:4096
    buffer_load_dwordx4 v[44:47], v245, s[12:15], s34 offen offset:1024 sc1
    v_mfma_f32_16x16x32_bf16 v[152:155], v[228:231], v[8:11], v[152:155]
    ds_read_b64_tr_b16 v[226:227], v240 offset:4608
    s_waitcnt lgkmcnt(4)
    v_add_u32 v240, 0xfffee000, v240
    v_mfma_f32_16x16x32_bf16 v[160:163], v[232:235], v[8:11], v[160:163]
    ds_read_b64_tr_b16 v[228:229], v241 offset:4096
    v_mfma_f32_16x16x32_bf16 v[164:167], v[232:235], v[12:15], v[164:167]
    ds_read_b64_tr_b16 v[230:231], v241 offset:4608
    s_waitcnt lgkmcnt(4)
    v_add_u32 v241, 0xfffee000, v241
    v_mfma_f32_16x16x32_bf16 v[172:175], v[236:239], v[12:15], v[172:175]
    ds_read_b64_tr_b16 v[232:233], v242 offset:4096
    v_mfma_f32_16x16x32_bf16 v[168:171], v[236:239], v[8:11], v[168:171]
    ds_read_b64_tr_b16 v[234:235], v242 offset:4608
    s_waitcnt lgkmcnt(4)
    v_add_u32 v242, 0xfffee000, v242
    v_mfma_f32_16x16x32_bf16 v[176:179], v[224:227], v[8:11], v[176:179]
    ds_read_b64_tr_b16 v[236:237], v243 offset:4096
    s_add_u32 s34, s30, 24576
    buffer_load_dwordx4 v[48:51], v245, s[12:15], s34 offen offset:0 sc1
    v_mfma_f32_16x16x32_bf16 v[180:183], v[224:227], v[12:15], v[180:183]
    ds_read_b64_tr_b16 v[238:239], v243 offset:4608
    s_waitcnt lgkmcnt(4)
    v_add_u32 v243, 0xfffee000, v243
    v_mfma_f32_16x16x32_bf16 v[188:191], v[228:231], v[12:15], v[188:191]
    ds_read_b64_tr_b16 v[224:225], v240 offset:8192
    v_mfma_f32_16x16x32_bf16 v[184:187], v[228:231], v[8:11], v[184:187]
    ds_read_b64_tr_b16 v[226:227], v240 offset:8704
    s_waitcnt lgkmcnt(4)
    v_add_u32 v240, 0x12000, v240
    v_mfma_f32_16x16x32_bf16 v[192:195], v[232:235], v[8:11], v[192:195]
    ds_read_b64_tr_b16 v[228:229], v241 offset:8192
    v_mfma_f32_16x16x32_bf16 v[196:199], v[232:235], v[12:15], v[196:199]
    ds_read_b64_tr_b16 v[230:231], v241 offset:8704
    s_waitcnt lgkmcnt(4)
    v_add_u32 v241, 0x12000, v241
    v_mfma_f32_16x16x32_bf16 v[204:207], v[236:239], v[12:15], v[204:207]
    ds_read_b64_tr_b16 v[232:233], v242 offset:8192
    buffer_load_dwordx4 v[52:55], v245, s[12:15], s34 offen offset:1024 sc1
    v_mfma_f32_16x16x32_bf16 v[200:203], v[236:239], v[8:11], v[200:203]
    ds_read_b64_tr_b16 v[234:235], v242 offset:8704
    s_waitcnt lgkmcnt(4)
    v_add_u32 v242, 0x12000, v242
    s_waitcnt vmcnt(8)
    v_mfma_f32_16x16x32_bf16 v[144:147], v[224:227], v[16:19], v[144:147]
    ds_read_b64_tr_b16 v[236:237], v243 offset:8192
    v_mfma_f32_16x16x32_bf16 v[148:151], v[224:227], v[20:23], v[148:151]
    ds_read_b64_tr_b16 v[238:239], v243 offset:8704
    s_waitcnt lgkmcnt(4)
    v_add_u32 v243, 0x12000, v243
    v_mfma_f32_16x16x32_bf16 v[156:159], v[228:231], v[20:23], v[156:159]
    ds_read_b64_tr_b16 v[224:225], v240 offset:8192
    v_mfma_f32_16x16x32_bf16 v[152:155], v[228:231], v[16:19], v[152:155]
    ds_read_b64_tr_b16 v[226:227], v240 offset:8704
    s_waitcnt lgkmcnt(4)
    v_add_u32 v240, 0xfffee000, v240
    v_mfma_f32_16x16x32_bf16 v[160:163], v[232:235], v[16:19], v[160:163]
    ds_read_b64_tr_b16 v[228:229], v241 offset:8192
    s_add_u32 s34, s30, 28672
    buffer_load_dwordx4 v[56:59], v245, s[12:15], s34 offen offset:0 sc1
    v_mfma_f32_16x16x32_bf16 v[164:167], v[232:235], v[20:23], v[164:167]
    ds_read_b64_tr_b16 v[230:231], v241 offset:8704
    s_waitcnt lgkmcnt(4)
    v_add_u32 v241, 0xfffee000, v241
    v_mfma_f32_16x16x32_bf16 v[172:175], v[236:239], v[20:23], v[172:175]
    ds_read_b64_tr_b16 v[232:233], v242 offset:8192
    v_mfma_f32_16x16x32_bf16 v[168:171], v[236:239], v[16:19], v[168:171]
    ds_read_b64_tr_b16 v[234:235], v242 offset:8704
    s_waitcnt lgkmcnt(4)
    v_add_u32 v242, 0xfffee000, v242
    v_mfma_f32_16x16x32_bf16 v[176:179], v[224:227], v[16:19], v[176:179]
    ds_read_b64_tr_b16 v[236:237], v243 offset:8192
    v_mfma_f32_16x16x32_bf16 v[180:183], v[224:227], v[20:23], v[180:183]
    ds_read_b64_tr_b16 v[238:239], v243 offset:8704
    s_waitcnt lgkmcnt(4)
    v_add_u32 v243, 0xfffee000, v243
    v_mfma_f32_16x16x32_bf16 v[188:191], v[228:231], v[20:23], v[188:191]
    ds_read_b64_tr_b16 v[224:225], v240 offset:12288
    buffer_load_dwordx4 v[60:63], v245, s[12:15], s34 offen offset:1024 sc1
    v_mfma_f32_16x16x32_bf16 v[184:187], v[228:231], v[16:19], v[184:187]
    ds_read_b64_tr_b16 v[226:227], v240 offset:12800
    s_waitcnt lgkmcnt(4)
    v_add_u32 v240, 0x12000, v240
    v_mfma_f32_16x16x32_bf16 v[192:195], v[232:235], v[16:19], v[192:195]
    ds_read_b64_tr_b16 v[228:229], v241 offset:12288
    v_mfma_f32_16x16x32_bf16 v[196:199], v[232:235], v[20:23], v[196:199]
    ds_read_b64_tr_b16 v[230:231], v241 offset:12800
    s_waitcnt lgkmcnt(4)
    v_add_u32 v241, 0x12000, v241
    v_mfma_f32_16x16x32_bf16 v[204:207], v[236:239], v[20:23], v[204:207]
    ds_read_b64_tr_b16 v[232:233], v242 offset:12288
    v_mfma_f32_16x16x32_bf16 v[200:203], v[236:239], v[16:19], v[200:203]
    ds_read_b64_tr_b16 v[234:235], v242 offset:12800
    s_waitcnt lgkmcnt(4)
    v_add_u32 v242, 0x12000, v242
    s_waitcnt vmcnt(8)
    v_mfma_f32_16x16x32_bf16 v[144:147], v[224:227], v[24:27], v[144:147]
    ds_read_b64_tr_b16 v[236:237], v243 offset:12288
    s_add_u32 s34, s30, 32768
    buffer_load_dwordx4 v[64:67], v245, s[12:15], s34 offen offset:0 sc1
    v_mfma_f32_16x16x32_bf16 v[148:151], v[224:227], v[28:31], v[148:151]
    ds_read_b64_tr_b16 v[238:239], v243 offset:12800
    s_waitcnt lgkmcnt(4)
    v_add_u32 v243, 0x12000, v243
    v_mfma_f32_16x16x32_bf16 v[156:159], v[228:231], v[28:31], v[156:159]
    ds_read_b64_tr_b16 v[224:225], v240 offset:12288
    v_mfma_f32_16x16x32_bf16 v[152:155], v[228:231], v[24:27], v[152:155]
    ds_read_b64_tr_b16 v[226:227], v240 offset:12800
    s_waitcnt lgkmcnt(4)
    v_add_u32 v240, 0xfffee000, v240
    v_mfma_f32_16x16x32_bf16 v[160:163], v[232:235], v[24:27], v[160:163]
    ds_read_b64_tr_b16 v[228:229], v241 offset:12288
    v_mfma_f32_16x16x32_bf16 v[164:167], v[232:235], v[28:31], v[164:167]
    ds_read_b64_tr_b16 v[230:231], v241 offset:12800
    s_waitcnt lgkmcnt(4)
    v_add_u32 v241, 0xfffee000, v241
    v_mfma_f32_16x16x32_bf16 v[172:175], v[236:239], v[28:31], v[172:175]
    ds_read_b64_tr_b16 v[232:233], v242 offset:12288
    buffer_load_dwordx4 v[68:71], v245, s[12:15], s34 offen offset:1024 sc1
    v_mfma_f32_16x16x32_bf16 v[168:171], v[236:239], v[24:27], v[168:171]
    ds_read_b64_tr_b16 v[234:235], v242 offset:12800
    s_waitcnt lgkmcnt(4)
    v_add_u32 v242, 0xfffee000, v242
    v_mfma_f32_16x16x32_bf16 v[176:179], v[224:227], v[24:27], v[176:179]
    ds_read_b64_tr_b16 v[236:237], v243 offset:12288
    v_mfma_f32_16x16x32_bf16 v[180:183], v[224:227], v[28:31], v[180:183]
    ds_read_b64_tr_b16 v[238:239], v243 offset:12800
    s_waitcnt lgkmcnt(4)
    v_add_u32 v243, 0xfffee000, v243
    v_mfma_f32_16x16x32_bf16 v[188:191], v[228:231], v[28:31], v[188:191]
    ds_read_b64_tr_b16 v[224:225], v240 offset:16384
    v_mfma_f32_16x16x32_bf16 v[184:187], v[228:231], v[24:27], v[184:187]
    ds_read_b64_tr_b16 v[226:227], v240 offset:16896
    s_waitcnt lgkmcnt(4)
    v_add_u32 v240, 0x12000, v240
    v_mfma_f32_16x16x32_bf16 v[192:195], v[232:235], v[24:27], v[192:195]
    ds_read_b64_tr_b16 v[228:229], v241 offset:16384
    s_add_u32 s34, s30, 36864
    buffer_load_dwordx4 v[72:75], v245, s[12:15], s34 offen offset:0 sc1
    v_mfma_f32_16x16x32_bf16 v[196:199], v[232:235], v[28:31], v[196:199]
    ds_read_b64_tr_b16 v[230:231], v241 offset:16896
    s_waitcnt lgkmcnt(4)
    v_add_u32 v241, 0x12000, v241
    v_mfma_f32_16x16x32_bf16 v[204:207], v[236:239], v[28:31], v[204:207]
    ds_read_b64_tr_b16 v[232:233], v242 offset:16384
    v_mfma_f32_16x16x32_bf16 v[200:203], v[236:239], v[24:27], v[200:203]
    ds_read_b64_tr_b16 v[234:235], v242 offset:16896
    s_waitcnt lgkmcnt(4)
    v_add_u32 v242, 0x12000, v242
    s_waitcnt vmcnt(9)
    v_mfma_f32_16x16x32_bf16 v[144:147], v[224:227], v[32:35], v[144:147]
    ds_read_b64_tr_b16 v[236:237], v243 offset:16384
    v_mfma_f32_16x16x32_bf16 v[148:151], v[224:227], v[36:39], v[148:151]
    ds_read_b64_tr_b16 v[238:239], v243 offset:16896
    s_waitcnt lgkmcnt(4)
    v_add_u32 v243, 0x12000, v243
    v_mfma_f32_16x16x32_bf16 v[156:159], v[228:231], v[36:39], v[156:159]
    ds_read_b64_tr_b16 v[224:225], v240 offset:16384
    buffer_load_dwordx4 v[76:79], v245, s[12:15], s34 offen offset:1024 sc1
    v_mfma_f32_16x16x32_bf16 v[152:155], v[228:231], v[32:35], v[152:155]
    ds_read_b64_tr_b16 v[226:227], v240 offset:16896
    s_waitcnt lgkmcnt(4)
    v_add_u32 v240, 0xfffee000, v240
    v_mfma_f32_16x16x32_bf16 v[160:163], v[232:235], v[32:35], v[160:163]
    ds_read_b64_tr_b16 v[228:229], v241 offset:16384
    v_mfma_f32_16x16x32_bf16 v[164:167], v[232:235], v[36:39], v[164:167]
    ds_read_b64_tr_b16 v[230:231], v241 offset:16896
    s_waitcnt lgkmcnt(4)
    v_add_u32 v241, 0xfffee000, v241
    v_mfma_f32_16x16x32_bf16 v[172:175], v[236:239], v[36:39], v[172:175]
    ds_read_b64_tr_b16 v[232:233], v242 offset:16384
    v_mfma_f32_16x16x32_bf16 v[168:171], v[236:239], v[32:35], v[168:171]
    ds_read_b64_tr_b16 v[234:235], v242 offset:16896
    s_waitcnt lgkmcnt(4)
    v_add_u32 v242, 0xfffee000, v242
    v_mfma_f32_16x16x32_bf16 v[176:179], v[224:227], v[32:35], v[176:179]
    ds_read_b64_tr_b16 v[236:237], v243 offset:16384
    s_add_u32 s34, s30, 40960
    buffer_load_dwordx4 v[80:83], v245, s[12:15], s34 offen offset:0 sc1
    v_mfma_f32_16x16x32_bf16 v[180:183], v[224:227], v[36:39], v[180:183]
    ds_read_b64_tr_b16 v[238:239], v243 offset:16896
    s_waitcnt lgkmcnt(4)
    v_add_u32 v243, 0xfffee000, v243
    v_mfma_f32_16x16x32_bf16 v[188:191], v[228:231], v[36:39], v[188:191]
    ds_read_b64_tr_b16 v[224:225], v240 offset:20480
    v_mfma_f32_16x16x32_bf16 v[184:187], v[228:231], v[32:35], v[184:187]
    ds_read_b64_tr_b16 v[226:227], v240 offset:20992
    s_waitcnt lgkmcnt(4)
    v_add_u32 v240, 0x12000, v240
    v_mfma_f32_16x16x32_bf16 v[192:195], v[232:235], v[32:35], v[192:195]
    ds_read_b64_tr_b16 v[228:229], v241 offset:20480
    v_mfma_f32_16x16x32_bf16 v[196:199], v[232:235], v[36:39], v[196:199]
    ds_read_b64_tr_b16 v[230:231], v241 offset:20992
    s_waitcnt lgkmcnt(4)
    v_add_u32 v241, 0x12000, v241
    v_mfma_f32_16x16x32_bf16 v[204:207], v[236:239], v[36:39], v[204:207]
    ds_read_b64_tr_b16 v[232:233], v242 offset:20480
    buffer_load_dwordx4 v[84:87], v245, s[12:15], s34 offen offset:1024 sc1
    v_mfma_f32_16x16x32_bf16 v[200:203], v[236:239], v[32:35], v[200:203]
    ds_read_b64_tr_b16 v[234:235], v242 offset:20992
    s_waitcnt lgkmcnt(4)
    v_add_u32 v242, 0x12000, v242
    s_waitcnt vmcnt(10)
    v_mfma_f32_16x16x32_bf16 v[144:147], v[224:227], v[40:43], v[144:147]
    ds_read_b64_tr_b16 v[236:237], v243 offset:20480
    v_mfma_f32_16x16x32_bf16 v[148:151], v[224:227], v[44:47], v[148:151]
    ds_read_b64_tr_b16 v[238:239], v243 offset:20992
    s_waitcnt lgkmcnt(4)
    v_add_u32 v243, 0x12000, v243
    v_mfma_f32_16x16x32_bf16 v[156:159], v[228:231], v[44:47], v[156:159]
    ds_read_b64_tr_b16 v[224:225], v240 offset:20480
    v_mfma_f32_16x16x32_bf16 v[152:155], v[228:231], v[40:43], v[152:155]
    ds_read_b64_tr_b16 v[226:227], v240 offset:20992
    s_waitcnt lgkmcnt(4)
    v_add_u32 v240, 0xfffee000, v240
    v_mfma_f32_16x16x32_bf16 v[160:163], v[232:235], v[40:43], v[160:163]
    ds_read_b64_tr_b16 v[228:229], v241 offset:20480
    s_add_u32 s34, s30, 45056
    buffer_load_dwordx4 v[88:91], v245, s[12:15], s34 offen offset:0 sc1
    v_mfma_f32_16x16x32_bf16 v[164:167], v[232:235], v[44:47], v[164:167]
    ds_read_b64_tr_b16 v[230:231], v241 offset:20992
    s_waitcnt lgkmcnt(4)
    v_add_u32 v241, 0xfffee000, v241
    v_mfma_f32_16x16x32_bf16 v[172:175], v[236:239], v[44:47], v[172:175]
    ds_read_b64_tr_b16 v[232:233], v242 offset:20480
    v_mfma_f32_16x16x32_bf16 v[168:171], v[236:239], v[40:43], v[168:171]
    ds_read_b64_tr_b16 v[234:235], v242 offset:20992
    s_waitcnt lgkmcnt(4)
    v_add_u32 v242, 0xfffee000, v242
    v_mfma_f32_16x16x32_bf16 v[176:179], v[224:227], v[40:43], v[176:179]
    ds_read_b64_tr_b16 v[236:237], v243 offset:20480
    v_mfma_f32_16x16x32_bf16 v[180:183], v[224:227], v[44:47], v[180:183]
    ds_read_b64_tr_b16 v[238:239], v243 offset:20992
    s_waitcnt lgkmcnt(4)
    v_add_u32 v243, 0xfffee000, v243
    v_mfma_f32_16x16x32_bf16 v[188:191], v[228:231], v[44:47], v[188:191]
    ds_read_b64_tr_b16 v[224:225], v240 offset:24576
    buffer_load_dwordx4 v[92:95], v245, s[12:15], s34 offen offset:1024 sc1
    v_mfma_f32_16x16x32_bf16 v[184:187], v[228:231], v[40:43], v[184:187]
    ds_read_b64_tr_b16 v[226:227], v240 offset:25088
    s_waitcnt lgkmcnt(4)
    v_add_u32 v240, 0x12000, v240
    v_mfma_f32_16x16x32_bf16 v[192:195], v[232:235], v[40:43], v[192:195]
    ds_read_b64_tr_b16 v[228:229], v241 offset:24576
    v_mfma_f32_16x16x32_bf16 v[196:199], v[232:235], v[44:47], v[196:199]
    ds_read_b64_tr_b16 v[230:231], v241 offset:25088
    s_waitcnt lgkmcnt(4)
    v_add_u32 v241, 0x12000, v241
    v_mfma_f32_16x16x32_bf16 v[204:207], v[236:239], v[44:47], v[204:207]
    ds_read_b64_tr_b16 v[232:233], v242 offset:24576
    v_mfma_f32_16x16x32_bf16 v[200:203], v[236:239], v[40:43], v[200:203]
    ds_read_b64_tr_b16 v[234:235], v242 offset:25088
    s_waitcnt lgkmcnt(4)
    v_add_u32 v242, 0x12000, v242
    s_waitcnt vmcnt(10)
    v_mfma_f32_16x16x32_bf16 v[144:147], v[224:227], v[48:51], v[144:147]
    ds_read_b64_tr_b16 v[236:237], v243 offset:24576
    s_add_u32 s34, s30, 49152
    buffer_load_dwordx4 v[96:99], v245, s[12:15], s34 offen offset:0 sc1
    v_mfma_f32_16x16x32_bf16 v[148:151], v[224:227], v[52:55], v[148:151]
    ds_read_b64_tr_b16 v[238:239], v243 offset:25088
    s_waitcnt lgkmcnt(4)
    v_add_u32 v243, 0x12000, v243
    v_mfma_f32_16x16x32_bf16 v[156:159], v[228:231], v[52:55], v[156:159]
    ds_read_b64_tr_b16 v[224:225], v240 offset:24576
    v_mfma_f32_16x16x32_bf16 v[152:155], v[228:231], v[48:51], v[152:155]
    ds_read_b64_tr_b16 v[226:227], v240 offset:25088
    s_waitcnt lgkmcnt(4)
    v_add_u32 v240, 0xfffee000, v240
    v_mfma_f32_16x16x32_bf16 v[160:163], v[232:235], v[48:51], v[160:163]
    ds_read_b64_tr_b16 v[228:229], v241 offset:24576
    v_mfma_f32_16x16x32_bf16 v[164:167], v[232:235], v[52:55], v[164:167]
    ds_read_b64_tr_b16 v[230:231], v241 offset:25088
    s_waitcnt lgkmcnt(4)
    v_add_u32 v241, 0xfffee000, v241
    v_mfma_f32_16x16x32_bf16 v[172:175], v[236:239], v[52:55], v[172:175]
    ds_read_b64_tr_b16 v[232:233], v242 offset:24576
    buffer_load_dwordx4 v[100:103], v245, s[12:15], s34 offen offset:1024 sc1
    v_mfma_f32_16x16x32_bf16 v[168:171], v[236:239], v[48:51], v[168:171]
    ds_read_b64_tr_b16 v[234:235], v242 offset:25088
    s_waitcnt lgkmcnt(4)
    v_add_u32 v242, 0xfffee000, v242
    s_setprio 0
    v_mfma_f32_16x16x32_bf16 v[176:179], v[224:227], v[48:51], v[176:179]
    ds_read_b64_tr_b16 v[236:237], v243 offset:24576
    v_mfma_f32_16x16x32_bf16 v[180:183], v[224:227], v[52:55], v[180:183]
    ds_read_b64_tr_b16 v[238:239], v243 offset:25088
    s_waitcnt lgkmcnt(4)
    v_add_u32 v243, 0xfffee000, v243
    v_mfma_f32_16x16x32_bf16 v[188:191], v[228:231], v[52:55], v[188:191]
    ds_read_b64_tr_b16 v[224:225], v240 offset:28672
    v_mfma_f32_16x16x32_bf16 v[184:187], v[228:231], v[48:51], v[184:187]
    ds_read_b64_tr_b16 v[226:227], v240 offset:29184
    s_waitcnt lgkmcnt(4)
    v_add_u32 v240, 0x12000, v240
    v_mfma_f32_16x16x32_bf16 v[192:195], v[232:235], v[48:51], v[192:195]
    ds_read_b64_tr_b16 v[228:229], v241 offset:28672
    s_add_u32 s34, s30, 53248
    buffer_load_dwordx4 v[104:107], v245, s[12:15], s34 offen offset:0 sc1
    v_mfma_f32_16x16x32_bf16 v[196:199], v[232:235], v[52:55], v[196:199]
    ds_read_b64_tr_b16 v[230:231], v241 offset:29184
    s_waitcnt lgkmcnt(4)
    v_add_u32 v241, 0x12000, v241
    v_mfma_f32_16x16x32_bf16 v[204:207], v[236:239], v[52:55], v[204:207]
    ds_read_b64_tr_b16 v[232:233], v242 offset:28672
    v_mfma_f32_16x16x32_bf16 v[200:203], v[236:239], v[48:51], v[200:203]
    ds_read_b64_tr_b16 v[234:235], v242 offset:29184
    s_waitcnt lgkmcnt(4)
    v_add_u32 v242, 0x12000, v242
    s_waitcnt vmcnt(11)
    v_mfma_f32_16x16x32_bf16 v[144:147], v[224:227], v[56:59], v[144:147]
    ds_read_b64_tr_b16 v[236:237], v243 offset:28672
    v_mfma_f32_16x16x32_bf16 v[148:151], v[224:227], v[60:63], v[148:151]
    ds_read_b64_tr_b16 v[238:239], v243 offset:29184
    s_waitcnt lgkmcnt(4)
    v_add_u32 v243, 0x12000, v243
    v_mfma_f32_16x16x32_bf16 v[156:159], v[228:231], v[60:63], v[156:159]
    ds_read_b64_tr_b16 v[224:225], v240 offset:28672
    buffer_load_dwordx4 v[108:111], v245, s[12:15], s34 offen offset:1024 sc1
    v_mfma_f32_16x16x32_bf16 v[152:155], v[228:231], v[56:59], v[152:155]
    ds_read_b64_tr_b16 v[226:227], v240 offset:29184
    s_waitcnt lgkmcnt(4)
    v_add_u32 v240, 0xfffee000, v240
    v_mfma_f32_16x16x32_bf16 v[160:163], v[232:235], v[56:59], v[160:163]
    ds_read_b64_tr_b16 v[228:229], v241 offset:28672
    v_mfma_f32_16x16x32_bf16 v[164:167], v[232:235], v[60:63], v[164:167]
    ds_read_b64_tr_b16 v[230:231], v241 offset:29184
    s_waitcnt lgkmcnt(4)
    v_add_u32 v241, 0xfffee000, v241
    v_mfma_f32_16x16x32_bf16 v[172:175], v[236:239], v[60:63], v[172:175]
    ds_read_b64_tr_b16 v[232:233], v242 offset:28672
    v_mfma_f32_16x16x32_bf16 v[168:171], v[236:239], v[56:59], v[168:171]
    ds_read_b64_tr_b16 v[234:235], v242 offset:29184
    s_waitcnt lgkmcnt(4)
    v_add_u32 v242, 0xfffee000, v242
    v_mfma_f32_16x16x32_bf16 v[176:179], v[224:227], v[56:59], v[176:179]
    ds_read_b64_tr_b16 v[236:237], v243 offset:28672
    s_add_u32 s34, s30, 57344
    buffer_load_dwordx4 v[112:115], v245, s[12:15], s34 offen offset:0 sc1
    v_mfma_f32_16x16x32_bf16 v[180:183], v[224:227], v[60:63], v[180:183]
    ds_read_b64_tr_b16 v[238:239], v243 offset:29184
    s_waitcnt lgkmcnt(4)
    v_add_u32 v243, 0xfffee000, v243
    v_mfma_f32_16x16x32_bf16 v[188:191], v[228:231], v[60:63], v[188:191]
    ds_read_b64_tr_b16 v[224:225], v240 offset:32768
    v_mfma_f32_16x16x32_bf16 v[184:187], v[228:231], v[56:59], v[184:187]
    ds_read_b64_tr_b16 v[226:227], v240 offset:33280
    s_waitcnt lgkmcnt(4)
    v_add_u32 v240, 0x12000, v240
    v_mfma_f32_16x16x32_bf16 v[192:195], v[232:235], v[56:59], v[192:195]
    ds_read_b64_tr_b16 v[228:229], v241 offset:32768
    v_mfma_f32_16x16x32_bf16 v[196:199], v[232:235], v[60:63], v[196:199]
    ds_read_b64_tr_b16 v[230:231], v241 offset:33280
    s_waitcnt lgkmcnt(4)
    v_add_u32 v241, 0x12000, v241
    v_mfma_f32_16x16x32_bf16 v[204:207], v[236:239], v[60:63], v[204:207]
    ds_read_b64_tr_b16 v[232:233], v242 offset:32768
    buffer_load_dwordx4 v[116:119], v245, s[12:15], s34 offen offset:1024 sc1
    v_mfma_f32_16x16x32_bf16 v[200:203], v[236:239], v[56:59], v[200:203]
    ds_read_b64_tr_b16 v[234:235], v242 offset:33280
    s_waitcnt lgkmcnt(4)
    v_add_u32 v242, 0x12000, v242
    s_waitcnt vmcnt(12)
    v_mfma_f32_16x16x32_bf16 v[144:147], v[224:227], v[64:67], v[144:147]
    ds_read_b64_tr_b16 v[236:237], v243 offset:32768
    v_mfma_f32_16x16x32_bf16 v[148:151], v[224:227], v[68:71], v[148:151]
    ds_read_b64_tr_b16 v[238:239], v243 offset:33280
    s_waitcnt lgkmcnt(4)
    v_add_u32 v243, 0x12000, v243
    v_mfma_f32_16x16x32_bf16 v[156:159], v[228:231], v[68:71], v[156:159]
    ds_read_b64_tr_b16 v[224:225], v240 offset:32768
    v_mfma_f32_16x16x32_bf16 v[152:155], v[228:231], v[64:67], v[152:155]
    ds_read_b64_tr_b16 v[226:227], v240 offset:33280
    s_waitcnt lgkmcnt(4)
    v_add_u32 v240, 0xffff7000, v240
    v_mfma_f32_16x16x32_bf16 v[160:163], v[232:235], v[64:67], v[160:163]
    ds_read_b64_tr_b16 v[228:229], v241 offset:32768
    s_add_u32 s34, s30, 61440
    buffer_load_dwordx4 v[120:123], v245, s[12:15], s34 offen offset:0 sc1
    v_mfma_f32_16x16x32_bf16 v[164:167], v[232:235], v[68:71], v[164:167]
    ds_read_b64_tr_b16 v[230:231], v241 offset:33280
    s_waitcnt lgkmcnt(4)
    v_add_u32 v241, 0xffff7000, v241
    v_mfma_f32_16x16x32_bf16 v[172:175], v[236:239], v[68:71], v[172:175]
    ds_read_b64_tr_b16 v[232:233], v242 offset:32768
    v_mfma_f32_16x16x32_bf16 v[168:171], v[236:239], v[64:67], v[168:171]
    ds_read_b64_tr_b16 v[234:235], v242 offset:33280
    s_waitcnt lgkmcnt(4)
    v_add_u32 v242, 0xffff7000, v242
    v_mfma_f32_16x16x32_bf16 v[176:179], v[224:227], v[64:67], v[176:179]
    ds_read_b64_tr_b16 v[236:237], v243 offset:32768
    v_mfma_f32_16x16x32_bf16 v[180:183], v[224:227], v[68:71], v[180:183]
    ds_read_b64_tr_b16 v[238:239], v243 offset:33280
    s_waitcnt lgkmcnt(4)
    v_add_u32 v243, 0xffff7000, v243
    v_mfma_f32_16x16x32_bf16 v[188:191], v[228:231], v[68:71], v[188:191]
    ds_read_b64_tr_b16 v[224:225], v240 offset:0
    buffer_load_dwordx4 v[124:127], v245, s[12:15], s34 offen offset:1024 sc1
    v_mfma_f32_16x16x32_bf16 v[184:187], v[228:231], v[64:67], v[184:187]
    ds_read_b64_tr_b16 v[226:227], v240 offset:512
    s_waitcnt lgkmcnt(4)
    v_mfma_f32_16x16x32_bf16 v[192:195], v[232:235], v[64:67], v[192:195]
    ds_read_b64_tr_b16 v[228:229], v241 offset:0
    v_mfma_f32_16x16x32_bf16 v[196:199], v[232:235], v[68:71], v[196:199]
    ds_read_b64_tr_b16 v[230:231], v241 offset:512
    s_waitcnt lgkmcnt(4)
    v_mfma_f32_16x16x32_bf16 v[204:207], v[236:239], v[68:71], v[204:207]
    ds_read_b64_tr_b16 v[232:233], v242 offset:0
    v_mfma_f32_16x16x32_bf16 v[200:203], v[236:239], v[64:67], v[200:203]
    ds_read_b64_tr_b16 v[234:235], v242 offset:512
    s_waitcnt lgkmcnt(4)
    s_cbranch_vccnz Lp6
    s_setprio 1
Lp6:
    s_waitcnt vmcnt(12)
    v_mfma_f32_16x16x32_bf16 v[144:147], v[224:227], v[72:75], v[144:147]
    ds_read_b64_tr_b16 v[236:237], v243 offset:0
    s_add_u32 s34, s30, 65536
    buffer_load_dwordx4 v[128:131], v245, s[12:15], s34 offen offset:0 sc1
    v_mfma_f32_16x16x32_bf16 v[148:151], v[224:227], v[76:79], v[148:151]
    ds_read_b64_tr_b16 v[238:239], v243 offset:512
    s_waitcnt lgkmcnt(4)
    v_mfma_f32_16x16x32_bf16 v[156:159], v[228:231], v[76:79], v[156:159]
    ds_read_b64_tr_b16 v[224:225], v240 offset:4096
    v_mfma_f32_16x16x32_bf16 v[152:155], v[228:231], v[72:75], v[152:155]
    ds_read_b64_tr_b16 v[226:227], v240 offset:4608
    s_waitcnt lgkmcnt(4)
    v_mfma_f32_16x16x32_bf16 v[160:163], v[232:235], v[72:75], v[160:163]
    ds_read_b64_tr_b16 v[228:229], v241 offset:4096
    v_mfma_f32_16x16x32_bf16 v[164:167], v[232:235], v[76:79], v[164:167]
    ds_read_b64_tr_b16 v[230:231], v241 offset:4608
    s_waitcnt lgkmcnt(4)
    v_mfma_f32_16x16x32_bf16 v[172:175], v[236:239], v[76:79], v[172:175]
    ds_read_b64_tr_b16 v[232:233], v242 offset:4096
    buffer_load_dwordx4 v[132:135], v245, s[12:15], s34 offen offset:1024 sc1
    v_mfma_f32_16x16x32_bf16 v[168:171], v[236:239], v[72:75], v[168:171]
    ds_read_b64_tr_b16 v[234:235], v242 offset:4608
    s_waitcnt lgkmcnt(4)
    s_waitcnt vmcnt(12)
    v_mfma_f32_16x16x32_bf16 v[144:147], v[224:227], v[80:83], v[144:147]
    ds_read_b64_tr_b16 v[236:237], v243 offset:4096
    v_mfma_f32_16x16x32_bf16 v[148:151], v[224:227], v[84:87], v[148:151]
    ds_read_b64_tr_b16 v[238:239], v243 offset:4608
    s_waitcnt lgkmcnt(4)
    v_mfma_f32_16x16x32_bf16 v[156:159], v[228:231], v[84:87], v[156:159]
    ds_read_b64_tr_b16 v[224:225], v240 offset:8192
    v_mfma_f32_16x16x32_bf16 v[152:155], v[228:231], v[80:83], v[152:155]
    ds_read_b64_tr_b16 v[226:227], v240 offset:8704
    s_waitcnt lgkmcnt(4)
    v_mfma_f32_16x16x32_bf16 v[160:163], v[232:235], v[80:83], v[160:163]
    ds_read_b64_tr_b16 v[228:229], v241 offset:8192
    s_add_u32 s34, s30, 69632
    buffer_load_dwordx4 v[136:139], v245, s[12:15], s34 offen offset:0 sc1
    v_mfma_f32_16x16x32_bf16 v[164:167], v[232:235], v[84:87], v[164:167]
    ds_read_b64_tr_b16 v[230:231], v241 offset:8704
    s_waitcnt lgkmcnt(4)
    v_mfma_f32_16x16x32_bf16 v[172:175], v[236:239], v[84:87], v[172:175]
    ds_read_b64_tr_b16 v[232:233], v242 offset:8192
    v_mfma_f32_16x16x32_bf16 v[168:171], v[236:239], v[80:83], v[168:171]
    ds_read_b64_tr_b16 v[234:235], v242 offset:8704
    s_waitcnt lgkmcnt(4)
    s_waitcnt vmcnt(11)
    v_mfma_f32_16x16x32_bf16 v[144:147], v[224:227], v[88:91], v[144:147]
    ds_read_b64_tr_b16 v[236:237], v243 offset:8192
    v_mfma_f32_16x16x32_bf16 v[148:151], v[224:227], v[92:95], v[148:151]
    ds_read_b64_tr_b16 v[238:239], v243 offset:8704
    s_waitcnt lgkmcnt(4)
    v_mfma_f32_16x16x32_bf16 v[156:159], v[228:231], v[92:95], v[156:159]
    ds_read_b64_tr_b16 v[224:225], v240 offset:12288
    buffer_load_dwordx4 v[140:143], v245, s[12:15], s34 offen offset:1024 sc1
    v_mfma_f32_16x16x32_bf16 v[152:155], v[228:231], v[88:91], v[152:155]
    ds_read_b64_tr_b16 v[226:227], v240 offset:12800
    s_waitcnt lgkmcnt(4)
    v_mfma_f32_16x16x32_bf16 v[160:163], v[232:235], v[88:91], v[160:163]
    ds_read_b64_tr_b16 v[228:229], v241 offset:12288
    buffer_load_dword v255, v255, s[60:63], s47 offen
    v_mfma_f32_16x16x32_bf16 v[164:167], v[232:235], v[92:95], v[164:167]
    ds_read_b64_tr_b16 v[230:231], v241 offset:12800
    s_waitcnt lgkmcnt(4)
    v_mfma_f32_16x16x32_bf16 v[172:175], v[236:239], v[92:95], v[172:175]
    ds_read_b64_tr_b16 v[232:233], v242 offset:12288
    buffer_load_dword v254, v254, s[64:67], 0 offen
    v_mfma_f32_16x16x32_bf16 v[168:171], v[236:239], v[88:91], v[168:171]
    ds_read_b64_tr_b16 v[234:235], v242 offset:12800
    s_waitcnt lgkmcnt(4)
    s_waitcnt vmcnt(12)
    v_mfma_f32_16x16x32_bf16 v[144:147], v[224:227], v[96:99], v[144:147]
    ds_read_b64_tr_b16 v[236:237], v243 offset:12288
    v_mfma_f32_16x16x32_bf16 v[148:151], v[224:227], v[100:103], v[148:151]
    ds_read_b64_tr_b16 v[238:239], v243 offset:12800
    s_waitcnt lgkmcnt(4)
    v_mfma_f32_16x16x32_bf16 v[156:159], v[228:231], v[100:103], v[156:159]
    ds_read_b64_tr_b16 v[224:225], v240 offset:16384
    v_mfma_f32_16x16x32_bf16 v[152:155], v[228:231], v[96:99], v[152:155]
    ds_read_b64_tr_b16 v[226:227], v240 offset:16896
    s_waitcnt lgkmcnt(4)
    v_mfma_f32_16x16x32_bf16 v[160:163], v[232:235], v[96:99], v[160:163]
    ds_read_b64_tr_b16 v[228:229], v241 offset:16384
    v_mfma_f32_16x16x32_bf16 v[164:167], v[232:235], v[100:103], v[164:167]
    ds_read_b64_tr_b16 v[230:231], v241 offset:16896
    s_waitcnt lgkmcnt(4)
    v_mfma_f32_16x16x32_bf16 v[172:175], v[236:239], v[100:103], v[172:175]
    ds_read_b64_tr_b16 v[232:233], v242 offset:16384
    v_mfma_f32_16x16x32_bf16 v[168:171], v[236:239], v[96:99], v[168:171]
    ds_read_b64_tr_b16 v[234:235], v242 offset:16896
    s_waitcnt lgkmcnt(4)
    s_waitcnt vmcnt(10)
    v_mfma_f32_16x16x32_bf16 v[144:147], v[224:227], v[104:107], v[144:147]
    ds_read_b64_tr_b16 v[236:237], v243 offset:16384
    v_mfma_f32_16x16x32_bf16 v[148:151], v[224:227], v[108:111], v[148:151]
    ds_read_b64_tr_b16 v[238:239], v243 offset:16896
    s_waitcnt lgkmcnt(4)
    v_mfma_f32_16x16x32_bf16 v[156:159], v[228:231], v[108:111], v[156:159]
    ds_read_b64_tr_b16 v[224:225], v240 offset:20480
    v_mfma_f32_16x16x32_bf16 v[152:155], v[228:231], v[104:107], v[152:155]
    ds_read_b64_tr_b16 v[226:227], v240 offset:20992
    s_waitcnt lgkmcnt(4)
    v_mfma_f32_16x16x32_bf16 v[160:163], v[232:235], v[104:107], v[160:163]
    ds_read_b64_tr_b16 v[228:229], v241 offset:20480
    v_mfma_f32_16x16x32_bf16 v[164:167], v[232:235], v[108:111], v[164:167]
    ds_read_b64_tr_b16 v[230:231], v241 offset:20992
    s_waitcnt lgkmcnt(4)
    v_mfma_f32_16x16x32_bf16 v[172:175], v[236:239], v[108:111], v[172:175]
    ds_read_b64_tr_b16 v[232:233], v242 offset:20480
    v_mfma_f32_16x16x32_bf16 v[168:171], v[236:239], v[104:107], v[168:171]
    ds_read_b64_tr_b16 v[234:235], v242 offset:20992
    s_waitcnt lgkmcnt(4)
    s_waitcnt vmcnt(8)
    v_mfma_f32_16x16x32_bf16 v[144:147], v[224:227], v[112:115], v[144:147]
    ds_read_b64_tr_b16 v[236:237], v243 offset:20480
    v_mfma_f32_16x16x32_bf16 v[148:151], v[224:227], v[116:119], v[148:151]
    ds_read_b64_tr_b16 v[238:239], v243 offset:20992
    s_waitcnt lgkmcnt(4)
    v_mfma_f32_16x16x32_bf16 v[156:159], v[228:231], v[116:119], v[156:159]
    ds_read_b64_tr_b16 v[224:225], v240 offset:24576
    v_mfma_f32_16x16x32_bf16 v[152:155], v[228:231], v[112:115], v[152:155]
    ds_read_b64_tr_b16 v[226:227], v240 offset:25088
    s_waitcnt lgkmcnt(4)
    v_mfma_f32_16x16x32_bf16 v[160:163], v[232:235], v[112:115], v[160:163]
    ds_read_b64_tr_b16 v[228:229], v241 offset:24576
    v_mfma_f32_16x16x32_bf16 v[164:167], v[232:235], v[116:119], v[164:167]
    ds_read_b64_tr_b16 v[230:231], v241 offset:25088
    s_waitcnt lgkmcnt(4)
    v_mfma_f32_16x16x32_bf16 v[172:175], v[236:239], v[116:119], v[172:175]
    ds_read_b64_tr_b16 v[232:233], v242 offset:24576
    v_mfma_f32_16x16x32_bf16 v[168:171], v[236:239], v[112:115], v[168:171]
    ds_read_b64_tr_b16 v[234:235], v242 offset:25088
    s_waitcnt lgkmcnt(4)
    s_waitcnt vmcnt(6)
    v_mfma_f32_16x16x32_bf16 v[144:147], v[224:227], v[120:123], v[144:147]
    ds_read_b64_tr_b16 v[236:237], v243 offset:24576
    v_mfma_f32_16x16x32_bf16 v[148:151], v[224:227], v[124:127], v[148:151]
    ds_read_b64_tr_b16 v[238:239], v243 offset:25088
    s_waitcnt lgkmcnt(4)
    v_mfma_f32_16x16x32_bf16 v[156:159], v[228:231], v[124:127], v[156:159]
    ds_read_b64_tr_b16 v[224:225], v240 offset:28672
    v_mfma_f32_16x16x32_bf16 v[152:155], v[228:231], v[120:123], v[152:155]
    ds_read_b64_tr_b16 v[226:227], v240 offset:29184
    s_waitcnt lgkmcnt(4)
    v_mfma_f32_16x16x32_bf16 v[160:163], v[232:235], v[120:123], v[160:163]
    ds_read_b64_tr_b16 v[228:229], v241 offset:28672
    v_mfma_f32_16x16x32_bf16 v[164:167], v[232:235], v[124:127], v[164:167]
    ds_read_b64_tr_b16 v[230:231], v241 offset:29184
    s_waitcnt lgkmcnt(4)
    v_mfma_f32_16x16x32_bf16 v[172:175], v[236:239], v[124:127], v[172:175]
    ds_read_b64_tr_b16 v[232:233], v242 offset:28672
    v_mfma_f32_16x16x32_bf16 v[168:171], v[236:239], v[120:123], v[168:171]
    ds_read_b64_tr_b16 v[234:235], v242 offset:29184
    s_waitcnt lgkmcnt(4)
    s_waitcnt vmcnt(4)
    v_mfma_f32_16x16x32_bf16 v[144:147], v[224:227], v[128:131], v[144:147]
    ds_read_b64_tr_b16 v[236:237], v243 offset:28672
    v_mfma_f32_16x16x32_bf16 v[148:151], v[224:227], v[132:135], v[148:151]
    ds_read_b64_tr_b16 v[238:239], v243 offset:29184
    s_waitcnt lgkmcnt(4)
    v_mfma_f32_16x16x32_bf16 v[156:159], v[228:231], v[132:135], v[156:159]
    ds_read_b64_tr_b16 v[224:225], v240 offset:32768
    v_mfma_f32_16x16x32_bf16 v[152:155], v[228:231], v[128:131], v[152:155]
    ds_read_b64_tr_b16 v[226:227], v240 offset:33280
    s_waitcnt lgkmcnt(4)
    v_add_u32 v240, 0x12000, v240
    v_mfma_f32_16x16x32_bf16 v[160:163], v[232:235], v[128:131], v[160:163]
    ds_read_b64_tr_b16 v[228:229], v241 offset:32768
    v_mfma_f32_16x16x32_bf16 v[164:167], v[232:235], v[132:135], v[164:167]
    ds_read_b64_tr_b16 v[230:231], v241 offset:33280
    s_waitcnt lgkmcnt(4)
    v_add_u32 v241, 0x12000, v241
    v_mfma_f32_16x16x32_bf16 v[172:175], v[236:239], v[132:135], v[172:175]
    ds_read_b64_tr_b16 v[232:233], v242 offset:32768
    v_mfma_f32_16x16x32_bf16 v[168:171], v[236:239], v[128:131], v[168:171]
    ds_read_b64_tr_b16 v[234:235], v242 offset:33280
    s_waitcnt lgkmcnt(4)
    v_add_u32 v242, 0x12000, v242
    s_waitcnt vmcnt(2)
    v_mfma_f32_16x16x32_bf16 v[144:147], v[224:227], v[136:139], v[144:147]
    ds_read_b64_tr_b16 v[236:237], v243 offset:32768
    v_mfma_f32_16x16x32_bf16 v[148:151], v[224:227], v[140:143], v[148:151]
    ds_read_b64_tr_b16 v[238:239], v243 offset:33280
    s_waitcnt lgkmcnt(4)
    v_add_u32 v243, 0x12000, v243
    v_mfma_f32_16x16x32_bf16 v[156:159], v[228:231], v[140:143], v[156:159]
    ds_read_b64_tr_b16 v[224:225], v240 offset:0
    v_mfma_f32_16x16x32_bf16 v[152:155], v[228:231], v[136:139], v[152:155]
    ds_read_b64_tr_b16 v[226:227], v240 offset:512
    s_waitcnt lgkmcnt(4)
    v_mfma_f32_16x16x32_bf16 v[160:163], v[232:235], v[136:139], v[160:163]
    ds_read_b64_tr_b16 v[228:229], v241 offset:0
    v_mfma_f32_16x16x32_bf16 v[164:167], v[232:235], v[140:143], v[164:167]
    ds_read_b64_tr_b16 v[230:231], v241 offset:512
    s_waitcnt lgkmcnt(4)
    v_mfma_f32_16x16x32_bf16 v[172:175], v[236:239], v[140:143], v[172:175]
    ds_read_b64_tr_b16 v[232:233], v242 offset:0
    v_mfma_f32_16x16x32_bf16 v[168:171], v[236:239], v[136:139], v[168:171]
    ds_read_b64_tr_b16 v[234:235], v242 offset:512
    s_waitcnt lgkmcnt(4)
    s_barrier
    v_mfma_f32_16x16x32_bf16 v[176:179], v[224:227], v[72:75], v[176:179]
    ds_read_b64_tr_b16 v[236:237], v243 offset:0
    v_mfma_f32_16x16x32_bf16 v[180:183], v[224:227], v[76:79], v[180:183]
    ds_read_b64_tr_b16 v[238:239], v243 offset:512
    s_waitcnt lgkmcnt(4)
    v_mfma_f32_16x16x32_bf16 v[188:191], v[228:231], v[76:79], v[188:191]
    ds_read_b64_tr_b16 v[224:225], v240 offset:4096
    s_add_u32 s25, s25, 144
    s_sub_u32 s26, s26, 1
    s_cmp_eq_u32 s26, 0
    s_cselect_b32 s18, 0, s18
    s_add_u32 m0, s29, 0
    s_mov_b32 s24, s25
    buffer_load_dwordx4 v244, s[16:19], s24 offen lds
    v_mfma_f32_16x16x32_bf16 v[184:187], v[228:231], v[72:75], v[184:187]
    ds_read_b64_tr_b16 v[226:227], v240 offset:4608
    s_waitcnt lgkmcnt(4)
    v_mfma_f32_16x16x32_bf16 v[192:195], v[232:235], v[72:75], v[192:195]
    ds_read_b64_tr_b16 v[228:229], v241 offset:4096
    s_add_u32 s32, s27, 0
    v_mfma_f32_16x16x32_bf16 v[196:199], v[232:235], v[76:79], v[196:199]
    ds_read_b64_tr_b16 v[230:231], v241 offset:4608
    s_waitcnt lgkmcnt(4)
    v_mul_f32 v144, s28, v144
    v_mfma_f32_16x16x32_bf16 v[204:207], v[236:239], v[76:79], v[204:207]
    ds_read_b64_tr_b16 v[232:233], v242 offset:4096
    v_mul_f32 v145, s28, v145
    v_mfma_f32_16x16x32_bf16 v[200:203], v[236:239], v[72:75], v[200:203]
    ds_read_b64_tr_b16 v[234:235], v242 offset:4608
    s_waitcnt lgkmcnt(4)
    v_mul_f32 v146, s28, v146
    v_mfma_f32_16x16x32_bf16 v[176:179], v[224:227], v[80:83], v[176:179]
    ds_read_b64_tr_b16 v[236:237], v243 offset:4096
    s_add_u32 m0, s29, 8192
    s_add_u32 s24, s24, s35
    buffer_load_dwordx4 v244, s[16:19], s24 offen lds
    v_mul_f32 v147, s28, v147
    v_mfma_f32_16x16x32_bf16 v[180:183], v[224:227], v[84:87], v[180:183]
    ds_read_b64_tr_b16 v[238:239], v243 offset:4608
    s_waitcnt lgkmcnt(4)
    v_cvt_pk_bf16_f32 v144, v144, v145
    v_mfma_f32_16x16x32_bf16 v[188:191], v[228:231], v[84:87], v[188:191]
    ds_read_b64_tr_b16 v[224:225], v240 offset:8192
    v_cvt_pk_bf16_f32 v145, v146, v147
    v_mfma_f32_16x16x32_bf16 v[184:187], v[228:231], v[80:83], v[184:187]
    ds_read_b64_tr_b16 v[226:227], v240 offset:8704
    s_waitcnt lgkmcnt(4)
    buffer_store_dwordx2 v[144:145], v246, s[12:15], s32 offen offset:0 sc1
    v_mfma_f32_16x16x32_bf16 v[192:195], v[232:235], v[80:83], v[192:195]
    ds_read_b64_tr_b16 v[228:229], v241 offset:8192
    v_mul_f32 v148, s28, v148
    v_mfma_f32_16x16x32_bf16 v[196:199], v[232:235], v[84:87], v[196:199]
    ds_read_b64_tr_b16 v[230:231], v241 offset:8704
    s_waitcnt lgkmcnt(4)
    v_mul_f32 v149, s28, v149
    v_mfma_f32_16x16x32_bf16 v[204:207], v[236:239], v[84:87], v[204:207]
    ds_read_b64_tr_b16 v[232:233], v242 offset:8192
    s_add_u32 m0, s29, 16384
    s_add_u32 s24, s24, s35
    buffer_load_dwordx4 v244, s[16:19], s24 offen lds
    v_mul_f32 v150, s28, v150
    v_mfma_f32_16x16x32_bf16 v[200:203], v[236:239], v[80:83], v[200:203]
    ds_read_b64_tr_b16 v[234:235], v242 offset:8704
    s_waitcnt lgkmcnt(4)
    v_mul_f32 v151, s28, v151
    v_mfma_f32_16x16x32_bf16 v[176:179], v[224:227], v[88:91], v[176:179]
    ds_read_b64_tr_b16 v[236:237], v243 offset:8192
    v_cvt_pk_bf16_f32 v148, v148, v149
    v_mfma_f32_16x16x32_bf16 v[180:183], v[224:227], v[92:95], v[180:183]
    ds_read_b64_tr_b16 v[238:239], v243 offset:8704
    s_waitcnt lgkmcnt(4)
    v_cvt_pk_bf16_f32 v149, v150, v151
    v_mfma_f32_16x16x32_bf16 v[188:191], v[228:231], v[92:95], v[188:191]
    ds_read_b64_tr_b16 v[224:225], v240 offset:12288
    buffer_store_dwordx2 v[148:149], v246, s[12:15], s32 offen offset:256 sc1
    v_mfma_f32_16x16x32_bf16 v[184:187], v[228:231], v[88:91], v[184:187]
    ds_read_b64_tr_b16 v[226:227], v240 offset:12800
    s_waitcnt lgkmcnt(4)
    s_add_u32 s32, s27, 65536
    v_mfma_f32_16x16x32_bf16 v[192:195], v[232:235], v[88:91], v[192:195]
    ds_read_b64_tr_b16 v[228:229], v241 offset:12288
    s_add_u32 m0, s29, 24576
    s_add_u32 s24, s24, s35
    buffer_load_dwordx4 v244, s[16:19], s24 offen lds
    v_mul_f32 v152, s28, v152
    v_mfma_f32_16x16x32_bf16 v[196:199], v[232:235], v[92:95], v[196:199]
    ds_read_b64_tr_b16 v[230:231], v241 offset:12800
    s_waitcnt lgkmcnt(4)
    v_mul_f32 v153, s28, v153
    v_mfma_f32_16x16x32_bf16 v[204:207], v[236:239], v[92:95], v[204:207]
    ds_read_b64_tr_b16 v[232:233], v242 offset:12288
    v_mul_f32 v154, s28, v154
    v_mfma_f32_16x16x32_bf16 v[200:203], v[236:239], v[88:91], v[200:203]
    ds_read_b64_tr_b16 v[234:235], v242 offset:12800
    s_waitcnt lgkmcnt(4)
    v_mul_f32 v155, s28, v155
    v_mfma_f32_16x16x32_bf16 v[176:179], v[224:227], v[96:99], v[176:179]
    ds_read_b64_tr_b16 v[236:237], v243 offset:12288
    v_cvt_pk_bf16_f32 v152, v152, v153
    v_mfma_f32_16x16x32_bf16 v[180:183], v[224:227], v[100:103], v[180:183]
    ds_read_b64_tr_b16 v[238:239], v243 offset:12800
    s_waitcnt lgkmcnt(4)
    v_cvt_pk_bf16_f32 v153, v154, v155
    v_mfma_f32_16x16x32_bf16 v[188:191], v[228:231], v[100:103], v[188:191]
    ds_read_b64_tr_b16 v[224:225], v240 offset:16384
    s_add_u32 m0, s29, 32768
    s_add_u32 s24, s24, s35
    buffer_load_dwordx4 v244, s[16:19], s24 offen lds
    buffer_store_dwordx2 v[152:153], v246, s[12:15], s32 offen offset:0 sc1
    v_mfma_f32_16x16x32_bf16 v[184:187], v[228:231], v[96:99], v[184:187]
    ds_read_b64_tr_b16 v[226:227], v240 offset:16896
    s_waitcnt lgkmcnt(4)
    v_mul_f32 v156, s28, v156
    v_mfma_f32_16x16x32_bf16 v[192:195], v[232:235], v[96:99], v[192:195]
    ds_read_b64_tr_b16 v[228:229], v241 offset:16384
    v_mul_f32 v157, s28, v157
    v_mfma_f32_16x16x32_bf16 v[196:199], v[232:235], v[100:103], v[196:199]
    ds_read_b64_tr_b16 v[230:231], v241 offset:16896
    s_waitcnt lgkmcnt(4)
    v_mul_f32 v158, s28, v158
    v_mfma_f32_16x16x32_bf16 v[204:207], v[236:239], v[100:103], v[204:207]
    ds_read_b64_tr_b16 v[232:233], v242 offset:16384
    v_mul_f32 v159, s28, v159
    v_mfma_f32_16x16x32_bf16 v[200:203], v[236:239], v[96:99], v[200:203]
    ds_read_b64_tr_b16 v[234:235], v242 offset:16896
    s_waitcnt lgkmcnt(4)
    v_cvt_pk_bf16_f32 v156, v156, v157
    s_setprio 0
    v_mfma_f32_16x16x32_bf16 v[176:179], v[224:227], v[104:107], v[176:179]
    ds_read_b64_tr_b16 v[236:237], v243 offset:16384
    s_add_u32 m0, s29, 40960
    s_add_u32 s24, s24, s35
    buffer_load_dwordx4 v244, s[16:19], s24 offen lds
    v_cvt_pk_bf16_f32 v157, v158, v159
    v_mfma_f32_16x16x32_bf16 v[180:183], v[224:227], v[108:111], v[180:183]
    ds_read_b64_tr_b16 v[238:239], v243 offset:16896
    s_waitcnt lgkmcnt(4)
    buffer_store_dwordx2 v[156:157], v246, s[12:15], s32 offen offset:256 sc1
    v_mfma_f32_16x16x32_bf16 v[188:191], v[228:231], v[108:111], v[188:191]
    ds_read_b64_tr_b16 v[224:225], v240 offset:20480
    s_add_u32 s32, s27, 131072
    v_mul_f32 v160, s28, v160
    v_mfma_f32_16x16x32_bf16 v[184:187], v[228:231], v[104:107], v[184:187]
    ds_read_b64_tr_b16 v[226:227], v240 offset:20992
    s_waitcnt lgkmcnt(4)
    v_mfma_f32_16x16x32_bf16 v[192:195], v[232:235], v[104:107], v[192:195]
    ds_read_b64_tr_b16 v[228:229], v241 offset:20480
    v_mul_f32 v161, s28, v161
    v_mfma_f32_16x16x32_bf16 v[196:199], v[232:235], v[108:111], v[196:199]
    ds_read_b64_tr_b16 v[230:231], v241 offset:20992
    s_waitcnt lgkmcnt(4)
    v_mul_f32 v162, s28, v162
    v_mfma_f32_16x16x32_bf16 v[204:207], v[236:239], v[108:111], v[204:207]
    ds_read_b64_tr_b16 v[232:233], v242 offset:20480
    s_add_u32 m0, s29, 49152
    s_add_u32 s24, s24, s35
    buffer_load_dwordx4 v244, s[16:19], s24 offen lds
    v_mul_f32 v163, s28, v163
    v_mfma_f32_16x16x32_bf16 v[200:203], v[236:239], v[104:107], v[200:203]
    ds_read_b64_tr_b16 v[234:235], v242 offset:20992
    s_waitcnt lgkmcnt(4)
    v_cvt_pk_bf16_f32 v160, v160, v161
    v_mfma_f32_16x16x32_bf16 v[176:179], v[224:227], v[112:115], v[176:179]
    ds_read_b64_tr_b16 v[236:237], v243 offset:20480
    v_cvt_pk_bf16_f32 v161, v162, v163
    v_mfma_f32_16x16x32_bf16 v[180:183], v[224:227], v[116:119], v[180:183]
    ds_read_b64_tr_b16 v[238:239], v243 offset:20992
    s_waitcnt lgkmcnt(4)
    buffer_store_dwordx2 v[160:161], v246, s[12:15], s32 offen offset:0 sc1
    v_mfma_f32_16x16x32_bf16 v[188:191], v[228:231], v[116:119], v[188:191]
    ds_read_b64_tr_b16 v[224:225], v240 offset:24576
    v_mul_f32 v164, s28, v164
    v_mfma_f32_16x16x32_bf16 v[184:187], v[228:231], v[112:115], v[184:187]
    ds_read_b64_tr_b16 v[226:227], v240 offset:25088
    s_waitcnt lgkmcnt(4)
    v_mul_f32 v165, s28, v165
    v_mfma_f32_16x16x32_bf16 v[192:195], v[232:235], v[112:115], v[192:195]
    ds_read_b64_tr_b16 v[228:229], v241 offset:24576
    s_add_u32 m0, s29, 57344
    s_add_u32 s24, s24, s35
    buffer_load_dwordx4 v244, s[16:19], s24 offen lds
    v_mul_f32 v166, s28, v166
    v_mfma_f32_16x16x32_bf16 v[196:199], v[232:235], v[116:119], v[196:199]
    ds_read_b64_tr_b16 v[230:231], v241 offset:25088
    s_waitcnt lgkmcnt(4)
    v_mul_f32 v167, s28, v167
    v_mfma_f32_16x16x32_bf16 v[204:207], v[236:239], v[116:119], v[204:207]
    ds_read_b64_tr_b16 v[232:233], v242 offset:24576
    v_cvt_pk_bf16_f32 v164, v164, v165
    v_mfma_f32_16x16x32_bf16 v[200:203], v[236:239], v[112:115], v[200:203]
    ds_read_b64_tr_b16 v[234:235], v242 offset:25088
    s_waitcnt lgkmcnt(4)
    v_cvt_pk_bf16_f32 v165, v166, v167
    v_mfma_f32_16x16x32_bf16 v[176:179], v[224:227], v[120:123], v[176:179]
    ds_read_b64_tr_b16 v[236:237], v243 offset:24576
    buffer_store_dwordx2 v[164:165], v246, s[12:15], s32 offen offset:256 sc1
    v_mfma_f32_16x16x32_bf16 v[180:183], v[224:227], v[124:127], v[180:183]
    ds_read_b64_tr_b16 v[238:239], v243 offset:25088
    s_waitcnt lgkmcnt(4)
    s_add_u32 s32, s27, 196608
    v_mfma_f32_16x16x32_bf16 v[188:191], v[228:231], v[124:127], v[188:191]
    ds_read_b64_tr_b16 v[224:225], v240 offset:28672
    s_add_u32 m0, s29, 65536
    s_add_u32 s24, s24, s35
    buffer_load_dwordx4 v244, s[16:19], s24 offen lds
    v_mul_f32 v168, s28, v168
    v_mfma_f32_16x16x32_bf16 v[184:187], v[228:231], v[120:123], v[184:187]
    ds_read_b64_tr_b16 v[226:227], v240 offset:29184
    s_waitcnt lgkmcnt(4)
    v_mul_f32 v169, s28, v169
    v_mfma_f32_16x16x32_bf16 v[192:195], v[232:235], v[120:123], v[192:195]
    ds_read_b64_tr_b16 v[228:229], v241 offset:28672
    v_mul_f32 v170, s28, v170
    v_mfma_f32_16x16x32_bf16 v[196:199], v[232:235], v[124:127], v[196:199]
    ds_read_b64_tr_b16 v[230:231], v241 offset:29184
    s_waitcnt lgkmcnt(4)
    v_mul_f32 v171, s28, v171
    v_mfma_f32_16x16x32_bf16 v[204:207], v[236:239], v[124:127], v[204:207]
    ds_read_b64_tr_b16 v[232:233], v242 offset:28672
    v_cvt_pk_bf16_f32 v168, v168, v169
    v_mfma_f32_16x16x32_bf16 v[200:203], v[236:239], v[120:123], v[200:203]
    ds_read_b64_tr_b16 v[234:235], v242 offset:29184
    s_waitcnt lgkmcnt(4)
    v_cvt_pk_bf16_f32 v169, v170, v171
    v_mfma_f32_16x16x32_bf16 v[176:179], v[224:227], v[128:131], v[176:179]
    ds_read_b64_tr_b16 v[236:237], v243 offset:28672
    buffer_store_dwordx2 v[168:169], v246, s[12:15], s32 offen offset:0 sc1
    v_mfma_f32_16x16x32_bf16 v[180:183], v[224:227], v[132:135], v[180:183]
    ds_read_b64_tr_b16 v[238:239], v243 offset:29184
    s_waitcnt lgkmcnt(4)
    v_mul_f32 v172, s28, v172
    v_mfma_f32_16x16x32_bf16 v[188:191], v[228:231], v[132:135], v[188:191]
    ds_read_b64_tr_b16 v[224:225], v240 offset:32768
    v_mul_f32 v173, s28, v173
    v_mfma_f32_16x16x32_bf16 v[184:187], v[228:231], v[128:131], v[184:187]
    ds_read_b64_tr_b16 v[226:227], v240 offset:33280
    s_waitcnt lgkmcnt(4)
    v_add_u32 v240, 0xfffe5000, v240
    v_mul_f32 v174, s28, v174
    v_mfma_f32_16x16x32_bf16 v[192:195], v[232:235], v[128:131], v[192:195]
    ds_read_b64_tr_b16 v[228:229], v241 offset:32768
    v_mul_f32 v175, s28, v175
    v_mfma_f32_16x16x32_bf16 v[196:199], v[232:235], v[132:135], v[196:199]
    ds_read_b64_tr_b16 v[230:231], v241 offset:33280
    s_waitcnt lgkmcnt(4)
    v_add_u32 v241, 0xfffe5000, v241
    v_cvt_pk_bf16_f32 v172, v172, v173
    v_mfma_f32_16x16x32_bf16 v[204:207], v[236:239], v[132:135], v[204:207]
    ds_read_b64_tr_b16 v[232:233], v242 offset:32768
    v_cvt_pk_bf16_f32 v173, v174, v175
    v_mfma_f32_16x16x32_bf16 v[200:203], v[236:239], v[128:131], v[200:203]
    ds_read_b64_tr_b16 v[234:235], v242 offset:33280
    s_waitcnt lgkmcnt(4)
    v_add_u32 v242, 0xfffe5000, v242
    buffer_store_dwordx2 v[172:173], v246, s[12:15], s32 offen offset:256 sc1
    v_mfma_f32_16x16x32_bf16 v[176:179], v[224:227], v[136:139], v[176:179]
    ds_read_b64_tr_b16 v[236:237], v243 offset:32768
    v_mfma_f32_16x16x32_bf16 v[180:183], v[224:227], v[140:143], v[180:183]
    ds_read_b64_tr_b16 v[238:239], v243 offset:33280
    s_waitcnt lgkmcnt(4)
    v_add_u32 v243, 0xfffe5000, v243
    s_waitcnt vmcnt(2)
    s_barrier
    v_mfma_f32_16x16x32_bf16 v[188:191], v[228:231], v[140:143], v[188:191]
    ds_read_b64_tr_b16 v[224:225], v240 offset:0
    v_mfma_f32_16x16x32_bf16 v[184:187], v[228:231], v[136:139], v[184:187]
    ds_read_b64_tr_b16 v[226:227], v240 offset:512
    s_waitcnt lgkmcnt(4)
    v_mfma_f32_16x16x32_bf16 v[192:195], v[232:235], v[136:139], v[192:195]
    ds_read_b64_tr_b16 v[228:229], v241 offset:0
    v_mfma_f32_16x16x32_bf16 v[196:199], v[232:235], v[140:143], v[196:199]
    ds_read_b64_tr_b16 v[230:231], v241 offset:512
    s_waitcnt lgkmcnt(4)
    v_mfma_f32_16x16x32_bf16 v[204:207], v[236:239], v[140:143], v[204:207]
    ds_read_b64_tr_b16 v[232:233], v242 offset:0
    v_mfma_f32_16x16x32_bf16 v[200:203], v[236:239], v[136:139], v[200:203]
    ds_read_b64_tr_b16 v[234:235], v242 offset:512
    s_waitcnt lgkmcnt(4)
    s_add_u32 s27, s27, 262144
.p2align 3
L1_qk_loop:
    s_add_u32 s25, s25, 144
    s_cbranch_vccnz Lp7
    s_setprio 1
Lp7:
    v_mfma_f32_16x16x32_bf16 v[144:147], v[224:227], v[0:3], 0
    ds_read_b64_tr_b16 v[236:237], v243 offset:0
    v_mfma_f32_16x16x32_bf16 v[148:151], v[224:227], v[4:7], 0
    ds_read_b64_tr_b16 v[238:239], v243 offset:512
    s_waitcnt lgkmcnt(4)
    v_mfma_f32_16x16x32_bf16 v[156:159], v[228:231], v[4:7], 0
    ds_read_b64_tr_b16 v[224:225], v240 offset:4096
    s_add_u32 m0, s29, 73728
    s_mov_b32 s24, s25
    buffer_load_dwordx4 v244, s[20:23], s24 offen lds
    v_mfma_f32_16x16x32_bf16 v[152:155], v[228:231], v[0:3], 0
    ds_read_b64_tr_b16 v[226:227], v240 offset:4608
    s_waitcnt lgkmcnt(4)
    v_mfma_f32_16x16x32_bf16 v[160:163], v[232:235], v[0:3], 0
    ds_read_b64_tr_b16 v[228:229], v241 offset:4096
    s_add_u32 s32, s27, 0
    v_mfma_f32_16x16x32_bf16 v[164:167], v[232:235], v[4:7], 0
    ds_read_b64_tr_b16 v[230:231], v241 offset:4608
    s_waitcnt lgkmcnt(4)
    v_mfma_f32_16x16x32_bf16 v[172:175], v[236:239], v[4:7], 0
    ds_read_b64_tr_b16 v[232:233], v242 offset:4096
    v_mul_f32 v176, s28, v176
    v_mfma_f32_16x16x32_bf16 v[168:171], v[236:239], v[0:3], 0
    ds_read_b64_tr_b16 v[234:235], v242 offset:4608
    s_waitcnt lgkmcnt(4)
    v_mfma_f32_16x16x32_bf16 v[144:147], v[224:227], v[8:11], v[144:147]
    ds_read_b64_tr_b16 v[236:237], v243 offset:4096
    v_mul_f32 v177, s28, v177
    v_mfma_f32_16x16x32_bf16 v[148:151], v[224:227], v[12:15], v[148:151]
    ds_read_b64_tr_b16 v[238:239], v243 offset:4608
    s_waitcnt lgkmcnt(4)
    v_mfma_f32_16x16x32_bf16 v[156:159], v[228:231], v[12:15], v[156:159]
    ds_read_b64_tr_b16 v[224:225], v240 offset:8192
    v_mul_f32 v178, s28, v178
    v_mfma_f32_16x16x32_bf16 v[152:155], v[228:231], v[8:11], v[152:155]
    ds_read_b64_tr_b16 v[226:227], v240 offset:8704
    s_waitcnt lgkmcnt(4)
    v_mfma_f32_16x16x32_bf16 v[160:163], v[232:235], v[8:11], v[160:163]
    ds_read_b64_tr_b16 v[228:229], v241 offset:8192
    s_add_u32 m0, s29, 81920
    s_add_u32 s24, s24, s35
    buffer_load_dwordx4 v244, s[20:23], s24 offen lds
    v_mul_f32 v179, s28, v179
    v_mfma_f32_16x16x32_bf16 v[164:167], v[232:235], v[12:15], v[164:167]
    ds_read_b64_tr_b16 v[230:231], v241 offset:8704
    s_waitcnt lgkmcnt(4)
    v_mfma_f32_16x16x32_bf16 v[172:175], v[236:239], v[12:15], v[172:175]
    ds_read_b64_tr_b16 v[232:233], v242 offset:8192
    v_mfma_f32_16x16x32_bf16 v[168:171], v[236:239], v[8:11], v[168:171]
    ds_read_b64_tr_b16 v[234:235], v242 offset:8704
    s_waitcnt lgkmcnt(4)
    v_cvt_pk_bf16_f32 v176, v176, v177
    v_mfma_f32_16x16x32_bf16 v[144:147], v[224:227], v[16:19], v[144:147]
    ds_read_b64_tr_b16 v[236:237], v243 offset:8192
    v_mfma_f32_16x16x32_bf16 v[148:151], v[224:227], v[20:23], v[148:151]
    ds_read_b64_tr_b16 v[238:239], v243 offset:8704
    s_waitcnt lgkmcnt(4)
    v_cvt_pk_bf16_f32 v177, v178, v179
    v_mfma_f32_16x16x32_bf16 v[156:159], v[228:231], v[20:23], v[156:159]
    ds_read_b64_tr_b16 v[224:225], v240 offset:12288
    v_mfma_f32_16x16x32_bf16 v[152:155], v[228:231], v[16:19], v[152:155]
    ds_read_b64_tr_b16 v[226:227], v240 offset:12800
    s_waitcnt lgkmcnt(4)
    buffer_store_dwordx2 v[176:177], v246, s[12:15], s32 offen offset:0 sc1
    v_mfma_f32_16x16x32_bf16 v[160:163], v[232:235], v[16:19], v[160:163]
    ds_read_b64_tr_b16 v[228:229], v241 offset:12288
    v_mfma_f32_16x16x32_bf16 v[164:167], v[232:235], v[20:23], v[164:167]
    ds_read_b64_tr_b16 v[230:231], v241 offset:12800
    s_waitcnt lgkmcnt(4)
    v_mul_f32 v180, s28, v180
    v_mfma_f32_16x16x32_bf16 v[172:175], v[236:239], v[20:23], v[172:175]
    ds_read_b64_tr_b16 v[232:233], v242 offset:12288
    s_add_u32 m0, s29, 90112
    s_add_u32 s24, s24, s35
    buffer_load_dwordx4 v244, s[20:23], s24 offen lds
    v_mfma_f32_16x16x32_bf16 v[168:171], v[236:239], v[16:19], v[168:171]
    ds_read_b64_tr_b16 v[234:235], v242 offset:12800
    s_waitcnt lgkmcnt(4)
    v_mul_f32 v181, s28, v181
    v_mfma_f32_16x16x32_bf16 v[144:147], v[224:227], v[24:27], v[144:147]
    ds_read_b64_tr_b16 v[236:237], v243 offset:12288
    v_mfma_f32_16x16x32_bf16 v[148:151], v[224:227], v[28:31], v[148:151]
    ds_read_b64_tr_b16 v[238:239], v243 offset:12800
    s_waitcnt lgkmcnt(4)
    v_mfma_f32_16x16x32_bf16 v[156:159], v[228:231], v[28:31], v[156:159]
    ds_read_b64_tr_b16 v[224:225], v240 offset:16384
    v_mul_f32 v182, s28, v182
    v_mfma_f32_16x16x32_bf16 v[152:155], v[228:231], v[24:27], v[152:155]
    ds_read_b64_tr_b16 v[226:227], v240 offset:16896
    s_waitcnt lgkmcnt(4)
    v_mfma_f32_16x16x32_bf16 v[160:163], v[232:235], v[24:27], v[160:163]
    ds_read_b64_tr_b16 v[228:229], v241 offset:16384
    v_mul_f32 v183, s28, v183
    v_mfma_f32_16x16x32_bf16 v[164:167], v[232:235], v[28:31], v[164:167]
    ds_read_b64_tr_b16 v[230:231], v241 offset:16896
    s_waitcnt lgkmcnt(4)
    v_mfma_f32_16x16x32_bf16 v[172:175], v[236:239], v[28:31], v[172:175]
    ds_read_b64_tr_b16 v[232:233], v242 offset:16384
    v_cvt_pk_bf16_f32 v180, v180, v181
    v_mfma_f32_16x16x32_bf16 v[168:171], v[236:239], v[24:27], v[168:171]
    ds_read_b64_tr_b16 v[234:235], v242 offset:16896
    s_waitcnt lgkmcnt(4)
    v_mfma_f32_16x16x32_bf16 v[144:147], v[224:227], v[32:35], v[144:147]
    ds_read_b64_tr_b16 v[236:237], v243 offset:16384
    s_add_u32 m0, s29, 98304
    s_add_u32 s24, s24, s35
    buffer_load_dwordx4 v244, s[20:23], s24 offen lds
    v_cvt_pk_bf16_f32 v181, v182, v183
    v_mfma_f32_16x16x32_bf16 v[148:151], v[224:227], v[36:39], v[148:151]
    ds_read_b64_tr_b16 v[238:239], v243 offset:16896
    s_waitcnt lgkmcnt(4)
    v_mfma_f32_16x16x32_bf16 v[156:159], v[228:231], v[36:39], v[156:159]
    ds_read_b64_tr_b16 v[224:225], v240 offset:20480
    buffer_store_dwordx2 v[180:181], v246, s[12:15], s32 offen offset:256 sc1
    v_mfma_f32_16x16x32_bf16 v[152:155], v[228:231], v[32:35], v[152:155]
    ds_read_b64_tr_b16 v[226:227], v240 offset:20992
    s_waitcnt lgkmcnt(4)
    v_mfma_f32_16x16x32_bf16 v[160:163], v[232:235], v[32:35], v[160:163]
    ds_read_b64_tr_b16 v[228:229], v241 offset:20480
    v_mfma_f32_16x16x32_bf16 v[164:167], v[232:235], v[36:39], v[164:167]
    ds_read_b64_tr_b16 v[230:231], v241 offset:20992
    s_waitcnt lgkmcnt(4)
    s_add_u32 s32, s27, 65536
    v_mfma_f32_16x16x32_bf16 v[172:175], v[236:239], v[36:39], v[172:175]
    ds_read_b64_tr_b16 v[232:233], v242 offset:20480
    v_mfma_f32_16x16x32_bf16 v[168:171], v[236:239], v[32:35], v[168:171]
    ds_read_b64_tr_b16 v[234:235], v242 offset:20992
    s_waitcnt lgkmcnt(4)
    v_mul_f32 v184, s28, v184
    v_mfma_f32_16x16x32_bf16 v[144:147], v[224:227], v[40:43], v[144:147]
    ds_read_b64_tr_b16 v[236:237], v243 offset:20480
    v_mfma_f32_16x16x32_bf16 v[148:151], v[224:227], v[44:47], v[148:151]
    ds_read_b64_tr_b16 v[238:239], v243 offset:20992
    s_waitcnt lgkmcnt(4)
    v_mul_f32 v185, s28, v185
    v_mfma_f32_16x16x32_bf16 v[156:159], v[228:231], v[44:47], v[156:159]
    ds_read_b64_tr_b16 v[224:225], v240 offset:24576
    s_add_u32 m0, s29, 106496
    s_add_u32 s24, s24, s35
    buffer_load_dwordx4 v244, s[20:23], s24 offen lds
    v_mfma_f32_16x16x32_bf16 v[152:155], v[228:231], v[40:43], v[152:155]
    ds_read_b64_tr_b16 v[226:227], v240 offset:25088
    s_waitcnt lgkmcnt(4)
    v_mul_f32 v186, s28, v186
    v_mfma_f32_16x16x32_bf16 v[160:163], v[232:235], v[40:43], v[160:163]
    ds_read_b64_tr_b16 v[228:229], v241 offset:24576
    v_mfma_f32_16x16x32_bf16 v[164:167], v[232:235], v[44:47], v[164:167]
    ds_read_b64_tr_b16 v[230:231], v241 offset:25088
    s_waitcnt lgkmcnt(4)
    v_mul_f32 v187, s28, v187
    v_mfma_f32_16x16x32_bf16 v[172:175], v[236:239], v[44:47], v[172:175]
    ds_read_b64_tr_b16 v[232:233], v242 offset:24576
    v_mfma_f32_16x16x32_bf16 v[168:171], v[236:239], v[40:43], v[168:171]
    ds_read_b64_tr_b16 v[234:235], v242 offset:25088
    s_waitcnt lgkmcnt(4)
    v_mfma_f32_16x16x32_bf16 v[144:147], v[224:227], v[48:51], v[144:147]
    ds_read_b64_tr_b16 v[236:237], v243 offset:24576
    v_cvt_pk_bf16_f32 v184, v184, v185
    v_mfma_f32_16x16x32_bf16 v[148:151], v[224:227], v[52:55], v[148:151]
    ds_read_b64_tr_b16 v[238:239], v243 offset:25088
    s_waitcnt lgkmcnt(4)
    v_mfma_f32_16x16x32_bf16 v[156:159], v[228:231], v[52:55], v[156:159]
    ds_read_b64_tr_b16 v[224:225], v240 offset:28672
    v_cvt_pk_bf16_f32 v185, v186, v187
    v_mfma_f32_16x16x32_bf16 v[152:155], v[228:231], v[48:51], v[152:155]
    ds_read_b64_tr_b16 v[226:227], v240 offset:29184
    s_waitcnt lgkmcnt(4)
    v_mfma_f32_16x16x32_bf16 v[160:163], v[232:235], v[48:51], v[160:163]
    ds_read_b64_tr_b16 v[228:229], v241 offset:28672
    s_add_u32 m0, s29, 114688
    s_add_u32 s24, s24, s35
    buffer_load_dwordx4 v244, s[20:23], s24 offen lds
    buffer_store_dwordx2 v[184:185], v246, s[12:15], s32 offen offset:0 sc1
    v_mfma_f32_16x16x32_bf16 v[164:167], v[232:235], v[52:55], v[164:167]
    ds_read_b64_tr_b16 v[230:231], v241 offset:29184
    s_waitcnt lgkmcnt(4)
    v_mfma_f32_16x16x32_bf16 v[172:175], v[236:239], v[52:55], v[172:175]
    ds_read_b64_tr_b16 v[232:233], v242 offset:28672
    v_mul_f32 v188, s28, v188
    v_mfma_f32_16x16x32_bf16 v[168:171], v[236:239], v[48:51], v[168:171]
    ds_read_b64_tr_b16 v[234:235], v242 offset:29184
    s_waitcnt lgkmcnt(4)
    v_mfma_f32_16x16x32_bf16 v[144:147], v[224:227], v[56:59], v[144:147]
    ds_read_b64_tr_b16 v[236:237], v243 offset:28672
    v_mul_f32 v189, s28, v189
    v_mfma_f32_16x16x32_bf16 v[148:151], v[224:227], v[60:63], v[148:151]
    ds_read_b64_tr_b16 v[238:239], v243 offset:29184
    s_waitcnt lgkmcnt(4)
    v_mfma_f32_16x16x32_bf16 v[156:159], v[228:231], v[60:63], v[156:159]
    ds_read_b64_tr_b16 v[224:225], v240 offset:32768
    v_mfma_f32_16x16x32_bf16 v[152:155], v[228:231], v[56:59], v[152:155]
    ds_read_b64_tr_b16 v[226:227], v240 offset:33280
    s_waitcnt lgkmcnt(4)
    v_add_u32 v240, 0x9000, v240
    v_mul_f32 v190, s28, v190
    v_mfma_f32_16x16x32_bf16 v[160:163], v[232:235], v[56:59], v[160:163]
    ds_read_b64_tr_b16 v[228:229], v241 offset:32768
    v_mfma_f32_16x16x32_bf16 v[164:167], v[232:235], v[60:63], v[164:167]
    ds_read_b64_tr_b16 v[230:231], v241 offset:33280
    s_waitcnt lgkmcnt(4)
    v_add_u32 v241, 0x9000, v241
    v_mul_f32 v191, s28, v191
    v_mfma_f32_16x16x32_bf16 v[172:175], v[236:239], v[60:63], v[172:175]
    ds_read_b64_tr_b16 v[232:233], v242 offset:32768
    s_add_u32 m0, s29, 122880
    s_add_u32 s24, s24, s35
    buffer_load_dwordx4 v244, s[20:23], s24 offen lds
    v_mfma_f32_16x16x32_bf16 v[168:171], v[236:239], v[56:59], v[168:171]
    ds_read_b64_tr_b16 v[234:235], v242 offset:33280
    s_waitcnt lgkmcnt(4)
    v_add_u32 v242, 0x9000, v242
    v_cvt_pk_bf16_f32 v188, v188, v189
    v_mfma_f32_16x16x32_bf16 v[144:147], v[224:227], v[64:67], v[144:147]
    ds_read_b64_tr_b16 v[236:237], v243 offset:32768
    v_mfma_f32_16x16x32_bf16 v[148:151], v[224:227], v[68:71], v[148:151]
    ds_read_b64_tr_b16 v[238:239], v243 offset:33280
    s_waitcnt lgkmcnt(4)
    v_add_u32 v243, 0x9000, v243
    v_cvt_pk_bf16_f32 v189, v190, v191
    v_mfma_f32_16x16x32_bf16 v[156:159], v[228:231], v[68:71], v[156:159]
    ds_read_b64_tr_b16 v[224:225], v240 offset:0
    v_mfma_f32_16x16x32_bf16 v[152:155], v[228:231], v[64:67], v[152:155]
    ds_read_b64_tr_b16 v[226:227], v240 offset:512
    s_waitcnt lgkmcnt(4)
    buffer_store_dwordx2 v[188:189], v246, s[12:15], s32 offen offset:256 sc1
    v_mfma_f32_16x16x32_bf16 v[160:163], v[232:235], v[64:67], v[160:163]
    ds_read_b64_tr_b16 v[228:229], v241 offset:0
    v_mfma_f32_16x16x32_bf16 v[164:167], v[232:235], v[68:71], v[164:167]
    ds_read_b64_tr_b16 v[230:231], v241 offset:512
    s_waitcnt lgkmcnt(4)
    v_mfma_f32_16x16x32_bf16 v[172:175], v[236:239], v[68:71], v[172:175]
    ds_read_b64_tr_b16 v[232:233], v242 offset:0
    s_add_u32 s32, s27, 131072
    v_mfma_f32_16x16x32_bf16 v[168:171], v[236:239], v[64:67], v[168:171]
    ds_read_b64_tr_b16 v[234:235], v242 offset:512
    s_waitcnt lgkmcnt(4)
    v_mfma_f32_16x16x32_bf16 v[144:147], v[224:227], v[72:75], v[144:147]
    ds_read_b64_tr_b16 v[236:237], v243 offset:0
    s_add_u32 m0, s29, 131072
    s_add_u32 s24, s24, s35
    buffer_load_dwordx4 v244, s[20:23], s24 offen lds
    v_mul_f32 v192, s28, v192
    v_mfma_f32_16x16x32_bf16 v[148:151], v[224:227], v[76:79], v[148:151]
    ds_read_b64_tr_b16 v[238:239], v243 offset:512
    s_waitcnt lgkmcnt(4)
    v_mfma_f32_16x16x32_bf16 v[156:159], v[228:231], v[76:79], v[156:159]
    ds_read_b64_tr_b16 v[224:225], v240 offset:4096
    v_mul_f32 v193, s28, v193
    v_mfma_f32_16x16x32_bf16 v[152:155], v[228:231], v[72:75], v[152:155]
    ds_read_b64_tr_b16 v[226:227], v240 offset:4608
    s_waitcnt lgkmcnt(4)
    v_mfma_f32_16x16x32_bf16 v[160:163], v[232:235], v[72:75], v[160:163]
    ds_read_b64_tr_b16 v[228:229], v241 offset:4096
    v_mul_f32 v194, s28, v194
    v_mfma_f32_16x16x32_bf16 v[164:167], v[232:235], v[76:79], v[164:167]
    ds_read_b64_tr_b16 v[230:231], v241 offset:4608
    s_waitcnt lgkmcnt(4)
    v_mfma_f32_16x16x32_bf16 v[172:175], v[236:239], v[76:79], v[172:175]
    ds_read_b64_tr_b16 v[232:233], v242 offset:4096
    v_mul_f32 v195, s28, v195
    v_mfma_f32_16x16x32_bf16 v[168:171], v[236:239], v[72:75], v[168:171]
    ds_read_b64_tr_b16 v[234:235], v242 offset:4608
    s_waitcnt lgkmcnt(4)
    v_mfma_f32_16x16x32_bf16 v[144:147], v[224:227], v[80:83], v[144:147]
    ds_read_b64_tr_b16 v[236:237], v243 offset:4096
    v_mfma_f32_16x16x32_bf16 v[148:151], v[224:227], v[84:87], v[148:151]
    ds_read_b64_tr_b16 v[238:239], v243 offset:4608
    s_waitcnt lgkmcnt(4)
    v_cvt_pk_bf16_f32 v192, v192, v193
    v_mfma_f32_16x16x32_bf16 v[156:159], v[228:231], v[84:87], v[156:159]
    ds_read_b64_tr_b16 v[224:225], v240 offset:8192
    s_add_u32 m0, s29, 139264
    s_add_u32 s24, s24, s35
    buffer_load_dwordx4 v244, s[20:23], s24 offen lds
    v_mfma_f32_16x16x32_bf16 v[152:155], v[228:231], v[80:83], v[152:155]
    ds_read_b64_tr_b16 v[226:227], v240 offset:8704
    s_waitcnt lgkmcnt(4)
    v_cvt_pk_bf16_f32 v193, v194, v195
    v_mfma_f32_16x16x32_bf16 v[160:163], v[232:235], v[80:83], v[160:163]
    ds_read_b64_tr_b16 v[228:229], v241 offset:8192
    v_mfma_f32_16x16x32_bf16 v[164:167], v[232:235], v[84:87], v[164:167]
    ds_read_b64_tr_b16 v[230:231], v241 offset:8704
    s_waitcnt lgkmcnt(4)
    buffer_store_dwordx2 v[192:193], v246, s[12:15], s32 offen offset:0 sc1
    v_mfma_f32_16x16x32_bf16 v[172:175], v[236:239], v[84:87], v[172:175]
    ds_read_b64_tr_b16 v[232:233], v242 offset:8192
    v_mfma_f32_16x16x32_bf16 v[168:171], v[236:239], v[80:83], v[168:171]
    ds_read_b64_tr_b16 v[234:235], v242 offset:8704
    s_waitcnt lgkmcnt(4)
    v_mul_f32 v196, s28, v196
    v_mfma_f32_16x16x32_bf16 v[144:147], v[224:227], v[88:91], v[144:147]
    ds_read_b64_tr_b16 v[236:237], v243 offset:8192
    v_mfma_f32_16x16x32_bf16 v[148:151], v[224:227], v[92:95], v[148:151]
    ds_read_b64_tr_b16 v[238:239], v243 offset:8704
    s_waitcnt lgkmcnt(4)
    v_mul_f32 v197, s28, v197
    v_mfma_f32_16x16x32_bf16 v[156:159], v[228:231], v[92:95], v[156:159]
    ds_read_b64_tr_b16 v[224:225], v240 offset:12288
    v_mfma_f32_16x16x32_bf16 v[152:155], v[228:231], v[88:91], v[152:155]
    ds_read_b64_tr_b16 v[226:227], v240 offset:12800
    s_waitcnt lgkmcnt(4)
    v_mfma_f32_16x16x32_bf16 v[160:163], v[232:235], v[88:91], v[160:163]
    ds_read_b64_tr_b16 v[228:229], v241 offset:12288
    v_mul_f32 v198, s28, v198
    v_mfma_f32_16x16x32_bf16 v[164:167], v[232:235], v[92:95], v[164:167]
    ds_read_b64_tr_b16 v[230:231], v241 offset:12800
    s_waitcnt lgkmcnt(4)
    v_mfma_f32_16x16x32_bf16 v[172:175], v[236:239], v[92:95], v[172:175]
    ds_read_b64_tr_b16 v[232:233], v242 offset:12288
    v_mul_f32 v199, s28, v199
    v_mfma_f32_16x16x32_bf16 v[168:171], v[236:239], v[88:91], v[168:171]
    ds_read_b64_tr_b16 v[234:235], v242 offset:12800
    s_waitcnt lgkmcnt(4)
    v_mfma_f32_16x16x32_bf16 v[144:147], v[224:227], v[96:99], v[144:147]
    ds_read_b64_tr_b16 v[236:237], v243 offset:12288
    v_cvt_pk_bf16_f32 v196, v196, v197
    v_mfma_f32_16x16x32_bf16 v[148:151], v[224:227], v[100:103], v[148:151]
    ds_read_b64_tr_b16 v[238:239], v243 offset:12800
    s_waitcnt lgkmcnt(4)
    v_mfma_f32_16x16x32_bf16 v[156:159], v[228:231], v[100:103], v[156:159]
    ds_read_b64_tr_b16 v[224:225], v240 offset:16384
    v_cvt_pk_bf16_f32 v197, v198, v199
    v_mfma_f32_16x16x32_bf16 v[152:155], v[228:231], v[96:99], v[152:155]
    ds_read_b64_tr_b16 v[226:227], v240 offset:16896
    s_waitcnt lgkmcnt(4)
    v_mfma_f32_16x16x32_bf16 v[160:163], v[232:235], v[96:99], v[160:163]
    ds_read_b64_tr_b16 v[228:229], v241 offset:16384
    buffer_store_dwordx2 v[196:197], v246, s[12:15], s32 offen offset:256 sc1
    v_mfma_f32_16x16x32_bf16 v[164:167], v[232:235], v[100:103], v[164:167]
    ds_read_b64_tr_b16 v[230:231], v241 offset:16896
    s_waitcnt lgkmcnt(4)
    v_mfma_f32_16x16x32_bf16 v[172:175], v[236:239], v[100:103], v[172:175]
    ds_read_b64_tr_b16 v[232:233], v242 offset:16384
    v_mfma_f32_16x16x32_bf16 v[168:171], v[236:239], v[96:99], v[168:171]
    ds_read_b64_tr_b16 v[234:235], v242 offset:16896
    s_waitcnt lgkmcnt(4)
    s_add_u32 s32, s27, 196608
    s_setprio 0
    v_mfma_f32_16x16x32_bf16 v[144:147], v[224:227], v[104:107], v[144:147]
    ds_read_b64_tr_b16 v[236:237], v243 offset:16384
    v_mfma_f32_16x16x32_bf16 v[148:151], v[224:227], v[108:111], v[148:151]
    ds_read_b64_tr_b16 v[238:239], v243 offset:16896
    s_waitcnt lgkmcnt(4)
    v_mul_f32 v200, s28, v200
    v_mfma_f32_16x16x32_bf16 v[156:159], v[228:231], v[108:111], v[156:159]
    ds_read_b64_tr_b16 v[224:225], v240 offset:20480
    v_mfma_f32_16x16x32_bf16 v[152:155], v[228:231], v[104:107], v[152:155]
    ds_read_b64_tr_b16 v[226:227], v240 offset:20992
    s_waitcnt lgkmcnt(4)
    v_mul_f32 v201, s28, v201
    v_mfma_f32_16x16x32_bf16 v[160:163], v[232:235], v[104:107], v[160:163]
    ds_read_b64_tr_b16 v[228:229], v241 offset:20480
    v_mfma_f32_16x16x32_bf16 v[164:167], v[232:235], v[108:111], v[164:167]
    ds_read_b64_tr_b16 v[230:231], v241 offset:20992
    s_waitcnt lgkmcnt(4)
    v_mul_f32 v202, s28, v202
    v_mfma_f32_16x16x32_bf16 v[172:175], v[236:239], v[108:111], v[172:175]
    ds_read_b64_tr_b16 v[232:233], v242 offset:20480
    v_mfma_f32_16x16x32_bf16 v[168:171], v[236:239], v[104:107], v[168:171]
    ds_read_b64_tr_b16 v[234:235], v242 offset:20992
    s_waitcnt lgkmcnt(4)
    v_mul_f32 v203, s28, v203
    v_mfma_f32_16x16x32_bf16 v[144:147], v[224:227], v[112:115], v[144:147]
    ds_read_b64_tr_b16 v[236:237], v243 offset:20480
    v_mfma_f32_16x16x32_bf16 v[148:151], v[224:227], v[116:119], v[148:151]
    ds_read_b64_tr_b16 v[238:239], v243 offset:20992
    s_waitcnt lgkmcnt(4)
    v_mfma_f32_16x16x32_bf16 v[156:159], v[228:231], v[116:119], v[156:159]
    ds_read_b64_tr_b16 v[224:225], v240 offset:24576
    v_cvt_pk_bf16_f32 v200, v200, v201
    v_mfma_f32_16x16x32_bf16 v[152:155], v[228:231], v[112:115], v[152:155]
    ds_read_b64_tr_b16 v[226:227], v240 offset:25088
    s_waitcnt lgkmcnt(4)
    v_mfma_f32_16x16x32_bf16 v[160:163], v[232:235], v[112:115], v[160:163]
    ds_read_b64_tr_b16 v[228:229], v241 offset:24576
    v_cvt_pk_bf16_f32 v201, v202, v203
    v_mfma_f32_16x16x32_bf16 v[164:167], v[232:235], v[116:119], v[164:167]
    ds_read_b64_tr_b16 v[230:231], v241 offset:25088
    s_waitcnt lgkmcnt(4)
    v_mfma_f32_16x16x32_bf16 v[172:175], v[236:239], v[116:119], v[172:175]
    ds_read_b64_tr_b16 v[232:233], v242 offset:24576
    buffer_store_dwordx2 v[200:201], v246, s[12:15], s32 offen offset:0 sc1
    v_mfma_f32_16x16x32_bf16 v[168:171], v[236:239], v[112:115], v[168:171]
    ds_read_b64_tr_b16 v[234:235], v242 offset:25088
    s_waitcnt lgkmcnt(4)
    v_mfma_f32_16x16x32_bf16 v[144:147], v[224:227], v[120:123], v[144:147]
    ds_read_b64_tr_b16 v[236:237], v243 offset:24576
    v_mul_f32 v204, s28, v204
    v_mfma_f32_16x16x32_bf16 v[148:151], v[224:227], v[124:127], v[148:151]
    ds_read_b64_tr_b16 v[238:239], v243 offset:25088
    s_waitcnt lgkmcnt(4)
    v_mfma_f32_16x16x32_bf16 v[156:159], v[228:231], v[124:127], v[156:159]
    ds_read_b64_tr_b16 v[224:225], v240 offset:28672
    v_mul_f32 v205, s28, v205
    v_mfma_f32_16x16x32_bf16 v[152:155], v[228:231], v[120:123], v[152:155]
    ds_read_b64_tr_b16 v[226:227], v240 offset:29184
    s_waitcnt lgkmcnt(4)
    v_mfma_f32_16x16x32_bf16 v[160:163], v[232:235], v[120:123], v[160:163]
    ds_read_b64_tr_b16 v[228:229], v241 offset:28672
    v_mfma_f32_16x16x32_bf16 v[164:167], v[232:235], v[124:127], v[164:167]
    ds_read_b64_tr_b16 v[230:231], v241 offset:29184
    s_waitcnt lgkmcnt(4)
    v_mul_f32 v206, s28, v206
    v_mfma_f32_16x16x32_bf16 v[172:175], v[236:239], v[124:127], v[172:175]
    ds_read_b64_tr_b16 v[232:233], v242 offset:28672
    v_mfma_f32_16x16x32_bf16 v[168:171], v[236:239], v[120:123], v[168:171]
    ds_read_b64_tr_b16 v[234:235], v242 offset:29184
    s_waitcnt lgkmcnt(4)
    v_mul_f32 v207, s28, v207
    v_mfma_f32_16x16x32_bf16 v[144:147], v[224:227], v[128:131], v[144:147]
    ds_read_b64_tr_b16 v[236:237], v243 offset:28672
    v_mfma_f32_16x16x32_bf16 v[148:151], v[224:227], v[132:135], v[148:151]
    ds_read_b64_tr_b16 v[238:239], v243 offset:29184
    s_waitcnt lgkmcnt(4)
    v_cvt_pk_bf16_f32 v204, v204, v205
    v_mfma_f32_16x16x32_bf16 v[156:159], v[228:231], v[132:135], v[156:159]
    ds_read_b64_tr_b16 v[224:225], v240 offset:32768
    v_mfma_f32_16x16x32_bf16 v[152:155], v[228:231], v[128:131], v[152:155]
    ds_read_b64_tr_b16 v[226:227], v240 offset:33280
    s_waitcnt lgkmcnt(4)
    v_add_u32 v240, 0x9000, v240
    v_cvt_pk_bf16_f32 v205, v206, v207
    v_mfma_f32_16x16x32_bf16 v[160:163], v[232:235], v[128:131], v[160:163]
    ds_read_b64_tr_b16 v[228:229], v241 offset:32768
    v_mfma_f32_16x16x32_bf16 v[164:167], v[232:235], v[132:135], v[164:167]
    ds_read_b64_tr_b16 v[230:231], v241 offset:33280
    s_waitcnt lgkmcnt(4)
    v_add_u32 v241, 0x9000, v241
    buffer_store_dwordx2 v[204:205], v246, s[12:15], s32 offen offset:256 sc1
    v_mfma_f32_16x16x32_bf16 v[172:175], v[236:239], v[132:135], v[172:175]
    ds_read_b64_tr_b16 v[232:233], v242 offset:32768
    v_mfma_f32_16x16x32_bf16 v[168:171], v[236:239], v[128:131], v[168:171]
    ds_read_b64_tr_b16 v[234:235], v242 offset:33280
    s_waitcnt lgkmcnt(4)
    v_add_u32 v242, 0x9000, v242
    v_mfma_f32_16x16x32_bf16 v[144:147], v[224:227], v[136:139], v[144:147]
    ds_read_b64_tr_b16 v[236:237], v243 offset:32768
    v_mfma_f32_16x16x32_bf16 v[148:151], v[224:227], v[140:143], v[148:151]
    ds_read_b64_tr_b16 v[238:239], v243 offset:33280
    s_waitcnt lgkmcnt(4)
    v_add_u32 v243, 0x9000, v243
    s_waitcnt vmcnt(4)
    s_barrier
    v_mfma_f32_16x16x32_bf16 v[156:159], v[228:231], v[140:143], v[156:159]
    ds_read_b64_tr_b16 v[224:225], v240 offset:0
    v_mfma_f32_16x16x32_bf16 v[152:155], v[228:231], v[136:139], v[152:155]
    ds_read_b64_tr_b16 v[226:227], v240 offset:512
    s_waitcnt lgkmcnt(4)
    v_mfma_f32_16x16x32_bf16 v[160:163], v[232:235], v[136:139], v[160:163]
    ds_read_b64_tr_b16 v[228:229], v241 offset:0
    v_mfma_f32_16x16x32_bf16 v[164:167], v[232:235], v[140:143], v[164:167]
    ds_read_b64_tr_b16 v[230:231], v241 offset:512
    s_waitcnt lgkmcnt(4)
    v_mfma_f32_16x16x32_bf16 v[172:175], v[236:239], v[140:143], v[172:175]
    ds_read_b64_tr_b16 v[232:233], v242 offset:0
    v_mfma_f32_16x16x32_bf16 v[168:171], v[236:239], v[136:139], v[168:171]
    ds_read_b64_tr_b16 v[234:235], v242 offset:512
    s_waitcnt lgkmcnt(4)
    s_add_u32 s27, s27, 262144
    s_add_u32 s25, s25, 144
    s_sub_u32 s26, s26, 1
    s_cmp_eq_u32 s26, 0
    s_cselect_b32 s18, 0, s18
    s_mov_b32 s16, s64
    s_mov_b32 s17, s65
    s_mov_b32 s18, s66
    s_mov_b32 s25, s36
    s_mov_b32 s35, 8192
    v_add_u32 v244, s29, v245
    s_cbranch_vccnz Lp8
    s_setprio 1
Lp8:
    v_mfma_f32_16x16x32_bf16 v[176:179], v[224:227], v[0:3], 0
    ds_read_b64_tr_b16 v[236:237], v243 offset:0
    v_mfma_f32_16x16x32_bf16 v[180:183], v[224:227], v[4:7], 0
    ds_read_b64_tr_b16 v[238:239], v243 offset:512
    s_waitcnt lgkmcnt(4)
    v_mfma_f32_16x16x32_bf16 v[188:191], v[228:231], v[4:7], 0
    ds_read_b64_tr_b16 v[224:225], v240 offset:4096
    s_add_u32 m0, s29, 0
    s_mov_b32 s24, s25
    buffer_load_dwordx4 v244, s[16:19], s24 offen lds
    v_mfma_f32_16x16x32_bf16 v[184:187], v[228:231], v[0:3], 0
    ds_read_b64_tr_b16 v[226:227], v240 offset:4608
    s_waitcnt lgkmcnt(4)
    v_mfma_f32_16x16x32_bf16 v[192:195], v[232:235], v[0:3], 0
    ds_read_b64_tr_b16 v[228:229], v241 offset:4096
    s_add_u32 s32, s27, 0
    v_mfma_f32_16x16x32_bf16 v[196:199], v[232:235], v[4:7], 0
    ds_read_b64_tr_b16 v[230:231], v241 offset:4608
    s_waitcnt lgkmcnt(4)
    v_mfma_f32_16x16x32_bf16 v[204:207], v[236:239], v[4:7], 0
    ds_read_b64_tr_b16 v[232:233], v242 offset:4096
    v_mul_f32 v144, s28, v144
    v_mfma_f32_16x16x32_bf16 v[200:203], v[236:239], v[0:3], 0
    ds_read_b64_tr_b16 v[234:235], v242 offset:4608
    s_waitcnt lgkmcnt(4)
    v_mfma_f32_16x16x32_bf16 v[176:179], v[224:227], v[8:11], v[176:179]
    ds_read_b64_tr_b16 v[236:237], v243 offset:4096
    v_mul_f32 v145, s28, v145
    v_mfma_f32_16x16x32_bf16 v[180:183], v[224:227], v[12:15], v[180:183]
    ds_read_b64_tr_b16 v[238:239], v243 offset:4608
    s_waitcnt lgkmcnt(4)
    v_mfma_f32_16x16x32_bf16 v[188:191], v[228:231], v[12:15], v[188:191]
    ds_read_b64_tr_b16 v[224:225], v240 offset:8192
    v_mul_f32 v146, s28, v146
    v_mfma_f32_16x16x32_bf16 v[184:187], v[228:231], v[8:11], v[184:187]
    ds_read_b64_tr_b16 v[226:227], v240 offset:8704
    s_waitcnt lgkmcnt(4)
    v_mfma_f32_16x16x32_bf16 v[192:195], v[232:235], v[8:11], v[192:195]
    ds_read_b64_tr_b16 v[228:229], v241 offset:8192
    s_add_u32 m0, s29, 8192
    s_add_u32 s24, s24, s35
    buffer_load_dwordx4 v244, s[16:19], s24 offen lds
    v_mul_f32 v147, s28, v147
    v_mfma_f32_16x16x32_bf16 v[196:199], v[232:235], v[12:15], v[196:199]
    ds_read_b64_tr_b16 v[230:231], v241 offset:8704
    s_waitcnt lgkmcnt(4)
    v_mfma_f32_16x16x32_bf16 v[204:207], v[236:239], v[12:15], v[204:207]
    ds_read_b64_tr_b16 v[232:233], v242 offset:8192
    v_mfma_f32_16x16x32_bf16 v[200:203], v[236:239], v[8:11], v[200:203]
    ds_read_b64_tr_b16 v[234:235], v242 offset:8704
    s_waitcnt lgkmcnt(4)
    v_cvt_pk_bf16_f32 v144, v144, v145
    v_mfma_f32_16x16x32_bf16 v[176:179], v[224:227], v[16:19], v[176:179]
    ds_read_b64_tr_b16 v[236:237], v243 offset:8192
    v_mfma_f32_16x16x32_bf16 v[180:183], v[224:227], v[20:23], v[180:183]
    ds_read_b64_tr_b16 v[238:239], v243 offset:8704
    s_waitcnt lgkmcnt(4)
    v_cvt_pk_bf16_f32 v145, v146, v147
    v_mfma_f32_16x16x32_bf16 v[188:191], v[228:231], v[20:23], v[188:191]
    ds_read_b64_tr_b16 v[224:225], v240 offset:12288
    v_mfma_f32_16x16x32_bf16 v[184:187], v[228:231], v[16:19], v[184:187]
    ds_read_b64_tr_b16 v[226:227], v240 offset:12800
    s_waitcnt lgkmcnt(4)
    buffer_store_dwordx2 v[144:145], v246, s[12:15], s32 offen offset:0 sc1
    v_mfma_f32_16x16x32_bf16 v[192:195], v[232:235], v[16:19], v[192:195]
    ds_read_b64_tr_b16 v[228:229], v241 offset:12288
    v_mfma_f32_16x16x32_bf16 v[196:199], v[232:235], v[20:23], v[196:199]
    ds_read_b64_tr_b16 v[230:231], v241 offset:12800
    s_waitcnt lgkmcnt(4)
    v_mul_f32 v148, s28, v148
    v_mfma_f32_16x16x32_bf16 v[204:207], v[236:239], v[20:23], v[204:207]
    ds_read_b64_tr_b16 v[232:233], v242 offset:12288
    s_add_u32 m0, s29, 16384
    s_add_u32 s24, s24, s35
    buffer_load_dwordx4 v244, s[16:19], s24 offen lds
    v_mfma_f32_16x16x32_bf16 v[200:203], v[236:239], v[16:19], v[200:203]
    ds_read_b64_tr_b16 v[234:235], v242 offset:12800
    s_waitcnt lgkmcnt(4)
    v_mul_f32 v149, s28, v149
    v_mfma_f32_16x16x32_bf16 v[176:179], v[224:227], v[24:27], v[176:179]
    ds_read_b64_tr_b16 v[236:237], v243 offset:12288
    v_mfma_f32_16x16x32_bf16 v[180:183], v[224:227], v[28:31], v[180:183]
    ds_read_b64_tr_b16 v[238:239], v243 offset:12800
    s_waitcnt lgkmcnt(4)
    v_mfma_f32_16x16x32_bf16 v[188:191], v[228:231], v[28:31], v[188:191]
    ds_read_b64_tr_b16 v[224:225], v240 offset:16384
    v_mul_f32 v150, s28, v150
    v_mfma_f32_16x16x32_bf16 v[184:187], v[228:231], v[24:27], v[184:187]
    ds_read_b64_tr_b16 v[226:227], v240 offset:16896
    s_waitcnt lgkmcnt(4)
    v_mfma_f32_16x16x32_bf16 v[192:195], v[232:235], v[24:27], v[192:195]
    ds_read_b64_tr_b16 v[228:229], v241 offset:16384
    v_mul_f32 v151, s28, v151
    v_mfma_f32_16x16x32_bf16 v[196:199], v[232:235], v[28:31], v[196:199]
    ds_read_b64_tr_b16 v[230:231], v241 offset:16896
    s_waitcnt lgkmcnt(4)
    v_mfma_f32_16x16x32_bf16 v[204:207], v[236:239], v[28:31], v[204:207]
    ds_read_b64_tr_b16 v[232:233], v242 offset:16384
    v_cvt_pk_bf16_f32 v148, v148, v149
    v_mfma_f32_16x16x32_bf16 v[200:203], v[236:239], v[24:27], v[200:203]
    ds_read_b64_tr_b16 v[234:235], v242 offset:16896
    s_waitcnt lgkmcnt(4)
    v_mfma_f32_16x16x32_bf16 v[176:179], v[224:227], v[32:35], v[176:179]
    ds_read_b64_tr_b16 v[236:237], v243 offset:16384
    s_add_u32 m0, s29, 24576
    s_add_u32 s24, s24, s35
    buffer_load_dwordx4 v244, s[16:19], s24 offen lds
    v_cvt_pk_bf16_f32 v149, v150, v151
    v_mfma_f32_16x16x32_bf16 v[180:183], v[224:227], v[36:39], v[180:183]
    ds_read_b64_tr_b16 v[238:239], v243 offset:16896
    s_waitcnt lgkmcnt(4)
    v_mfma_f32_16x16x32_bf16 v[188:191], v[228:231], v[36:39], v[188:191]
    ds_read_b64_tr_b16 v[224:225], v240 offset:20480
    buffer_store_dwordx2 v[148:149], v246, s[12:15], s32 offen offset:256 sc1
    v_mfma_f32_16x16x32_bf16 v[184:187], v[228:231], v[32:35], v[184:187]
    ds_read_b64_tr_b16 v[226:227], v240 offset:20992
    s_waitcnt lgkmcnt(4)
    v_mfma_f32_16x16x32_bf16 v[192:195], v[232:235], v[32:35], v[192:195]
    ds_read_b64_tr_b16 v[228:229], v241 offset:20480
    v_mfma_f32_16x16x32_bf16 v[196:199], v[232:235], v[36:39], v[196:199]
    ds_read_b64_tr_b16 v[230:231], v241 offset:20992
    s_waitcnt lgkmcnt(4)
    s_add_u32 s32, s27, 65536
    v_mfma_f32_16x16x32_bf16 v[204:207], v[236:239], v[36:39], v[204:207]
    ds_read_b64_tr_b16 v[232:233], v242 offset:20480
    v_mfma_f32_16x16x32_bf16 v[200:203], v[236:239], v[32:35], v[200:203]
    ds_read_b64_tr_b16 v[234:235], v242 offset:20992
    s_waitcnt lgkmcnt(4)
    v_mul_f32 v152, s28, v152
    v_mfma_f32_16x16x32_bf16 v[176:179], v[224:227], v[40:43], v[176:179]
    ds_read_b64_tr_b16 v[236:237], v243 offset:20480
    v_mfma_f32_16x16x32_bf16 v[180:183], v[224:227], v[44:47], v[180:183]
    ds_read_b64_tr_b16 v[238:239], v243 offset:20992
    s_waitcnt lgkmcnt(4)
    v_mul_f32 v153, s28, v153
    v_mfma_f32_16x16x32_bf16 v[188:191], v[228:231], v[44:47], v[188:191]
    ds_read_b64_tr_b16 v[224:225], v240 offset:24576
    s_add_u32 m0, s29, 32768
    s_add_u32 s24, s24, s35
    buffer_load_dwordx4 v244, s[16:19], s24 offen lds
    v_mfma_f32_16x16x32_bf16 v[184:187], v[228:231], v[40:43], v[184:187]
    ds_read_b64_tr_b16 v[226:227], v240 offset:25088
    s_waitcnt lgkmcnt(4)
    v_mul_f32 v154, s28, v154
    v_mfma_f32_16x16x32_bf16 v[192:195], v[232:235], v[40:43], v[192:195]
    ds_read_b64_tr_b16 v[228:229], v241 offset:24576
    v_mfma_f32_16x16x32_bf16 v[196:199], v[232:235], v[44:47], v[196:199]
    ds_read_b64_tr_b16 v[230:231], v241 offset:25088
    s_waitcnt lgkmcnt(4)
    v_mul_f32 v155, s28, v155
    v_mfma_f32_16x16x32_bf16 v[204:207], v[236:239], v[44:47], v[204:207]
    ds_read_b64_tr_b16 v[232:233], v242 offset:24576
    v_mfma_f32_16x16x32_bf16 v[200:203], v[236:239], v[40:43], v[200:203]
    ds_read_b64_tr_b16 v[234:235], v242 offset:25088
    s_waitcnt lgkmcnt(4)
    v_mfma_f32_16x16x32_bf16 v[176:179], v[224:227], v[48:51], v[176:179]
    ds_read_b64_tr_b16 v[236:237], v243 offset:24576
    v_cvt_pk_bf16_f32 v152, v152, v153
    v_mfma_f32_16x16x32_bf16 v[180:183], v[224:227], v[52:55], v[180:183]
    ds_read_b64_tr_b16 v[238:239], v243 offset:25088
    s_waitcnt lgkmcnt(4)
    v_mfma_f32_16x16x32_bf16 v[188:191], v[228:231], v[52:55], v[188:191]
    ds_read_b64_tr_b16 v[224:225], v240 offset:28672
    v_cvt_pk_bf16_f32 v153, v154, v155
    v_mfma_f32_16x16x32_bf16 v[184:187], v[228:231], v[48:51], v[184:187]
    ds_read_b64_tr_b16 v[226:227], v240 offset:29184
    s_waitcnt lgkmcnt(4)
    v_mfma_f32_16x16x32_bf16 v[192:195], v[232:235], v[48:51], v[192:195]
    ds_read_b64_tr_b16 v[228:229], v241 offset:28672
    s_add_u32 m0, s29, 40960
    s_add_u32 s24, s24, s35
    buffer_load_dwordx4 v244, s[16:19], s24 offen lds
    buffer_store_dwordx2 v[152:153], v246, s[12:15], s32 offen offset:0 sc1
    v_mfma_f32_16x16x32_bf16 v[196:199], v[232:235], v[52:55], v[196:199]
    ds_read_b64_tr_b16 v[230:231], v241 offset:29184
    s_waitcnt lgkmcnt(4)
    v_mfma_f32_16x16x32_bf16 v[204:207], v[236:239], v[52:55], v[204:207]
    ds_read_b64_tr_b16 v[232:233], v242 offset:28672
    v_mul_f32 v156, s28, v156
    v_mfma_f32_16x16x32_bf16 v[200:203], v[236:239], v[48:51], v[200:203]
    ds_read_b64_tr_b16 v[234:235], v242 offset:29184
    s_waitcnt lgkmcnt(4)
    v_mfma_f32_16x16x32_bf16 v[176:179], v[224:227], v[56:59], v[176:179]
    ds_read_b64_tr_b16 v[236:237], v243 offset:28672
    v_mul_f32 v157, s28, v157
    v_mfma_f32_16x16x32_bf16 v[180:183], v[224:227], v[60:63], v[180:183]
    ds_read_b64_tr_b16 v[238:239], v243 offset:29184
    s_waitcnt lgkmcnt(4)
    v_mfma_f32_16x16x32_bf16 v[188:191], v[228:231], v[60:63], v[188:191]
    ds_read_b64_tr_b16 v[224:225], v240 offset:32768
    v_mfma_f32_16x16x32_bf16 v[184:187], v[228:231], v[56:59], v[184:187]
    ds_read_b64_tr_b16 v[226:227], v240 offset:33280
    s_waitcnt lgkmcnt(4)
    v_add_u32 v240, 0x9000, v240
    v_mul_f32 v158, s28, v158
    v_mfma_f32_16x16x32_bf16 v[192:195], v[232:235], v[56:59], v[192:195]
    ds_read_b64_tr_b16 v[228:229], v241 offset:32768
    v_mfma_f32_16x16x32_bf16 v[196:199], v[232:235], v[60:63], v[196:199]
    ds_read_b64_tr_b16 v[230:231], v241 offset:33280
    s_waitcnt lgkmcnt(4)
    v_add_u32 v241, 0x9000, v241
    v_mul_f32 v159, s28, v159
    v_mfma_f32_16x16x32_bf16 v[204:207], v[236:239], v[60:63], v[204:207]
    ds_read_b64_tr_b16 v[232:233], v242 offset:32768
    s_add_u32 m0, s29, 49152
    s_add_u32 s24, s24, s35
    buffer_load_dwordx4 v244, s[16:19], s24 offen lds
    v_mfma_f32_16x16x32_bf16 v[200:203], v[236:239], v[56:59], v[200:203]
    ds_read_b64_tr_b16 v[234:235], v242 offset:33280
    s_waitcnt lgkmcnt(4)
    v_add_u32 v242, 0x9000, v242
    v_cvt_pk_bf16_f32 v156, v156, v157
    v_mfma_f32_16x16x32_bf16 v[176:179], v[224:227], v[64:67], v[176:179]
    ds_read_b64_tr_b16 v[236:237], v243 offset:32768
    v_mfma_f32_16x16x32_bf16 v[180:183], v[224:227], v[68:71], v[180:183]
    ds_read_b64_tr_b16 v[238:239], v243 offset:33280
    s_waitcnt lgkmcnt(4)
    v_add_u32 v243, 0x9000, v243
    v_cvt_pk_bf16_f32 v157, v158, v159
    v_mfma_f32_16x16x32_bf16 v[188:191], v[228:231], v[68:71], v[188:191]
    ds_read_b64_tr_b16 v[224:225], v240 offset:0
    v_mfma_f32_16x16x32_bf16 v[184:187], v[228:231], v[64:67], v[184:187]
    ds_read_b64_tr_b16 v[226:227], v240 offset:512
    s_waitcnt lgkmcnt(4)
    buffer_store_dwordx2 v[156:157], v246, s[12:15], s32 offen offset:256 sc1
    v_mfma_f32_16x16x32_bf16 v[192:195], v[232:235], v[64:67], v[192:195]
    ds_read_b64_tr_b16 v[228:229], v241 offset:0
    v_mfma_f32_16x16x32_bf16 v[196:199], v[232:235], v[68:71], v[196:199]
    ds_read_b64_tr_b16 v[230:231], v241 offset:512
    s_waitcnt lgkmcnt(4)
    v_mfma_f32_16x16x32_bf16 v[204:207], v[236:239], v[68:71], v[204:207]
    ds_read_b64_tr_b16 v[232:233], v242 offset:0
    s_add_u32 s32, s27, 131072
    v_mfma_f32_16x16x32_bf16 v[200:203], v[236:239], v[64:67], v[200:203]
    ds_read_b64_tr_b16 v[234:235], v242 offset:512
    s_waitcnt lgkmcnt(4)
    v_mfma_f32_16x16x32_bf16 v[176:179], v[224:227], v[72:75], v[176:179]
    ds_read_b64_tr_b16 v[236:237], v243 offset:0
    s_add_u32 m0, s29, 57344
    s_add_u32 s24, s24, s35
    buffer_load_dwordx4 v244, s[16:19], s24 offen lds
    v_mul_f32 v160, s28, v160
    v_mfma_f32_16x16x32_bf16 v[180:183], v[224:227], v[76:79], v[180:183]
    ds_read_b64_tr_b16 v[238:239], v243 offset:512
    s_waitcnt lgkmcnt(4)
    v_mfma_f32_16x16x32_bf16 v[188:191], v[228:231], v[76:79], v[188:191]
    ds_read_b64_tr_b16 v[224:225], v240 offset:4096
    v_mul_f32 v161, s28, v161
    v_mfma_f32_16x16x32_bf16 v[184:187], v[228:231], v[72:75], v[184:187]
    ds_read_b64_tr_b16 v[226:227], v240 offset:4608
    s_waitcnt lgkmcnt(4)
    v_mfma_f32_16x16x32_bf16 v[192:195], v[232:235], v[72:75], v[192:195]
    ds_read_b64_tr_b16 v[228:229], v241 offset:4096
    v_mul_f32 v162, s28, v162
    v_mfma_f32_16x16x32_bf16 v[196:199], v[232:235], v[76:79], v[196:199]
    ds_read_b64_tr_b16 v[230:231], v241 offset:4608
    s_waitcnt lgkmcnt(4)
    v_mfma_f32_16x16x32_bf16 v[204:207], v[236:239], v[76:79], v[204:207]
    ds_read_b64_tr_b16 v[232:233], v242 offset:4096
    v_mul_f32 v163, s28, v163
    v_mfma_f32_16x16x32_bf16 v[200:203], v[236:239], v[72:75], v[200:203]
    ds_read_b64_tr_b16 v[234:235], v242 offset:4608
    s_waitcnt lgkmcnt(4)
    v_mfma_f32_16x16x32_bf16 v[176:179], v[224:227], v[80:83], v[176:179]
    ds_read_b64_tr_b16 v[236:237], v243 offset:4096
    v_mfma_f32_16x16x32_bf16 v[180:183], v[224:227], v[84:87], v[180:183]
    ds_read_b64_tr_b16 v[238:239], v243 offset:4608
    s_waitcnt lgkmcnt(4)
    v_cvt_pk_bf16_f32 v160, v160, v161
    v_mfma_f32_16x16x32_bf16 v[188:191], v[228:231], v[84:87], v[188:191]
    ds_read_b64_tr_b16 v[224:225], v240 offset:8192
    s_add_u32 m0, s29, 65536
    s_add_u32 s24, s24, s35
    buffer_load_dwordx4 v244, s[16:19], s24 offen lds
    v_mfma_f32_16x16x32_bf16 v[184:187], v[228:231], v[80:83], v[184:187]
    ds_read_b64_tr_b16 v[226:227], v240 offset:8704
    s_waitcnt lgkmcnt(4)
    v_cvt_pk_bf16_f32 v161, v162, v163
    v_mfma_f32_16x16x32_bf16 v[192:195], v[232:235], v[80:83], v[192:195]
    ds_read_b64_tr_b16 v[228:229], v241 offset:8192
    v_mfma_f32_16x16x32_bf16 v[196:199], v[232:235], v[84:87], v[196:199]
    ds_read_b64_tr_b16 v[230:231], v241 offset:8704
    s_waitcnt lgkmcnt(4)
    buffer_store_dwordx2 v[160:161], v246, s[12:15], s32 offen offset:0 sc1
    v_mfma_f32_16x16x32_bf16 v[204:207], v[236:239], v[84:87], v[204:207]
    ds_read_b64_tr_b16 v[232:233], v242 offset:8192
    v_mfma_f32_16x16x32_bf16 v[200:203], v[236:239], v[80:83], v[200:203]
    ds_read_b64_tr_b16 v[234:235], v242 offset:8704
    s_waitcnt lgkmcnt(4)
    v_mul_f32 v164, s28, v164
    v_mfma_f32_16x16x32_bf16 v[176:179], v[224:227], v[88:91], v[176:179]
    ds_read_b64_tr_b16 v[236:237], v243 offset:8192
    v_mfma_f32_16x16x32_bf16 v[180:183], v[224:227], v[92:95], v[180:183]
    ds_read_b64_tr_b16 v[238:239], v243 offset:8704
    s_waitcnt lgkmcnt(4)
    v_mul_f32 v165, s28, v165
    v_mfma_f32_16x16x32_bf16 v[188:191], v[228:231], v[92:95], v[188:191]
    ds_read_b64_tr_b16 v[224:225], v240 offset:12288
    v_mfma_f32_16x16x32_bf16 v[184:187], v[228:231], v[88:91], v[184:187]
    ds_read_b64_tr_b16 v[226:227], v240 offset:12800
    s_waitcnt lgkmcnt(4)
    v_mfma_f32_16x16x32_bf16 v[192:195], v[232:235], v[88:91], v[192:195]
    ds_read_b64_tr_b16 v[228:229], v241 offset:12288
    v_mul_f32 v166, s28, v166
    v_mfma_f32_16x16x32_bf16 v[196:199], v[232:235], v[92:95], v[196:199]
    ds_read_b64_tr_b16 v[230:231], v241 offset:12800
    s_waitcnt lgkmcnt(4)
    v_mfma_f32_16x16x32_bf16 v[204:207], v[236:239], v[92:95], v[204:207]
    ds_read_b64_tr_b16 v[232:233], v242 offset:12288
    v_mul_f32 v167, s28, v167
    v_mfma_f32_16x16x32_bf16 v[200:203], v[236:239], v[88:91], v[200:203]
    ds_read_b64_tr_b16 v[234:235], v242 offset:12800
    s_waitcnt lgkmcnt(4)
    v_mfma_f32_16x16x32_bf16 v[176:179], v[224:227], v[96:99], v[176:179]
    ds_read_b64_tr_b16 v[236:237], v243 offset:12288
    v_cvt_pk_bf16_f32 v164, v164, v165
    v_mfma_f32_16x16x32_bf16 v[180:183], v[224:227], v[100:103], v[180:183]
    ds_read_b64_tr_b16 v[238:239], v243 offset:12800
    s_waitcnt lgkmcnt(4)
    v_mfma_f32_16x16x32_bf16 v[188:191], v[228:231], v[100:103], v[188:191]
    ds_read_b64_tr_b16 v[224:225], v240 offset:16384
    v_cvt_pk_bf16_f32 v165, v166, v167
    v_mfma_f32_16x16x32_bf16 v[184:187], v[228:231], v[96:99], v[184:187]
    ds_read_b64_tr_b16 v[226:227], v240 offset:16896
    s_waitcnt lgkmcnt(4)
    v_mfma_f32_16x16x32_bf16 v[192:195], v[232:235], v[96:99], v[192:195]
    ds_read_b64_tr_b16 v[228:229], v241 offset:16384
    buffer_store_dwordx2 v[164:165], v246, s[12:15], s32 offen offset:256 sc1
    v_mfma_f32_16x16x32_bf16 v[196:199], v[232:235], v[100:103], v[196:199]
    ds_read_b64_tr_b16 v[230:231], v241 offset:16896
    s_waitcnt lgkmcnt(4)
    v_mfma_f32_16x16x32_bf16 v[204:207], v[236:239], v[100:103], v[204:207]
    ds_read_b64_tr_b16 v[232:233], v242 offset:16384
    v_mfma_f32_16x16x32_bf16 v[200:203], v[236:239], v[96:99], v[200:203]
    ds_read_b64_tr_b16 v[234:235], v242 offset:16896
    s_waitcnt lgkmcnt(4)
    s_add_u32 s32, s27, 196608
    s_setprio 0
    v_mfma_f32_16x16x32_bf16 v[176:179], v[224:227], v[104:107], v[176:179]
    ds_read_b64_tr_b16 v[236:237], v243 offset:16384
    v_mfma_f32_16x16x32_bf16 v[180:183], v[224:227], v[108:111], v[180:183]
    ds_read_b64_tr_b16 v[238:239], v243 offset:16896
    s_waitcnt lgkmcnt(4)
    v_mul_f32 v168, s28, v168
    v_mfma_f32_16x16x32_bf16 v[188:191], v[228:231], v[108:111], v[188:191]
    ds_read_b64_tr_b16 v[224:225], v240 offset:20480
    v_mfma_f32_16x16x32_bf16 v[184:187], v[228:231], v[104:107], v[184:187]
    ds_read_b64_tr_b16 v[226:227], v240 offset:20992
    s_waitcnt lgkmcnt(4)
    v_mul_f32 v169, s28, v169
    v_mfma_f32_16x16x32_bf16 v[192:195], v[232:235], v[104:107], v[192:195]
    ds_read_b64_tr_b16 v[228:229], v241 offset:20480
    v_mfma_f32_16x16x32_bf16 v[196:199], v[232:235], v[108:111], v[196:199]
    ds_read_b64_tr_b16 v[230:231], v241 offset:20992
    s_waitcnt lgkmcnt(4)
    v_mul_f32 v170, s28, v170
    v_mfma_f32_16x16x32_bf16 v[204:207], v[236:239], v[108:111], v[204:207]
    ds_read_b64_tr_b16 v[232:233], v242 offset:20480
    v_mfma_f32_16x16x32_bf16 v[200:203], v[236:239], v[104:107], v[200:203]
    ds_read_b64_tr_b16 v[234:235], v242 offset:20992
    s_waitcnt lgkmcnt(4)
    v_mul_f32 v171, s28, v171
    v_mfma_f32_16x16x32_bf16 v[176:179], v[224:227], v[112:115], v[176:179]
    ds_read_b64_tr_b16 v[236:237], v243 offset:20480
    v_mfma_f32_16x16x32_bf16 v[180:183], v[224:227], v[116:119], v[180:183]
    ds_read_b64_tr_b16 v[238:239], v243 offset:20992
    s_waitcnt lgkmcnt(4)
    v_mfma_f32_16x16x32_bf16 v[188:191], v[228:231], v[116:119], v[188:191]
    ds_read_b64_tr_b16 v[224:225], v240 offset:24576
    v_cvt_pk_bf16_f32 v168, v168, v169
    v_mfma_f32_16x16x32_bf16 v[184:187], v[228:231], v[112:115], v[184:187]
    ds_read_b64_tr_b16 v[226:227], v240 offset:25088
    s_waitcnt lgkmcnt(4)
    v_mfma_f32_16x16x32_bf16 v[192:195], v[232:235], v[112:115], v[192:195]
    ds_read_b64_tr_b16 v[228:229], v241 offset:24576
    v_cvt_pk_bf16_f32 v169, v170, v171
    v_mfma_f32_16x16x32_bf16 v[196:199], v[232:235], v[116:119], v[196:199]
    ds_read_b64_tr_b16 v[230:231], v241 offset:25088
    s_waitcnt lgkmcnt(4)
    v_mfma_f32_16x16x32_bf16 v[204:207], v[236:239], v[116:119], v[204:207]
    ds_read_b64_tr_b16 v[232:233], v242 offset:24576
    buffer_store_dwordx2 v[168:169], v246, s[12:15], s32 offen offset:0 sc1
    v_mfma_f32_16x16x32_bf16 v[200:203], v[236:239], v[112:115], v[200:203]
    ds_read_b64_tr_b16 v[234:235], v242 offset:25088
    s_waitcnt lgkmcnt(4)
    v_mfma_f32_16x16x32_bf16 v[176:179], v[224:227], v[120:123], v[176:179]
    ds_read_b64_tr_b16 v[236:237], v243 offset:24576
    v_mul_f32 v172, s28, v172
    v_mfma_f32_16x16x32_bf16 v[180:183], v[224:227], v[124:127], v[180:183]
    ds_read_b64_tr_b16 v[238:239], v243 offset:25088
    s_waitcnt lgkmcnt(4)
    v_mfma_f32_16x16x32_bf16 v[188:191], v[228:231], v[124:127], v[188:191]
    ds_read_b64_tr_b16 v[224:225], v240 offset:28672
    v_mul_f32 v173, s28, v173
    v_mfma_f32_16x16x32_bf16 v[184:187], v[228:231], v[120:123], v[184:187]
    ds_read_b64_tr_b16 v[226:227], v240 offset:29184
    s_waitcnt lgkmcnt(4)
    v_mfma_f32_16x16x32_bf16 v[192:195], v[232:235], v[120:123], v[192:195]
    ds_read_b64_tr_b16 v[228:229], v241 offset:28672
    v_mfma_f32_16x16x32_bf16 v[196:199], v[232:235], v[124:127], v[196:199]
    ds_read_b64_tr_b16 v[230:231], v241 offset:29184
    s_waitcnt lgkmcnt(4)
    v_mul_f32 v174, s28, v174
    v_mfma_f32_16x16x32_bf16 v[204:207], v[236:239], v[124:127], v[204:207]
    ds_read_b64_tr_b16 v[232:233], v242 offset:28672
    v_mfma_f32_16x16x32_bf16 v[200:203], v[236:239], v[120:123], v[200:203]
    ds_read_b64_tr_b16 v[234:235], v242 offset:29184
    s_waitcnt lgkmcnt(4)
    v_mul_f32 v175, s28, v175
    v_mfma_f32_16x16x32_bf16 v[176:179], v[224:227], v[128:131], v[176:179]
    ds_read_b64_tr_b16 v[236:237], v243 offset:28672
    v_mfma_f32_16x16x32_bf16 v[180:183], v[224:227], v[132:135], v[180:183]
    ds_read_b64_tr_b16 v[238:239], v243 offset:29184
    s_waitcnt lgkmcnt(4)
    v_cvt_pk_bf16_f32 v172, v172, v173
    v_mfma_f32_16x16x32_bf16 v[188:191], v[228:231], v[132:135], v[188:191]
    ds_read_b64_tr_b16 v[224:225], v240 offset:32768
    v_mfma_f32_16x16x32_bf16 v[184:187], v[228:231], v[128:131], v[184:187]
    ds_read_b64_tr_b16 v[226:227], v240 offset:33280
    s_waitcnt lgkmcnt(4)
    v_add_u32 v240, 0xfffe5000, v240
    v_cvt_pk_bf16_f32 v173, v174, v175
    v_mfma_f32_16x16x32_bf16 v[192:195], v[232:235], v[128:131], v[192:195]
    ds_read_b64_tr_b16 v[228:229], v241 offset:32768
    v_mfma_f32_16x16x32_bf16 v[196:199], v[232:235], v[132:135], v[196:199]
    ds_read_b64_tr_b16 v[230:231], v241 offset:33280
    s_waitcnt lgkmcnt(4)
    v_add_u32 v241, 0xfffe5000, v241
    buffer_store_dwordx2 v[172:173], v246, s[12:15], s32 offen offset:256 sc1
    v_mfma_f32_16x16x32_bf16 v[204:207], v[236:239], v[132:135], v[204:207]
    ds_read_b64_tr_b16 v[232:233], v242 offset:32768
    v_mfma_f32_16x16x32_bf16 v[200:203], v[236:239], v[128:131], v[200:203]
    ds_read_b64_tr_b16 v[234:235], v242 offset:33280
    s_waitcnt lgkmcnt(4)
    v_add_u32 v242, 0xfffe5000, v242
    v_mfma_f32_16x16x32_bf16 v[176:179], v[224:227], v[136:139], v[176:179]
    ds_read_b64_tr_b16 v[236:237], v243 offset:32768
    v_mfma_f32_16x16x32_bf16 v[180:183], v[224:227], v[140:143], v[180:183]
    ds_read_b64_tr_b16 v[238:239], v243 offset:33280
    s_waitcnt lgkmcnt(4)
    v_add_u32 v243, 0xfffe5000, v243
    s_waitcnt vmcnt(4)
    s_barrier
    v_mfma_f32_16x16x32_bf16 v[188:191], v[228:231], v[140:143], v[188:191]
    ds_read_b64_tr_b16 v[224:225], v240 offset:0
    v_mfma_f32_16x16x32_bf16 v[184:187], v[228:231], v[136:139], v[184:187]
    ds_read_b64_tr_b16 v[226:227], v240 offset:512
    s_waitcnt lgkmcnt(4)
    v_mfma_f32_16x16x32_bf16 v[192:195], v[232:235], v[136:139], v[192:195]
    ds_read_b64_tr_b16 v[228:229], v241 offset:0
    v_mfma_f32_16x16x32_bf16 v[196:199], v[232:235], v[140:143], v[196:199]
    ds_read_b64_tr_b16 v[230:231], v241 offset:512
    s_waitcnt lgkmcnt(4)
    v_mfma_f32_16x16x32_bf16 v[204:207], v[236:239], v[140:143], v[204:207]
    ds_read_b64_tr_b16 v[232:233], v242 offset:0
    v_mfma_f32_16x16x32_bf16 v[200:203], v[236:239], v[136:139], v[200:203]
    ds_read_b64_tr_b16 v[234:235], v242 offset:512
    s_waitcnt lgkmcnt(4)
    s_add_u32 s27, s27, 262144
L1_qk_tail:
    s_setprio 0
    s_nop 7
    s_add_u32 s32, s27, 0
    v_mul_f32 v176, s28, v176
    v_mul_f32 v177, s28, v177
    v_mul_f32 v178, s28, v178
    v_mul_f32 v179, s28, v179
    v_cvt_pk_bf16_f32 v176, v176, v177
    v_cvt_pk_bf16_f32 v177, v178, v179
    buffer_store_dwordx2 v[176:177], v246, s[12:15], s32 offen offset:0 sc1
    v_mul_f32 v180, s28, v180
    v_mul_f32 v181, s28, v181
    v_mul_f32 v182, s28, v182
    v_mul_f32 v183, s28, v183
    v_cvt_pk_bf16_f32 v180, v180, v181
    v_cvt_pk_bf16_f32 v181, v182, v183
    buffer_store_dwordx2 v[180:181], v246, s[12:15], s32 offen offset:256 sc1
    s_add_u32 s32, s27, 65536
    v_mul_f32 v184, s28, v184
    v_mul_f32 v185, s28, v185
    v_mul_f32 v186, s28, v186
    v_mul_f32 v187, s28, v187
    v_cvt_pk_bf16_f32 v184, v184, v185
    v_cvt_pk_bf16_f32 v185, v186, v187
    buffer_store_dwordx2 v[184:185], v246, s[12:15], s32 offen offset:0 sc1
    v_mul_f32 v188, s28, v188
    v_mul_f32 v189, s28, v189
    v_mul_f32 v190, s28, v190
    v_mul_f32 v191, s28, v191
    v_cvt_pk_bf16_f32 v188, v188, v189
    v_cvt_pk_bf16_f32 v189, v190, v191
    buffer_store_dwordx2 v[188:189], v246, s[12:15], s32 offen offset:256 sc1
    s_add_u32 s32, s27, 131072
    v_mul_f32 v192, s28, v192
    v_mul_f32 v193, s28, v193
    v_mul_f32 v194, s28, v194
    v_mul_f32 v195, s28, v195
    v_cvt_pk_bf16_f32 v192, v192, v193
    v_cvt_pk_bf16_f32 v193, v194, v195
    buffer_store_dwordx2 v[192:193], v246, s[12:15], s32 offen offset:0 sc1
    v_mul_f32 v196, s28, v196
    v_mul_f32 v197, s28, v197
    v_mul_f32 v198, s28, v198
    v_mul_f32 v199, s28, v199
    v_cvt_pk_bf16_f32 v196, v196, v197
    v_cvt_pk_bf16_f32 v197, v198, v199
    buffer_store_dwordx2 v[196:197], v246, s[12:15], s32 offen offset:256 sc1
    s_add_u32 s32, s27, 196608
    v_mul_f32 v200, s28, v200
    v_mul_f32 v201, s28, v201
    v_mul_f32 v202, s28, v202
    v_mul_f32 v203, s28, v203
    v_cvt_pk_bf16_f32 v200, v200, v201
    v_cvt_pk_bf16_f32 v201, v202, v203
    buffer_store_dwordx2 v[200:201], v246, s[12:15], s32 offen offset:0 sc1
    v_mul_f32 v204, s28, v204
    v_mul_f32 v205, s28, v205
    v_mul_f32 v206, s28, v206
    v_mul_f32 v207, s28, v207
    v_cvt_pk_bf16_f32 v204, v204, v205
    v_cvt_pk_bf16_f32 v205, v206, v207
    buffer_store_dwordx2 v[204:205], v246, s[12:15], s32 offen offset:256 sc1
    s_waitcnt lgkmcnt(0)
    s_branch L1_sp_tail
L1_v:
    v_lshrrev_b32 v249, 4, v247
    v_bfe_u32 v250, v247, 2, 2
    v_lshl_add_u32 v250, v249, 3, v250
    v_lshlrev_b32 v250, 7, v250
    v_and_b32 v251, 3, v247
    v_lshl_add_u32 v250, v251, 3, v250
    v_bfe_u32 v249, v247, 3, 2
    v_xor_b32 v251, 0, v249
    v_lshl_add_u32 v240, v251, 5, v250
    v_xor_b32 v251, 1, v249
    v_lshl_add_u32 v241, v251, 5, v250
    v_xor_b32 v251, 2, v249
    v_lshl_add_u32 v242, v251, 5, v250
    v_xor_b32 v251, 3, v249
    v_lshl_add_u32 v243, v251, 5, v250
    v_and_b32 v249, 15, v247
    v_lshrrev_b32 v250, 4, v247
    v_and_b32 v251, 1, v250
    v_mul_u32_u24 v246, 320, v251
    v_lshl_add_u32 v246, v249, 4, v246
    v_lshrrev_b32 v251, 1, v250
    v_lshl_add_u32 v246, v251, 3, v246
    s_mov_b32 s38, s28
    s_mov_b32 s39, s28
    s_lshr_b32 s33, s42, 2
    s_mul_i32 s33, s33, 6
    s_add_u32 s33, s33, s41
    s_mul_i32 s36, s33, 73728
    s_waitcnt vmcnt(0) lgkmcnt(0)
    s_barrier
    s_add_u32 s25, s25, 144
    v_mov_b32 v248, 157736
    ds_read_b64 v[248:249], v248
    s_add_u32 s34, s30, 0
    buffer_load_dwordx4 v[0:3], v245, s[12:15], s34 offen offset:0 sc1
    buffer_load_dwordx4 v[4:7], v245, s[12:15], s34 offen offset:1024 sc1
    s_add_u32 s34, s30, 4096
    buffer_load_dwordx4 v[8:11], v245, s[12:15], s34 offen offset:0 sc1
    buffer_load_dwordx4 v[12:15], v245, s[12:15], s34 offen offset:1024 sc1
    s_add_u32 s34, s30, 8192
    buffer_load_dwordx4 v[16:19], v245, s[12:15], s34 offen offset:0 sc1
    buffer_load_dwordx4 v[20:23], v245, s[12:15], s34 offen offset:1024 sc1
    s_add_u32 s34, s30, 12288
    buffer_load_dwordx4 v[24:27], v245, s[12:15], s34 offen offset:0 sc1
    buffer_load_dwordx4 v[28:31], v245, s[12:15], s34 offen offset:1024 sc1
    s_waitcnt lgkmcnt(0)
    v_readfirstlane_b32 s44, v248
    v_readfirstlane_b32 s45, v249
    ds_read_b64_tr_b16 v[224:225], v240 offset:0
    ds_read_b64_tr_b16 v[226:227], v240 offset:512
    ds_read_b64_tr_b16 v[228:229], v241 offset:0
    ds_read_b64_tr_b16 v[230:231], v241 offset:512
    ds_read_b64_tr_b16 v[232:233], v242 offset:0
    ds_read_b64_tr_b16 v[234:235], v242 offset:512
    s_waitcnt lgkmcnt(4)
    s_cmp_lt_u32 s3, 4
    s_cselect_b64 vcc, -1, 0
    v_add_u32 v240, 0x12000, v240
    v_add_u32 v241, 0x12000, v241
    v_add_u32 v242, 0x12000, v242
    s_cbranch_vccnz Lp9
    s_setprio 1
Lp9:
    s_waitcnt vmcnt(6)
    v_mfma_f32_16x16x32_bf16 v[144:147], v[0:3], v[224:227], 0
    ds_read_b64_tr_b16 v[236:237], v243 offset:0
    s_add_u32 s34, s30, 16384
    buffer_load_dwordx4 v[32:35], v245, s[12:15], s34 offen offset:0 sc1
    v_mfma_f32_16x16x32_bf16 v[148:151], v[4:7], v[224:227], 0
    ds_read_b64_tr_b16 v[238:239], v243 offset:512
    s_waitcnt lgkmcnt(4)
    v_add_u32 v243, 0x12000, v243
    v_mfma_f32_16x16x32_bf16 v[156:159], v[4:7], v[228:231], 0
    ds_read_b64_tr_b16 v[224:225], v240 offset:0
    v_mfma_f32_16x16x32_bf16 v[152:155], v[0:3], v[228:231], 0
    ds_read_b64_tr_b16 v[226:227], v240 offset:512
    s_waitcnt lgkmcnt(4)
    v_add_u32 v240, 0xfffee000, v240
    v_mfma_f32_16x16x32_bf16 v[160:163], v[0:3], v[232:235], 0
    ds_read_b64_tr_b16 v[228:229], v241 offset:0
    v_mfma_f32_16x16x32_bf16 v[164:167], v[4:7], v[232:235], 0
    ds_read_b64_tr_b16 v[230:231], v241 offset:512
    s_waitcnt lgkmcnt(4)
    v_add_u32 v241, 0xfffee000, v241
    v_mfma_f32_16x16x32_bf16 v[172:175], v[4:7], v[236:239], 0
    ds_read_b64_tr_b16 v[232:233], v242 offset:0
    buffer_load_dwordx4 v[36:39], v245, s[12:15], s34 offen offset:1024 sc1
    v_mfma_f32_16x16x32_bf16 v[168:171], v[0:3], v[236:239], 0
    ds_read_b64_tr_b16 v[234:235], v242 offset:512
    s_waitcnt lgkmcnt(4)
    v_add_u32 v242, 0xfffee000, v242
    v_mfma_f32_16x16x32_bf16 v[176:179], v[0:3], v[224:227], 0
    ds_read_b64_tr_b16 v[236:237], v243 offset:0
    v_mfma_f32_16x16x32_bf16 v[180:183], v[4:7], v[224:227], 0
    ds_read_b64_tr_b16 v[238:239], v243 offset:512
    s_waitcnt lgkmcnt(4)
    v_add_u32 v243, 0xfffee000, v243
    v_mfma_f32_16x16x32_bf16 v[188:191], v[4:7], v[228:231], 0
    ds_read_b64_tr_b16 v[224:225], v240 offset:4096
    v_mfma_f32_16x16x32_bf16 v[184:187], v[0:3], v[228:231], 0
    ds_read_b64_tr_b16 v[226:227], v240 offset:4608
    s_waitcnt lgkmcnt(4)
    v_add_u32 v240, 0x12000, v240
    v_mfma_f32_16x16x32_bf16 v[192:195], v[0:3], v[232:235], 0
    ds_read_b64_tr_b16 v[228:229], v241 offset:4096
    s_add_u32 s34, s30, 20480
    buffer_load_dwordx4 v[40:43], v245, s[12:15], s34 offen offset:0 sc1
    v_mfma_f32_16x16x32_bf16 v[196:199], v[4:7], v[232:235], 0
    ds_read_b64_tr_b16 v[230:231], v241 offset:4608
    s_waitcnt lgkmcnt(4)
    v_add_u32 v241, 0x12000, v241
    v_mfma_f32_16x16x32_bf16 v[204:207], v[4:7], v[236:239], 0
    ds_read_b64_tr_b16 v[232:233], v242 offset:4096
    v_mfma_f32_16x16x32_bf16 v[200:203], v[0:3], v[236:239], 0
    ds_read_b64_tr_b16 v[234:235], v242 offset:4608
    s_waitcnt lgkmcnt(4)
    v_add_u32 v242, 0x12000, v242
    s_waitcnt vmcnt(7)
    v_mfma_f32_16x16x32_bf16 v[144:147], v[8:11], v[224:227], v[144:147]
    ds_read_b64_tr_b16 v[236:237], v243 offset:4096
    v_mfma_f32_16x16x32_bf16 v[148:151], v[12:15], v[224:227], v[148:151]
    ds_read_b64_tr_b16 v[238:239], v243 offset:4608
    s_waitcnt lgkmcnt(4)
    v_add_u32 v243, 0x12000, v243
    v_mfma_f32_16x16x32_bf16 v[156:159], v[12:15], v[228:231], v[156:159]
    ds_read_b64_tr_b16 v[224:225], v240 offset:4096
    buffer_load_dwordx4 v[44:47], v245, s[12:15], s34 offen offset:1024 sc1
    v_mfma_f32_16x16x32_bf16 v[152:155], v[8:11], v[228:231], v[152:155]
    ds_read_b64_tr_b16 v[226:227], v240 offset:4608
    s_waitcnt lgkmcnt(4)
    v_add_u32 v240, 0xfffee000, v240
    v_mfma_f32_16x16x32_bf16 v[160:163], v[8:11], v[232:235], v[160:163]
    ds_read_b64_tr_b16 v[228:229], v241 offset:4096
    v_mfma_f32_16x16x32_bf16 v[164:167], v[12:15], v[232:235], v[164:167]
    ds_read_b64_tr_b16 v[230:231], v241 offset:4608
    s_waitcnt lgkmcnt(4)
    v_add_u32 v241, 0xfffee000, v241
    v_mfma_f32_16x16x32_bf16 v[172:175], v[12:15], v[236:239], v[172:175]
    ds_read_b64_tr_b16 v[232:233], v242 offset:4096
    v_mfma_f32_16x16x32_bf16 v[168:171], v[8:11], v[236:239], v[168:171]
    ds_read_b64_tr_b16 v[234:235], v242 offset:4608
    s_waitcnt lgkmcnt(4)
    v_add_u32 v242, 0xfffee000, v242
    v_mfma_f32_16x16x32_bf16 v[176:179], v[8:11], v[224:227], v[176:179]
    ds_read_b64_tr_b16 v[236:237], v243 offset:4096
    s_add_u32 s34, s30, 24576
    buffer_load_dwordx4 v[48:51], v245, s[12:15], s34 offen offset:0 sc1
    v_mfma_f32_16x16x32_bf16 v[180:183], v[12:15], v[224:227], v[180:183]
    ds_read_b64_tr_b16 v[238:239], v243 offset:4608
    s_waitcnt lgkmcnt(4)
    v_add_u32 v243, 0xfffee000, v243
    v_mfma_f32_16x16x32_bf16 v[188:191], v[12:15], v[228:231], v[188:191]
    ds_read_b64_tr_b16 v[224:225], v240 offset:8192
    v_mfma_f32_16x16x32_bf16 v[184:187], v[8:11], v[228:231], v[184:187]
    ds_read_b64_tr_b16 v[226:227], v240 offset:8704
    s_waitcnt lgkmcnt(4)
    v_add_u32 v240, 0x12000, v240
    v_mfma_f32_16x16x32_bf16 v[192:195], v[8:11], v[232:235], v[192:195]
    ds_read_b64_tr_b16 v[228:229], v241 offset:8192
    v_mfma_f32_16x16x32_bf16 v[196:199], v[12:15], v[232:235], v[196:199]
    ds_read_b64_tr_b16 v[230:231], v241 offset:8704
    s_waitcnt lgkmcnt(4)
    v_add_u32 v241, 0x12000, v241
    v_mfma_f32_16x16x32_bf16 v[204:207], v[12:15], v[236:239], v[204:207]
    ds_read_b64_tr_b16 v[232:233], v242 offset:8192
    buffer_load_dwordx4 v[52:55], v245, s[12:15], s34 offen offset:1024 sc1
    v_mfma_f32_16x16x32_bf16 v[200:203], v[8:11], v[236:239], v[200:203]
    ds_read_b64_tr_b16 v[234:235], v242 offset:8704
    s_waitcnt lgkmcnt(4)
    v_add_u32 v242, 0x12000, v242
    s_waitcnt vmcnt(8)
    v_mfma_f32_16x16x32_bf16 v[144:147], v[16:19], v[224:227], v[144:147]
    ds_read_b64_tr_b16 v[236:237], v243 offset:8192
    v_mfma_f32_16x16x32_bf16 v[148:151], v[20:23], v[224:227], v[148:151]
    ds_read_b64_tr_b16 v[238:239], v243 offset:8704
    s_waitcnt lgkmcnt(4)
    v_add_u32 v243, 0x12000, v243
    v_mfma_f32_16x16x32_bf16 v[156:159], v[20:23], v[228:231], v[156:159]
    ds_read_b64_tr_b16 v[224:225], v240 offset:8192
    v_mfma_f32_16x16x32_bf16 v[152:155], v[16:19], v[228:231], v[152:155]
    ds_read_b64_tr_b16 v[226:227], v240 offset:8704
    s_waitcnt lgkmcnt(4)
    v_add_u32 v240, 0xfffee000, v240
    v_mfma_f32_16x16x32_bf16 v[160:163], v[16:19], v[232:235], v[160:163]
    ds_read_b64_tr_b16 v[228:229], v241 offset:8192
    s_add_u32 s34, s30, 28672
    buffer_load_dwordx4 v[56:59], v245, s[12:15], s34 offen offset:0 sc1
    v_mfma_f32_16x16x32_bf16 v[164:167], v[20:23], v[232:235], v[164:167]
    ds_read_b64_tr_b16 v[230:231], v241 offset:8704
    s_waitcnt lgkmcnt(4)
    v_add_u32 v241, 0xfffee000, v241
    v_mfma_f32_16x16x32_bf16 v[172:175], v[20:23], v[236:239], v[172:175]
    ds_read_b64_tr_b16 v[232:233], v242 offset:8192
    v_mfma_f32_16x16x32_bf16 v[168:171], v[16:19], v[236:239], v[168:171]
    ds_read_b64_tr_b16 v[234:235], v242 offset:8704
    s_waitcnt lgkmcnt(4)
    v_add_u32 v242, 0xfffee000, v242
    v_mfma_f32_16x16x32_bf16 v[176:179], v[16:19], v[224:227], v[176:179]
    ds_read_b64_tr_b16 v[236:237], v243 offset:8192
    v_mfma_f32_16x16x32_bf16 v[180:183], v[20:23], v[224:227], v[180:183]
    ds_read_b64_tr_b16 v[238:239], v243 offset:8704
    s_waitcnt lgkmcnt(4)
    v_add_u32 v243, 0xfffee000, v243
    v_mfma_f32_16x16x32_bf16 v[188:191], v[20:23], v[228:231], v[188:191]
    ds_read_b64_tr_b16 v[224:225], v240 offset:12288
    buffer_load_dwordx4 v[60:63], v245, s[12:15], s34 offen offset:1024 sc1
    v_mfma_f32_16x16x32_bf16 v[184:187], v[16:19], v[228:231], v[184:187]
    ds_read_b64_tr_b16 v[226:227], v240 offset:12800
    s_waitcnt lgkmcnt(4)
    v_add_u32 v240, 0x12000, v240
    v_mfma_f32_16x16x32_bf16 v[192:195], v[16:19], v[232:235], v[192:195]
    ds_read_b64_tr_b16 v[228:229], v241 offset:12288
    v_mfma_f32_16x16x32_bf16 v[196:199], v[20:23], v[232:235], v[196:199]
    ds_read_b64_tr_b16 v[230:231], v241 offset:12800
    s_waitcnt lgkmcnt(4)
    v_add_u32 v241, 0x12000, v241
    v_mfma_f32_16x16x32_bf16 v[204:207], v[20:23], v[236:239], v[204:207]
    ds_read_b64_tr_b16 v[232:233], v242 offset:12288
    v_mfma_f32_16x16x32_bf16 v[200:203], v[16:19], v[236:239], v[200:203]
    ds_read_b64_tr_b16 v[234:235], v242 offset:12800
    s_waitcnt lgkmcnt(4)
    v_add_u32 v242, 0x12000, v242
    s_waitcnt vmcnt(8)
    v_mfma_f32_16x16x32_bf16 v[144:147], v[24:27], v[224:227], v[144:147]
    ds_read_b64_tr_b16 v[236:237], v243 offset:12288
    s_add_u32 s34, s30, 32768
    buffer_load_dwordx4 v[64:67], v245, s[12:15], s34 offen offset:0 sc1
    v_mfma_f32_16x16x32_bf16 v[148:151], v[28:31], v[224:227], v[148:151]
    ds_read_b64_tr_b16 v[238:239], v243 offset:12800
    s_waitcnt lgkmcnt(4)
    v_add_u32 v243, 0x12000, v243
    v_mfma_f32_16x16x32_bf16 v[156:159], v[28:31], v[228:231], v[156:159]
    ds_read_b64_tr_b16 v[224:225], v240 offset:12288
    v_mfma_f32_16x16x32_bf16 v[152:155], v[24:27], v[228:231], v[152:155]
    ds_read_b64_tr_b16 v[226:227], v240 offset:12800
    s_waitcnt lgkmcnt(4)
    v_add_u32 v240, 0xfffee000, v240
    v_mfma_f32_16x16x32_bf16 v[160:163], v[24:27], v[232:235], v[160:163]
    ds_read_b64_tr_b16 v[228:229], v241 offset:12288
    v_mfma_f32_16x16x32_bf16 v[164:167], v[28:31], v[232:235], v[164:167]
    ds_read_b64_tr_b16 v[230:231], v241 offset:12800
    s_waitcnt lgkmcnt(4)
    v_add_u32 v241, 0xfffee000, v241
    v_mfma_f32_16x16x32_bf16 v[172:175], v[28:31], v[236:239], v[172:175]
    ds_read_b64_tr_b16 v[232:233], v242 offset:12288
    buffer_load_dwordx4 v[68:71], v245, s[12:15], s34 offen offset:1024 sc1
    v_mfma_f32_16x16x32_bf16 v[168:171], v[24:27], v[236:239], v[168:171]
    ds_read_b64_tr_b16 v[234:235], v242 offset:12800
    s_waitcnt lgkmcnt(4)
    v_add_u32 v242, 0xfffee000, v242
    v_mfma_f32_16x16x32_bf16 v[176:179], v[24:27], v[224:227], v[176:179]
    ds_read_b64_tr_b16 v[236:237], v243 offset:12288
    v_mfma_f32_16x16x32_bf16 v[180:183], v[28:31], v[224:227], v[180:183]
    ds_read_b64_tr_b16 v[238:239], v243 offset:12800
    s_waitcnt lgkmcnt(4)
    v_add_u32 v243, 0xfffee000, v243
    v_mfma_f32_16x16x32_bf16 v[188:191], v[28:31], v[228:231], v[188:191]
    ds_read_b64_tr_b16 v[224:225], v240 offset:16384
    v_mfma_f32_16x16x32_bf16 v[184:187], v[24:27], v[228:231], v[184:187]
    ds_read_b64_tr_b16 v[226:227], v240 offset:16896
    s_waitcnt lgkmcnt(4)
    v_add_u32 v240, 0x12000, v240
    v_mfma_f32_16x16x32_bf16 v[192:195], v[24:27], v[232:235], v[192:195]
    ds_read_b64_tr_b16 v[228:229], v241 offset:16384
    s_add_u32 s34, s30, 36864
    buffer_load_dwordx4 v[72:75], v245, s[12:15], s34 offen offset:0 sc1
    v_mfma_f32_16x16x32_bf16 v[196:199], v[28:31], v[232:235], v[196:199]
    ds_read_b64_tr_b16 v[230:231], v241 offset:16896
    s_waitcnt lgkmcnt(4)
    v_add_u32 v241, 0x12000, v241
    v_mfma_f32_16x16x32_bf16 v[204:207], v[28:31], v[236:239], v[204:207]
    ds_read_b64_tr_b16 v[232:233], v242 offset:16384
    v_mfma_f32_16x16x32_bf16 v[200:203], v[24:27], v[236:239], v[200:203]
    ds_read_b64_tr_b16 v[234:235], v242 offset:16896
    s_waitcnt lgkmcnt(4)
    v_add_u32 v242, 0x12000, v242
    s_waitcnt vmcnt(9)
    v_mfma_f32_16x16x32_bf16 v[144:147], v[32:35], v[224:227], v[144:147]
    ds_read_b64_tr_b16 v[236:237], v243 offset:16384
    v_mfma_f32_16x16x32_bf16 v[148:151], v[36:39], v[224:227], v[148:151]
    ds_read_b64_tr_b16 v[238:239], v243 offset:16896
    s_waitcnt lgkmcnt(4)
    v_add_u32 v243, 0x12000, v243
    v_mfma_f32_16x16x32_bf16 v[156:159], v[36:39], v[228:231], v[156:159]
    ds_read_b64_tr_b16 v[224:225], v240 offset:16384
    buffer_load_dwordx4 v[76:79], v245, s[12:15], s34 offen offset:1024 sc1
    v_mfma_f32_16x16x32_bf16 v[152:155], v[32:35], v[228:231], v[152:155]
    ds_read_b64_tr_b16 v[226:227], v240 offset:16896
    s_waitcnt lgkmcnt(4)
    v_add_u32 v240, 0xfffee000, v240
    v_mfma_f32_16x16x32_bf16 v[160:163], v[32:35], v[232:235], v[160:163]
    ds_read_b64_tr_b16 v[228:229], v241 offset:16384
    v_mfma_f32_16x16x32_bf16 v[164:167], v[36:39], v[232:235], v[164:167]
    ds_read_b64_tr_b16 v[230:231], v241 offset:16896
    s_waitcnt lgkmcnt(4)
    v_add_u32 v241, 0xfffee000, v241
    v_mfma_f32_16x16x32_bf16 v[172:175], v[36:39], v[236:239], v[172:175]
    ds_read_b64_tr_b16 v[232:233], v242 offset:16384
    v_mfma_f32_16x16x32_bf16 v[168:171], v[32:35], v[236:239], v[168:171]
    ds_read_b64_tr_b16 v[234:235], v242 offset:16896
    s_waitcnt lgkmcnt(4)
    v_add_u32 v242, 0xfffee000, v242
    v_mfma_f32_16x16x32_bf16 v[176:179], v[32:35], v[224:227], v[176:179]
    ds_read_b64_tr_b16 v[236:237], v243 offset:16384
    s_add_u32 s34, s30, 40960
    buffer_load_dwordx4 v[80:83], v245, s[12:15], s34 offen offset:0 sc1
    v_mfma_f32_16x16x32_bf16 v[180:183], v[36:39], v[224:227], v[180:183]
    ds_read_b64_tr_b16 v[238:239], v243 offset:16896
    s_waitcnt lgkmcnt(4)
    v_add_u32 v243, 0xfffee000, v243
    v_mfma_f32_16x16x32_bf16 v[188:191], v[36:39], v[228:231], v[188:191]
    ds_read_b64_tr_b16 v[224:225], v240 offset:20480
    v_mfma_f32_16x16x32_bf16 v[184:187], v[32:35], v[228:231], v[184:187]
    ds_read_b64_tr_b16 v[226:227], v240 offset:20992
    s_waitcnt lgkmcnt(4)
    v_add_u32 v240, 0x12000, v240
    v_mfma_f32_16x16x32_bf16 v[192:195], v[32:35], v[232:235], v[192:195]
    ds_read_b64_tr_b16 v[228:229], v241 offset:20480
    v_mfma_f32_16x16x32_bf16 v[196:199], v[36:39], v[232:235], v[196:199]
    ds_read_b64_tr_b16 v[230:231], v241 offset:20992
    s_waitcnt lgkmcnt(4)
    v_add_u32 v241, 0x12000, v241
    v_mfma_f32_16x16x32_bf16 v[204:207], v[36:39], v[236:239], v[204:207]
    ds_read_b64_tr_b16 v[232:233], v242 offset:20480
    buffer_load_dwordx4 v[84:87], v245, s[12:15], s34 offen offset:1024 sc1
    v_mfma_f32_16x16x32_bf16 v[200:203], v[32:35], v[236:239], v[200:203]
    ds_read_b64_tr_b16 v[234:235], v242 offset:20992
    s_waitcnt lgkmcnt(4)
    v_add_u32 v242, 0x12000, v242
    s_waitcnt vmcnt(10)
    v_mfma_f32_16x16x32_bf16 v[144:147], v[40:43], v[224:227], v[144:147]
    ds_read_b64_tr_b16 v[236:237], v243 offset:20480
    v_mfma_f32_16x16x32_bf16 v[148:151], v[44:47], v[224:227], v[148:151]
    ds_read_b64_tr_b16 v[238:239], v243 offset:20992
    s_waitcnt lgkmcnt(4)
    v_add_u32 v243, 0x12000, v243
    v_mfma_f32_16x16x32_bf16 v[156:159], v[44:47], v[228:231], v[156:159]
    ds_read_b64_tr_b16 v[224:225], v240 offset:20480
    v_mfma_f32_16x16x32_bf16 v[152:155], v[40:43], v[228:231], v[152:155]
    ds_read_b64_tr_b16 v[226:227], v240 offset:20992
    s_waitcnt lgkmcnt(4)
    v_add_u32 v240, 0xfffee000, v240
    v_mfma_f32_16x16x32_bf16 v[160:163], v[40:43], v[232:235], v[160:163]
    ds_read_b64_tr_b16 v[228:229], v241 offset:20480
    s_add_u32 s34, s30, 45056
    buffer_load_dwordx4 v[88:91], v245, s[12:15], s34 offen offset:0 sc1
    v_mfma_f32_16x16x32_bf16 v[164:167], v[44:47], v[232:235], v[164:167]
    ds_read_b64_tr_b16 v[230:231], v241 offset:20992
    s_waitcnt lgkmcnt(4)
    v_add_u32 v241, 0xfffee000, v241
    v_mfma_f32_16x16x32_bf16 v[172:175], v[44:47], v[236:239], v[172:175]
    ds_read_b64_tr_b16 v[232:233], v242 offset:20480
    v_mfma_f32_16x16x32_bf16 v[168:171], v[40:43], v[236:239], v[168:171]
    ds_read_b64_tr_b16 v[234:235], v242 offset:20992
    s_waitcnt lgkmcnt(4)
    v_add_u32 v242, 0xfffee000, v242
    v_mfma_f32_16x16x32_bf16 v[176:179], v[40:43], v[224:227], v[176:179]
    ds_read_b64_tr_b16 v[236:237], v243 offset:20480
    v_mfma_f32_16x16x32_bf16 v[180:183], v[44:47], v[224:227], v[180:183]
    ds_read_b64_tr_b16 v[238:239], v243 offset:20992
    s_waitcnt lgkmcnt(4)
    v_add_u32 v243, 0xfffee000, v243
    v_mfma_f32_16x16x32_bf16 v[188:191], v[44:47], v[228:231], v[188:191]
    ds_read_b64_tr_b16 v[224:225], v240 offset:24576
    buffer_load_dwordx4 v[92:95], v245, s[12:15], s34 offen offset:1024 sc1
    v_mfma_f32_16x16x32_bf16 v[184:187], v[40:43], v[228:231], v[184:187]
    ds_read_b64_tr_b16 v[226:227], v240 offset:25088
    s_waitcnt lgkmcnt(4)
    v_add_u32 v240, 0x12000, v240
    v_mfma_f32_16x16x32_bf16 v[192:195], v[40:43], v[232:235], v[192:195]
    ds_read_b64_tr_b16 v[228:229], v241 offset:24576
    v_mfma_f32_16x16x32_bf16 v[196:199], v[44:47], v[232:235], v[196:199]
    ds_read_b64_tr_b16 v[230:231], v241 offset:25088
    s_waitcnt lgkmcnt(4)
    v_add_u32 v241, 0x12000, v241
    v_mfma_f32_16x16x32_bf16 v[204:207], v[44:47], v[236:239], v[204:207]
    ds_read_b64_tr_b16 v[232:233], v242 offset:24576
    v_mfma_f32_16x16x32_bf16 v[200:203], v[40:43], v[236:239], v[200:203]
    ds_read_b64_tr_b16 v[234:235], v242 offset:25088
    s_waitcnt lgkmcnt(4)
    v_add_u32 v242, 0x12000, v242
    s_waitcnt vmcnt(10)
    v_mfma_f32_16x16x32_bf16 v[144:147], v[48:51], v[224:227], v[144:147]
    ds_read_b64_tr_b16 v[236:237], v243 offset:24576
    s_add_u32 s34, s30, 49152
    buffer_load_dwordx4 v[96:99], v245, s[12:15], s34 offen offset:0 sc1
    v_mfma_f32_16x16x32_bf16 v[148:151], v[52:55], v[224:227], v[148:151]
    ds_read_b64_tr_b16 v[238:239], v243 offset:25088
    s_waitcnt lgkmcnt(4)
    v_add_u32 v243, 0x12000, v243
    v_mfma_f32_16x16x32_bf16 v[156:159], v[52:55], v[228:231], v[156:159]
    ds_read_b64_tr_b16 v[224:225], v240 offset:24576
    v_mfma_f32_16x16x32_bf16 v[152:155], v[48:51], v[228:231], v[152:155]
    ds_read_b64_tr_b16 v[226:227], v240 offset:25088
    s_waitcnt lgkmcnt(4)
    v_add_u32 v240, 0xfffee000, v240
    v_mfma_f32_16x16x32_bf16 v[160:163], v[48:51], v[232:235], v[160:163]
    ds_read_b64_tr_b16 v[228:229], v241 offset:24576
    v_mfma_f32_16x16x32_bf16 v[164:167], v[52:55], v[232:235], v[164:167]
    ds_read_b64_tr_b16 v[230:231], v241 offset:25088
    s_waitcnt lgkmcnt(4)
    v_add_u32 v241, 0xfffee000, v241
    v_mfma_f32_16x16x32_bf16 v[172:175], v[52:55], v[236:239], v[172:175]
    ds_read_b64_tr_b16 v[232:233], v242 offset:24576
    buffer_load_dwordx4 v[100:103], v245, s[12:15], s34 offen offset:1024 sc1
    v_mfma_f32_16x16x32_bf16 v[168:171], v[48:51], v[236:239], v[168:171]
    ds_read_b64_tr_b16 v[234:235], v242 offset:25088
    s_waitcnt lgkmcnt(4)
    v_add_u32 v242, 0xfffee000, v242
    s_setprio 0
    v_mfma_f32_16x16x32_bf16 v[176:179], v[48:51], v[224:227], v[176:179]
    ds_read_b64_tr_b16 v[236:237], v243 offset:24576
    v_mfma_f32_16x16x32_bf16 v[180:183], v[52:55], v[224:227], v[180:183]
    ds_read_b64_tr_b16 v[238:239], v243 offset:25088
    s_waitcnt lgkmcnt(4)
    v_add_u32 v243, 0xfffee000, v243
    v_mfma_f32_16x16x32_bf16 v[188:191], v[52:55], v[228:231], v[188:191]
    ds_read_b64_tr_b16 v[224:225], v240 offset:28672
    v_mfma_f32_16x16x32_bf16 v[184:187], v[48:51], v[228:231], v[184:187]
    ds_read_b64_tr_b16 v[226:227], v240 offset:29184
    s_waitcnt lgkmcnt(4)
    v_add_u32 v240, 0x12000, v240
    v_mfma_f32_16x16x32_bf16 v[192:195], v[48:51], v[232:235], v[192:195]
    ds_read_b64_tr_b16 v[228:229], v241 offset:28672
    s_add_u32 s34, s30, 53248
    buffer_load_dwordx4 v[104:107], v245, s[12:15], s34 offen offset:0 sc1
    v_mfma_f32_16x16x32_bf16 v[196:199], v[52:55], v[232:235], v[196:199]
    ds_read_b64_tr_b16 v[230:231], v241 offset:29184
    s_waitcnt lgkmcnt(4)
    v_add_u32 v241, 0x12000, v241
    v_mfma_f32_16x16x32_bf16 v[204:207], v[52:55], v[236:239], v[204:207]
    ds_read_b64_tr_b16 v[232:233], v242 offset:28672
    v_mfma_f32_16x16x32_bf16 v[200:203], v[48:51], v[236:239], v[200:203]
    ds_read_b64_tr_b16 v[234:235], v242 offset:29184
    s_waitcnt lgkmcnt(4)
    v_add_u32 v242, 0x12000, v242
    s_waitcnt vmcnt(11)
    v_mfma_f32_16x16x32_bf16 v[144:147], v[56:59], v[224:227], v[144:147]
    ds_read_b64_tr_b16 v[236:237], v243 offset:28672
    v_mfma_f32_16x16x32_bf16 v[148:151], v[60:63], v[224:227], v[148:151]
    ds_read_b64_tr_b16 v[238:239], v243 offset:29184
    s_waitcnt lgkmcnt(4)
    v_add_u32 v243, 0x12000, v243
    v_mfma_f32_16x16x32_bf16 v[156:159], v[60:63], v[228:231], v[156:159]
    ds_read_b64_tr_b16 v[224:225], v240 offset:28672
    buffer_load_dwordx4 v[108:111], v245, s[12:15], s34 offen offset:1024 sc1
    v_mfma_f32_16x16x32_bf16 v[152:155], v[56:59], v[228:231], v[152:155]
    ds_read_b64_tr_b16 v[226:227], v240 offset:29184
    s_waitcnt lgkmcnt(4)
    v_add_u32 v240, 0xfffee000, v240
    v_mfma_f32_16x16x32_bf16 v[160:163], v[56:59], v[232:235], v[160:163]
    ds_read_b64_tr_b16 v[228:229], v241 offset:28672
    v_mfma_f32_16x16x32_bf16 v[164:167], v[60:63], v[232:235], v[164:167]
    ds_read_b64_tr_b16 v[230:231], v241 offset:29184
    s_waitcnt lgkmcnt(4)
    v_add_u32 v241, 0xfffee000, v241
    v_mfma_f32_16x16x32_bf16 v[172:175], v[60:63], v[236:239], v[172:175]
    ds_read_b64_tr_b16 v[232:233], v242 offset:28672
    v_mfma_f32_16x16x32_bf16 v[168:171], v[56:59], v[236:239], v[168:171]
    ds_read_b64_tr_b16 v[234:235], v242 offset:29184
    s_waitcnt lgkmcnt(4)
    v_add_u32 v242, 0xfffee000, v242
    v_mfma_f32_16x16x32_bf16 v[176:179], v[56:59], v[224:227], v[176:179]
    ds_read_b64_tr_b16 v[236:237], v243 offset:28672
    s_add_u32 s34, s30, 57344
    buffer_load_dwordx4 v[112:115], v245, s[12:15], s34 offen offset:0 sc1
    v_mfma_f32_16x16x32_bf16 v[180:183], v[60:63], v[224:227], v[180:183]
    ds_read_b64_tr_b16 v[238:239], v243 offset:29184
    s_waitcnt lgkmcnt(4)
    v_add_u32 v243, 0xfffee000, v243
    v_mfma_f32_16x16x32_bf16 v[188:191], v[60:63], v[228:231], v[188:191]
    ds_read_b64_tr_b16 v[224:225], v240 offset:32768
    v_mfma_f32_16x16x32_bf16 v[184:187], v[56:59], v[228:231], v[184:187]
    ds_read_b64_tr_b16 v[226:227], v240 offset:33280
    s_waitcnt lgkmcnt(4)
    v_add_u32 v240, 0x12000, v240
    v_mfma_f32_16x16x32_bf16 v[192:195], v[56:59], v[232:235], v[192:195]
    ds_read_b64_tr_b16 v[228:229], v241 offset:32768
    v_mfma_f32_16x16x32_bf16 v[196:199], v[60:63], v[232:235], v[196:199]
    ds_read_b64_tr_b16 v[230:231], v241 offset:33280
    s_waitcnt lgkmcnt(4)
    v_add_u32 v241, 0x12000, v241
    v_mfma_f32_16x16x32_bf16 v[204:207], v[60:63], v[236:239], v[204:207]
    ds_read_b64_tr_b16 v[232:233], v242 offset:32768
    buffer_load_dwordx4 v[116:119], v245, s[12:15], s34 offen offset:1024 sc1
    v_mfma_f32_16x16x32_bf16 v[200:203], v[56:59], v[236:239], v[200:203]
    ds_read_b64_tr_b16 v[234:235], v242 offset:33280
    s_waitcnt lgkmcnt(4)
    v_add_u32 v242, 0x12000, v242
    s_waitcnt vmcnt(12)
    v_mfma_f32_16x16x32_bf16 v[144:147], v[64:67], v[224:227], v[144:147]
    ds_read_b64_tr_b16 v[236:237], v243 offset:32768
    v_mfma_f32_16x16x32_bf16 v[148:151], v[68:71], v[224:227], v[148:151]
    ds_read_b64_tr_b16 v[238:239], v243 offset:33280
    s_waitcnt lgkmcnt(4)
    v_add_u32 v243, 0x12000, v243
    v_mfma_f32_16x16x32_bf16 v[156:159], v[68:71], v[228:231], v[156:159]
    ds_read_b64_tr_b16 v[224:225], v240 offset:32768
    v_mfma_f32_16x16x32_bf16 v[152:155], v[64:67], v[228:231], v[152:155]
    ds_read_b64_tr_b16 v[226:227], v240 offset:33280
    s_waitcnt lgkmcnt(4)
    v_add_u32 v240, 0xffff7000, v240
    v_mfma_f32_16x16x32_bf16 v[160:163], v[64:67], v[232:235], v[160:163]
    ds_read_b64_tr_b16 v[228:229], v241 offset:32768
    s_add_u32 s34, s30, 61440
    buffer_load_dwordx4 v[120:123], v245, s[12:15], s34 offen offset:0 sc1
    v_mfma_f32_16x16x32_bf16 v[164:167], v[68:71], v[232:235], v[164:167]
    ds_read_b64_tr_b16 v[230:231], v241 offset:33280
    s_waitcnt lgkmcnt(4)
    v_add_u32 v241, 0xffff7000, v241
    v_mfma_f32_16x16x32_bf16 v[172:175], v[68:71], v[236:239], v[172:175]
    ds_read_b64_tr_b16 v[232:233], v242 offset:32768
    v_mfma_f32_16x16x32_bf16 v[168:171], v[64:67], v[236:239], v[168:171]
    ds_read_b64_tr_b16 v[234:235], v242 offset:33280
    s_waitcnt lgkmcnt(4)
    v_add_u32 v242, 0xffff7000, v242
    v_mfma_f32_16x16x32_bf16 v[176:179], v[64:67], v[224:227], v[176:179]
    ds_read_b64_tr_b16 v[236:237], v243 offset:32768
    v_mfma_f32_16x16x32_bf16 v[180:183], v[68:71], v[224:227], v[180:183]
    ds_read_b64_tr_b16 v[238:239], v243 offset:33280
    s_waitcnt lgkmcnt(4)
    v_add_u32 v243, 0xffff7000, v243
    v_mfma_f32_16x16x32_bf16 v[188:191], v[68:71], v[228:231], v[188:191]
    ds_read_b64_tr_b16 v[224:225], v240 offset:0
    buffer_load_dwordx4 v[124:127], v245, s[12:15], s34 offen offset:1024 sc1
    v_mfma_f32_16x16x32_bf16 v[184:187], v[64:67], v[228:231], v[184:187]
    ds_read_b64_tr_b16 v[226:227], v240 offset:512
    s_waitcnt lgkmcnt(4)
    v_mfma_f32_16x16x32_bf16 v[192:195], v[64:67], v[232:235], v[192:195]
    ds_read_b64_tr_b16 v[228:229], v241 offset:0
    v_mfma_f32_16x16x32_bf16 v[196:199], v[68:71], v[232:235], v[196:199]
    ds_read_b64_tr_b16 v[230:231], v241 offset:512
    s_waitcnt lgkmcnt(4)
    v_mfma_f32_16x16x32_bf16 v[204:207], v[68:71], v[236:239], v[204:207]
    ds_read_b64_tr_b16 v[232:233], v242 offset:0
    v_mfma_f32_16x16x32_bf16 v[200:203], v[64:67], v[236:239], v[200:203]
    ds_read_b64_tr_b16 v[234:235], v242 offset:512
    s_waitcnt lgkmcnt(4)
    s_cbranch_vccnz Lp10
    s_setprio 1
Lp10:
    s_waitcnt vmcnt(12)
    v_mfma_f32_16x16x32_bf16 v[144:147], v[72:75], v[224:227], v[144:147]
    ds_read_b64_tr_b16 v[236:237], v243 offset:0
    s_add_u32 s34, s30, 65536
    buffer_load_dwordx4 v[128:131], v245, s[12:15], s34 offen offset:0 sc1
    v_mfma_f32_16x16x32_bf16 v[148:151], v[76:79], v[224:227], v[148:151]
    ds_read_b64_tr_b16 v[238:239], v243 offset:512
    s_waitcnt lgkmcnt(4)
    v_mfma_f32_16x16x32_bf16 v[156:159], v[76:79], v[228:231], v[156:159]
    ds_read_b64_tr_b16 v[224:225], v240 offset:4096
    v_mfma_f32_16x16x32_bf16 v[152:155], v[72:75], v[228:231], v[152:155]
    ds_read_b64_tr_b16 v[226:227], v240 offset:4608
    s_waitcnt lgkmcnt(4)
    v_mfma_f32_16x16x32_bf16 v[160:163], v[72:75], v[232:235], v[160:163]
    ds_read_b64_tr_b16 v[228:229], v241 offset:4096
    v_mfma_f32_16x16x32_bf16 v[164:167], v[76:79], v[232:235], v[164:167]
    ds_read_b64_tr_b16 v[230:231], v241 offset:4608
    s_waitcnt lgkmcnt(4)
    v_mfma_f32_16x16x32_bf16 v[172:175], v[76:79], v[236:239], v[172:175]
    ds_read_b64_tr_b16 v[232:233], v242 offset:4096
    buffer_load_dwordx4 v[132:135], v245, s[12:15], s34 offen offset:1024 sc1
    v_mfma_f32_16x16x32_bf16 v[168:171], v[72:75], v[236:239], v[168:171]
    ds_read_b64_tr_b16 v[234:235], v242 offset:4608
    s_waitcnt lgkmcnt(4)
    s_waitcnt vmcnt(12)
    v_mfma_f32_16x16x32_bf16 v[144:147], v[80:83], v[224:227], v[144:147]
    ds_read_b64_tr_b16 v[236:237], v243 offset:4096
    v_mfma_f32_16x16x32_bf16 v[148:151], v[84:87], v[224:227], v[148:151]
    ds_read_b64_tr_b16 v[238:239], v243 offset:4608
    s_waitcnt lgkmcnt(4)
    v_mfma_f32_16x16x32_bf16 v[156:159], v[84:87], v[228:231], v[156:159]
    ds_read_b64_tr_b16 v[224:225], v240 offset:8192
    v_mfma_f32_16x16x32_bf16 v[152:155], v[80:83], v[228:231], v[152:155]
    ds_read_b64_tr_b16 v[226:227], v240 offset:8704
    s_waitcnt lgkmcnt(4)
    v_mfma_f32_16x16x32_bf16 v[160:163], v[80:83], v[232:235], v[160:163]
    ds_read_b64_tr_b16 v[228:229], v241 offset:8192
    s_add_u32 s34, s30, 69632
    buffer_load_dwordx4 v[136:139], v245, s[12:15], s34 offen offset:0 sc1
    v_mfma_f32_16x16x32_bf16 v[164:167], v[84:87], v[232:235], v[164:167]
    ds_read_b64_tr_b16 v[230:231], v241 offset:8704
    s_waitcnt lgkmcnt(4)
    v_mfma_f32_16x16x32_bf16 v[172:175], v[84:87], v[236:239], v[172:175]
    ds_read_b64_tr_b16 v[232:233], v242 offset:8192
    v_mfma_f32_16x16x32_bf16 v[168:171], v[80:83], v[236:239], v[168:171]
    ds_read_b64_tr_b16 v[234:235], v242 offset:8704
    s_waitcnt lgkmcnt(4)
    s_waitcnt vmcnt(11)
    v_mfma_f32_16x16x32_bf16 v[144:147], v[88:91], v[224:227], v[144:147]
    ds_read_b64_tr_b16 v[236:237], v243 offset:8192
    v_mfma_f32_16x16x32_bf16 v[148:151], v[92:95], v[224:227], v[148:151]
    ds_read_b64_tr_b16 v[238:239], v243 offset:8704
    s_waitcnt lgkmcnt(4)
    v_mfma_f32_16x16x32_bf16 v[156:159], v[92:95], v[228:231], v[156:159]
    ds_read_b64_tr_b16 v[224:225], v240 offset:12288
    buffer_load_dwordx4 v[140:143], v245, s[12:15], s34 offen offset:1024 sc1
    v_mfma_f32_16x16x32_bf16 v[152:155], v[88:91], v[228:231], v[152:155]
    ds_read_b64_tr_b16 v[226:227], v240 offset:12800
    s_waitcnt lgkmcnt(4)
    v_mfma_f32_16x16x32_bf16 v[160:163], v[88:91], v[232:235], v[160:163]
    ds_read_b64_tr_b16 v[228:229], v241 offset:12288
    buffer_load_dword v255, v255, s[60:63], s47 offen
    v_mfma_f32_16x16x32_bf16 v[164:167], v[92:95], v[232:235], v[164:167]
    ds_read_b64_tr_b16 v[230:231], v241 offset:12800
    s_waitcnt lgkmcnt(4)
    v_mfma_f32_16x16x32_bf16 v[172:175], v[92:95], v[236:239], v[172:175]
    ds_read_b64_tr_b16 v[232:233], v242 offset:12288
    buffer_load_dword v254, v254, s[64:67], 0 offen
    v_mfma_f32_16x16x32_bf16 v[168:171], v[88:91], v[236:239], v[168:171]
    ds_read_b64_tr_b16 v[234:235], v242 offset:12800
    s_waitcnt lgkmcnt(4)
    s_waitcnt vmcnt(12)
    v_mfma_f32_16x16x32_bf16 v[144:147], v[96:99], v[224:227], v[144:147]
    ds_read_b64_tr_b16 v[236:237], v243 offset:12288
    v_mfma_f32_16x16x32_bf16 v[148:151], v[100:103], v[224:227], v[148:151]
    ds_read_b64_tr_b16 v[238:239], v243 offset:12800
    s_waitcnt lgkmcnt(4)
    v_mfma_f32_16x16x32_bf16 v[156:159], v[100:103], v[228:231], v[156:159]
    ds_read_b64_tr_b16 v[224:225], v240 offset:16384
    v_mfma_f32_16x16x32_bf16 v[152:155], v[96:99], v[228:231], v[152:155]
    ds_read_b64_tr_b16 v[226:227], v240 offset:16896
    s_waitcnt lgkmcnt(4)
    v_mfma_f32_16x16x32_bf16 v[160:163], v[96:99], v[232:235], v[160:163]
    ds_read_b64_tr_b16 v[228:229], v241 offset:16384
    v_mfma_f32_16x16x32_bf16 v[164:167], v[100:103], v[232:235], v[164:167]
    ds_read_b64_tr_b16 v[230:231], v241 offset:16896
    s_waitcnt lgkmcnt(4)
    v_mfma_f32_16x16x32_bf16 v[172:175], v[100:103], v[236:239], v[172:175]
    ds_read_b64_tr_b16 v[232:233], v242 offset:16384
    v_mfma_f32_16x16x32_bf16 v[168:171], v[96:99], v[236:239], v[168:171]
    ds_read_b64_tr_b16 v[234:235], v242 offset:16896
    s_waitcnt lgkmcnt(4)
    s_waitcnt vmcnt(10)
    v_mfma_f32_16x16x32_bf16 v[144:147], v[104:107], v[224:227], v[144:147]
    ds_read_b64_tr_b16 v[236:237], v243 offset:16384
    v_mfma_f32_16x16x32_bf16 v[148:151], v[108:111], v[224:227], v[148:151]
    ds_read_b64_tr_b16 v[238:239], v243 offset:16896
    s_waitcnt lgkmcnt(4)
    v_mfma_f32_16x16x32_bf16 v[156:159], v[108:111], v[228:231], v[156:159]
    ds_read_b64_tr_b16 v[224:225], v240 offset:20480
    v_mfma_f32_16x16x32_bf16 v[152:155], v[104:107], v[228:231], v[152:155]
    ds_read_b64_tr_b16 v[226:227], v240 offset:20992
    s_waitcnt lgkmcnt(4)
    v_mfma_f32_16x16x32_bf16 v[160:163], v[104:107], v[232:235], v[160:163]
    ds_read_b64_tr_b16 v[228:229], v241 offset:20480
    v_mfma_f32_16x16x32_bf16 v[164:167], v[108:111], v[232:235], v[164:167]
    ds_read_b64_tr_b16 v[230:231], v241 offset:20992
    s_waitcnt lgkmcnt(4)
    v_mfma_f32_16x16x32_bf16 v[172:175], v[108:111], v[236:239], v[172:175]
    ds_read_b64_tr_b16 v[232:233], v242 offset:20480
    v_mfma_f32_16x16x32_bf16 v[168:171], v[104:107], v[236:239], v[168:171]
    ds_read_b64_tr_b16 v[234:235], v242 offset:20992
    s_waitcnt lgkmcnt(4)
    s_waitcnt vmcnt(8)
    v_mfma_f32_16x16x32_bf16 v[144:147], v[112:115], v[224:227], v[144:147]
    ds_read_b64_tr_b16 v[236:237], v243 offset:20480
    v_mfma_f32_16x16x32_bf16 v[148:151], v[116:119], v[224:227], v[148:151]
    ds_read_b64_tr_b16 v[238:239], v243 offset:20992
    s_waitcnt lgkmcnt(4)
    v_mfma_f32_16x16x32_bf16 v[156:159], v[116:119], v[228:231], v[156:159]
    ds_read_b64_tr_b16 v[224:225], v240 offset:24576
    v_mfma_f32_16x16x32_bf16 v[152:155], v[112:115], v[228:231], v[152:155]
    ds_read_b64_tr_b16 v[226:227], v240 offset:25088
    s_waitcnt lgkmcnt(4)
    v_mfma_f32_16x16x32_bf16 v[160:163], v[112:115], v[232:235], v[160:163]
    ds_read_b64_tr_b16 v[228:229], v241 offset:24576
    v_mfma_f32_16x16x32_bf16 v[164:167], v[116:119], v[232:235], v[164:167]
    ds_read_b64_tr_b16 v[230:231], v241 offset:25088
    s_waitcnt lgkmcnt(4)
    v_mfma_f32_16x16x32_bf16 v[172:175], v[116:119], v[236:239], v[172:175]
    ds_read_b64_tr_b16 v[232:233], v242 offset:24576
    v_mfma_f32_16x16x32_bf16 v[168:171], v[112:115], v[236:239], v[168:171]
    ds_read_b64_tr_b16 v[234:235], v242 offset:25088
    s_waitcnt lgkmcnt(4)
    s_waitcnt vmcnt(6)
    v_mfma_f32_16x16x32_bf16 v[144:147], v[120:123], v[224:227], v[144:147]
    ds_read_b64_tr_b16 v[236:237], v243 offset:24576
    v_mfma_f32_16x16x32_bf16 v[148:151], v[124:127], v[224:227], v[148:151]
    ds_read_b64_tr_b16 v[238:239], v243 offset:25088
    s_waitcnt lgkmcnt(4)
    v_mfma_f32_16x16x32_bf16 v[156:159], v[124:127], v[228:231], v[156:159]
    ds_read_b64_tr_b16 v[224:225], v240 offset:28672
    v_mfma_f32_16x16x32_bf16 v[152:155], v[120:123], v[228:231], v[152:155]
    ds_read_b64_tr_b16 v[226:227], v240 offset:29184
    s_waitcnt lgkmcnt(4)
    v_mfma_f32_16x16x32_bf16 v[160:163], v[120:123], v[232:235], v[160:163]
    ds_read_b64_tr_b16 v[228:229], v241 offset:28672
    v_mfma_f32_16x16x32_bf16 v[164:167], v[124:127], v[232:235], v[164:167]
    ds_read_b64_tr_b16 v[230:231], v241 offset:29184
    s_waitcnt lgkmcnt(4)
    v_mfma_f32_16x16x32_bf16 v[172:175], v[124:127], v[236:239], v[172:175]
    ds_read_b64_tr_b16 v[232:233], v242 offset:28672
    v_mfma_f32_16x16x32_bf16 v[168:171], v[120:123], v[236:239], v[168:171]
    ds_read_b64_tr_b16 v[234:235], v242 offset:29184
    s_waitcnt lgkmcnt(4)
    s_waitcnt vmcnt(4)
    v_mfma_f32_16x16x32_bf16 v[144:147], v[128:131], v[224:227], v[144:147]
    ds_read_b64_tr_b16 v[236:237], v243 offset:28672
    v_mfma_f32_16x16x32_bf16 v[148:151], v[132:135], v[224:227], v[148:151]
    ds_read_b64_tr_b16 v[238:239], v243 offset:29184
    s_waitcnt lgkmcnt(4)
    v_mfma_f32_16x16x32_bf16 v[156:159], v[132:135], v[228:231], v[156:159]
    ds_read_b64_tr_b16 v[224:225], v240 offset:32768
    v_mfma_f32_16x16x32_bf16 v[152:155], v[128:131], v[228:231], v[152:155]
    ds_read_b64_tr_b16 v[226:227], v240 offset:33280
    s_waitcnt lgkmcnt(4)
    v_add_u32 v240, 0x12000, v240
    v_mfma_f32_16x16x32_bf16 v[160:163], v[128:131], v[232:235], v[160:163]
    ds_read_b64_tr_b16 v[228:229], v241 offset:32768
    v_mfma_f32_16x16x32_bf16 v[164:167], v[132:135], v[232:235], v[164:167]
    ds_read_b64_tr_b16 v[230:231], v241 offset:33280
    s_waitcnt lgkmcnt(4)
    v_add_u32 v241, 0x12000, v241
    v_mfma_f32_16x16x32_bf16 v[172:175], v[132:135], v[236:239], v[172:175]
    ds_read_b64_tr_b16 v[232:233], v242 offset:32768
    v_mfma_f32_16x16x32_bf16 v[168:171], v[128:131], v[236:239], v[168:171]
    ds_read_b64_tr_b16 v[234:235], v242 offset:33280
    s_waitcnt lgkmcnt(4)
    v_add_u32 v242, 0x12000, v242
    s_waitcnt vmcnt(2)
    v_mfma_f32_16x16x32_bf16 v[144:147], v[136:139], v[224:227], v[144:147]
    ds_read_b64_tr_b16 v[236:237], v243 offset:32768
    v_mfma_f32_16x16x32_bf16 v[148:151], v[140:143], v[224:227], v[148:151]
    ds_read_b64_tr_b16 v[238:239], v243 offset:33280
    s_waitcnt lgkmcnt(4)
    v_add_u32 v243, 0x12000, v243
    v_mfma_f32_16x16x32_bf16 v[156:159], v[140:143], v[228:231], v[156:159]
    ds_read_b64_tr_b16 v[224:225], v240 offset:0
    v_mfma_f32_16x16x32_bf16 v[152:155], v[136:139], v[228:231], v[152:155]
    ds_read_b64_tr_b16 v[226:227], v240 offset:512
    s_waitcnt lgkmcnt(4)
    v_mfma_f32_16x16x32_bf16 v[160:163], v[136:139], v[232:235], v[160:163]
    ds_read_b64_tr_b16 v[228:229], v241 offset:0
    v_mfma_f32_16x16x32_bf16 v[164:167], v[140:143], v[232:235], v[164:167]
    ds_read_b64_tr_b16 v[230:231], v241 offset:512
    s_waitcnt lgkmcnt(4)
    v_mfma_f32_16x16x32_bf16 v[172:175], v[140:143], v[236:239], v[172:175]
    ds_read_b64_tr_b16 v[232:233], v242 offset:0
    v_mfma_f32_16x16x32_bf16 v[168:171], v[136:139], v[236:239], v[168:171]
    ds_read_b64_tr_b16 v[234:235], v242 offset:512
    s_waitcnt lgkmcnt(4)
    s_barrier
    v_mfma_f32_16x16x32_bf16 v[176:179], v[72:75], v[224:227], v[176:179]
    ds_read_b64_tr_b16 v[236:237], v243 offset:0
    v_mfma_f32_16x16x32_bf16 v[180:183], v[76:79], v[224:227], v[180:183]
    ds_read_b64_tr_b16 v[238:239], v243 offset:512
    s_waitcnt lgkmcnt(4)
    v_mfma_f32_16x16x32_bf16 v[188:191], v[76:79], v[228:231], v[188:191]
    ds_read_b64_tr_b16 v[224:225], v240 offset:4096
    s_add_u32 s25, s25, 144
    s_sub_u32 s26, s26, 1
    s_cmp_eq_u32 s26, 0
    s_cselect_b32 s18, 0, s18
    s_add_u32 m0, s29, 0
    s_mov_b32 s24, s25
    buffer_load_dwordx4 v244, s[16:19], s24 offen lds
    v_mfma_f32_16x16x32_bf16 v[184:187], v[72:75], v[228:231], v[184:187]
    ds_read_b64_tr_b16 v[226:227], v240 offset:4608
    s_waitcnt lgkmcnt(4)
    v_mfma_f32_16x16x32_bf16 v[192:195], v[72:75], v[232:235], v[192:195]
    ds_read_b64_tr_b16 v[228:229], v241 offset:4096
    s_add_u32 s32, s27, 0
    v_mfma_f32_16x16x32_bf16 v[196:199], v[76:79], v[232:235], v[196:199]
    ds_read_b64_tr_b16 v[230:231], v241 offset:4608
    s_waitcnt lgkmcnt(4)
    v_mfma_f32_16x16x32_bf16 v[204:207], v[76:79], v[236:239], v[204:207]
    ds_read_b64_tr_b16 v[232:233], v242 offset:4096
    v_cvt_pk_bf16_f32 v144, v144, v145
    v_mfma_f32_16x16x32_bf16 v[200:203], v[72:75], v[236:239], v[200:203]
    ds_read_b64_tr_b16 v[234:235], v242 offset:4608
    s_waitcnt lgkmcnt(4)
    v_mfma_f32_16x16x32_bf16 v[176:179], v[80:83], v[224:227], v[176:179]
    ds_read_b64_tr_b16 v[236:237], v243 offset:4096
    s_add_u32 m0, s29, 8192
    s_add_u32 s24, s24, s35
    buffer_load_dwordx4 v244, s[16:19], s24 offen lds
    v_cvt_pk_bf16_f32 v145, v146, v147
    v_mfma_f32_16x16x32_bf16 v[180:183], v[84:87], v[224:227], v[180:183]
    ds_read_b64_tr_b16 v[238:239], v243 offset:4608
    s_waitcnt lgkmcnt(4)
    v_mfma_f32_16x16x32_bf16 v[188:191], v[84:87], v[228:231], v[188:191]
    ds_read_b64_tr_b16 v[224:225], v240 offset:8192
    buffer_store_dwordx2 v[144:145], v246, s[12:15], s32 offen offset:0 sc1
    v_mfma_f32_16x16x32_bf16 v[184:187], v[80:83], v[228:231], v[184:187]
    ds_read_b64_tr_b16 v[226:227], v240 offset:8704
    s_waitcnt lgkmcnt(4)
    v_mfma_f32_16x16x32_bf16 v[192:195], v[80:83], v[232:235], v[192:195]
    ds_read_b64_tr_b16 v[228:229], v241 offset:8192
    v_cvt_pk_bf16_f32 v148, v148, v149
    v_mfma_f32_16x16x32_bf16 v[196:199], v[84:87], v[232:235], v[196:199]
    ds_read_b64_tr_b16 v[230:231], v241 offset:8704
    s_waitcnt lgkmcnt(4)
    v_mfma_f32_16x16x32_bf16 v[204:207], v[84:87], v[236:239], v[204:207]
    ds_read_b64_tr_b16 v[232:233], v242 offset:8192
    s_add_u32 m0, s29, 16384
    s_add_u32 s24, s24, s35
    buffer_load_dwordx4 v244, s[16:19], s24 offen lds
    v_cvt_pk_bf16_f32 v149, v150, v151
    v_mfma_f32_16x16x32_bf16 v[200:203], v[80:83], v[236:239], v[200:203]
    ds_read_b64_tr_b16 v[234:235], v242 offset:8704
    s_waitcnt lgkmcnt(4)
    v_mfma_f32_16x16x32_bf16 v[176:179], v[88:91], v[224:227], v[176:179]
    ds_read_b64_tr_b16 v[236:237], v243 offset:8192
    buffer_store_dwordx2 v[148:149], v246, s[12:15], s32 offen offset:640 sc1
    v_mfma_f32_16x16x32_bf16 v[180:183], v[92:95], v[224:227], v[180:183]
    ds_read_b64_tr_b16 v[238:239], v243 offset:8704
    s_waitcnt lgkmcnt(4)
    v_mfma_f32_16x16x32_bf16 v[188:191], v[92:95], v[228:231], v[188:191]
    ds_read_b64_tr_b16 v[224:225], v240 offset:12288
    v_mfma_f32_16x16x32_bf16 v[184:187], v[88:91], v[228:231], v[184:187]
    ds_read_b64_tr_b16 v[226:227], v240 offset:12800
    s_waitcnt lgkmcnt(4)
    s_add_u32 s32, s27, 81920
    v_mfma_f32_16x16x32_bf16 v[192:195], v[88:91], v[232:235], v[192:195]
    ds_read_b64_tr_b16 v[228:229], v241 offset:12288
    s_add_u32 m0, s29, 24576
    s_add_u32 s24, s24, s35
    buffer_load_dwordx4 v244, s[16:19], s24 offen lds
    v_mfma_f32_16x16x32_bf16 v[196:199], v[92:95], v[232:235], v[196:199]
    ds_read_b64_tr_b16 v[230:231], v241 offset:12800
    s_waitcnt lgkmcnt(4)
    v_cvt_pk_bf16_f32 v152, v152, v153
    v_mfma_f32_16x16x32_bf16 v[204:207], v[92:95], v[236:239], v[204:207]
    ds_read_b64_tr_b16 v[232:233], v242 offset:12288
    v_mfma_f32_16x16x32_bf16 v[200:203], v[88:91], v[236:239], v[200:203]
    ds_read_b64_tr_b16 v[234:235], v242 offset:12800
    s_waitcnt lgkmcnt(4)
    v_cvt_pk_bf16_f32 v153, v154, v155
    v_mfma_f32_16x16x32_bf16 v[176:179], v[96:99], v[224:227], v[176:179]
    ds_read_b64_tr_b16 v[236:237], v243 offset:12288
    v_mfma_f32_16x16x32_bf16 v[180:183], v[100:103], v[224:227], v[180:183]
    ds_read_b64_tr_b16 v[238:239], v243 offset:12800
    s_waitcnt lgkmcnt(4)
    buffer_store_dwordx2 v[152:153], v246, s[12:15], s32 offen offset:0 sc1
    v_mfma_f32_16x16x32_bf16 v[188:191], v[100:103], v[228:231], v[188:191]
    ds_read_b64_tr_b16 v[224:225], v240 offset:16384
    s_add_u32 m0, s29, 32768
    s_add_u32 s24, s24, s35
    buffer_load_dwordx4 v244, s[16:19], s24 offen lds
    v_mfma_f32_16x16x32_bf16 v[184:187], v[96:99], v[228:231], v[184:187]
    ds_read_b64_tr_b16 v[226:227], v240 offset:16896
    s_waitcnt lgkmcnt(4)
    v_cvt_pk_bf16_f32 v156, v156, v157
    v_mfma_f32_16x16x32_bf16 v[192:195], v[96:99], v[232:235], v[192:195]
    ds_read_b64_tr_b16 v[228:229], v241 offset:16384
    v_mfma_f32_16x16x32_bf16 v[196:199], v[100:103], v[232:235], v[196:199]
    ds_read_b64_tr_b16 v[230:231], v241 offset:16896
    s_waitcnt lgkmcnt(4)
    v_cvt_pk_bf16_f32 v157, v158, v159
    v_mfma_f32_16x16x32_bf16 v[204:207], v[100:103], v[236:239], v[204:207]
    ds_read_b64_tr_b16 v[232:233], v242 offset:16384
    v_mfma_f32_16x16x32_bf16 v[200:203], v[96:99], v[236:239], v[200:203]
    ds_read_b64_tr_b16 v[234:235], v242 offset:16896
    s_waitcnt lgkmcnt(4)
    buffer_store_dwordx2 v[156:157], v246, s[12:15], s32 offen offset:640 sc1
    s_setprio 0
    v_mfma_f32_16x16x32_bf16 v[176:179], v[104:107], v[224:227], v[176:179]
    ds_read_b64_tr_b16 v[236:237], v243 offset:16384
    s_add_u32 m0, s29, 40960
    s_add_u32 s24, s24, s35
    buffer_load_dwordx4 v244, s[16:19], s24 offen lds
    v_mfma_f32_16x16x32_bf16 v[180:183], v[108:111], v[224:227], v[180:183]
    ds_read_b64_tr_b16 v[238:239], v243 offset:16896
    s_waitcnt lgkmcnt(4)
    v_mfma_f32_16x16x32_bf16 v[188:191], v[108:111], v[228:231], v[188:191]
    ds_read_b64_tr_b16 v[224:225], v240 offset:20480
    s_add_u32 s32, s27, 163840
    v_mfma_f32_16x16x32_bf16 v[184:187], v[104:107], v[228:231], v[184:187]
    ds_read_b64_tr_b16 v[226:227], v240 offset:20992
    s_waitcnt lgkmcnt(4)
    v_mfma_f32_16x16x32_bf16 v[192:195], v[104:107], v[232:235], v[192:195]
    ds_read_b64_tr_b16 v[228:229], v241 offset:20480
    v_cvt_pk_bf16_f32 v160, v160, v161
    v_mfma_f32_16x16x32_bf16 v[196:199], v[108:111], v[232:235], v[196:199]
    ds_read_b64_tr_b16 v[230:231], v241 offset:20992
    s_waitcnt lgkmcnt(4)
    v_mfma_f32_16x16x32_bf16 v[204:207], v[108:111], v[236:239], v[204:207]
    ds_read_b64_tr_b16 v[232:233], v242 offset:20480
    s_add_u32 m0, s29, 49152
    s_add_u32 s24, s24, s35
    buffer_load_dwordx4 v244, s[16:19], s24 offen lds
    v_cvt_pk_bf16_f32 v161, v162, v163
    v_mfma_f32_16x16x32_bf16 v[200:203], v[104:107], v[236:239], v[200:203]
    ds_read_b64_tr_b16 v[234:235], v242 offset:20992
    s_waitcnt lgkmcnt(4)
    v_mfma_f32_16x16x32_bf16 v[176:179], v[112:115], v[224:227], v[176:179]
    ds_read_b64_tr_b16 v[236:237], v243 offset:20480
    buffer_store_dwordx2 v[160:161], v246, s[12:15], s32 offen offset:0 sc1
    v_mfma_f32_16x16x32_bf16 v[180:183], v[116:119], v[224:227], v[180:183]
    ds_read_b64_tr_b16 v[238:239], v243 offset:20992
    s_waitcnt lgkmcnt(4)
    v_mfma_f32_16x16x32_bf16 v[188:191], v[116:119], v[228:231], v[188:191]
    ds_read_b64_tr_b16 v[224:225], v240 offset:24576
    v_cvt_pk_bf16_f32 v164, v164, v165
    v_mfma_f32_16x16x32_bf16 v[184:187], v[112:115], v[228:231], v[184:187]
    ds_read_b64_tr_b16 v[226:227], v240 offset:25088
    s_waitcnt lgkmcnt(4)
    v_mfma_f32_16x16x32_bf16 v[192:195], v[112:115], v[232:235], v[192:195]
    ds_read_b64_tr_b16 v[228:229], v241 offset:24576
    s_add_u32 m0, s29, 57344
    s_add_u32 s24, s24, s35
    buffer_load_dwordx4 v244, s[16:19], s24 offen lds
    v_cvt_pk_bf16_f32 v165, v166, v167
    v_mfma_f32_16x16x32_bf16 v[196:199], v[116:119], v[232:235], v[196:199]
    ds_read_b64_tr_b16 v[230:231], v241 offset:25088
    s_waitcnt lgkmcnt(4)
    v_mfma_f32_16x16x32_bf16 v[204:207], v[116:119], v[236:239], v[204:207]
    ds_read_b64_tr_b16 v[232:233], v242 offset:24576
    buffer_store_dwordx2 v[164:165], v246, s[12:15], s32 offen offset:640 sc1
    v_mfma_f32_16x16x32_bf16 v[200:203], v[112:115], v[236:239], v[200:203]
    ds_read_b64_tr_b16 v[234:235], v242 offset:25088
    s_waitcnt lgkmcnt(4)
    v_mfma_f32_16x16x32_bf16 v[176:179], v[120:123], v[224:227], v[176:179]
    ds_read_b64_tr_b16 v[236:237], v243 offset:24576
    v_mfma_f32_16x16x32_bf16 v[180:183], v[124:127], v[224:227], v[180:183]
    ds_read_b64_tr_b16 v[238:239], v243 offset:25088
    s_waitcnt lgkmcnt(4)
    s_add_u32 s32, s27, 245760
    v_mfma_f32_16x16x32_bf16 v[188:191], v[124:127], v[228:231], v[188:191]
    ds_read_b64_tr_b16 v[224:225], v240 offset:28672
    s_add_u32 m0, s29, 65536
    s_add_u32 s24, s24, s35
    buffer_load_dwordx4 v244, s[16:19], s24 offen lds
    v_mfma_f32_16x16x32_bf16 v[184:187], v[120:123], v[228:231], v[184:187]
    ds_read_b64_tr_b16 v[226:227], v240 offset:29184
    s_waitcnt lgkmcnt(4)
    v_cvt_pk_bf16_f32 v168, v168, v169
    v_mfma_f32_16x16x32_bf16 v[192:195], v[120:123], v[232:235], v[192:195]
    ds_read_b64_tr_b16 v[228:229], v241 offset:28672
    v_mfma_f32_16x16x32_bf16 v[196:199], v[124:127], v[232:235], v[196:199]
    ds_read_b64_tr_b16 v[230:231], v241 offset:29184
    s_waitcnt lgkmcnt(4)
    v_cvt_pk_bf16_f32 v169, v170, v171
    v_mfma_f32_16x16x32_bf16 v[204:207], v[124:127], v[236:239], v[204:207]
    ds_read_b64_tr_b16 v[232:233], v242 offset:28672
    v_mfma_f32_16x16x32_bf16 v[200:203], v[120:123], v[236:239], v[200:203]
    ds_read_b64_tr_b16 v[234:235], v242 offset:29184
    s_waitcnt lgkmcnt(4)
    buffer_store_dwordx2 v[168:169], v246, s[12:15], s32 offen offset:0 sc1
    v_mfma_f32_16x16x32_bf16 v[176:179], v[128:131], v[224:227], v[176:179]
    ds_read_b64_tr_b16 v[236:237], v243 offset:28672
    v_mfma_f32_16x16x32_bf16 v[180:183], v[132:135], v[224:227], v[180:183]
    ds_read_b64_tr_b16 v[238:239], v243 offset:29184
    s_waitcnt lgkmcnt(4)
    v_cvt_pk_bf16_f32 v172, v172, v173
    v_mfma_f32_16x16x32_bf16 v[188:191], v[132:135], v[228:231], v[188:191]
    ds_read_b64_tr_b16 v[224:225], v240 offset:32768
    v_mfma_f32_16x16x32_bf16 v[184:187], v[128:131], v[228:231], v[184:187]
    ds_read_b64_tr_b16 v[226:227], v240 offset:33280
    s_waitcnt lgkmcnt(4)
    v_add_u32 v240, 0xfffe5000, v240
    v_cvt_pk_bf16_f32 v173, v174, v175
    v_mfma_f32_16x16x32_bf16 v[192:195], v[128:131], v[232:235], v[192:195]
    ds_read_b64_tr_b16 v[228:229], v241 offset:32768
    v_mfma_f32_16x16x32_bf16 v[196:199], v[132:135], v[232:235], v[196:199]
    ds_read_b64_tr_b16 v[230:231], v241 offset:33280
    s_waitcnt lgkmcnt(4)
    v_add_u32 v241, 0xfffe5000, v241
    buffer_store_dwordx2 v[172:173], v246, s[12:15], s32 offen offset:640 sc1
    v_mfma_f32_16x16x32_bf16 v[204:207], v[132:135], v[236:239], v[204:207]
    ds_read_b64_tr_b16 v[232:233], v242 offset:32768
    v_mfma_f32_16x16x32_bf16 v[200:203], v[128:131], v[236:239], v[200:203]
    ds_read_b64_tr_b16 v[234:235], v242 offset:33280
    s_waitcnt lgkmcnt(4)
    v_add_u32 v242, 0xfffe5000, v242
    v_mfma_f32_16x16x32_bf16 v[176:179], v[136:139], v[224:227], v[176:179]
    ds_read_b64_tr_b16 v[236:237], v243 offset:32768
    v_mfma_f32_16x16x32_bf16 v[180:183], v[140:143], v[224:227], v[180:183]
    ds_read_b64_tr_b16 v[238:239], v243 offset:33280
    s_waitcnt lgkmcnt(4)
    v_add_u32 v243, 0xfffe5000, v243
    s_waitcnt vmcnt(2)
    s_barrier
    v_mfma_f32_16x16x32_bf16 v[188:191], v[140:143], v[228:231], v[188:191]
    ds_read_b64_tr_b16 v[224:225], v240 offset:0
    v_mfma_f32_16x16x32_bf16 v[184:187], v[136:139], v[228:231], v[184:187]
    ds_read_b64_tr_b16 v[226:227], v240 offset:512
    s_waitcnt lgkmcnt(4)
    v_mfma_f32_16x16x32_bf16 v[192:195], v[136:139], v[232:235], v[192:195]
    ds_read_b64_tr_b16 v[228:229], v241 offset:0
    v_mfma_f32_16x16x32_bf16 v[196:199], v[140:143], v[232:235], v[196:199]
    ds_read_b64_tr_b16 v[230:231], v241 offset:512
    s_waitcnt lgkmcnt(4)
    v_mfma_f32_16x16x32_bf16 v[204:207], v[140:143], v[236:239], v[204:207]
    ds_read_b64_tr_b16 v[232:233], v242 offset:0
    v_mfma_f32_16x16x32_bf16 v[200:203], v[136:139], v[236:239], v[200:203]
    ds_read_b64_tr_b16 v[234:235], v242 offset:512
    s_waitcnt lgkmcnt(4)
    s_add_u32 s27, s27, 327680
.p2align 3
L1_v_loop:
    s_add_u32 s25, s25, 144
    s_cbranch_vccnz Lp11
    s_setprio 1
Lp11:
    v_mfma_f32_16x16x32_bf16 v[144:147], v[0:3], v[224:227], 0
    ds_read_b64_tr_b16 v[236:237], v243 offset:0
    v_mfma_f32_16x16x32_bf16 v[148:151], v[4:7], v[224:227], 0
    ds_read_b64_tr_b16 v[238:239], v243 offset:512
    s_waitcnt lgkmcnt(4)
    v_mfma_f32_16x16x32_bf16 v[156:159], v[4:7], v[228:231], 0
    ds_read_b64_tr_b16 v[224:225], v240 offset:4096
    s_add_u32 m0, s29, 73728
    s_mov_b32 s24, s25
    buffer_load_dwordx4 v244, s[20:23], s24 offen lds
    v_mfma_f32_16x16x32_bf16 v[152:155], v[0:3], v[228:231], 0
    ds_read_b64_tr_b16 v[226:227], v240 offset:4608
    s_waitcnt lgkmcnt(4)
    v_mfma_f32_16x16x32_bf16 v[160:163], v[0:3], v[232:235], 0
    ds_read_b64_tr_b16 v[228:229], v241 offset:4096
    s_add_u32 s32, s27, 0
    v_mfma_f32_16x16x32_bf16 v[164:167], v[4:7], v[232:235], 0
    ds_read_b64_tr_b16 v[230:231], v241 offset:4608
    s_waitcnt lgkmcnt(4)
    v_mfma_f32_16x16x32_bf16 v[172:175], v[4:7], v[236:239], 0
    ds_read_b64_tr_b16 v[232:233], v242 offset:4096
    v_mfma_f32_16x16x32_bf16 v[168:171], v[0:3], v[236:239], 0
    ds_read_b64_tr_b16 v[234:235], v242 offset:4608
    s_waitcnt lgkmcnt(4)
    v_mfma_f32_16x16x32_bf16 v[144:147], v[8:11], v[224:227], v[144:147]
    ds_read_b64_tr_b16 v[236:237], v243 offset:4096
    v_cvt_pk_bf16_f32 v176, v176, v177
    v_mfma_f32_16x16x32_bf16 v[148:151], v[12:15], v[224:227], v[148:151]
    ds_read_b64_tr_b16 v[238:239], v243 offset:4608
    s_waitcnt lgkmcnt(4)
    v_mfma_f32_16x16x32_bf16 v[156:159], v[12:15], v[228:231], v[156:159]
    ds_read_b64_tr_b16 v[224:225], v240 offset:8192
    v_mfma_f32_16x16x32_bf16 v[152:155], v[8:11], v[228:231], v[152:155]
    ds_read_b64_tr_b16 v[226:227], v240 offset:8704
    s_waitcnt lgkmcnt(4)
    v_mfma_f32_16x16x32_bf16 v[160:163], v[8:11], v[232:235], v[160:163]
    ds_read_b64_tr_b16 v[228:229], v241 offset:8192
    s_add_u32 m0, s29, 81920
    s_add_u32 s24, s24, s35
    buffer_load_dwordx4 v244, s[20:23], s24 offen lds
    v_mfma_f32_16x16x32_bf16 v[164:167], v[12:15], v[232:235], v[164:167]
    ds_read_b64_tr_b16 v[230:231], v241 offset:8704
    s_waitcnt lgkmcnt(4)
    v_cvt_pk_bf16_f32 v177, v178, v179
    v_mfma_f32_16x16x32_bf16 v[172:175], v[12:15], v[236:239], v[172:175]
    ds_read_b64_tr_b16 v[232:233], v242 offset:8192
    v_mfma_f32_16x16x32_bf16 v[168:171], v[8:11], v[236:239], v[168:171]
    ds_read_b64_tr_b16 v[234:235], v242 offset:8704
    s_waitcnt lgkmcnt(4)
    v_mfma_f32_16x16x32_bf16 v[144:147], v[16:19], v[224:227], v[144:147]
    ds_read_b64_tr_b16 v[236:237], v243 offset:8192
    v_mfma_f32_16x16x32_bf16 v[148:151], v[20:23], v[224:227], v[148:151]
    ds_read_b64_tr_b16 v[238:239], v243 offset:8704
    s_waitcnt lgkmcnt(4)
    v_mfma_f32_16x16x32_bf16 v[156:159], v[20:23], v[228:231], v[156:159]
    ds_read_b64_tr_b16 v[224:225], v240 offset:12288
    buffer_store_dwordx2 v[176:177], v246, s[12:15], s32 offen offset:0 sc1
    v_mfma_f32_16x16x32_bf16 v[152:155], v[16:19], v[228:231], v[152:155]
    ds_read_b64_tr_b16 v[226:227], v240 offset:12800
    s_waitcnt lgkmcnt(4)
    v_mfma_f32_16x16x32_bf16 v[160:163], v[16:19], v[232:235], v[160:163]
    ds_read_b64_tr_b16 v[228:229], v241 offset:12288
    v_mfma_f32_16x16x32_bf16 v[164:167], v[20:23], v[232:235], v[164:167]
    ds_read_b64_tr_b16 v[230:231], v241 offset:12800
    s_waitcnt lgkmcnt(4)
    v_mfma_f32_16x16x32_bf16 v[172:175], v[20:23], v[236:239], v[172:175]
    ds_read_b64_tr_b16 v[232:233], v242 offset:12288
    s_add_u32 m0, s29, 90112
    s_add_u32 s24, s24, s35
    buffer_load_dwordx4 v244, s[20:23], s24 offen lds
    v_cvt_pk_bf16_f32 v180, v180, v181
    v_mfma_f32_16x16x32_bf16 v[168:171], v[16:19], v[236:239], v[168:171]
    ds_read_b64_tr_b16 v[234:235], v242 offset:12800
    s_waitcnt lgkmcnt(4)
    v_mfma_f32_16x16x32_bf16 v[144:147], v[24:27], v[224:227], v[144:147]
    ds_read_b64_tr_b16 v[236:237], v243 offset:12288
    v_mfma_f32_16x16x32_bf16 v[148:151], v[28:31], v[224:227], v[148:151]
    ds_read_b64_tr_b16 v[238:239], v243 offset:12800
    s_waitcnt lgkmcnt(4)
    v_mfma_f32_16x16x32_bf16 v[156:159], v[28:31], v[228:231], v[156:159]
    ds_read_b64_tr_b16 v[224:225], v240 offset:16384
    v_mfma_f32_16x16x32_bf16 v[152:155], v[24:27], v[228:231], v[152:155]
    ds_read_b64_tr_b16 v[226:227], v240 offset:16896
    s_waitcnt lgkmcnt(4)
    v_cvt_pk_bf16_f32 v181, v182, v183
    v_mfma_f32_16x16x32_bf16 v[160:163], v[24:27], v[232:235], v[160:163]
    ds_read_b64_tr_b16 v[228:229], v241 offset:16384
    v_mfma_f32_16x16x32_bf16 v[164:167], v[28:31], v[232:235], v[164:167]
    ds_read_b64_tr_b16 v[230:231], v241 offset:16896
    s_waitcnt lgkmcnt(4)
    v_mfma_f32_16x16x32_bf16 v[172:175], v[28:31], v[236:239], v[172:175]
    ds_read_b64_tr_b16 v[232:233], v242 offset:16384
    v_mfma_f32_16x16x32_bf16 v[168:171], v[24:27], v[236:239], v[168:171]
    ds_read_b64_tr_b16 v[234:235], v242 offset:16896
    s_waitcnt lgkmcnt(4)
    v_mfma_f32_16x16x32_bf16 v[144:147], v[32:35], v[224:227], v[144:147]
    ds_read_b64_tr_b16 v[236:237], v243 offset:16384
    s_add_u32 m0, s29, 98304
    s_add_u32 s24, s24, s35
    buffer_load_dwordx4 v244, s[20:23], s24 offen lds
    buffer_store_dwordx2 v[180:181], v246, s[12:15], s32 offen offset:640 sc1
    v_mfma_f32_16x16x32_bf16 v[148:151], v[36:39], v[224:227], v[148:151]
    ds_read_b64_tr_b16 v[238:239], v243 offset:16896
    s_waitcnt lgkmcnt(4)
    v_mfma_f32_16x16x32_bf16 v[156:159], v[36:39], v[228:231], v[156:159]
    ds_read_b64_tr_b16 v[224:225], v240 offset:20480
    v_mfma_f32_16x16x32_bf16 v[152:155], v[32:35], v[228:231], v[152:155]
    ds_read_b64_tr_b16 v[226:227], v240 offset:20992
    s_waitcnt lgkmcnt(4)
    v_mfma_f32_16x16x32_bf16 v[160:163], v[32:35], v[232:235], v[160:163]
    ds_read_b64_tr_b16 v[228:229], v241 offset:20480
    v_mfma_f32_16x16x32_bf16 v[164:167], v[36:39], v[232:235], v[164:167]
    ds_read_b64_tr_b16 v[230:231], v241 offset:20992
    s_waitcnt lgkmcnt(4)
    s_add_u32 s32, s27, 81920
    v_mfma_f32_16x16x32_bf16 v[172:175], v[36:39], v[236:239], v[172:175]
    ds_read_b64_tr_b16 v[232:233], v242 offset:20480
    v_mfma_f32_16x16x32_bf16 v[168:171], v[32:35], v[236:239], v[168:171]
    ds_read_b64_tr_b16 v[234:235], v242 offset:20992
    s_waitcnt lgkmcnt(4)
    v_mfma_f32_16x16x32_bf16 v[144:147], v[40:43], v[224:227], v[144:147]
    ds_read_b64_tr_b16 v[236:237], v243 offset:20480
    v_mfma_f32_16x16x32_bf16 v[148:151], v[44:47], v[224:227], v[148:151]
    ds_read_b64_tr_b16 v[238:239], v243 offset:20992
    s_waitcnt lgkmcnt(4)
    v_cvt_pk_bf16_f32 v184, v184, v185
    v_mfma_f32_16x16x32_bf16 v[156:159], v[44:47], v[228:231], v[156:159]
    ds_read_b64_tr_b16 v[224:225], v240 offset:24576
    s_add_u32 m0, s29, 106496
    s_add_u32 s24, s24, s35
    buffer_load_dwordx4 v244, s[20:23], s24 offen lds
    v_mfma_f32_16x16x32_bf16 v[152:155], v[40:43], v[228:231], v[152:155]
    ds_read_b64_tr_b16 v[226:227], v240 offset:25088
    s_waitcnt lgkmcnt(4)
    v_mfma_f32_16x16x32_bf16 v[160:163], v[40:43], v[232:235], v[160:163]
    ds_read_b64_tr_b16 v[228:229], v241 offset:24576
    v_mfma_f32_16x16x32_bf16 v[164:167], v[44:47], v[232:235], v[164:167]
    ds_read_b64_tr_b16 v[230:231], v241 offset:25088
    s_waitcnt lgkmcnt(4)
    v_mfma_f32_16x16x32_bf16 v[172:175], v[44:47], v[236:239], v[172:175]
    ds_read_b64_tr_b16 v[232:233], v242 offset:24576
    v_cvt_pk_bf16_f32 v185, v186, v187
    v_mfma_f32_16x16x32_bf16 v[168:171], v[40:43], v[236:239], v[168:171]
    ds_read_b64_tr_b16 v[234:235], v242 offset:25088
    s_waitcnt lgkmcnt(4)
    v_mfma_f32_16x16x32_bf16 v[144:147], v[48:51], v[224:227], v[144:147]
    ds_read_b64_tr_b16 v[236:237], v243 offset:24576
    v_mfma_f32_16x16x32_bf16 v[148:151], v[52:55], v[224:227], v[148:151]
    ds_read_b64_tr_b16 v[238:239], v243 offset:25088
    s_waitcnt lgkmcnt(4)
    v_mfma_f32_16x16x32_bf16 v[156:159], v[52:55], v[228:231], v[156:159]
    ds_read_b64_tr_b16 v[224:225], v240 offset:28672
    v_mfma_f32_16x16x32_bf16 v[152:155], v[48:51], v[228:231], v[152:155]
    ds_read_b64_tr_b16 v[226:227], v240 offset:29184
    s_waitcnt lgkmcnt(4)
    buffer_store_dwordx2 v[184:185], v246, s[12:15], s32 offen offset:0 sc1
    v_mfma_f32_16x16x32_bf16 v[160:163], v[48:51], v[232:235], v[160:163]
    ds_read_b64_tr_b16 v[228:229], v241 offset:28672
    s_add_u32 m0, s29, 114688
    s_add_u32 s24, s24, s35
    buffer_load_dwordx4 v244, s[20:23], s24 offen lds
    v_mfma_f32_16x16x32_bf16 v[164:167], v[52:55], v[232:235], v[164:167]
    ds_read_b64_tr_b16 v[230:231], v241 offset:29184
    s_waitcnt lgkmcnt(4)
    v_mfma_f32_16x16x32_bf16 v[172:175], v[52:55], v[236:239], v[172:175]
    ds_read_b64_tr_b16 v[232:233], v242 offset:28672
    v_mfma_f32_16x16x32_bf16 v[168:171], v[48:51], v[236:239], v[168:171]
    ds_read_b64_tr_b16 v[234:235], v242 offset:29184
    s_waitcnt lgkmcnt(4)
    v_cvt_pk_bf16_f32 v188, v188, v189
    v_mfma_f32_16x16x32_bf16 v[144:147], v[56:59], v[224:227], v[144:147]
    ds_read_b64_tr_b16 v[236:237], v243 offset:28672
    v_mfma_f32_16x16x32_bf16 v[148:151], v[60:63], v[224:227], v[148:151]
    ds_read_b64_tr_b16 v[238:239], v243 offset:29184
    s_waitcnt lgkmcnt(4)
    v_mfma_f32_16x16x32_bf16 v[156:159], v[60:63], v[228:231], v[156:159]
    ds_read_b64_tr_b16 v[224:225], v240 offset:32768
    v_mfma_f32_16x16x32_bf16 v[152:155], v[56:59], v[228:231], v[152:155]
    ds_read_b64_tr_b16 v[226:227], v240 offset:33280
    s_waitcnt lgkmcnt(4)
    v_add_u32 v240, 0x9000, v240
    v_mfma_f32_16x16x32_bf16 v[160:163], v[56:59], v[232:235], v[160:163]
    ds_read_b64_tr_b16 v[228:229], v241 offset:32768
    v_cvt_pk_bf16_f32 v189, v190, v191
    v_mfma_f32_16x16x32_bf16 v[164:167], v[60:63], v[232:235], v[164:167]
    ds_read_b64_tr_b16 v[230:231], v241 offset:33280
    s_waitcnt lgkmcnt(4)
    v_add_u32 v241, 0x9000, v241
    v_mfma_f32_16x16x32_bf16 v[172:175], v[60:63], v[236:239], v[172:175]
    ds_read_b64_tr_b16 v[232:233], v242 offset:32768
    s_add_u32 m0, s29, 122880
    s_add_u32 s24, s24, s35
    buffer_load_dwordx4 v244, s[20:23], s24 offen lds
    v_mfma_f32_16x16x32_bf16 v[168:171], v[56:59], v[236:239], v[168:171]
    ds_read_b64_tr_b16 v[234:235], v242 offset:33280
    s_waitcnt lgkmcnt(4)
    v_add_u32 v242, 0x9000, v242
    v_mfma_f32_16x16x32_bf16 v[144:147], v[64:67], v[224:227], v[144:147]
    ds_read_b64_tr_b16 v[236:237], v243 offset:32768
    v_mfma_f32_16x16x32_bf16 v[148:151], v[68:71], v[224:227], v[148:151]
    ds_read_b64_tr_b16 v[238:239], v243 offset:33280
    s_waitcnt lgkmcnt(4)
    v_add_u32 v243, 0x9000, v243
    buffer_store_dwordx2 v[188:189], v246, s[12:15], s32 offen offset:640 sc1
    v_mfma_f32_16x16x32_bf16 v[156:159], v[68:71], v[228:231], v[156:159]
    ds_read_b64_tr_b16 v[224:225], v240 offset:0
    v_mfma_f32_16x16x32_bf16 v[152:155], v[64:67], v[228:231], v[152:155]
    ds_read_b64_tr_b16 v[226:227], v240 offset:512
    s_waitcnt lgkmcnt(4)
    v_mfma_f32_16x16x32_bf16 v[160:163], v[64:67], v[232:235], v[160:163]
    ds_read_b64_tr_b16 v[228:229], v241 offset:0
    v_mfma_f32_16x16x32_bf16 v[164:167], v[68:71], v[232:235], v[164:167]
    ds_read_b64_tr_b16 v[230:231], v241 offset:512
    s_waitcnt lgkmcnt(4)
    v_mfma_f32_16x16x32_bf16 v[172:175], v[68:71], v[236:239], v[172:175]
    ds_read_b64_tr_b16 v[232:233], v242 offset:0
    s_add_u32 s32, s27, 163840
    v_mfma_f32_16x16x32_bf16 v[168:171], v[64:67], v[236:239], v[168:171]
    ds_read_b64_tr_b16 v[234:235], v242 offset:512
    s_waitcnt lgkmcnt(4)
    v_mfma_f32_16x16x32_bf16 v[144:147], v[72:75], v[224:227], v[144:147]
    ds_read_b64_tr_b16 v[236:237], v243 offset:0
    s_add_u32 m0, s29, 131072
    s_add_u32 s24, s24, s35
    buffer_load_dwordx4 v244, s[20:23], s24 offen lds
    v_mfma_f32_16x16x32_bf16 v[148:151], v[76:79], v[224:227], v[148:151]
    ds_read_b64_tr_b16 v[238:239], v243 offset:512
    s_waitcnt lgkmcnt(4)
    v_mfma_f32_16x16x32_bf16 v[156:159], v[76:79], v[228:231], v[156:159]
    ds_read_b64_tr_b16 v[224:225], v240 offset:4096
    v_cvt_pk_bf16_f32 v192, v192, v193
    v_mfma_f32_16x16x32_bf16 v[152:155], v[72:75], v[228:231], v[152:155]
    ds_read_b64_tr_b16 v[226:227], v240 offset:4608
    s_waitcnt lgkmcnt(4)
    v_mfma_f32_16x16x32_bf16 v[160:163], v[72:75], v[232:235], v[160:163]
    ds_read_b64_tr_b16 v[228:229], v241 offset:4096
    v_mfma_f32_16x16x32_bf16 v[164:167], v[76:79], v[232:235], v[164:167]
    ds_read_b64_tr_b16 v[230:231], v241 offset:4608
    s_waitcnt lgkmcnt(4)
    v_mfma_f32_16x16x32_bf16 v[172:175], v[76:79], v[236:239], v[172:175]
    ds_read_b64_tr_b16 v[232:233], v242 offset:4096
    v_mfma_f32_16x16x32_bf16 v[168:171], v[72:75], v[236:239], v[168:171]
    ds_read_b64_tr_b16 v[234:235], v242 offset:4608
    s_waitcnt lgkmcnt(4)
    v_cvt_pk_bf16_f32 v193, v194, v195
    v_mfma_f32_16x16x32_bf16 v[144:147], v[80:83], v[224:227], v[144:147]
    ds_read_b64_tr_b16 v[236:237], v243 offset:4096
    v_mfma_f32_16x16x32_bf16 v[148:151], v[84:87], v[224:227], v[148:151]
    ds_read_b64_tr_b16 v[238:239], v243 offset:4608
    s_waitcnt lgkmcnt(4)
    v_mfma_f32_16x16x32_bf16 v[156:159], v[84:87], v[228:231], v[156:159]
    ds_read_b64_tr_b16 v[224:225], v240 offset:8192
    s_add_u32 m0, s29, 139264
    s_add_u32 s24, s24, s35
    buffer_load_dwordx4 v244, s[20:23], s24 offen lds
    v_mfma_f32_16x16x32_bf16 v[152:155], v[80:83], v[228:231], v[152:155]
    ds_read_b64_tr_b16 v[226:227], v240 offset:8704
    s_waitcnt lgkmcnt(4)
    v_mfma_f32_16x16x32_bf16 v[160:163], v[80:83], v[232:235], v[160:163]
    ds_read_b64_tr_b16 v[228:229], v241 offset:8192
    buffer_store_dwordx2 v[192:193], v246, s[12:15], s32 offen offset:0 sc1
    v_mfma_f32_16x16x32_bf16 v[164:167], v[84:87], v[232:235], v[164:167]
    ds_read_b64_tr_b16 v[230:231], v241 offset:8704
    s_waitcnt lgkmcnt(4)
    v_mfma_f32_16x16x32_bf16 v[172:175], v[84:87], v[236:239], v[172:175]
    ds_read_b64_tr_b16 v[232:233], v242 offset:8192
    v_mfma_f32_16x16x32_bf16 v[168:171], v[80:83], v[236:239], v[168:171]
    ds_read_b64_tr_b16 v[234:235], v242 offset:8704
    s_waitcnt lgkmcnt(4)
    v_mfma_f32_16x16x32_bf16 v[144:147], v[88:91], v[224:227], v[144:147]
    ds_read_b64_tr_b16 v[236:237], v243 offset:8192
    v_cvt_pk_bf16_f32 v196, v196, v197
    v_mfma_f32_16x16x32_bf16 v[148:151], v[92:95], v[224:227], v[148:151]
    ds_read_b64_tr_b16 v[238:239], v243 offset:8704
    s_waitcnt lgkmcnt(4)
    v_mfma_f32_16x16x32_bf16 v[156:159], v[92:95], v[228:231], v[156:159]
    ds_read_b64_tr_b16 v[224:225], v240 offset:12288
    v_mfma_f32_16x16x32_bf16 v[152:155], v[88:91], v[228:231], v[152:155]
    ds_read_b64_tr_b16 v[226:227], v240 offset:12800
    s_waitcnt lgkmcnt(4)
    v_mfma_f32_16x16x32_bf16 v[160:163], v[88:91], v[232:235], v[160:163]
    ds_read_b64_tr_b16 v[228:229], v241 offset:12288
    v_mfma_f32_16x16x32_bf16 v[164:167], v[92:95], v[232:235], v[164:167]
    ds_read_b64_tr_b16 v[230:231], v241 offset:12800
    s_waitcnt lgkmcnt(4)
    v_cvt_pk_bf16_f32 v197, v198, v199
    v_mfma_f32_16x16x32_bf16 v[172:175], v[92:95], v[236:239], v[172:175]
    ds_read_b64_tr_b16 v[232:233], v242 offset:12288
    v_mfma_f32_16x16x32_bf16 v[168:171], v[88:91], v[236:239], v[168:171]
    ds_read_b64_tr_b16 v[234:235], v242 offset:12800
    s_waitcnt lgkmcnt(4)
    v_mfma_f32_16x16x32_bf16 v[144:147], v[96:99], v[224:227], v[144:147]
    ds_read_b64_tr_b16 v[236:237], v243 offset:12288
    v_mfma_f32_16x16x32_bf16 v[148:151], v[100:103], v[224:227], v[148:151]
    ds_read_b64_tr_b16 v[238:239], v243 offset:12800
    s_waitcnt lgkmcnt(4)
    v_mfma_f32_16x16x32_bf16 v[156:159], v[100:103], v[228:231], v[156:159]
    ds_read_b64_tr_b16 v[224:225], v240 offset:16384
    buffer_store_dwordx2 v[196:197], v246, s[12:15], s32 offen offset:640 sc1
    v_mfma_f32_16x16x32_bf16 v[152:155], v[96:99], v[228:231], v[152:155]
    ds_read_b64_tr_b16 v[226:227], v240 offset:16896
    s_waitcnt lgkmcnt(4)
    v_mfma_f32_16x16x32_bf16 v[160:163], v[96:99], v[232:235], v[160:163]
    ds_read_b64_tr_b16 v[228:229], v241 offset:16384
    v_mfma_f32_16x16x32_bf16 v[164:167], v[100:103], v[232:235], v[164:167]
    ds_read_b64_tr_b16 v[230:231], v241 offset:16896
    s_waitcnt lgkmcnt(4)
    v_mfma_f32_16x16x32_bf16 v[172:175], v[100:103], v[236:239], v[172:175]
    ds_read_b64_tr_b16 v[232:233], v242 offset:16384
    v_mfma_f32_16x16x32_bf16 v[168:171], v[96:99], v[236:239], v[168:171]
    ds_read_b64_tr_b16 v[234:235], v242 offset:16896
    s_waitcnt lgkmcnt(4)
    s_add_u32 s32, s27, 245760
    s_setprio 0
    v_mfma_f32_16x16x32_bf16 v[144:147], v[104:107], v[224:227], v[144:147]
    ds_read_b64_tr_b16 v[236:237], v243 offset:16384
    v_mfma_f32_16x16x32_bf16 v[148:151], v[108:111], v[224:227], v[148:151]
    ds_read_b64_tr_b16 v[238:239], v243 offset:16896
    s_waitcnt lgkmcnt(4)
    v_mfma_f32_16x16x32_bf16 v[156:159], v[108:111], v[228:231], v[156:159]
    ds_read_b64_tr_b16 v[224:225], v240 offset:20480
    v_mfma_f32_16x16x32_bf16 v[152:155], v[104:107], v[228:231], v[152:155]
    ds_read_b64_tr_b16 v[226:227], v240 offset:20992
    s_waitcnt lgkmcnt(4)
    v_cvt_pk_bf16_f32 v200, v200, v201
    v_mfma_f32_16x16x32_bf16 v[160:163], v[104:107], v[232:235], v[160:163]
    ds_read_b64_tr_b16 v[228:229], v241 offset:20480
    v_mfma_f32_16x16x32_bf16 v[164:167], v[108:111], v[232:235], v[164:167]
    ds_read_b64_tr_b16 v[230:231], v241 offset:20992
    s_waitcnt lgkmcnt(4)
    v_mfma_f32_16x16x32_bf16 v[172:175], v[108:111], v[236:239], v[172:175]
    ds_read_b64_tr_b16 v[232:233], v242 offset:20480
    v_mfma_f32_16x16x32_bf16 v[168:171], v[104:107], v[236:239], v[168:171]
    ds_read_b64_tr_b16 v[234:235], v242 offset:20992
    s_waitcnt lgkmcnt(4)
    v_mfma_f32_16x16x32_bf16 v[144:147], v[112:115], v[224:227], v[144:147]
    ds_read_b64_tr_b16 v[236:237], v243 offset:20480
    v_cvt_pk_bf16_f32 v201, v202, v203
    v_mfma_f32_16x16x32_bf16 v[148:151], v[116:119], v[224:227], v[148:151]
    ds_read_b64_tr_b16 v[238:239], v243 offset:20992
    s_waitcnt lgkmcnt(4)
    v_mfma_f32_16x16x32_bf16 v[156:159], v[116:119], v[228:231], v[156:159]
    ds_read_b64_tr_b16 v[224:225], v240 offset:24576
    v_mfma_f32_16x16x32_bf16 v[152:155], v[112:115], v[228:231], v[152:155]
    ds_read_b64_tr_b16 v[226:227], v240 offset:25088
    s_waitcnt lgkmcnt(4)
    v_mfma_f32_16x16x32_bf16 v[160:163], v[112:115], v[232:235], v[160:163]
    ds_read_b64_tr_b16 v[228:229], v241 offset:24576
    v_mfma_f32_16x16x32_bf16 v[164:167], v[116:119], v[232:235], v[164:167]
    ds_read_b64_tr_b16 v[230:231], v241 offset:25088
    s_waitcnt lgkmcnt(4)
    buffer_store_dwordx2 v[200:201], v246, s[12:15], s32 offen offset:0 sc1
    v_mfma_f32_16x16x32_bf16 v[172:175], v[116:119], v[236:239], v[172:175]
    ds_read_b64_tr_b16 v[232:233], v242 offset:24576
    v_mfma_f32_16x16x32_bf16 v[168:171], v[112:115], v[236:239], v[168:171]
    ds_read_b64_tr_b16 v[234:235], v242 offset:25088
    s_waitcnt lgkmcnt(4)
    v_mfma_f32_16x16x32_bf16 v[144:147], v[120:123], v[224:227], v[144:147]
    ds_read_b64_tr_b16 v[236:237], v243 offset:24576
    v_mfma_f32_16x16x32_bf16 v[148:151], v[124:127], v[224:227], v[148:151]
    ds_read_b64_tr_b16 v[238:239], v243 offset:25088
    s_waitcnt lgkmcnt(4)
    v_cvt_pk_bf16_f32 v204, v204, v205
    v_mfma_f32_16x16x32_bf16 v[156:159], v[124:127], v[228:231], v[156:159]
    ds_read_b64_tr_b16 v[224:225], v240 offset:28672
    v_mfma_f32_16x16x32_bf16 v[152:155], v[120:123], v[228:231], v[152:155]
    ds_read_b64_tr_b16 v[226:227], v240 offset:29184
    s_waitcnt lgkmcnt(4)
    v_mfma_f32_16x16x32_bf16 v[160:163], v[120:123], v[232:235], v[160:163]
    ds_read_b64_tr_b16 v[228:229], v241 offset:28672
    v_mfma_f32_16x16x32_bf16 v[164:167], v[124:127], v[232:235], v[164:167]
    ds_read_b64_tr_b16 v[230:231], v241 offset:29184
    s_waitcnt lgkmcnt(4)
    v_mfma_f32_16x16x32_bf16 v[172:175], v[124:127], v[236:239], v[172:175]
    ds_read_b64_tr_b16 v[232:233], v242 offset:28672
    v_cvt_pk_bf16_f32 v205, v206, v207
    v_mfma_f32_16x16x32_bf16 v[168:171], v[120:123], v[236:239], v[168:171]
    ds_read_b64_tr_b16 v[234:235], v242 offset:29184
    s_waitcnt lgkmcnt(4)
    v_mfma_f32_16x16x32_bf16 v[144:147], v[128:131], v[224:227], v[144:147]
    ds_read_b64_tr_b16 v[236:237], v243 offset:28672
    v_mfma_f32_16x16x32_bf16 v[148:151], v[132:135], v[224:227], v[148:151]
    ds_read_b64_tr_b16 v[238:239], v243 offset:29184
    s_waitcnt lgkmcnt(4)
    v_mfma_f32_16x16x32_bf16 v[156:159], v[132:135], v[228:231], v[156:159]
    ds_read_b64_tr_b16 v[224:225], v240 offset:32768
    v_mfma_f32_16x16x32_bf16 v[152:155], v[128:131], v[228:231], v[152:155]
    ds_read_b64_tr_b16 v[226:227], v240 offset:33280
    s_waitcnt lgkmcnt(4)
    v_add_u32 v240, 0x9000, v240
    buffer_store_dwordx2 v[204:205], v246, s[12:15], s32 offen offset:640 sc1
    v_mfma_f32_16x16x32_bf16 v[160:163], v[128:131], v[232:235], v[160:163]
    ds_read_b64_tr_b16 v[228:229], v241 offset:32768
    v_mfma_f32_16x16x32_bf16 v[164:167], v[132:135], v[232:235], v[164:167]
    ds_read_b64_tr_b16 v[230:231], v241 offset:33280
    s_waitcnt lgkmcnt(4)
    v_add_u32 v241, 0x9000, v241
    v_mfma_f32_16x16x32_bf16 v[172:175], v[132:135], v[236:239], v[172:175]
    ds_read_b64_tr_b16 v[232:233], v242 offset:32768
    v_mfma_f32_16x16x32_bf16 v[168:171], v[128:131], v[236:239], v[168:171]
    ds_read_b64_tr_b16 v[234:235], v242 offset:33280
    s_waitcnt lgkmcnt(4)
    v_add_u32 v242, 0x9000, v242
    v_mfma_f32_16x16x32_bf16 v[144:147], v[136:139], v[224:227], v[144:147]
    ds_read_b64_tr_b16 v[236:237], v243 offset:32768
    v_mfma_f32_16x16x32_bf16 v[148:151], v[140:143], v[224:227], v[148:151]
    ds_read_b64_tr_b16 v[238:239], v243 offset:33280
    s_waitcnt lgkmcnt(4)
    v_add_u32 v243, 0x9000, v243
    s_waitcnt vmcnt(4)
    s_barrier
    v_mfma_f32_16x16x32_bf16 v[156:159], v[140:143], v[228:231], v[156:159]
    ds_read_b64_tr_b16 v[224:225], v240 offset:0
    v_mfma_f32_16x16x32_bf16 v[152:155], v[136:139], v[228:231], v[152:155]
    ds_read_b64_tr_b16 v[226:227], v240 offset:512
    s_waitcnt lgkmcnt(4)
    v_mfma_f32_16x16x32_bf16 v[160:163], v[136:139], v[232:235], v[160:163]
    ds_read_b64_tr_b16 v[228:229], v241 offset:0
    v_mfma_f32_16x16x32_bf16 v[164:167], v[140:143], v[232:235], v[164:167]
    ds_read_b64_tr_b16 v[230:231], v241 offset:512
    s_waitcnt lgkmcnt(4)
    v_mfma_f32_16x16x32_bf16 v[172:175], v[140:143], v[236:239], v[172:175]
    ds_read_b64_tr_b16 v[232:233], v242 offset:0
    v_mfma_f32_16x16x32_bf16 v[168:171], v[136:139], v[236:239], v[168:171]
    ds_read_b64_tr_b16 v[234:235], v242 offset:512
    s_waitcnt lgkmcnt(4)
    s_add_u32 s27, s27, 327680
    s_add_u32 s25, s25, 144
    s_sub_u32 s26, s26, 1
    s_cmp_eq_u32 s26, 0
    s_cselect_b32 s18, 0, s18
    s_mov_b32 s16, s64
    s_mov_b32 s17, s65
    s_mov_b32 s18, s66
    s_mov_b32 s25, s36
    s_mov_b32 s35, 8192
    v_add_u32 v244, s29, v245
    s_cbranch_vccnz Lp12
    s_setprio 1
Lp12:
    v_mfma_f32_16x16x32_bf16 v[176:179], v[0:3], v[224:227], 0
    ds_read_b64_tr_b16 v[236:237], v243 offset:0
    v_mfma_f32_16x16x32_bf16 v[180:183], v[4:7], v[224:227], 0
    ds_read_b64_tr_b16 v[238:239], v243 offset:512
    s_waitcnt lgkmcnt(4)
    v_mfma_f32_16x16x32_bf16 v[188:191], v[4:7], v[228:231], 0
    ds_read_b64_tr_b16 v[224:225], v240 offset:4096
    s_add_u32 m0, s29, 0
    s_mov_b32 s24, s25
    buffer_load_dwordx4 v244, s[16:19], s24 offen lds
    v_mfma_f32_16x16x32_bf16 v[184:187], v[0:3], v[228:231], 0
    ds_read_b64_tr_b16 v[226:227], v240 offset:4608
    s_waitcnt lgkmcnt(4)
    v_mfma_f32_16x16x32_bf16 v[192:195], v[0:3], v[232:235], 0
    ds_read_b64_tr_b16 v[228:229], v241 offset:4096
    s_add_u32 s32, s27, 0
    v_mfma_f32_16x16x32_bf16 v[196:199], v[4:7], v[232:235], 0
    ds_read_b64_tr_b16 v[230:231], v241 offset:4608
    s_waitcnt lgkmcnt(4)
    v_mfma_f32_16x16x32_bf16 v[204:207], v[4:7], v[236:239], 0
    ds_read_b64_tr_b16 v[232:233], v242 offset:4096
    v_mfma_f32_16x16x32_bf16 v[200:203], v[0:3], v[236:239], 0
    ds_read_b64_tr_b16 v[234:235], v242 offset:4608
    s_waitcnt lgkmcnt(4)
    v_mfma_f32_16x16x32_bf16 v[176:179], v[8:11], v[224:227], v[176:179]
    ds_read_b64_tr_b16 v[236:237], v243 offset:4096
    v_cvt_pk_bf16_f32 v144, v144, v145
    v_mfma_f32_16x16x32_bf16 v[180:183], v[12:15], v[224:227], v[180:183]
    ds_read_b64_tr_b16 v[238:239], v243 offset:4608
    s_waitcnt lgkmcnt(4)
    v_mfma_f32_16x16x32_bf16 v[188:191], v[12:15], v[228:231], v[188:191]
    ds_read_b64_tr_b16 v[224:225], v240 offset:8192
    v_mfma_f32_16x16x32_bf16 v[184:187], v[8:11], v[228:231], v[184:187]
    ds_read_b64_tr_b16 v[226:227], v240 offset:8704
    s_waitcnt lgkmcnt(4)
    v_mfma_f32_16x16x32_bf16 v[192:195], v[8:11], v[232:235], v[192:195]
    ds_read_b64_tr_b16 v[228:229], v241 offset:8192
    s_add_u32 m0, s29, 8192
    s_add_u32 s24, s24, s35
    buffer_load_dwordx4 v244, s[16:19], s24 offen lds
    v_mfma_f32_16x16x32_bf16 v[196:199], v[12:15], v[232:235], v[196:199]
    ds_read_b64_tr_b16 v[230:231], v241 offset:8704
    s_waitcnt lgkmcnt(4)
    v_cvt_pk_bf16_f32 v145, v146, v147
    v_mfma_f32_16x16x32_bf16 v[204:207], v[12:15], v[236:239], v[204:207]
    ds_read_b64_tr_b16 v[232:233], v242 offset:8192
    v_mfma_f32_16x16x32_bf16 v[200:203], v[8:11], v[236:239], v[200:203]
    ds_read_b64_tr_b16 v[234:235], v242 offset:8704
    s_waitcnt lgkmcnt(4)
    v_mfma_f32_16x16x32_bf16 v[176:179], v[16:19], v[224:227], v[176:179]
    ds_read_b64_tr_b16 v[236:237], v243 offset:8192
    v_mfma_f32_16x16x32_bf16 v[180:183], v[20:23], v[224:227], v[180:183]
    ds_read_b64_tr_b16 v[238:239], v243 offset:8704
    s_waitcnt lgkmcnt(4)
    v_mfma_f32_16x16x32_bf16 v[188:191], v[20:23], v[228:231], v[188:191]
    ds_read_b64_tr_b16 v[224:225], v240 offset:12288
    buffer_store_dwordx2 v[144:145], v246, s[12:15], s32 offen offset:0 sc1
    v_mfma_f32_16x16x32_bf16 v[184:187], v[16:19], v[228:231], v[184:187]
    ds_read_b64_tr_b16 v[226:227], v240 offset:12800
    s_waitcnt lgkmcnt(4)
    v_mfma_f32_16x16x32_bf16 v[192:195], v[16:19], v[232:235], v[192:195]
    ds_read_b64_tr_b16 v[228:229], v241 offset:12288
    v_mfma_f32_16x16x32_bf16 v[196:199], v[20:23], v[232:235], v[196:199]
    ds_read_b64_tr_b16 v[230:231], v241 offset:12800
    s_waitcnt lgkmcnt(4)
    v_mfma_f32_16x16x32_bf16 v[204:207], v[20:23], v[236:239], v[204:207]
    ds_read_b64_tr_b16 v[232:233], v242 offset:12288
    s_add_u32 m0, s29, 16384
    s_add_u32 s24, s24, s35
    buffer_load_dwordx4 v244, s[16:19], s24 offen lds
    v_cvt_pk_bf16_f32 v148, v148, v149
    v_mfma_f32_16x16x32_bf16 v[200:203], v[16:19], v[236:239], v[200:203]
    ds_read_b64_tr_b16 v[234:235], v242 offset:12800
    s_waitcnt lgkmcnt(4)
    v_mfma_f32_16x16x32_bf16 v[176:179], v[24:27], v[224:227], v[176:179]
    ds_read_b64_tr_b16 v[236:237], v243 offset:12288
    v_mfma_f32_16x16x32_bf16 v[180:183], v[28:31], v[224:227], v[180:183]
    ds_read_b64_tr_b16 v[238:239], v243 offset:12800
    s_waitcnt lgkmcnt(4)
    v_mfma_f32_16x16x32_bf16 v[188:191], v[28:31], v[228:231], v[188:191]
    ds_read_b64_tr_b16 v[224:225], v240 offset:16384
    v_mfma_f32_16x16x32_bf16 v[184:187], v[24:27], v[228:231], v[184:187]
    ds_read_b64_tr_b16 v[226:227], v240 offset:16896
    s_waitcnt lgkmcnt(4)
    v_cvt_pk_bf16_f32 v149, v150, v151
    v_mfma_f32_16x16x32_bf16 v[192:195], v[24:27], v[232:235], v[192:195]
    ds_read_b64_tr_b16 v[228:229], v241 offset:16384
    v_mfma_f32_16x16x32_bf16 v[196:199], v[28:31], v[232:235], v[196:199]
    ds_read_b64_tr_b16 v[230:231], v241 offset:16896
    s_waitcnt lgkmcnt(4)
    v_mfma_f32_16x16x32_bf16 v[204:207], v[28:31], v[236:239], v[204:207]
    ds_read_b64_tr_b16 v[232:233], v242 offset:16384
    v_mfma_f32_16x16x32_bf16 v[200:203], v[24:27], v[236:239], v[200:203]
    ds_read_b64_tr_b16 v[234:235], v242 offset:16896
    s_waitcnt lgkmcnt(4)
    v_mfma_f32_16x16x32_bf16 v[176:179], v[32:35], v[224:227], v[176:179]
    ds_read_b64_tr_b16 v[236:237], v243 offset:16384
    s_add_u32 m0, s29, 24576
    s_add_u32 s24, s24, s35
    buffer_load_dwordx4 v244, s[16:19], s24 offen lds
    buffer_store_dwordx2 v[148:149], v246, s[12:15], s32 offen offset:640 sc1
    v_mfma_f32_16x16x32_bf16 v[180:183], v[36:39], v[224:227], v[180:183]
    ds_read_b64_tr_b16 v[238:239], v243 offset:16896
    s_waitcnt lgkmcnt(4)
    v_mfma_f32_16x16x32_bf16 v[188:191], v[36:39], v[228:231], v[188:191]
    ds_read_b64_tr_b16 v[224:225], v240 offset:20480
    v_mfma_f32_16x16x32_bf16 v[184:187], v[32:35], v[228:231], v[184:187]
    ds_read_b64_tr_b16 v[226:227], v240 offset:20992
    s_waitcnt lgkmcnt(4)
    v_mfma_f32_16x16x32_bf16 v[192:195], v[32:35], v[232:235], v[192:195]
    ds_read_b64_tr_b16 v[228:229], v241 offset:20480
    v_mfma_f32_16x16x32_bf16 v[196:199], v[36:39], v[232:235], v[196:199]
    ds_read_b64_tr_b16 v[230:231], v241 offset:20992
    s_waitcnt lgkmcnt(4)
    s_add_u32 s32, s27, 81920
    v_mfma_f32_16x16x32_bf16 v[204:207], v[36:39], v[236:239], v[204:207]
    ds_read_b64_tr_b16 v[232:233], v242 offset:20480
    v_mfma_f32_16x16x32_bf16 v[200:203], v[32:35], v[236:239], v[200:203]
    ds_read_b64_tr_b16 v[234:235], v242 offset:20992
    s_waitcnt lgkmcnt(4)
    v_mfma_f32_16x16x32_bf16 v[176:179], v[40:43], v[224:227], v[176:179]
    ds_read_b64_tr_b16 v[236:237], v243 offset:20480
    v_mfma_f32_16x16x32_bf16 v[180:183], v[44:47], v[224:227], v[180:183]
    ds_read_b64_tr_b16 v[238:239], v243 offset:20992
    s_waitcnt lgkmcnt(4)
    v_cvt_pk_bf16_f32 v152, v152, v153
    v_mfma_f32_16x16x32_bf16 v[188:191], v[44:47], v[228:231], v[188:191]
    ds_read_b64_tr_b16 v[224:225], v240 offset:24576
    s_add_u32 m0, s29, 32768
    s_add_u32 s24, s24, s35
    buffer_load_dwordx4 v244, s[16:19], s24 offen lds
    v_mfma_f32_16x16x32_bf16 v[184:187], v[40:43], v[228:231], v[184:187]
    ds_read_b64_tr_b16 v[226:227], v240 offset:25088
    s_waitcnt lgkmcnt(4)
    v_mfma_f32_16x16x32_bf16 v[192:195], v[40:43], v[232:235], v[192:195]
    ds_read_b64_tr_b16 v[228:229], v241 offset:24576
    v_mfma_f32_16x16x32_bf16 v[196:199], v[44:47], v[232:235], v[196:199]
    ds_read_b64_tr_b16 v[230:231], v241 offset:25088
    s_waitcnt lgkmcnt(4)
    v_mfma_f32_16x16x32_bf16 v[204:207], v[44:47], v[236:239], v[204:207]
    ds_read_b64_tr_b16 v[232:233], v242 offset:24576
    v_cvt_pk_bf16_f32 v153, v154, v155
    v_mfma_f32_16x16x32_bf16 v[200:203], v[40:43], v[236:239], v[200:203]
    ds_read_b64_tr_b16 v[234:235], v242 offset:25088
    s_waitcnt lgkmcnt(4)
    v_mfma_f32_16x16x32_bf16 v[176:179], v[48:51], v[224:227], v[176:179]
    ds_read_b64_tr_b16 v[236:237], v243 offset:24576
    v_mfma_f32_16x16x32_bf16 v[180:183], v[52:55], v[224:227], v[180:183]
    ds_read_b64_tr_b16 v[238:239], v243 offset:25088
    s_waitcnt lgkmcnt(4)
    v_mfma_f32_16x16x32_bf16 v[188:191], v[52:55], v[228:231], v[188:191]
    ds_read_b64_tr_b16 v[224:225], v240 offset:28672
    v_mfma_f32_16x16x32_bf16 v[184:187], v[48:51], v[228:231], v[184:187]
    ds_read_b64_tr_b16 v[226:227], v240 offset:29184
    s_waitcnt lgkmcnt(4)
    buffer_store_dwordx2 v[152:153], v246, s[12:15], s32 offen offset:0 sc1
    v_mfma_f32_16x16x32_bf16 v[192:195], v[48:51], v[232:235], v[192:195]
    ds_read_b64_tr_b16 v[228:229], v241 offset:28672
    s_add_u32 m0, s29, 40960
    s_add_u32 s24, s24, s35
    buffer_load_dwordx4 v244, s[16:19], s24 offen lds
    v_mfma_f32_16x16x32_bf16 v[196:199], v[52:55], v[232:235], v[196:199]
    ds_read_b64_tr_b16 v[230:231], v241 offset:29184
    s_waitcnt lgkmcnt(4)
    v_mfma_f32_16x16x32_bf16 v[204:207], v[52:55], v[236:239], v[204:207]
    ds_read_b64_tr_b16 v[232:233], v242 offset:28672
    v_mfma_f32_16x16x32_bf16 v[200:203], v[48:51], v[236:239], v[200:203]
    ds_read_b64_tr_b16 v[234:235], v242 offset:29184
    s_waitcnt lgkmcnt(4)
    v_cvt_pk_bf16_f32 v156, v156, v157
    v_mfma_f32_16x16x32_bf16 v[176:179], v[56:59], v[224:227], v[176:179]
    ds_read_b64_tr_b16 v[236:237], v243 offset:28672
    v_mfma_f32_16x16x32_bf16 v[180:183], v[60:63], v[224:227], v[180:183]
    ds_read_b64_tr_b16 v[238:239], v243 offset:29184
    s_waitcnt lgkmcnt(4)
    v_mfma_f32_16x16x32_bf16 v[188:191], v[60:63], v[228:231], v[188:191]
    ds_read_b64_tr_b16 v[224:225], v240 offset:32768
    v_mfma_f32_16x16x32_bf16 v[184:187], v[56:59], v[228:231], v[184:187]
    ds_read_b64_tr_b16 v[226:227], v240 offset:33280
    s_waitcnt lgkmcnt(4)
    v_add_u32 v240, 0x9000, v240
    v_mfma_f32_16x16x32_bf16 v[192:195], v[56:59], v[232:235], v[192:195]
    ds_read_b64_tr_b16 v[228:229], v241 offset:32768
    v_cvt_pk_bf16_f32 v157, v158, v159
    v_mfma_f32_16x16x32_bf16 v[196:199], v[60:63], v[232:235], v[196:199]
    ds_read_b64_tr_b16 v[230:231], v241 offset:33280
    s_waitcnt lgkmcnt(4)
    v_add_u32 v241, 0x9000, v241
    v_mfma_f32_16x16x32_bf16 v[204:207], v[60:63], v[236:239], v[204:207]
    ds_read_b64_tr_b16 v[232:233], v242 offset:32768
    s_add_u32 m0, s29, 49152
    s_add_u32 s24, s24, s35
    buffer_load_dwordx4 v244, s[16:19], s24 offen lds
    v_mfma_f32_16x16x32_bf16 v[200:203], v[56:59], v[236:239], v[200:203]
    ds_read_b64_tr_b16 v[234:235], v242 offset:33280
    s_waitcnt lgkmcnt(4)
    v_add_u32 v242, 0x9000, v242
    v_mfma_f32_16x16x32_bf16 v[176:179], v[64:67], v[224:227], v[176:179]
    ds_read_b64_tr_b16 v[236:237], v243 offset:32768
    v_mfma_f32_16x16x32_bf16 v[180:183], v[68:71], v[224:227], v[180:183]
    ds_read_b64_tr_b16 v[238:239], v243 offset:33280
    s_waitcnt lgkmcnt(4)
    v_add_u32 v243, 0x9000, v243
    buffer_store_dwordx2 v[156:157], v246, s[12:15], s32 offen offset:640 sc1
    v_mfma_f32_16x16x32_bf16 v[188:191], v[68:71], v[228:231], v[188:191]
    ds_read_b64_tr_b16 v[224:225], v240 offset:0
    v_mfma_f32_16x16x32_bf16 v[184:187], v[64:67], v[228:231], v[184:187]
    ds_read_b64_tr_b16 v[226:227], v240 offset:512
    s_waitcnt lgkmcnt(4)
    v_mfma_f32_16x16x32_bf16 v[192:195], v[64:67], v[232:235], v[192:195]
    ds_read_b64_tr_b16 v[228:229], v241 offset:0
    v_mfma_f32_16x16x32_bf16 v[196:199], v[68:71], v[232:235], v[196:199]
    ds_read_b64_tr_b16 v[230:231], v241 offset:512
    s_waitcnt lgkmcnt(4)
    v_mfma_f32_16x16x32_bf16 v[204:207], v[68:71], v[236:239], v[204:207]
    ds_read_b64_tr_b16 v[232:233], v242 offset:0
    s_add_u32 s32, s27, 163840
    v_mfma_f32_16x16x32_bf16 v[200:203], v[64:67], v[236:239], v[200:203]
    ds_read_b64_tr_b16 v[234:235], v242 offset:512
    s_waitcnt lgkmcnt(4)
    v_mfma_f32_16x16x32_bf16 v[176:179], v[72:75], v[224:227], v[176:179]
    ds_read_b64_tr_b16 v[236:237], v243 offset:0
    s_add_u32 m0, s29, 57344
    s_add_u32 s24, s24, s35
    buffer_load_dwordx4 v244, s[16:19], s24 offen lds
    v_mfma_f32_16x16x32_bf16 v[180:183], v[76:79], v[224:227], v[180:183]
    ds_read_b64_tr_b16 v[238:239], v243 offset:512
    s_waitcnt lgkmcnt(4)
    v_mfma_f32_16x16x32_bf16 v[188:191], v[76:79], v[228:231], v[188:191]
    ds_read_b64_tr_b16 v[224:225], v240 offset:4096
    v_cvt_pk_bf16_f32 v160, v160, v161
    v_mfma_f32_16x16x32_bf16 v[184:187], v[72:75], v[228:231], v[184:187]
    ds_read_b64_tr_b16 v[226:227], v240 offset:4608
    s_waitcnt lgkmcnt(4)
    v_mfma_f32_16x16x32_bf16 v[192:195], v[72:75], v[232:235], v[192:195]
    ds_read_b64_tr_b16 v[228:229], v241 offset:4096
    v_mfma_f32_16x16x32_bf16 v[196:199], v[76:79], v[232:235], v[196:199]
    ds_read_b64_tr_b16 v[230:231], v241 offset:4608
    s_waitcnt lgkmcnt(4)
    v_mfma_f32_16x16x32_bf16 v[204:207], v[76:79], v[236:239], v[204:207]
    ds_read_b64_tr_b16 v[232:233], v242 offset:4096
    v_mfma_f32_16x16x32_bf16 v[200:203], v[72:75], v[236:239], v[200:203]
    ds_read_b64_tr_b16 v[234:235], v242 offset:4608
    s_waitcnt lgkmcnt(4)
    v_cvt_pk_bf16_f32 v161, v162, v163
    v_mfma_f32_16x16x32_bf16 v[176:179], v[80:83], v[224:227], v[176:179]
    ds_read_b64_tr_b16 v[236:237], v243 offset:4096
    v_mfma_f32_16x16x32_bf16 v[180:183], v[84:87], v[224:227], v[180:183]
    ds_read_b64_tr_b16 v[238:239], v243 offset:4608
    s_waitcnt lgkmcnt(4)
    v_mfma_f32_16x16x32_bf16 v[188:191], v[84:87], v[228:231], v[188:191]
    ds_read_b64_tr_b16 v[224:225], v240 offset:8192
    s_add_u32 m0, s29, 65536
    s_add_u32 s24, s24, s35
    buffer_load_dwordx4 v244, s[16:19], s24 offen lds
    v_mfma_f32_16x16x32_bf16 v[184:187], v[80:83], v[228:231], v[184:187]
    ds_read_b64_tr_b16 v[226:227], v240 offset:8704
    s_waitcnt lgkmcnt(4)
    v_mfma_f32_16x16x32_bf16 v[192:195], v[80:83], v[232:235], v[192:195]
    ds_read_b64_tr_b16 v[228:229], v241 offset:8192
    buffer_store_dwordx2 v[160:161], v246, s[12:15], s32 offen offset:0 sc1
    v_mfma_f32_16x16x32_bf16 v[196:199], v[84:87], v[232:235], v[196:199]
    ds_read_b64_tr_b16 v[230:231], v241 offset:8704
    s_waitcnt lgkmcnt(4)
    v_mfma_f32_16x16x32_bf16 v[204:207], v[84:87], v[236:239], v[204:207]
    ds_read_b64_tr_b16 v[232:233], v242 offset:8192
    v_mfma_f32_16x16x32_bf16 v[200:203], v[80:83], v[236:239], v[200:203]
    ds_read_b64_tr_b16 v[234:235], v242 offset:8704
    s_waitcnt lgkmcnt(4)
    v_mfma_f32_16x16x32_bf16 v[176:179], v[88:91], v[224:227], v[176:179]
    ds_read_b64_tr_b16 v[236:237], v243 offset:8192
    v_cvt_pk_bf16_f32 v164, v164, v165
    v_mfma_f32_16x16x32_bf16 v[180:183], v[92:95], v[224:227], v[180:183]
    ds_read_b64_tr_b16 v[238:239], v243 offset:8704
    s_waitcnt lgkmcnt(4)
    v_mfma_f32_16x16x32_bf16 v[188:191], v[92:95], v[228:231], v[188:191]
    ds_read_b64_tr_b16 v[224:225], v240 offset:12288
    v_mfma_f32_16x16x32_bf16 v[184:187], v[88:91], v[228:231], v[184:187]
    ds_read_b64_tr_b16 v[226:227], v240 offset:12800
    s_waitcnt lgkmcnt(4)
    v_mfma_f32_16x16x32_bf16 v[192:195], v[88:91], v[232:235], v[192:195]
    ds_read_b64_tr_b16 v[228:229], v241 offset:12288
    v_mfma_f32_16x16x32_bf16 v[196:199], v[92:95], v[232:235], v[196:199]
    ds_read_b64_tr_b16 v[230:231], v241 offset:12800
    s_waitcnt lgkmcnt(4)
    v_cvt_pk_bf16_f32 v165, v166, v167
    v_mfma_f32_16x16x32_bf16 v[204:207], v[92:95], v[236:239], v[204:207]
    ds_read_b64_tr_b16 v[232:233], v242 offset:12288
    v_mfma_f32_16x16x32_bf16 v[200:203], v[88:91], v[236:239], v[200:203]
    ds_read_b64_tr_b16 v[234:235], v242 offset:12800
    s_waitcnt lgkmcnt(4)
    v_mfma_f32_16x16x32_bf16 v[176:179], v[96:99], v[224:227], v[176:179]
    ds_read_b64_tr_b16 v[236:237], v243 offset:12288
    v_mfma_f32_16x16x32_bf16 v[180:183], v[100:103], v[224:227], v[180:183]
    ds_read_b64_tr_b16 v[238:239], v243 offset:12800
    s_waitcnt lgkmcnt(4)
    v_mfma_f32_16x16x32_bf16 v[188:191], v[100:103], v[228:231], v[188:191]
    ds_read_b64_tr_b16 v[224:225], v240 offset:16384
    buffer_store_dwordx2 v[164:165], v246, s[12:15], s32 offen offset:640 sc1
    v_mfma_f32_16x16x32_bf16 v[184:187], v[96:99], v[228:231], v[184:187]
    ds_read_b64_tr_b16 v[226:227], v240 offset:16896
    s_waitcnt lgkmcnt(4)
    v_mfma_f32_16x16x32_bf16 v[192:195], v[96:99], v[232:235], v[192:195]
    ds_read_b64_tr_b16 v[228:229], v241 offset:16384
    v_mfma_f32_16x16x32_bf16 v[196:199], v[100:103], v[232:235], v[196:199]
    ds_read_b64_tr_b16 v[230:231], v241 offset:16896
    s_waitcnt lgkmcnt(4)
    v_mfma_f32_16x16x32_bf16 v[204:207], v[100:103], v[236:239], v[204:207]
    ds_read_b64_tr_b16 v[232:233], v242 offset:16384
    v_mfma_f32_16x16x32_bf16 v[200:203], v[96:99], v[236:239], v[200:203]
    ds_read_b64_tr_b16 v[234:235], v242 offset:16896
    s_waitcnt lgkmcnt(4)
    s_add_u32 s32, s27, 245760
    s_setprio 0
    v_mfma_f32_16x16x32_bf16 v[176:179], v[104:107], v[224:227], v[176:179]
    ds_read_b64_tr_b16 v[236:237], v243 offset:16384
    v_mfma_f32_16x16x32_bf16 v[180:183], v[108:111], v[224:227], v[180:183]
    ds_read_b64_tr_b16 v[238:239], v243 offset:16896
    s_waitcnt lgkmcnt(4)
    v_mfma_f32_16x16x32_bf16 v[188:191], v[108:111], v[228:231], v[188:191]
    ds_read_b64_tr_b16 v[224:225], v240 offset:20480
    v_mfma_f32_16x16x32_bf16 v[184:187], v[104:107], v[228:231], v[184:187]
    ds_read_b64_tr_b16 v[226:227], v240 offset:20992
    s_waitcnt lgkmcnt(4)
    v_cvt_pk_bf16_f32 v168, v168, v169
    v_mfma_f32_16x16x32_bf16 v[192:195], v[104:107], v[232:235], v[192:195]
    ds_read_b64_tr_b16 v[228:229], v241 offset:20480
    v_mfma_f32_16x16x32_bf16 v[196:199], v[108:111], v[232:235], v[196:199]
    ds_read_b64_tr_b16 v[230:231], v241 offset:20992
    s_waitcnt lgkmcnt(4)
    v_mfma_f32_16x16x32_bf16 v[204:207], v[108:111], v[236:239], v[204:207]
    ds_read_b64_tr_b16 v[232:233], v242 offset:20480
    v_mfma_f32_16x16x32_bf16 v[200:203], v[104:107], v[236:239], v[200:203]
    ds_read_b64_tr_b16 v[234:235], v242 offset:20992
    s_waitcnt lgkmcnt(4)
    v_mfma_f32_16x16x32_bf16 v[176:179], v[112:115], v[224:227], v[176:179]
    ds_read_b64_tr_b16 v[236:237], v243 offset:20480
    v_cvt_pk_bf16_f32 v169, v170, v171
    v_mfma_f32_16x16x32_bf16 v[180:183], v[116:119], v[224:227], v[180:183]
    ds_read_b64_tr_b16 v[238:239], v243 offset:20992
    s_waitcnt lgkmcnt(4)
    v_mfma_f32_16x16x32_bf16 v[188:191], v[116:119], v[228:231], v[188:191]
    ds_read_b64_tr_b16 v[224:225], v240 offset:24576
    v_mfma_f32_16x16x32_bf16 v[184:187], v[112:115], v[228:231], v[184:187]
    ds_read_b64_tr_b16 v[226:227], v240 offset:25088
    s_waitcnt lgkmcnt(4)
    v_mfma_f32_16x16x32_bf16 v[192:195], v[112:115], v[232:235], v[192:195]
    ds_read_b64_tr_b16 v[228:229], v241 offset:24576
    v_mfma_f32_16x16x32_bf16 v[196:199], v[116:119], v[232:235], v[196:199]
    ds_read_b64_tr_b16 v[230:231], v241 offset:25088
    s_waitcnt lgkmcnt(4)
    buffer_store_dwordx2 v[168:169], v246, s[12:15], s32 offen offset:0 sc1
    v_mfma_f32_16x16x32_bf16 v[204:207], v[116:119], v[236:239], v[204:207]
    ds_read_b64_tr_b16 v[232:233], v242 offset:24576
    v_mfma_f32_16x16x32_bf16 v[200:203], v[112:115], v[236:239], v[200:203]
    ds_read_b64_tr_b16 v[234:235], v242 offset:25088
    s_waitcnt lgkmcnt(4)
    v_mfma_f32_16x16x32_bf16 v[176:179], v[120:123], v[224:227], v[176:179]
    ds_read_b64_tr_b16 v[236:237], v243 offset:24576
    v_mfma_f32_16x16x32_bf16 v[180:183], v[124:127], v[224:227], v[180:183]
    ds_read_b64_tr_b16 v[238:239], v243 offset:25088
    s_waitcnt lgkmcnt(4)
    v_cvt_pk_bf16_f32 v172, v172, v173
    v_mfma_f32_16x16x32_bf16 v[188:191], v[124:127], v[228:231], v[188:191]
    ds_read_b64_tr_b16 v[224:225], v240 offset:28672
    v_mfma_f32_16x16x32_bf16 v[184:187], v[120:123], v[228:231], v[184:187]
    ds_read_b64_tr_b16 v[226:227], v240 offset:29184
    s_waitcnt lgkmcnt(4)
    v_mfma_f32_16x16x32_bf16 v[192:195], v[120:123], v[232:235], v[192:195]
    ds_read_b64_tr_b16 v[228:229], v241 offset:28672
    v_mfma_f32_16x16x32_bf16 v[196:199], v[124:127], v[232:235], v[196:199]
    ds_read_b64_tr_b16 v[230:231], v241 offset:29184
    s_waitcnt lgkmcnt(4)
    v_mfma_f32_16x16x32_bf16 v[204:207], v[124:127], v[236:239], v[204:207]
    ds_read_b64_tr_b16 v[232:233], v242 offset:28672
    v_cvt_pk_bf16_f32 v173, v174, v175
    v_mfma_f32_16x16x32_bf16 v[200:203], v[120:123], v[236:239], v[200:203]
    ds_read_b64_tr_b16 v[234:235], v242 offset:29184
    s_waitcnt lgkmcnt(4)
    v_mfma_f32_16x16x32_bf16 v[176:179], v[128:131], v[224:227], v[176:179]
    ds_read_b64_tr_b16 v[236:237], v243 offset:28672
    v_mfma_f32_16x16x32_bf16 v[180:183], v[132:135], v[224:227], v[180:183]
    ds_read_b64_tr_b16 v[238:239], v243 offset:29184
    s_waitcnt lgkmcnt(4)
    v_mfma_f32_16x16x32_bf16 v[188:191], v[132:135], v[228:231], v[188:191]
    ds_read_b64_tr_b16 v[224:225], v240 offset:32768
    v_mfma_f32_16x16x32_bf16 v[184:187], v[128:131], v[228:231], v[184:187]
    ds_read_b64_tr_b16 v[226:227], v240 offset:33280
    s_waitcnt lgkmcnt(4)
    v_add_u32 v240, 0xfffe5000, v240
    buffer_store_dwordx2 v[172:173], v246, s[12:15], s32 offen offset:640 sc1
    v_mfma_f32_16x16x32_bf16 v[192:195], v[128:131], v[232:235], v[192:195]
    ds_read_b64_tr_b16 v[228:229], v241 offset:32768
    v_mfma_f32_16x16x32_bf16 v[196:199], v[132:135], v[232:235], v[196:199]
    ds_read_b64_tr_b16 v[230:231], v241 offset:33280
    s_waitcnt lgkmcnt(4)
    v_add_u32 v241, 0xfffe5000, v241
    v_mfma_f32_16x16x32_bf16 v[204:207], v[132:135], v[236:239], v[204:207]
    ds_read_b64_tr_b16 v[232:233], v242 offset:32768
    v_mfma_f32_16x16x32_bf16 v[200:203], v[128:131], v[236:239], v[200:203]
    ds_read_b64_tr_b16 v[234:235], v242 offset:33280
    s_waitcnt lgkmcnt(4)
    v_add_u32 v242, 0xfffe5000, v242
    v_mfma_f32_16x16x32_bf16 v[176:179], v[136:139], v[224:227], v[176:179]
    ds_read_b64_tr_b16 v[236:237], v243 offset:32768
    v_mfma_f32_16x16x32_bf16 v[180:183], v[140:143], v[224:227], v[180:183]
    ds_read_b64_tr_b16 v[238:239], v243 offset:33280
    s_waitcnt lgkmcnt(4)
    v_add_u32 v243, 0xfffe5000, v243
    s_waitcnt vmcnt(4)
    s_barrier
    v_mfma_f32_16x16x32_bf16 v[188:191], v[140:143], v[228:231], v[188:191]
    ds_read_b64_tr_b16 v[224:225], v240 offset:0
    v_mfma_f32_16x16x32_bf16 v[184:187], v[136:139], v[228:231], v[184:187]
    ds_read_b64_tr_b16 v[226:227], v240 offset:512
    s_waitcnt lgkmcnt(4)
    v_mfma_f32_16x16x32_bf16 v[192:195], v[136:139], v[232:235], v[192:195]
    ds_read_b64_tr_b16 v[228:229], v241 offset:0
    v_mfma_f32_16x16x32_bf16 v[196:199], v[140:143], v[232:235], v[196:199]
    ds_read_b64_tr_b16 v[230:231], v241 offset:512
    s_waitcnt lgkmcnt(4)
    v_mfma_f32_16x16x32_bf16 v[204:207], v[140:143], v[236:239], v[204:207]
    ds_read_b64_tr_b16 v[232:233], v242 offset:0
    v_mfma_f32_16x16x32_bf16 v[200:203], v[136:139], v[236:239], v[200:203]
    ds_read_b64_tr_b16 v[234:235], v242 offset:512
    s_waitcnt lgkmcnt(4)
    s_add_u32 s27, s27, 327680
L1_v_tail:
    s_setprio 0
    s_nop 7
    s_add_u32 s32, s27, 0
    v_cvt_pk_bf16_f32 v176, v176, v177
    v_cvt_pk_bf16_f32 v177, v178, v179
    buffer_store_dwordx2 v[176:177], v246, s[12:15], s32 offen offset:0 sc1
    v_cvt_pk_bf16_f32 v180, v180, v181
    v_cvt_pk_bf16_f32 v181, v182, v183
    buffer_store_dwordx2 v[180:181], v246, s[12:15], s32 offen offset:640 sc1
    s_add_u32 s32, s27, 81920
    v_cvt_pk_bf16_f32 v184, v184, v185
    v_cvt_pk_bf16_f32 v185, v186, v187
    buffer_store_dwordx2 v[184:185], v246, s[12:15], s32 offen offset:0 sc1
    v_cvt_pk_bf16_f32 v188, v188, v189
    v_cvt_pk_bf16_f32 v189, v190, v191
    buffer_store_dwordx2 v[188:189], v246, s[12:15], s32 offen offset:640 sc1
    s_add_u32 s32, s27, 163840
    v_cvt_pk_bf16_f32 v192, v192, v193
    v_cvt_pk_bf16_f32 v193, v194, v195
    buffer_store_dwordx2 v[192:193], v246, s[12:15], s32 offen offset:0 sc1
    v_cvt_pk_bf16_f32 v196, v196, v197
    v_cvt_pk_bf16_f32 v197, v198, v199
    buffer_store_dwordx2 v[196:197], v246, s[12:15], s32 offen offset:640 sc1
    s_add_u32 s32, s27, 245760
    v_cvt_pk_bf16_f32 v200, v200, v201
    v_cvt_pk_bf16_f32 v201, v202, v203
    buffer_store_dwordx2 v[200:201], v246, s[12:15], s32 offen offset:0 sc1
    v_cvt_pk_bf16_f32 v204, v204, v205
    v_cvt_pk_bf16_f32 v205, v206, v207
    buffer_store_dwordx2 v[204:205], v246, s[12:15], s32 offen offset:640 sc1
    s_waitcnt lgkmcnt(0)
    s_branch L1_sp_tail
L1_qkr:
    v_lshrrev_b32 v249, 4, v247
    v_bfe_u32 v250, v247, 2, 2
    v_lshl_add_u32 v250, v249, 3, v250
    v_lshlrev_b32 v250, 7, v250
    v_and_b32 v251, 3, v247
    v_lshl_add_u32 v250, v251, 3, v250
    v_bfe_u32 v249, v247, 3, 2
    v_xor_b32 v251, 0, v249
    v_lshl_add_u32 v240, v251, 5, v250
    v_xor_b32 v251, 1, v249
    v_lshl_add_u32 v241, v251, 5, v250
    v_xor_b32 v251, 2, v249
    v_lshl_add_u32 v242, v251, 5, v250
    v_xor_b32 v251, 3, v249
    v_lshl_add_u32 v243, v251, 5, v250
    v_and_b32 v249, 15, v247
    v_lshrrev_b32 v250, 4, v247
    v_lshlrev_b32 v246, 14, v250
    v_lshl_add_u32 v246, v249, 2, v246
    s_mov_b32 s38, s28
    s_mov_b32 s39, s28
    s_waitcnt vmcnt(0) lgkmcnt(0)
    s_barrier
    s_add_u32 m0, s29, 0
    s_mov_b32 s24, s25
    buffer_load_dwordx4 v244, s[16:19], s24 offen sc1 lds
    s_add_u32 m0, s29, 8192
    s_add_u32 s24, s24, s35
    buffer_load_dwordx4 v244, s[16:19], s24 offen sc1 lds
    s_add_u32 m0, s29, 16384
    s_add_u32 s24, s24, s35
    buffer_load_dwordx4 v244, s[16:19], s24 offen sc1 lds
    s_add_u32 m0, s29, 24576
    s_add_u32 s24, s24, s35
    buffer_load_dwordx4 v244, s[16:19], s24 offen sc1 lds
    s_add_u32 m0, s29, 32768
    s_add_u32 s24, s24, s35
    buffer_load_dwordx4 v244, s[16:19], s24 offen sc1 lds
    s_add_u32 m0, s29, 40960
    s_add_u32 s24, s24, s35
    buffer_load_dwordx4 v244, s[16:19], s24 offen sc1 lds
    s_add_u32 m0, s29, 49152
    s_add_u32 s24, s24, s35
    buffer_load_dwordx4 v244, s[16:19], s24 offen sc1 lds
    s_add_u32 m0, s29, 57344
    s_add_u32 s24, s24, s35
    buffer_load_dwordx4 v244, s[16:19], s24 offen sc1 lds
    s_add_u32 m0, s29, 65536
    s_add_u32 s24, s24, s35
    buffer_load_dwordx4 v244, s[16:19], s24 offen sc1 lds
    s_add_u32 s25, s25, 128
    s_add_u32 m0, s29, 73728
    s_mov_b32 s24, s25
    buffer_load_dwordx4 v244, s[20:23], s24 offen sc1 lds
    s_add_u32 m0, s29, 81920
    s_add_u32 s24, s24, s35
    buffer_load_dwordx4 v244, s[20:23], s24 offen sc1 lds
    s_add_u32 m0, s29, 90112
    s_add_u32 s24, s24, s35
    buffer_load_dwordx4 v244, s[20:23], s24 offen sc1 lds
    s_add_u32 m0, s29, 98304
    s_add_u32 s24, s24, s35
    buffer_load_dwordx4 v244, s[20:23], s24 offen sc1 lds
    s_add_u32 m0, s29, 106496
    s_add_u32 s24, s24, s35
    buffer_load_dwordx4 v244, s[20:23], s24 offen sc1 lds
    s_add_u32 m0, s29, 114688
    s_add_u32 s24, s24, s35
    buffer_load_dwordx4 v244, s[20:23], s24 offen sc1 lds
    s_add_u32 m0, s29, 122880
    s_add_u32 s24, s24, s35
    buffer_load_dwordx4 v244, s[20:23], s24 offen sc1 lds
    s_add_u32 m0, s29, 131072
    s_add_u32 s24, s24, s35
    buffer_load_dwordx4 v244, s[20:23], s24 offen sc1 lds
    s_add_u32 m0, s29, 139264
    s_add_u32 s24, s24, s35
    buffer_load_dwordx4 v244, s[20:23], s24 offen sc1 lds
    s_waitcnt vmcnt(0)
    s_barrier
    v_mov_b32 v248, 157736
    ds_read_b64 v[248:249], v248
    s_add_u32 s34, s30, 0
    buffer_load_dwordx4 v[0:3], v245, s[12:15], s34 offen offset:0 sc1
    buffer_load_dwordx4 v[4:7], v245, s[12:15], s34 offen offset:1024 sc1
    s_add_u32 s34, s30, 4096
    buffer_load_dwordx4 v[8:11], v245, s[12:15], s34 offen offset:0 sc1
    buffer_load_dwordx4 v[12:15], v245, s[12:15], s34 offen offset:1024 sc1
    s_add_u32 s34, s30, 8192
    buffer_load_dwordx4 v[16:19], v245, s[12:15], s34 offen offset:0 sc1
    buffer_load_dwordx4 v[20:23], v245, s[12:15], s34 offen offset:1024 sc1
    s_add_u32 s34, s30, 12288
    buffer_load_dwordx4 v[24:27], v245, s[12:15], s34 offen offset:0 sc1
    buffer_load_dwordx4 v[28:31], v245, s[12:15], s34 offen offset:1024 sc1
    s_waitcnt lgkmcnt(0)
    v_readfirstlane_b32 s44, v248
    v_readfirstlane_b32 s45, v249
    ds_read_b64_tr_b16 v[224:225], v240 offset:0
    ds_read_b64_tr_b16 v[226:227], v240 offset:512
    ds_read_b64_tr_b16 v[228:229], v241 offset:0
    ds_read_b64_tr_b16 v[230:231], v241 offset:512
    ds_read_b64_tr_b16 v[232:233], v242 offset:0
    ds_read_b64_tr_b16 v[234:235], v242 offset:512
    s_waitcnt lgkmcnt(4)
    s_cmp_lt_u32 s3, 4
    s_cselect_b64 vcc, -1, 0
    v_add_u32 v240, 0x12000, v240
    v_add_u32 v241, 0x12000, v241
    v_add_u32 v242, 0x12000, v242
    s_cbranch_vccnz Lp13
    s_setprio 1
Lp13:
    s_waitcnt vmcnt(6)
    v_mfma_f32_16x16x32_bf16 v[144:147], v[224:227], v[0:3], 0
    ds_read_b64_tr_b16 v[236:237], v243 offset:0
    s_add_u32 s34, s30, 16384
    buffer_load_dwordx4 v[32:35], v245, s[12:15], s34 offen offset:0 sc1
    v_mfma_f32_16x16x32_bf16 v[148:151], v[224:227], v[4:7], 0
    ds_read_b64_tr_b16 v[238:239], v243 offset:512
    s_waitcnt lgkmcnt(4)
    v_add_u32 v243, 0x12000, v243
    v_mfma_f32_16x16x32_bf16 v[156:159], v[228:231], v[4:7], 0
    ds_read_b64_tr_b16 v[224:225], v240 offset:0
    v_mfma_f32_16x16x32_bf16 v[152:155], v[228:231], v[0:3], 0
    ds_read_b64_tr_b16 v[226:227], v240 offset:512
    s_waitcnt lgkmcnt(4)
    v_add_u32 v240, 0xfffee000, v240
    v_mfma_f32_16x16x32_bf16 v[160:163], v[232:235], v[0:3], 0
    ds_read_b64_tr_b16 v[228:229], v241 offset:0
    v_mfma_f32_16x16x32_bf16 v[164:167], v[232:235], v[4:7], 0
    ds_read_b64_tr_b16 v[230:231], v241 offset:512
    s_waitcnt lgkmcnt(4)
    v_add_u32 v241, 0xfffee000, v241
    v_mfma_f32_16x16x32_bf16 v[172:175], v[236:239], v[4:7], 0
    ds_read_b64_tr_b16 v[232:233], v242 offset:0
    buffer_load_dwordx4 v[36:39], v245, s[12:15], s34 offen offset:1024 sc1
    v_mfma_f32_16x16x32_bf16 v[168:171], v[236:239], v[0:3], 0
    ds_read_b64_tr_b16 v[234:235], v242 offset:512
    s_waitcnt lgkmcnt(4)
    v_add_u32 v242, 0xfffee000, v242
    v_mfma_f32_16x16x32_bf16 v[176:179], v[224:227], v[0:3], 0
    ds_read_b64_tr_b16 v[236:237], v243 offset:0
    v_mfma_f32_16x16x32_bf16 v[180:183], v[224:227], v[4:7], 0
    ds_read_b64_tr_b16 v[238:239], v243 offset:512
    s_waitcnt lgkmcnt(4)
    v_add_u32 v243, 0xfffee000, v243
    v_mfma_f32_16x16x32_bf16 v[188:191], v[228:231], v[4:7], 0
    ds_read_b64_tr_b16 v[224:225], v240 offset:4096
    v_mfma_f32_16x16x32_bf16 v[184:187], v[228:231], v[0:3], 0
    ds_read_b64_tr_b16 v[226:227], v240 offset:4608
    s_waitcnt lgkmcnt(4)
    v_add_u32 v240, 0x12000, v240
    v_mfma_f32_16x16x32_bf16 v[192:195], v[232:235], v[0:3], 0
    ds_read_b64_tr_b16 v[228:229], v241 offset:4096
    s_add_u32 s34, s30, 20480
    buffer_load_dwordx4 v[40:43], v245, s[12:15], s34 offen offset:0 sc1
    v_mfma_f32_16x16x32_bf16 v[196:199], v[232:235], v[4:7], 0
    ds_read_b64_tr_b16 v[230:231], v241 offset:4608
    s_waitcnt lgkmcnt(4)
    v_add_u32 v241, 0x12000, v241
    v_mfma_f32_16x16x32_bf16 v[204:207], v[236:239], v[4:7], 0
    ds_read_b64_tr_b16 v[232:233], v242 offset:4096
    v_mfma_f32_16x16x32_bf16 v[200:203], v[236:239], v[0:3], 0
    ds_read_b64_tr_b16 v[234:235], v242 offset:4608
    s_waitcnt lgkmcnt(4)
    v_add_u32 v242, 0x12000, v242
    s_waitcnt vmcnt(7)
    v_mfma_f32_16x16x32_bf16 v[144:147], v[224:227], v[8:11], v[144:147]
    ds_read_b64_tr_b16 v[236:237], v243 offset:4096
    v_mfma_f32_16x16x32_bf16 v[148:151], v[224:227], v[12:15], v[148:151]
    ds_read_b64_tr_b16 v[238:239], v243 offset:4608
    s_waitcnt lgkmcnt(4)
    v_add_u32 v243, 0x12000, v243
    v_mfma_f32_16x16x32_bf16 v[156:159], v[228:231], v[12:15], v[156:159]
    ds_read_b64_tr_b16 v[224:225], v240 offset:4096
    buffer_load_dwordx4 v[44:47], v245, s[12:15], s34 offen offset:1024 sc1
    v_mfma_f32_16x16x32_bf16 v[152:155], v[228:231], v[8:11], v[152:155]
    ds_read_b64_tr_b16 v[226:227], v240 offset:4608
    s_waitcnt lgkmcnt(4)
    v_add_u32 v240, 0xfffee000, v240
    v_mfma_f32_16x16x32_bf16 v[160:163], v[232:235], v[8:11], v[160:163]
    ds_read_b64_tr_b16 v[228:229], v241 offset:4096
    v_mfma_f32_16x16x32_bf16 v[164:167], v[232:235], v[12:15], v[164:167]
    ds_read_b64_tr_b16 v[230:231], v241 offset:4608
    s_waitcnt lgkmcnt(4)
    v_add_u32 v241, 0xfffee000, v241
    v_mfma_f32_16x16x32_bf16 v[172:175], v[236:239], v[12:15], v[172:175]
    ds_read_b64_tr_b16 v[232:233], v242 offset:4096
    v_mfma_f32_16x16x32_bf16 v[168:171], v[236:239], v[8:11], v[168:171]
    ds_read_b64_tr_b16 v[234:235], v242 offset:4608
    s_waitcnt lgkmcnt(4)
    v_add_u32 v242, 0xfffee000, v242
    v_mfma_f32_16x16x32_bf16 v[176:179], v[224:227], v[8:11], v[176:179]
    ds_read_b64_tr_b16 v[236:237], v243 offset:4096
    s_add_u32 s34, s30, 24576
    buffer_load_dwordx4 v[48:51], v245, s[12:15], s34 offen offset:0 sc1
    v_mfma_f32_16x16x32_bf16 v[180:183], v[224:227], v[12:15], v[180:183]
    ds_read_b64_tr_b16 v[238:239], v243 offset:4608
    s_waitcnt lgkmcnt(4)
    v_add_u32 v243, 0xfffee000, v243
    v_mfma_f32_16x16x32_bf16 v[188:191], v[228:231], v[12:15], v[188:191]
    ds_read_b64_tr_b16 v[224:225], v240 offset:8192
    v_mfma_f32_16x16x32_bf16 v[184:187], v[228:231], v[8:11], v[184:187]
    ds_read_b64_tr_b16 v[226:227], v240 offset:8704
    s_waitcnt lgkmcnt(4)
    v_add_u32 v240, 0x12000, v240
    v_mfma_f32_16x16x32_bf16 v[192:195], v[232:235], v[8:11], v[192:195]
    ds_read_b64_tr_b16 v[228:229], v241 offset:8192
    v_mfma_f32_16x16x32_bf16 v[196:199], v[232:235], v[12:15], v[196:199]
    ds_read_b64_tr_b16 v[230:231], v241 offset:8704
    s_waitcnt lgkmcnt(4)
    v_add_u32 v241, 0x12000, v241
    v_mfma_f32_16x16x32_bf16 v[204:207], v[236:239], v[12:15], v[204:207]
    ds_read_b64_tr_b16 v[232:233], v242 offset:8192
    buffer_load_dwordx4 v[52:55], v245, s[12:15], s34 offen offset:1024 sc1
    v_mfma_f32_16x16x32_bf16 v[200:203], v[236:239], v[8:11], v[200:203]
    ds_read_b64_tr_b16 v[234:235], v242 offset:8704
    s_waitcnt lgkmcnt(4)
    v_add_u32 v242, 0x12000, v242
    s_waitcnt vmcnt(8)
    v_mfma_f32_16x16x32_bf16 v[144:147], v[224:227], v[16:19], v[144:147]
    ds_read_b64_tr_b16 v[236:237], v243 offset:8192
    v_mfma_f32_16x16x32_bf16 v[148:151], v[224:227], v[20:23], v[148:151]
    ds_read_b64_tr_b16 v[238:239], v243 offset:8704
    s_waitcnt lgkmcnt(4)
    v_add_u32 v243, 0x12000, v243
    v_mfma_f32_16x16x32_bf16 v[156:159], v[228:231], v[20:23], v[156:159]
    ds_read_b64_tr_b16 v[224:225], v240 offset:8192
    v_mfma_f32_16x16x32_bf16 v[152:155], v[228:231], v[16:19], v[152:155]
    ds_read_b64_tr_b16 v[226:227], v240 offset:8704
    s_waitcnt lgkmcnt(4)
    v_add_u32 v240, 0xfffee000, v240
    v_mfma_f32_16x16x32_bf16 v[160:163], v[232:235], v[16:19], v[160:163]
    ds_read_b64_tr_b16 v[228:229], v241 offset:8192
    s_add_u32 s34, s30, 28672
    buffer_load_dwordx4 v[56:59], v245, s[12:15], s34 offen offset:0 sc1
    v_mfma_f32_16x16x32_bf16 v[164:167], v[232:235], v[20:23], v[164:167]
    ds_read_b64_tr_b16 v[230:231], v241 offset:8704
    s_waitcnt lgkmcnt(4)
    v_add_u32 v241, 0xfffee000, v241
    v_mfma_f32_16x16x32_bf16 v[172:175], v[236:239], v[20:23], v[172:175]
    ds_read_b64_tr_b16 v[232:233], v242 offset:8192
    v_mfma_f32_16x16x32_bf16 v[168:171], v[236:239], v[16:19], v[168:171]
    ds_read_b64_tr_b16 v[234:235], v242 offset:8704
    s_waitcnt lgkmcnt(4)
    v_add_u32 v242, 0xfffee000, v242
    v_mfma_f32_16x16x32_bf16 v[176:179], v[224:227], v[16:19], v[176:179]
    ds_read_b64_tr_b16 v[236:237], v243 offset:8192
    v_mfma_f32_16x16x32_bf16 v[180:183], v[224:227], v[20:23], v[180:183]
    ds_read_b64_tr_b16 v[238:239], v243 offset:8704
    s_waitcnt lgkmcnt(4)
    v_add_u32 v243, 0xfffee000, v243
    v_mfma_f32_16x16x32_bf16 v[188:191], v[228:231], v[20:23], v[188:191]
    ds_read_b64_tr_b16 v[224:225], v240 offset:12288
    buffer_load_dwordx4 v[60:63], v245, s[12:15], s34 offen offset:1024 sc1
    v_mfma_f32_16x16x32_bf16 v[184:187], v[228:231], v[16:19], v[184:187]
    ds_read_b64_tr_b16 v[226:227], v240 offset:12800
    s_waitcnt lgkmcnt(4)
    v_add_u32 v240, 0x12000, v240
    v_mfma_f32_16x16x32_bf16 v[192:195], v[232:235], v[16:19], v[192:195]
    ds_read_b64_tr_b16 v[228:229], v241 offset:12288
    v_mfma_f32_16x16x32_bf16 v[196:199], v[232:235], v[20:23], v[196:199]
    ds_read_b64_tr_b16 v[230:231], v241 offset:12800
    s_waitcnt lgkmcnt(4)
    v_add_u32 v241, 0x12000, v241
    v_mfma_f32_16x16x32_bf16 v[204:207], v[236:239], v[20:23], v[204:207]
    ds_read_b64_tr_b16 v[232:233], v242 offset:12288
    v_mfma_f32_16x16x32_bf16 v[200:203], v[236:239], v[16:19], v[200:203]
    ds_read_b64_tr_b16 v[234:235], v242 offset:12800
    s_waitcnt lgkmcnt(4)
    v_add_u32 v242, 0x12000, v242
    s_waitcnt vmcnt(8)
    v_mfma_f32_16x16x32_bf16 v[144:147], v[224:227], v[24:27], v[144:147]
    ds_read_b64_tr_b16 v[236:237], v243 offset:12288
    s_add_u32 s34, s30, 32768
    buffer_load_dwordx4 v[64:67], v245, s[12:15], s34 offen offset:0 sc1
    v_mfma_f32_16x16x32_bf16 v[148:151], v[224:227], v[28:31], v[148:151]
    ds_read_b64_tr_b16 v[238:239], v243 offset:12800
    s_waitcnt lgkmcnt(4)
    v_add_u32 v243, 0x12000, v243
    v_mfma_f32_16x16x32_bf16 v[156:159], v[228:231], v[28:31], v[156:159]
    ds_read_b64_tr_b16 v[224:225], v240 offset:12288
    v_mfma_f32_16x16x32_bf16 v[152:155], v[228:231], v[24:27], v[152:155]
    ds_read_b64_tr_b16 v[226:227], v240 offset:12800
    s_waitcnt lgkmcnt(4)
    v_add_u32 v240, 0xfffee000, v240
    v_mfma_f32_16x16x32_bf16 v[160:163], v[232:235], v[24:27], v[160:163]
    ds_read_b64_tr_b16 v[228:229], v241 offset:12288
    v_mfma_f32_16x16x32_bf16 v[164:167], v[232:235], v[28:31], v[164:167]
    ds_read_b64_tr_b16 v[230:231], v241 offset:12800
    s_waitcnt lgkmcnt(4)
    v_add_u32 v241, 0xfffee000, v241
    v_mfma_f32_16x16x32_bf16 v[172:175], v[236:239], v[28:31], v[172:175]
    ds_read_b64_tr_b16 v[232:233], v242 offset:12288
    buffer_load_dwordx4 v[68:71], v245, s[12:15], s34 offen offset:1024 sc1
    v_mfma_f32_16x16x32_bf16 v[168:171], v[236:239], v[24:27], v[168:171]
    ds_read_b64_tr_b16 v[234:235], v242 offset:12800
    s_waitcnt lgkmcnt(4)
    v_add_u32 v242, 0xfffee000, v242
    v_mfma_f32_16x16x32_bf16 v[176:179], v[224:227], v[24:27], v[176:179]
    ds_read_b64_tr_b16 v[236:237], v243 offset:12288
    v_mfma_f32_16x16x32_bf16 v[180:183], v[224:227], v[28:31], v[180:183]
    ds_read_b64_tr_b16 v[238:239], v243 offset:12800
    s_waitcnt lgkmcnt(4)
    v_add_u32 v243, 0xfffee000, v243
    v_mfma_f32_16x16x32_bf16 v[188:191], v[228:231], v[28:31], v[188:191]
    ds_read_b64_tr_b16 v[224:225], v240 offset:16384
    v_mfma_f32_16x16x32_bf16 v[184:187], v[228:231], v[24:27], v[184:187]
    ds_read_b64_tr_b16 v[226:227], v240 offset:16896
    s_waitcnt lgkmcnt(4)
    v_add_u32 v240, 0x12000, v240
    v_mfma_f32_16x16x32_bf16 v[192:195], v[232:235], v[24:27], v[192:195]
    ds_read_b64_tr_b16 v[228:229], v241 offset:16384
    s_add_u32 s34, s30, 36864
    buffer_load_dwordx4 v[72:75], v245, s[12:15], s34 offen offset:0 sc1
    v_mfma_f32_16x16x32_bf16 v[196:199], v[232:235], v[28:31], v[196:199]
    ds_read_b64_tr_b16 v[230:231], v241 offset:16896
    s_waitcnt lgkmcnt(4)
    v_add_u32 v241, 0x12000, v241
    v_mfma_f32_16x16x32_bf16 v[204:207], v[236:239], v[28:31], v[204:207]
    ds_read_b64_tr_b16 v[232:233], v242 offset:16384
    v_mfma_f32_16x16x32_bf16 v[200:203], v[236:239], v[24:27], v[200:203]
    ds_read_b64_tr_b16 v[234:235], v242 offset:16896
    s_waitcnt lgkmcnt(4)
    v_add_u32 v242, 0x12000, v242
    s_waitcnt vmcnt(9)
    v_mfma_f32_16x16x32_bf16 v[144:147], v[224:227], v[32:35], v[144:147]
    ds_read_b64_tr_b16 v[236:237], v243 offset:16384
    v_mfma_f32_16x16x32_bf16 v[148:151], v[224:227], v[36:39], v[148:151]
    ds_read_b64_tr_b16 v[238:239], v243 offset:16896
    s_waitcnt lgkmcnt(4)
    v_add_u32 v243, 0x12000, v243
    v_mfma_f32_16x16x32_bf16 v[156:159], v[228:231], v[36:39], v[156:159]
    ds_read_b64_tr_b16 v[224:225], v240 offset:16384
    buffer_load_dwordx4 v[76:79], v245, s[12:15], s34 offen offset:1024 sc1
    v_mfma_f32_16x16x32_bf16 v[152:155], v[228:231], v[32:35], v[152:155]
    ds_read_b64_tr_b16 v[226:227], v240 offset:16896
    s_waitcnt lgkmcnt(4)
    v_add_u32 v240, 0xfffee000, v240
    v_mfma_f32_16x16x32_bf16 v[160:163], v[232:235], v[32:35], v[160:163]
    ds_read_b64_tr_b16 v[228:229], v241 offset:16384
    v_mfma_f32_16x16x32_bf16 v[164:167], v[232:235], v[36:39], v[164:167]
    ds_read_b64_tr_b16 v[230:231], v241 offset:16896
    s_waitcnt lgkmcnt(4)
    v_add_u32 v241, 0xfffee000, v241
    v_mfma_f32_16x16x32_bf16 v[172:175], v[236:239], v[36:39], v[172:175]
    ds_read_b64_tr_b16 v[232:233], v242 offset:16384
    v_mfma_f32_16x16x32_bf16 v[168:171], v[236:239], v[32:35], v[168:171]
    ds_read_b64_tr_b16 v[234:235], v242 offset:16896
    s_waitcnt lgkmcnt(4)
    v_add_u32 v242, 0xfffee000, v242
    v_mfma_f32_16x16x32_bf16 v[176:179], v[224:227], v[32:35], v[176:179]
    ds_read_b64_tr_b16 v[236:237], v243 offset:16384
    s_add_u32 s34, s30, 40960
    buffer_load_dwordx4 v[80:83], v245, s[12:15], s34 offen offset:0 sc1
    v_mfma_f32_16x16x32_bf16 v[180:183], v[224:227], v[36:39], v[180:183]
    ds_read_b64_tr_b16 v[238:239], v243 offset:16896
    s_waitcnt lgkmcnt(4)
    v_add_u32 v243, 0xfffee000, v243
    v_mfma_f32_16x16x32_bf16 v[188:191], v[228:231], v[36:39], v[188:191]
    ds_read_b64_tr_b16 v[224:225], v240 offset:20480
    v_mfma_f32_16x16x32_bf16 v[184:187], v[228:231], v[32:35], v[184:187]
    ds_read_b64_tr_b16 v[226:227], v240 offset:20992
    s_waitcnt lgkmcnt(4)
    v_add_u32 v240, 0x12000, v240
    v_mfma_f32_16x16x32_bf16 v[192:195], v[232:235], v[32:35], v[192:195]
    ds_read_b64_tr_b16 v[228:229], v241 offset:20480
    v_mfma_f32_16x16x32_bf16 v[196:199], v[232:235], v[36:39], v[196:199]
    ds_read_b64_tr_b16 v[230:231], v241 offset:20992
    s_waitcnt lgkmcnt(4)
    v_add_u32 v241, 0x12000, v241
    v_mfma_f32_16x16x32_bf16 v[204:207], v[236:239], v[36:39], v[204:207]
    ds_read_b64_tr_b16 v[232:233], v242 offset:20480
    buffer_load_dwordx4 v[84:87], v245, s[12:15], s34 offen offset:1024 sc1
    v_mfma_f32_16x16x32_bf16 v[200:203], v[236:239], v[32:35], v[200:203]
    ds_read_b64_tr_b16 v[234:235], v242 offset:20992
    s_waitcnt lgkmcnt(4)
    v_add_u32 v242, 0x12000, v242
    s_waitcnt vmcnt(10)
    v_mfma_f32_16x16x32_bf16 v[144:147], v[224:227], v[40:43], v[144:147]
    ds_read_b64_tr_b16 v[236:237], v243 offset:20480
    v_mfma_f32_16x16x32_bf16 v[148:151], v[224:227], v[44:47], v[148:151]
    ds_read_b64_tr_b16 v[238:239], v243 offset:20992
    s_waitcnt lgkmcnt(4)
    v_add_u32 v243, 0x12000, v243
    v_mfma_f32_16x16x32_bf16 v[156:159], v[228:231], v[44:47], v[156:159]
    ds_read_b64_tr_b16 v[224:225], v240 offset:20480
    v_mfma_f32_16x16x32_bf16 v[152:155], v[228:231], v[40:43], v[152:155]
    ds_read_b64_tr_b16 v[226:227], v240 offset:20992
    s_waitcnt lgkmcnt(4)
    v_add_u32 v240, 0xfffee000, v240
    v_mfma_f32_16x16x32_bf16 v[160:163], v[232:235], v[40:43], v[160:163]
    ds_read_b64_tr_b16 v[228:229], v241 offset:20480
    s_add_u32 s34, s30, 45056
    buffer_load_dwordx4 v[88:91], v245, s[12:15], s34 offen offset:0 sc1
    v_mfma_f32_16x16x32_bf16 v[164:167], v[232:235], v[44:47], v[164:167]
    ds_read_b64_tr_b16 v[230:231], v241 offset:20992
    s_waitcnt lgkmcnt(4)
    v_add_u32 v241, 0xfffee000, v241
    v_mfma_f32_16x16x32_bf16 v[172:175], v[236:239], v[44:47], v[172:175]
    ds_read_b64_tr_b16 v[232:233], v242 offset:20480
    v_mfma_f32_16x16x32_bf16 v[168:171], v[236:239], v[40:43], v[168:171]
    ds_read_b64_tr_b16 v[234:235], v242 offset:20992
    s_waitcnt lgkmcnt(4)
    v_add_u32 v242, 0xfffee000, v242
    v_mfma_f32_16x16x32_bf16 v[176:179], v[224:227], v[40:43], v[176:179]
    ds_read_b64_tr_b16 v[236:237], v243 offset:20480
    v_mfma_f32_16x16x32_bf16 v[180:183], v[224:227], v[44:47], v[180:183]
    ds_read_b64_tr_b16 v[238:239], v243 offset:20992
    s_waitcnt lgkmcnt(4)
    v_add_u32 v243, 0xfffee000, v243
    v_mfma_f32_16x16x32_bf16 v[188:191], v[228:231], v[44:47], v[188:191]
    ds_read_b64_tr_b16 v[224:225], v240 offset:24576
    buffer_load_dwordx4 v[92:95], v245, s[12:15], s34 offen offset:1024 sc1
    v_mfma_f32_16x16x32_bf16 v[184:187], v[228:231], v[40:43], v[184:187]
    ds_read_b64_tr_b16 v[226:227], v240 offset:25088
    s_waitcnt lgkmcnt(4)
    v_add_u32 v240, 0x12000, v240
    v_mfma_f32_16x16x32_bf16 v[192:195], v[232:235], v[40:43], v[192:195]
    ds_read_b64_tr_b16 v[228:229], v241 offset:24576
    v_mfma_f32_16x16x32_bf16 v[196:199], v[232:235], v[44:47], v[196:199]
    ds_read_b64_tr_b16 v[230:231], v241 offset:25088
    s_waitcnt lgkmcnt(4)
    v_add_u32 v241, 0x12000, v241
    v_mfma_f32_16x16x32_bf16 v[204:207], v[236:239], v[44:47], v[204:207]
    ds_read_b64_tr_b16 v[232:233], v242 offset:24576
    v_mfma_f32_16x16x32_bf16 v[200:203], v[236:239], v[40:43], v[200:203]
    ds_read_b64_tr_b16 v[234:235], v242 offset:25088
    s_waitcnt lgkmcnt(4)
    v_add_u32 v242, 0x12000, v242
    s_waitcnt vmcnt(10)
    v_mfma_f32_16x16x32_bf16 v[144:147], v[224:227], v[48:51], v[144:147]
    ds_read_b64_tr_b16 v[236:237], v243 offset:24576
    s_add_u32 s34, s30, 49152
    buffer_load_dwordx4 v[96:99], v245, s[12:15], s34 offen offset:0 sc1
    v_mfma_f32_16x16x32_bf16 v[148:151], v[224:227], v[52:55], v[148:151]
    ds_read_b64_tr_b16 v[238:239], v243 offset:25088
    s_waitcnt lgkmcnt(4)
    v_add_u32 v243, 0x12000, v243
    v_mfma_f32_16x16x32_bf16 v[156:159], v[228:231], v[52:55], v[156:159]
    ds_read_b64_tr_b16 v[224:225], v240 offset:24576
    v_mfma_f32_16x16x32_bf16 v[152:155], v[228:231], v[48:51], v[152:155]
    ds_read_b64_tr_b16 v[226:227], v240 offset:25088
    s_waitcnt lgkmcnt(4)
    v_add_u32 v240, 0xfffee000, v240
    v_mfma_f32_16x16x32_bf16 v[160:163], v[232:235], v[48:51], v[160:163]
    ds_read_b64_tr_b16 v[228:229], v241 offset:24576
    v_mfma_f32_16x16x32_bf16 v[164:167], v[232:235], v[52:55], v[164:167]
    ds_read_b64_tr_b16 v[230:231], v241 offset:25088
    s_waitcnt lgkmcnt(4)
    v_add_u32 v241, 0xfffee000, v241
    v_mfma_f32_16x16x32_bf16 v[172:175], v[236:239], v[52:55], v[172:175]
    ds_read_b64_tr_b16 v[232:233], v242 offset:24576
    buffer_load_dwordx4 v[100:103], v245, s[12:15], s34 offen offset:1024 sc1
    v_mfma_f32_16x16x32_bf16 v[168:171], v[236:239], v[48:51], v[168:171]
    ds_read_b64_tr_b16 v[234:235], v242 offset:25088
    s_waitcnt lgkmcnt(4)
    v_add_u32 v242, 0xfffee000, v242
    s_setprio 0
    v_mfma_f32_16x16x32_bf16 v[176:179], v[224:227], v[48:51], v[176:179]
    ds_read_b64_tr_b16 v[236:237], v243 offset:24576
    v_mfma_f32_16x16x32_bf16 v[180:183], v[224:227], v[52:55], v[180:183]
    ds_read_b64_tr_b16 v[238:239], v243 offset:25088
    s_waitcnt lgkmcnt(4)
    v_add_u32 v243, 0xfffee000, v243
    v_mfma_f32_16x16x32_bf16 v[188:191], v[228:231], v[52:55], v[188:191]
    ds_read_b64_tr_b16 v[224:225], v240 offset:28672
    v_mfma_f32_16x16x32_bf16 v[184:187], v[228:231], v[48:51], v[184:187]
    ds_read_b64_tr_b16 v[226:227], v240 offset:29184
    s_waitcnt lgkmcnt(4)
    v_add_u32 v240, 0x12000, v240
    v_mfma_f32_16x16x32_bf16 v[192:195], v[232:235], v[48:51], v[192:195]
    ds_read_b64_tr_b16 v[228:229], v241 offset:28672
    s_add_u32 s34, s30, 53248
    buffer_load_dwordx4 v[104:107], v245, s[12:15], s34 offen offset:0 sc1
    v_mfma_f32_16x16x32_bf16 v[196:199], v[232:235], v[52:55], v[196:199]
    ds_read_b64_tr_b16 v[230:231], v241 offset:29184
    s_waitcnt lgkmcnt(4)
    v_add_u32 v241, 0x12000, v241
    v_mfma_f32_16x16x32_bf16 v[204:207], v[236:239], v[52:55], v[204:207]
    ds_read_b64_tr_b16 v[232:233], v242 offset:28672
    v_mfma_f32_16x16x32_bf16 v[200:203], v[236:239], v[48:51], v[200:203]
    ds_read_b64_tr_b16 v[234:235], v242 offset:29184
    s_waitcnt lgkmcnt(4)
    v_add_u32 v242, 0x12000, v242
    s_waitcnt vmcnt(11)
    v_mfma_f32_16x16x32_bf16 v[144:147], v[224:227], v[56:59], v[144:147]
    ds_read_b64_tr_b16 v[236:237], v243 offset:28672
    v_mfma_f32_16x16x32_bf16 v[148:151], v[224:227], v[60:63], v[148:151]
    ds_read_b64_tr_b16 v[238:239], v243 offset:29184
    s_waitcnt lgkmcnt(4)
    v_add_u32 v243, 0x12000, v243
    v_mfma_f32_16x16x32_bf16 v[156:159], v[228:231], v[60:63], v[156:159]
    ds_read_b64_tr_b16 v[224:225], v240 offset:28672
    buffer_load_dwordx4 v[108:111], v245, s[12:15], s34 offen offset:1024 sc1
    v_mfma_f32_16x16x32_bf16 v[152:155], v[228:231], v[56:59], v[152:155]
    ds_read_b64_tr_b16 v[226:227], v240 offset:29184
    s_waitcnt lgkmcnt(4)
    v_add_u32 v240, 0xfffee000, v240
    v_mfma_f32_16x16x32_bf16 v[160:163], v[232:235], v[56:59], v[160:163]
    ds_read_b64_tr_b16 v[228:229], v241 offset:28672
    v_mfma_f32_16x16x32_bf16 v[164:167], v[232:235], v[60:63], v[164:167]
    ds_read_b64_tr_b16 v[230:231], v241 offset:29184
    s_waitcnt lgkmcnt(4)
    v_add_u32 v241, 0xfffee000, v241
    v_mfma_f32_16x16x32_bf16 v[172:175], v[236:239], v[60:63], v[172:175]
    ds_read_b64_tr_b16 v[232:233], v242 offset:28672
    v_mfma_f32_16x16x32_bf16 v[168:171], v[236:239], v[56:59], v[168:171]
    ds_read_b64_tr_b16 v[234:235], v242 offset:29184
    s_waitcnt lgkmcnt(4)
    v_add_u32 v242, 0xfffee000, v242
    v_mfma_f32_16x16x32_bf16 v[176:179], v[224:227], v[56:59], v[176:179]
    ds_read_b64_tr_b16 v[236:237], v243 offset:28672
    s_add_u32 s34, s30, 57344
    buffer_load_dwordx4 v[112:115], v245, s[12:15], s34 offen offset:0 sc1
    v_mfma_f32_16x16x32_bf16 v[180:183], v[224:227], v[60:63], v[180:183]
    ds_read_b64_tr_b16 v[238:239], v243 offset:29184
    s_waitcnt lgkmcnt(4)
    v_add_u32 v243, 0xfffee000, v243
    v_mfma_f32_16x16x32_bf16 v[188:191], v[228:231], v[60:63], v[188:191]
    ds_read_b64_tr_b16 v[224:225], v240 offset:32768
    v_mfma_f32_16x16x32_bf16 v[184:187], v[228:231], v[56:59], v[184:187]
    ds_read_b64_tr_b16 v[226:227], v240 offset:33280
    s_waitcnt lgkmcnt(4)
    v_add_u32 v240, 0x12000, v240
    v_mfma_f32_16x16x32_bf16 v[192:195], v[232:235], v[56:59], v[192:195]
    ds_read_b64_tr_b16 v[228:229], v241 offset:32768
    v_mfma_f32_16x16x32_bf16 v[196:199], v[232:235], v[60:63], v[196:199]
    ds_read_b64_tr_b16 v[230:231], v241 offset:33280
    s_waitcnt lgkmcnt(4)
    v_add_u32 v241, 0x12000, v241
    v_mfma_f32_16x16x32_bf16 v[204:207], v[236:239], v[60:63], v[204:207]
    ds_read_b64_tr_b16 v[232:233], v242 offset:32768
    buffer_load_dwordx4 v[116:119], v245, s[12:15], s34 offen offset:1024 sc1
    v_mfma_f32_16x16x32_bf16 v[200:203], v[236:239], v[56:59], v[200:203]
    ds_read_b64_tr_b16 v[234:235], v242 offset:33280
    s_waitcnt lgkmcnt(4)
    v_add_u32 v242, 0x12000, v242
    s_waitcnt vmcnt(12)
    v_mfma_f32_16x16x32_bf16 v[144:147], v[224:227], v[64:67], v[144:147]
    ds_read_b64_tr_b16 v[236:237], v243 offset:32768
    v_mfma_f32_16x16x32_bf16 v[148:151], v[224:227], v[68:71], v[148:151]
    ds_read_b64_tr_b16 v[238:239], v243 offset:33280
    s_waitcnt lgkmcnt(4)
    v_add_u32 v243, 0x12000, v243
    v_mfma_f32_16x16x32_bf16 v[156:159], v[228:231], v[68:71], v[156:159]
    ds_read_b64_tr_b16 v[224:225], v240 offset:32768
    v_mfma_f32_16x16x32_bf16 v[152:155], v[228:231], v[64:67], v[152:155]
    ds_read_b64_tr_b16 v[226:227], v240 offset:33280
    s_waitcnt lgkmcnt(4)
    v_add_u32 v240, 0xffff7000, v240
    v_mfma_f32_16x16x32_bf16 v[160:163], v[232:235], v[64:67], v[160:163]
    ds_read_b64_tr_b16 v[228:229], v241 offset:32768
    s_add_u32 s34, s30, 61440
    buffer_load_dwordx4 v[120:123], v245, s[12:15], s34 offen offset:0 sc1
    v_mfma_f32_16x16x32_bf16 v[164:167], v[232:235], v[68:71], v[164:167]
    ds_read_b64_tr_b16 v[230:231], v241 offset:33280
    s_waitcnt lgkmcnt(4)
    v_add_u32 v241, 0xffff7000, v241
    v_mfma_f32_16x16x32_bf16 v[172:175], v[236:239], v[68:71], v[172:175]
    ds_read_b64_tr_b16 v[232:233], v242 offset:32768
    v_mfma_f32_16x16x32_bf16 v[168:171], v[236:239], v[64:67], v[168:171]
    ds_read_b64_tr_b16 v[234:235], v242 offset:33280
    s_waitcnt lgkmcnt(4)
    v_add_u32 v242, 0xffff7000, v242
    v_mfma_f32_16x16x32_bf16 v[176:179], v[224:227], v[64:67], v[176:179]
    ds_read_b64_tr_b16 v[236:237], v243 offset:32768
    v_mfma_f32_16x16x32_bf16 v[180:183], v[224:227], v[68:71], v[180:183]
    ds_read_b64_tr_b16 v[238:239], v243 offset:33280
    s_waitcnt lgkmcnt(4)
    v_add_u32 v243, 0xffff7000, v243
    v_mfma_f32_16x16x32_bf16 v[188:191], v[228:231], v[68:71], v[188:191]
    ds_read_b64_tr_b16 v[224:225], v240 offset:0
    buffer_load_dwordx4 v[124:127], v245, s[12:15], s34 offen offset:1024 sc1
    v_mfma_f32_16x16x32_bf16 v[184:187], v[228:231], v[64:67], v[184:187]
    ds_read_b64_tr_b16 v[226:227], v240 offset:512
    s_waitcnt lgkmcnt(4)
    v_mfma_f32_16x16x32_bf16 v[192:195], v[232:235], v[64:67], v[192:195]
    ds_read_b64_tr_b16 v[228:229], v241 offset:0
    v_mfma_f32_16x16x32_bf16 v[196:199], v[232:235], v[68:71], v[196:199]
    ds_read_b64_tr_b16 v[230:231], v241 offset:512
    s_waitcnt lgkmcnt(4)
    v_mfma_f32_16x16x32_bf16 v[204:207], v[236:239], v[68:71], v[204:207]
    ds_read_b64_tr_b16 v[232:233], v242 offset:0
    v_mfma_f32_16x16x32_bf16 v[200:203], v[236:239], v[64:67], v[200:203]
    ds_read_b64_tr_b16 v[234:235], v242 offset:512
    s_waitcnt lgkmcnt(4)
    s_cbranch_vccnz Lp14
    s_setprio 1
Lp14:
    s_waitcnt vmcnt(12)
    v_mfma_f32_16x16x32_bf16 v[144:147], v[224:227], v[72:75], v[144:147]
    ds_read_b64_tr_b16 v[236:237], v243 offset:0
    s_add_u32 s34, s30, 65536
    buffer_load_dwordx4 v[128:131], v245, s[12:15], s34 offen offset:0 sc1
    v_mfma_f32_16x16x32_bf16 v[148:151], v[224:227], v[76:79], v[148:151]
    ds_read_b64_tr_b16 v[238:239], v243 offset:512
    s_waitcnt lgkmcnt(4)
    v_mfma_f32_16x16x32_bf16 v[156:159], v[228:231], v[76:79], v[156:159]
    ds_read_b64_tr_b16 v[224:225], v240 offset:4096
    v_mfma_f32_16x16x32_bf16 v[152:155], v[228:231], v[72:75], v[152:155]
    ds_read_b64_tr_b16 v[226:227], v240 offset:4608
    s_waitcnt lgkmcnt(4)
    v_mfma_f32_16x16x32_bf16 v[160:163], v[232:235], v[72:75], v[160:163]
    ds_read_b64_tr_b16 v[228:229], v241 offset:4096
    v_mfma_f32_16x16x32_bf16 v[164:167], v[232:235], v[76:79], v[164:167]
    ds_read_b64_tr_b16 v[230:231], v241 offset:4608
    s_waitcnt lgkmcnt(4)
    v_mfma_f32_16x16x32_bf16 v[172:175], v[236:239], v[76:79], v[172:175]
    ds_read_b64_tr_b16 v[232:233], v242 offset:4096
    buffer_load_dwordx4 v[132:135], v245, s[12:15], s34 offen offset:1024 sc1
    v_mfma_f32_16x16x32_bf16 v[168:171], v[236:239], v[72:75], v[168:171]
    ds_read_b64_tr_b16 v[234:235], v242 offset:4608
    s_waitcnt lgkmcnt(4)
    s_waitcnt vmcnt(12)
    v_mfma_f32_16x16x32_bf16 v[144:147], v[224:227], v[80:83], v[144:147]
    ds_read_b64_tr_b16 v[236:237], v243 offset:4096
    v_mfma_f32_16x16x32_bf16 v[148:151], v[224:227], v[84:87], v[148:151]
    ds_read_b64_tr_b16 v[238:239], v243 offset:4608
    s_waitcnt lgkmcnt(4)
    v_mfma_f32_16x16x32_bf16 v[156:159], v[228:231], v[84:87], v[156:159]
    ds_read_b64_tr_b16 v[224:225], v240 offset:8192
    v_mfma_f32_16x16x32_bf16 v[152:155], v[228:231], v[80:83], v[152:155]
    ds_read_b64_tr_b16 v[226:227], v240 offset:8704
    s_waitcnt lgkmcnt(4)
    v_mfma_f32_16x16x32_bf16 v[160:163], v[232:235], v[80:83], v[160:163]
    ds_read_b64_tr_b16 v[228:229], v241 offset:8192
    s_add_u32 s34, s30, 69632
    buffer_load_dwordx4 v[136:139], v245, s[12:15], s34 offen offset:0 sc1
    v_mfma_f32_16x16x32_bf16 v[164:167], v[232:235], v[84:87], v[164:167]
    ds_read_b64_tr_b16 v[230:231], v241 offset:8704
    s_waitcnt lgkmcnt(4)
    v_mfma_f32_16x16x32_bf16 v[172:175], v[236:239], v[84:87], v[172:175]
    ds_read_b64_tr_b16 v[232:233], v242 offset:8192
    v_mfma_f32_16x16x32_bf16 v[168:171], v[236:239], v[80:83], v[168:171]
    ds_read_b64_tr_b16 v[234:235], v242 offset:8704
    s_waitcnt lgkmcnt(4)
    s_waitcnt vmcnt(11)
    v_mfma_f32_16x16x32_bf16 v[144:147], v[224:227], v[88:91], v[144:147]
    ds_read_b64_tr_b16 v[236:237], v243 offset:8192
    v_mfma_f32_16x16x32_bf16 v[148:151], v[224:227], v[92:95], v[148:151]
    ds_read_b64_tr_b16 v[238:239], v243 offset:8704
    s_waitcnt lgkmcnt(4)
    v_mfma_f32_16x16x32_bf16 v[156:159], v[228:231], v[92:95], v[156:159]
    ds_read_b64_tr_b16 v[224:225], v240 offset:12288
    buffer_load_dwordx4 v[140:143], v245, s[12:15], s34 offen offset:1024 sc1
    v_mfma_f32_16x16x32_bf16 v[152:155], v[228:231], v[88:91], v[152:155]
    ds_read_b64_tr_b16 v[226:227], v240 offset:12800
    s_waitcnt lgkmcnt(4)
    v_mfma_f32_16x16x32_bf16 v[160:163], v[232:235], v[88:91], v[160:163]
    ds_read_b64_tr_b16 v[228:229], v241 offset:12288
    buffer_load_dword v255, v255, s[60:63], s47 offen
    v_mfma_f32_16x16x32_bf16 v[164:167], v[232:235], v[92:95], v[164:167]
    ds_read_b64_tr_b16 v[230:231], v241 offset:12800
    s_waitcnt lgkmcnt(4)
    v_mfma_f32_16x16x32_bf16 v[172:175], v[236:239], v[92:95], v[172:175]
    ds_read_b64_tr_b16 v[232:233], v242 offset:12288
    buffer_load_dword v254, v254, s[64:67], 0 offen
    v_mfma_f32_16x16x32_bf16 v[168:171], v[236:239], v[88:91], v[168:171]
    ds_read_b64_tr_b16 v[234:235], v242 offset:12800
    s_waitcnt lgkmcnt(4)
    s_waitcnt vmcnt(12)
    v_mfma_f32_16x16x32_bf16 v[144:147], v[224:227], v[96:99], v[144:147]
    ds_read_b64_tr_b16 v[236:237], v243 offset:12288
    v_mfma_f32_16x16x32_bf16 v[148:151], v[224:227], v[100:103], v[148:151]
    ds_read_b64_tr_b16 v[238:239], v243 offset:12800
    s_waitcnt lgkmcnt(4)
    v_mfma_f32_16x16x32_bf16 v[156:159], v[228:231], v[100:103], v[156:159]
    ds_read_b64_tr_b16 v[224:225], v240 offset:16384
    v_mfma_f32_16x16x32_bf16 v[152:155], v[228:231], v[96:99], v[152:155]
    ds_read_b64_tr_b16 v[226:227], v240 offset:16896
    s_waitcnt lgkmcnt(4)
    v_mfma_f32_16x16x32_bf16 v[160:163], v[232:235], v[96:99], v[160:163]
    ds_read_b64_tr_b16 v[228:229], v241 offset:16384
    v_mfma_f32_16x16x32_bf16 v[164:167], v[232:235], v[100:103], v[164:167]
    ds_read_b64_tr_b16 v[230:231], v241 offset:16896
    s_waitcnt lgkmcnt(4)
    v_mfma_f32_16x16x32_bf16 v[172:175], v[236:239], v[100:103], v[172:175]
    ds_read_b64_tr_b16 v[232:233], v242 offset:16384
    v_mfma_f32_16x16x32_bf16 v[168:171], v[236:239], v[96:99], v[168:171]
    ds_read_b64_tr_b16 v[234:235], v242 offset:16896
    s_waitcnt lgkmcnt(4)
    s_waitcnt vmcnt(10)
    v_mfma_f32_16x16x32_bf16 v[144:147], v[224:227], v[104:107], v[144:147]
    ds_read_b64_tr_b16 v[236:237], v243 offset:16384
    v_mfma_f32_16x16x32_bf16 v[148:151], v[224:227], v[108:111], v[148:151]
    ds_read_b64_tr_b16 v[238:239], v243 offset:16896
    s_waitcnt lgkmcnt(4)
    v_mfma_f32_16x16x32_bf16 v[156:159], v[228:231], v[108:111], v[156:159]
    ds_read_b64_tr_b16 v[224:225], v240 offset:20480
    v_mfma_f32_16x16x32_bf16 v[152:155], v[228:231], v[104:107], v[152:155]
    ds_read_b64_tr_b16 v[226:227], v240 offset:20992
    s_waitcnt lgkmcnt(4)
    v_mfma_f32_16x16x32_bf16 v[160:163], v[232:235], v[104:107], v[160:163]
    ds_read_b64_tr_b16 v[228:229], v241 offset:20480
    v_mfma_f32_16x16x32_bf16 v[164:167], v[232:235], v[108:111], v[164:167]
    ds_read_b64_tr_b16 v[230:231], v241 offset:20992
    s_waitcnt lgkmcnt(4)
    v_mfma_f32_16x16x32_bf16 v[172:175], v[236:239], v[108:111], v[172:175]
    ds_read_b64_tr_b16 v[232:233], v242 offset:20480
    v_mfma_f32_16x16x32_bf16 v[168:171], v[236:239], v[104:107], v[168:171]
    ds_read_b64_tr_b16 v[234:235], v242 offset:20992
    s_waitcnt lgkmcnt(4)
    s_waitcnt vmcnt(8)
    v_mfma_f32_16x16x32_bf16 v[144:147], v[224:227], v[112:115], v[144:147]
    ds_read_b64_tr_b16 v[236:237], v243 offset:20480
    v_mfma_f32_16x16x32_bf16 v[148:151], v[224:227], v[116:119], v[148:151]
    ds_read_b64_tr_b16 v[238:239], v243 offset:20992
    s_waitcnt lgkmcnt(4)
    v_mfma_f32_16x16x32_bf16 v[156:159], v[228:231], v[116:119], v[156:159]
    ds_read_b64_tr_b16 v[224:225], v240 offset:24576
    v_mfma_f32_16x16x32_bf16 v[152:155], v[228:231], v[112:115], v[152:155]
    ds_read_b64_tr_b16 v[226:227], v240 offset:25088
    s_waitcnt lgkmcnt(4)
    v_mfma_f32_16x16x32_bf16 v[160:163], v[232:235], v[112:115], v[160:163]
    ds_read_b64_tr_b16 v[228:229], v241 offset:24576
    v_mfma_f32_16x16x32_bf16 v[164:167], v[232:235], v[116:119], v[164:167]
    ds_read_b64_tr_b16 v[230:231], v241 offset:25088
    s_waitcnt lgkmcnt(4)
    v_mfma_f32_16x16x32_bf16 v[172:175], v[236:239], v[116:119], v[172:175]
    ds_read_b64_tr_b16 v[232:233], v242 offset:24576
    v_mfma_f32_16x16x32_bf16 v[168:171], v[236:239], v[112:115], v[168:171]
    ds_read_b64_tr_b16 v[234:235], v242 offset:25088
    s_waitcnt lgkmcnt(4)
    s_waitcnt vmcnt(6)
    v_mfma_f32_16x16x32_bf16 v[144:147], v[224:227], v[120:123], v[144:147]
    ds_read_b64_tr_b16 v[236:237], v243 offset:24576
    v_mfma_f32_16x16x32_bf16 v[148:151], v[224:227], v[124:127], v[148:151]
    ds_read_b64_tr_b16 v[238:239], v243 offset:25088
    s_waitcnt lgkmcnt(4)
    v_mfma_f32_16x16x32_bf16 v[156:159], v[228:231], v[124:127], v[156:159]
    ds_read_b64_tr_b16 v[224:225], v240 offset:28672
    v_mfma_f32_16x16x32_bf16 v[152:155], v[228:231], v[120:123], v[152:155]
    ds_read_b64_tr_b16 v[226:227], v240 offset:29184
    s_waitcnt lgkmcnt(4)
    v_mfma_f32_16x16x32_bf16 v[160:163], v[232:235], v[120:123], v[160:163]
    ds_read_b64_tr_b16 v[228:229], v241 offset:28672
    v_mfma_f32_16x16x32_bf16 v[164:167], v[232:235], v[124:127], v[164:167]
    ds_read_b64_tr_b16 v[230:231], v241 offset:29184
    s_waitcnt lgkmcnt(4)
    v_mfma_f32_16x16x32_bf16 v[172:175], v[236:239], v[124:127], v[172:175]
    ds_read_b64_tr_b16 v[232:233], v242 offset:28672
    v_mfma_f32_16x16x32_bf16 v[168:171], v[236:239], v[120:123], v[168:171]
    ds_read_b64_tr_b16 v[234:235], v242 offset:29184
    s_waitcnt lgkmcnt(4)
    s_waitcnt vmcnt(4)
    v_mfma_f32_16x16x32_bf16 v[144:147], v[224:227], v[128:131], v[144:147]
    ds_read_b64_tr_b16 v[236:237], v243 offset:28672
    v_mfma_f32_16x16x32_bf16 v[148:151], v[224:227], v[132:135], v[148:151]
    ds_read_b64_tr_b16 v[238:239], v243 offset:29184
    s_waitcnt lgkmcnt(4)
    v_mfma_f32_16x16x32_bf16 v[156:159], v[228:231], v[132:135], v[156:159]
    ds_read_b64_tr_b16 v[224:225], v240 offset:32768
    v_mfma_f32_16x16x32_bf16 v[152:155], v[228:231], v[128:131], v[152:155]
    ds_read_b64_tr_b16 v[226:227], v240 offset:33280
    s_waitcnt lgkmcnt(4)
    v_add_u32 v240, 0x12000, v240
    v_mfma_f32_16x16x32_bf16 v[160:163], v[232:235], v[128:131], v[160:163]
    ds_read_b64_tr_b16 v[228:229], v241 offset:32768
    v_mfma_f32_16x16x32_bf16 v[164:167], v[232:235], v[132:135], v[164:167]
    ds_read_b64_tr_b16 v[230:231], v241 offset:33280
    s_waitcnt lgkmcnt(4)
    v_add_u32 v241, 0x12000, v241
    v_mfma_f32_16x16x32_bf16 v[172:175], v[236:239], v[132:135], v[172:175]
    ds_read_b64_tr_b16 v[232:233], v242 offset:32768
    v_mfma_f32_16x16x32_bf16 v[168:171], v[236:239], v[128:131], v[168:171]
    ds_read_b64_tr_b16 v[234:235], v242 offset:33280
    s_waitcnt lgkmcnt(4)
    v_add_u32 v242, 0x12000, v242
    s_waitcnt vmcnt(2)
    v_mfma_f32_16x16x32_bf16 v[144:147], v[224:227], v[136:139], v[144:147]
    ds_read_b64_tr_b16 v[236:237], v243 offset:32768
    v_mfma_f32_16x16x32_bf16 v[148:151], v[224:227], v[140:143], v[148:151]
    ds_read_b64_tr_b16 v[238:239], v243 offset:33280
    s_waitcnt lgkmcnt(4)
    v_add_u32 v243, 0x12000, v243
    v_mfma_f32_16x16x32_bf16 v[156:159], v[228:231], v[140:143], v[156:159]
    ds_read_b64_tr_b16 v[224:225], v240 offset:0
    v_mfma_f32_16x16x32_bf16 v[152:155], v[228:231], v[136:139], v[152:155]
    ds_read_b64_tr_b16 v[226:227], v240 offset:512
    s_waitcnt lgkmcnt(4)
    v_mfma_f32_16x16x32_bf16 v[160:163], v[232:235], v[136:139], v[160:163]
    ds_read_b64_tr_b16 v[228:229], v241 offset:0
    v_mfma_f32_16x16x32_bf16 v[164:167], v[232:235], v[140:143], v[164:167]
    ds_read_b64_tr_b16 v[230:231], v241 offset:512
    s_waitcnt lgkmcnt(4)
    v_mfma_f32_16x16x32_bf16 v[172:175], v[236:239], v[140:143], v[172:175]
    ds_read_b64_tr_b16 v[232:233], v242 offset:0
    v_mfma_f32_16x16x32_bf16 v[168:171], v[236:239], v[136:139], v[168:171]
    ds_read_b64_tr_b16 v[234:235], v242 offset:512
    s_waitcnt lgkmcnt(4)
    s_barrier
    v_mfma_f32_16x16x32_bf16 v[176:179], v[224:227], v[72:75], v[176:179]
    ds_read_b64_tr_b16 v[236:237], v243 offset:0
    v_mfma_f32_16x16x32_bf16 v[180:183], v[224:227], v[76:79], v[180:183]
    ds_read_b64_tr_b16 v[238:239], v243 offset:512
    s_waitcnt lgkmcnt(4)
    v_mfma_f32_16x16x32_bf16 v[188:191], v[228:231], v[76:79], v[188:191]
    ds_read_b64_tr_b16 v[224:225], v240 offset:4096
    s_add_u32 s25, s25, 128
    s_sub_u32 s26, s26, 1
    s_cmp_eq_u32 s26, 0
    s_cselect_b32 s18, 0, s18
    s_add_u32 m0, s29, 0
    s_mov_b32 s24, s25
    buffer_load_dwordx4 v244, s[16:19], s24 offen sc1 lds
    v_mfma_f32_16x16x32_bf16 v[184:187], v[228:231], v[72:75], v[184:187]
    ds_read_b64_tr_b16 v[226:227], v240 offset:4608
    s_waitcnt lgkmcnt(4)
    v_mfma_f32_16x16x32_bf16 v[192:195], v[232:235], v[72:75], v[192:195]
    ds_read_b64_tr_b16 v[228:229], v241 offset:4096
    s_add_u32 s32, s27, 0
    s_add_u32 s33, s27, 8192
    v_mfma_f32_16x16x32_bf16 v[196:199], v[232:235], v[76:79], v[196:199]
    ds_read_b64_tr_b16 v[230:231], v241 offset:4608
    s_waitcnt lgkmcnt(4)
    v_mul_f32 v144, s28, v144
    v_mfma_f32_16x16x32_bf16 v[204:207], v[236:239], v[76:79], v[204:207]
    ds_read_b64_tr_b16 v[232:233], v242 offset:4096
    v_mul_f32 v145, s28, v145
    v_mfma_f32_16x16x32_bf16 v[200:203], v[236:239], v[72:75], v[200:203]
    ds_read_b64_tr_b16 v[234:235], v242 offset:4608
    s_waitcnt lgkmcnt(4)
    v_mul_f32 v146, s28, v146
    v_mfma_f32_16x16x32_bf16 v[176:179], v[224:227], v[80:83], v[176:179]
    ds_read_b64_tr_b16 v[236:237], v243 offset:4096
    s_add_u32 m0, s29, 8192
    s_add_u32 s24, s24, s35
    buffer_load_dwordx4 v244, s[16:19], s24 offen sc1 lds
    v_mul_f32 v147, s28, v147
    v_mfma_f32_16x16x32_bf16 v[180:183], v[224:227], v[84:87], v[180:183]
    ds_read_b64_tr_b16 v[238:239], v243 offset:4608
    s_waitcnt lgkmcnt(4)
    v_cvt_pk_bf16_f32 v144, v144, v145
    v_mul_f32 v148, s28, v148
    v_mfma_f32_16x16x32_bf16 v[188:191], v[228:231], v[84:87], v[188:191]
    ds_read_b64_tr_b16 v[224:225], v240 offset:8192
    v_cvt_pk_bf16_f32 v145, v146, v147
    v_mfma_f32_16x16x32_bf16 v[184:187], v[228:231], v[80:83], v[184:187]
    ds_read_b64_tr_b16 v[226:227], v240 offset:8704
    s_waitcnt lgkmcnt(4)
    buffer_store_dword v144, v246, s[12:15], s32 offen offset:0 sc1
    v_mfma_f32_16x16x32_bf16 v[192:195], v[232:235], v[80:83], v[192:195]
    ds_read_b64_tr_b16 v[228:229], v241 offset:8192
    buffer_store_dword v145, v246, s[12:15], s33 offen offset:0 sc1
    v_mfma_f32_16x16x32_bf16 v[196:199], v[232:235], v[84:87], v[196:199]
    ds_read_b64_tr_b16 v[230:231], v241 offset:8704
    s_waitcnt lgkmcnt(4)
    v_mul_f32 v149, s28, v149
    v_mfma_f32_16x16x32_bf16 v[204:207], v[236:239], v[84:87], v[204:207]
    ds_read_b64_tr_b16 v[232:233], v242 offset:8192
    s_add_u32 m0, s29, 16384
    s_add_u32 s24, s24, s35
    buffer_load_dwordx4 v244, s[16:19], s24 offen sc1 lds
    v_mul_f32 v150, s28, v150
    v_mul_f32 v151, s28, v151
    v_mfma_f32_16x16x32_bf16 v[200:203], v[236:239], v[80:83], v[200:203]
    ds_read_b64_tr_b16 v[234:235], v242 offset:8704
    s_waitcnt lgkmcnt(4)
    v_cvt_pk_bf16_f32 v148, v148, v149
    v_mfma_f32_16x16x32_bf16 v[176:179], v[224:227], v[88:91], v[176:179]
    ds_read_b64_tr_b16 v[236:237], v243 offset:8192
    v_cvt_pk_bf16_f32 v149, v150, v151
    v_mfma_f32_16x16x32_bf16 v[180:183], v[224:227], v[92:95], v[180:183]
    ds_read_b64_tr_b16 v[238:239], v243 offset:8704
    s_waitcnt lgkmcnt(4)
    buffer_store_dword v148, v246, s[12:15], s32 offen offset:64 sc1
    v_mfma_f32_16x16x32_bf16 v[188:191], v[228:231], v[92:95], v[188:191]
    ds_read_b64_tr_b16 v[224:225], v240 offset:12288
    buffer_store_dword v149, v246, s[12:15], s33 offen offset:64 sc1
    v_mfma_f32_16x16x32_bf16 v[184:187], v[228:231], v[88:91], v[184:187]
    ds_read_b64_tr_b16 v[226:227], v240 offset:12800
    s_waitcnt lgkmcnt(4)
    s_add_u32 s32, s27, 65536
    s_add_u32 s33, s27, 73728
    v_mfma_f32_16x16x32_bf16 v[192:195], v[232:235], v[88:91], v[192:195]
    ds_read_b64_tr_b16 v[228:229], v241 offset:12288
    s_add_u32 m0, s29, 24576
    s_add_u32 s24, s24, s35
    buffer_load_dwordx4 v244, s[16:19], s24 offen sc1 lds
    v_mul_f32 v152, s28, v152
    v_mfma_f32_16x16x32_bf16 v[196:199], v[232:235], v[92:95], v[196:199]
    ds_read_b64_tr_b16 v[230:231], v241 offset:12800
    s_waitcnt lgkmcnt(4)
    v_mul_f32 v153, s28, v153
    v_mfma_f32_16x16x32_bf16 v[204:207], v[236:239], v[92:95], v[204:207]
    ds_read_b64_tr_b16 v[232:233], v242 offset:12288
    v_mul_f32 v154, s28, v154
    v_mfma_f32_16x16x32_bf16 v[200:203], v[236:239], v[88:91], v[200:203]
    ds_read_b64_tr_b16 v[234:235], v242 offset:12800
    s_waitcnt lgkmcnt(4)
    v_mul_f32 v155, s28, v155
    v_mfma_f32_16x16x32_bf16 v[176:179], v[224:227], v[96:99], v[176:179]
    ds_read_b64_tr_b16 v[236:237], v243 offset:12288
    v_cvt_pk_bf16_f32 v152, v152, v153
    v_mul_f32 v156, s28, v156
    v_mfma_f32_16x16x32_bf16 v[180:183], v[224:227], v[100:103], v[180:183]
    ds_read_b64_tr_b16 v[238:239], v243 offset:12800
    s_waitcnt lgkmcnt(4)
    v_cvt_pk_bf16_f32 v153, v154, v155
    v_mfma_f32_16x16x32_bf16 v[188:191], v[228:231], v[100:103], v[188:191]
    ds_read_b64_tr_b16 v[224:225], v240 offset:16384
    s_add_u32 m0, s29, 32768
    s_add_u32 s24, s24, s35
    buffer_load_dwordx4 v244, s[16:19], s24 offen sc1 lds
    buffer_store_dword v152, v246, s[12:15], s32 offen offset:0 sc1
    v_mfma_f32_16x16x32_bf16 v[184:187], v[228:231], v[96:99], v[184:187]
    ds_read_b64_tr_b16 v[226:227], v240 offset:16896
    s_waitcnt lgkmcnt(4)
    buffer_store_dword v153, v246, s[12:15], s33 offen offset:0 sc1
    v_mfma_f32_16x16x32_bf16 v[192:195], v[232:235], v[96:99], v[192:195]
    ds_read_b64_tr_b16 v[228:229], v241 offset:16384
    v_mul_f32 v157, s28, v157
    v_mfma_f32_16x16x32_bf16 v[196:199], v[232:235], v[100:103], v[196:199]
    ds_read_b64_tr_b16 v[230:231], v241 offset:16896
    s_waitcnt lgkmcnt(4)
    v_mul_f32 v158, s28, v158
    v_mul_f32 v159, s28, v159
    v_mfma_f32_16x16x32_bf16 v[204:207], v[236:239], v[100:103], v[204:207]
    ds_read_b64_tr_b16 v[232:233], v242 offset:16384
    v_cvt_pk_bf16_f32 v156, v156, v157
    v_mfma_f32_16x16x32_bf16 v[200:203], v[236:239], v[96:99], v[200:203]
    ds_read_b64_tr_b16 v[234:235], v242 offset:16896
    s_waitcnt lgkmcnt(4)
    v_cvt_pk_bf16_f32 v157, v158, v159
    s_setprio 0
    v_mfma_f32_16x16x32_bf16 v[176:179], v[224:227], v[104:107], v[176:179]
    ds_read_b64_tr_b16 v[236:237], v243 offset:16384
    s_add_u32 m0, s29, 40960
    s_add_u32 s24, s24, s35
    buffer_load_dwordx4 v244, s[16:19], s24 offen sc1 lds
    buffer_store_dword v156, v246, s[12:15], s32 offen offset:64 sc1
    v_mfma_f32_16x16x32_bf16 v[180:183], v[224:227], v[108:111], v[180:183]
    ds_read_b64_tr_b16 v[238:239], v243 offset:16896
    s_waitcnt lgkmcnt(4)
    buffer_store_dword v157, v246, s[12:15], s33 offen offset:64 sc1
    v_mfma_f32_16x16x32_bf16 v[188:191], v[228:231], v[108:111], v[188:191]
    ds_read_b64_tr_b16 v[224:225], v240 offset:20480
    s_add_u32 s32, s27, 131072
    s_add_u32 s33, s27, 139264
    v_mfma_f32_16x16x32_bf16 v[184:187], v[228:231], v[104:107], v[184:187]
    ds_read_b64_tr_b16 v[226:227], v240 offset:20992
    s_waitcnt lgkmcnt(4)
    v_mul_f32 v160, s28, v160
    v_mfma_f32_16x16x32_bf16 v[192:195], v[232:235], v[104:107], v[192:195]
    ds_read_b64_tr_b16 v[228:229], v241 offset:20480
    v_mul_f32 v161, s28, v161
    v_mfma_f32_16x16x32_bf16 v[196:199], v[232:235], v[108:111], v[196:199]
    ds_read_b64_tr_b16 v[230:231], v241 offset:20992
    s_waitcnt lgkmcnt(4)
    v_mul_f32 v162, s28, v162
    v_mfma_f32_16x16x32_bf16 v[204:207], v[236:239], v[108:111], v[204:207]
    ds_read_b64_tr_b16 v[232:233], v242 offset:20480
    s_add_u32 m0, s29, 49152
    s_add_u32 s24, s24, s35
    buffer_load_dwordx4 v244, s[16:19], s24 offen sc1 lds
    v_mul_f32 v163, s28, v163
    v_mfma_f32_16x16x32_bf16 v[200:203], v[236:239], v[104:107], v[200:203]
    ds_read_b64_tr_b16 v[234:235], v242 offset:20992
    s_waitcnt lgkmcnt(4)
    v_cvt_pk_bf16_f32 v160, v160, v161
    v_mul_f32 v164, s28, v164
    v_mfma_f32_16x16x32_bf16 v[176:179], v[224:227], v[112:115], v[176:179]
    ds_read_b64_tr_b16 v[236:237], v243 offset:20480
    v_cvt_pk_bf16_f32 v161, v162, v163
    v_mfma_f32_16x16x32_bf16 v[180:183], v[224:227], v[116:119], v[180:183]
    ds_read_b64_tr_b16 v[238:239], v243 offset:20992
    s_waitcnt lgkmcnt(4)
    buffer_store_dword v160, v246, s[12:15], s32 offen offset:0 sc1
    v_mfma_f32_16x16x32_bf16 v[188:191], v[228:231], v[116:119], v[188:191]
    ds_read_b64_tr_b16 v[224:225], v240 offset:24576
    buffer_store_dword v161, v246, s[12:15], s33 offen offset:0 sc1
    v_mfma_f32_16x16x32_bf16 v[184:187], v[228:231], v[112:115], v[184:187]
    ds_read_b64_tr_b16 v[226:227], v240 offset:25088
    s_waitcnt lgkmcnt(4)
    v_mul_f32 v165, s28, v165
    v_mfma_f32_16x16x32_bf16 v[192:195], v[232:235], v[112:115], v[192:195]
    ds_read_b64_tr_b16 v[228:229], v241 offset:24576
    s_add_u32 m0, s29, 57344
    s_add_u32 s24, s24, s35
    buffer_load_dwordx4 v244, s[16:19], s24 offen sc1 lds
    v_mul_f32 v166, s28, v166
    v_mul_f32 v167, s28, v167
    v_mfma_f32_16x16x32_bf16 v[196:199], v[232:235], v[116:119], v[196:199]
    ds_read_b64_tr_b16 v[230:231], v241 offset:25088
    s_waitcnt lgkmcnt(4)
    v_cvt_pk_bf16_f32 v164, v164, v165
    v_mfma_f32_16x16x32_bf16 v[204:207], v[236:239], v[116:119], v[204:207]
    ds_read_b64_tr_b16 v[232:233], v242 offset:24576
    v_cvt_pk_bf16_f32 v165, v166, v167
    v_mfma_f32_16x16x32_bf16 v[200:203], v[236:239], v[112:115], v[200:203]
    ds_read_b64_tr_b16 v[234:235], v242 offset:25088
    s_waitcnt lgkmcnt(4)
    buffer_store_dword v164, v246, s[12:15], s32 offen offset:64 sc1
    v_mfma_f32_16x16x32_bf16 v[176:179], v[224:227], v[120:123], v[176:179]
    ds_read_b64_tr_b16 v[236:237], v243 offset:24576
    buffer_store_dword v165, v246, s[12:15], s33 offen offset:64 sc1
    v_mfma_f32_16x16x32_bf16 v[180:183], v[224:227], v[124:127], v[180:183]
    ds_read_b64_tr_b16 v[238:239], v243 offset:25088
    s_waitcnt lgkmcnt(4)
    s_add_u32 s32, s27, 196608
    s_add_u32 s33, s27, 204800
    v_mfma_f32_16x16x32_bf16 v[188:191], v[228:231], v[124:127], v[188:191]
    ds_read_b64_tr_b16 v[224:225], v240 offset:28672
    s_add_u32 m0, s29, 65536
    s_add_u32 s24, s24, s35
    buffer_load_dwordx4 v244, s[16:19], s24 offen sc1 lds
    v_mul_f32 v168, s28, v168
    v_mfma_f32_16x16x32_bf16 v[184:187], v[228:231], v[120:123], v[184:187]
    ds_read_b64_tr_b16 v[226:227], v240 offset:29184
    s_waitcnt lgkmcnt(4)
    v_mul_f32 v169, s28, v169
    v_mfma_f32_16x16x32_bf16 v[192:195], v[232:235], v[120:123], v[192:195]
    ds_read_b64_tr_b16 v[228:229], v241 offset:28672
    v_mul_f32 v170, s28, v170
    v_mfma_f32_16x16x32_bf16 v[196:199], v[232:235], v[124:127], v[196:199]
    ds_read_b64_tr_b16 v[230:231], v241 offset:29184
    s_waitcnt lgkmcnt(4)
    v_mul_f32 v171, s28, v171
    v_mfma_f32_16x16x32_bf16 v[204:207], v[236:239], v[124:127], v[204:207]
    ds_read_b64_tr_b16 v[232:233], v242 offset:28672
    v_cvt_pk_bf16_f32 v168, v168, v169
    v_mul_f32 v172, s28, v172
    v_mfma_f32_16x16x32_bf16 v[200:203], v[236:239], v[120:123], v[200:203]
    ds_read_b64_tr_b16 v[234:235], v242 offset:29184
    s_waitcnt lgkmcnt(4)
    v_cvt_pk_bf16_f32 v169, v170, v171
    v_mfma_f32_16x16x32_bf16 v[176:179], v[224:227], v[128:131], v[176:179]
    ds_read_b64_tr_b16 v[236:237], v243 offset:28672
    buffer_store_dword v168, v246, s[12:15], s32 offen offset:0 sc1
    v_mfma_f32_16x16x32_bf16 v[180:183], v[224:227], v[132:135], v[180:183]
    ds_read_b64_tr_b16 v[238:239], v243 offset:29184
    s_waitcnt lgkmcnt(4)
    buffer_store_dword v169, v246, s[12:15], s33 offen offset:0 sc1
    v_mfma_f32_16x16x32_bf16 v[188:191], v[228:231], v[132:135], v[188:191]
    ds_read_b64_tr_b16 v[224:225], v240 offset:32768
    v_mul_f32 v173, s28, v173
    v_mfma_f32_16x16x32_bf16 v[184:187], v[228:231], v[128:131], v[184:187]
    ds_read_b64_tr_b16 v[226:227], v240 offset:33280
    s_waitcnt lgkmcnt(4)
    v_add_u32 v240, 0xfffe5000, v240
    v_mul_f32 v174, s28, v174
    v_mul_f32 v175, s28, v175
    v_mfma_f32_16x16x32_bf16 v[192:195], v[232:235], v[128:131], v[192:195]
    ds_read_b64_tr_b16 v[228:229], v241 offset:32768
    v_cvt_pk_bf16_f32 v172, v172, v173
    v_mfma_f32_16x16x32_bf16 v[196:199], v[232:235], v[132:135], v[196:199]
    ds_read_b64_tr_b16 v[230:231], v241 offset:33280
    s_waitcnt lgkmcnt(4)
    v_add_u32 v241, 0xfffe5000, v241
    v_cvt_pk_bf16_f32 v173, v174, v175
    v_mfma_f32_16x16x32_bf16 v[204:207], v[236:239], v[132:135], v[204:207]
    ds_read_b64_tr_b16 v[232:233], v242 offset:32768
    buffer_store_dword v172, v246, s[12:15], s32 offen offset:64 sc1
    v_mfma_f32_16x16x32_bf16 v[200:203], v[236:239], v[128:131], v[200:203]
    ds_read_b64_tr_b16 v[234:235], v242 offset:33280
    s_waitcnt lgkmcnt(4)
    v_add_u32 v242, 0xfffe5000, v242
    buffer_store_dword v173, v246, s[12:15], s33 offen offset:64 sc1
    v_mfma_f32_16x16x32_bf16 v[176:179], v[224:227], v[136:139], v[176:179]
    ds_read_b64_tr_b16 v[236:237], v243 offset:32768
    v_mfma_f32_16x16x32_bf16 v[180:183], v[224:227], v[140:143], v[180:183]
    ds_read_b64_tr_b16 v[238:239], v243 offset:33280
    s_waitcnt lgkmcnt(4)
    v_add_u32 v243, 0xfffe5000, v243
    s_waitcnt vmcnt(4)
    s_barrier
    v_mfma_f32_16x16x32_bf16 v[188:191], v[228:231], v[140:143], v[188:191]
    ds_read_b64_tr_b16 v[224:225], v240 offset:0
    v_mfma_f32_16x16x32_bf16 v[184:187], v[228:231], v[136:139], v[184:187]
    ds_read_b64_tr_b16 v[226:227], v240 offset:512
    s_waitcnt lgkmcnt(4)
    v_mfma_f32_16x16x32_bf16 v[192:195], v[232:235], v[136:139], v[192:195]
    ds_read_b64_tr_b16 v[228:229], v241 offset:0
    v_mfma_f32_16x16x32_bf16 v[196:199], v[232:235], v[140:143], v[196:199]
    ds_read_b64_tr_b16 v[230:231], v241 offset:512
    s_waitcnt lgkmcnt(4)
    v_mfma_f32_16x16x32_bf16 v[204:207], v[236:239], v[140:143], v[204:207]
    ds_read_b64_tr_b16 v[232:233], v242 offset:0
    v_mfma_f32_16x16x32_bf16 v[200:203], v[236:239], v[136:139], v[200:203]
    ds_read_b64_tr_b16 v[234:235], v242 offset:512
    s_waitcnt lgkmcnt(4)
    s_add_u32 s27, s27, 262144
    s_mov_b32 s28, 1.0
L1_qkr_tail:
    s_setprio 0
    s_nop 7
    s_add_u32 s32, s27, 0
    s_add_u32 s33, s27, 8192
    v_mul_f32 v176, s28, v176
    v_mul_f32 v177, s28, v177
    v_mul_f32 v178, s28, v178
    v_mul_f32 v179, s28, v179
    v_cvt_pk_bf16_f32 v176, v176, v177
    v_cvt_pk_bf16_f32 v177, v178, v179
    buffer_store_dword v176, v246, s[12:15], s32 offen offset:0 sc1
    buffer_store_dword v177, v246, s[12:15], s33 offen offset:0 sc1
    v_mul_f32 v180, s28, v180
    v_mul_f32 v181, s28, v181
    v_mul_f32 v182, s28, v182
    v_mul_f32 v183, s28, v183
    v_cvt_pk_bf16_f32 v180, v180, v181
    v_cvt_pk_bf16_f32 v181, v182, v183
    buffer_store_dword v180, v246, s[12:15], s32 offen offset:64 sc1
    buffer_store_dword v181, v246, s[12:15], s33 offen offset:64 sc1
    s_add_u32 s32, s27, 65536
    s_add_u32 s33, s27, 73728
    v_mul_f32 v184, s28, v184
    v_mul_f32 v185, s28, v185
    v_mul_f32 v186, s28, v186
    v_mul_f32 v187, s28, v187
    v_cvt_pk_bf16_f32 v184, v184, v185
    v_cvt_pk_bf16_f32 v185, v186, v187
    buffer_store_dword v184, v246, s[12:15], s32 offen offset:0 sc1
    buffer_store_dword v185, v246, s[12:15], s33 offen offset:0 sc1
    v_mul_f32 v188, s28, v188
    v_mul_f32 v189, s28, v189
    v_mul_f32 v190, s28, v190
    v_mul_f32 v191, s28, v191
    v_cvt_pk_bf16_f32 v188, v188, v189
    v_cvt_pk_bf16_f32 v189, v190, v191
    buffer_store_dword v188, v246, s[12:15], s32 offen offset:64 sc1
    buffer_store_dword v189, v246, s[12:15], s33 offen offset:64 sc1
    s_add_u32 s32, s27, 131072
    s_add_u32 s33, s27, 139264
    v_mul_f32 v192, s28, v192
    v_mul_f32 v193, s28, v193
    v_mul_f32 v194, s28, v194
    v_mul_f32 v195, s28, v195
    v_cvt_pk_bf16_f32 v192, v192, v193
    v_cvt_pk_bf16_f32 v193, v194, v195
    buffer_store_dword v192, v246, s[12:15], s32 offen offset:0 sc1
    buffer_store_dword v193, v246, s[12:15], s33 offen offset:0 sc1
    v_mul_f32 v196, s28, v196
    v_mul_f32 v197, s28, v197
    v_mul_f32 v198, s28, v198
    v_mul_f32 v199, s28, v199
    v_cvt_pk_bf16_f32 v196, v196, v197
    v_cvt_pk_bf16_f32 v197, v198, v199
    buffer_store_dword v196, v246, s[12:15], s32 offen offset:64 sc1
    buffer_store_dword v197, v246, s[12:15], s33 offen offset:64 sc1
    s_add_u32 s32, s27, 196608
    s_add_u32 s33, s27, 204800
    v_mul_f32 v200, s28, v200
    v_mul_f32 v201, s28, v201
    v_mul_f32 v202, s28, v202
    v_mul_f32 v203, s28, v203
    v_cvt_pk_bf16_f32 v200, v200, v201
    v_cvt_pk_bf16_f32 v201, v202, v203
    buffer_store_dword v200, v246, s[12:15], s32 offen offset:0 sc1
    buffer_store_dword v201, v246, s[12:15], s33 offen offset:0 sc1
    v_mul_f32 v204, s28, v204
    v_mul_f32 v205, s28, v205
    v_mul_f32 v206, s28, v206
    v_mul_f32 v207, s28, v207
    v_cvt_pk_bf16_f32 v204, v204, v205
    v_cvt_pk_bf16_f32 v205, v206, v207
    buffer_store_dword v204, v246, s[12:15], s32 offen offset:64 sc1
    buffer_store_dword v205, v246, s[12:15], s33 offen offset:64 sc1
    s_waitcnt lgkmcnt(0)
    s_branch L1_sp_tail
L1_vr:
    v_lshrrev_b32 v249, 4, v247
    v_bfe_u32 v250, v247, 2, 2
    v_lshl_add_u32 v250, v249, 3, v250
    v_lshlrev_b32 v250, 7, v250
    v_and_b32 v251, 3, v247
    v_lshl_add_u32 v250, v251, 3, v250
    v_bfe_u32 v249, v247, 3, 2
    v_xor_b32 v251, 0, v249
    v_lshl_add_u32 v240, v251, 5, v250
    v_xor_b32 v251, 1, v249
    v_lshl_add_u32 v241, v251, 5, v250
    v_xor_b32 v251, 2, v249
    v_lshl_add_u32 v242, v251, 5, v250
    v_xor_b32 v251, 3, v249
    v_lshl_add_u32 v243, v251, 5, v250
    v_and_b32 v249, 15, v247
    v_lshrrev_b32 v250, 4, v247
    v_and_b32 v251, 1, v250
    v_mul_u32_u24 v246, 320, v251
    v_lshrrev_b32 v251, 1, v250
    v_lshl_add_u32 v246, v251, 3, v246
    v_and_b32 v251, 1, v249
    v_lshl_add_u32 v246, v251, 4, v246
    v_add_u32 v246, 256, v246
    v_lshrrev_b32 v251, 1, v249
    v_mul_u32_u24 v251, 81920, v251
    v_add_u32 v246, v246, v251
    s_mov_b32 s38, s28
    s_mov_b32 s39, s28
    s_waitcnt vmcnt(0) lgkmcnt(0)
    s_barrier
    s_add_u32 m0, s29, 0
    s_mov_b32 s24, s25
    buffer_load_dwordx4 v244, s[16:19], s24 offen sc1 lds
    s_add_u32 m0, s29, 8192
    s_add_u32 s24, s24, s35
    buffer_load_dwordx4 v244, s[16:19], s24 offen sc1 lds
    s_add_u32 m0, s29, 16384
    s_add_u32 s24, s24, s35
    buffer_load_dwordx4 v244, s[16:19], s24 offen sc1 lds
    s_add_u32 m0, s29, 24576
    s_add_u32 s24, s24, s35
    buffer_load_dwordx4 v244, s[16:19], s24 offen sc1 lds
    s_add_u32 m0, s29, 32768
    s_add_u32 s24, s24, s35
    buffer_load_dwordx4 v244, s[16:19], s24 offen sc1 lds
    s_add_u32 m0, s29, 40960
    s_add_u32 s24, s24, s35
    buffer_load_dwordx4 v244, s[16:19], s24 offen sc1 lds
    s_add_u32 m0, s29, 49152
    s_add_u32 s24, s24, s35
    buffer_load_dwordx4 v244, s[16:19], s24 offen sc1 lds
    s_add_u32 m0, s29, 57344
    s_add_u32 s24, s24, s35
    buffer_load_dwordx4 v244, s[16:19], s24 offen sc1 lds
    s_add_u32 m0, s29, 65536
    s_add_u32 s24, s24, s35
    buffer_load_dwordx4 v244, s[16:19], s24 offen sc1 lds
    s_add_u32 s25, s25, 0
    s_waitcnt vmcnt(0)
    s_barrier
    v_mov_b32 v248, 157736
    ds_read_b64 v[248:249], v248
    s_add_u32 s34, s30, 0
    buffer_load_dwordx4 v[0:3], v245, s[12:15], s34 offen offset:0 sc1
    buffer_load_dwordx4 v[4:7], v245, s[12:15], s34 offen offset:1024 sc1
    s_add_u32 s34, s30, 4096
    buffer_load_dwordx4 v[8:11], v245, s[12:15], s34 offen offset:0 sc1
    buffer_load_dwordx4 v[12:15], v245, s[12:15], s34 offen offset:1024 sc1
    s_add_u32 s34, s30, 8192
    buffer_load_dwordx4 v[16:19], v245, s[12:15], s34 offen offset:0 sc1
    buffer_load_dwordx4 v[20:23], v245, s[12:15], s34 offen offset:1024 sc1
    s_add_u32 s34, s30, 12288
    buffer_load_dwordx4 v[24:27], v245, s[12:15], s34 offen offset:0 sc1
    buffer_load_dwordx4 v[28:31], v245, s[12:15], s34 offen offset:1024 sc1
    s_waitcnt lgkmcnt(0)
    v_readfirstlane_b32 s44, v248
    v_readfirstlane_b32 s45, v249
    ds_read_b64_tr_b16 v[224:225], v240 offset:0
    ds_read_b64_tr_b16 v[226:227], v240 offset:512
    ds_read_b64_tr_b16 v[228:229], v241 offset:0
    ds_read_b64_tr_b16 v[230:231], v241 offset:512
    ds_read_b64_tr_b16 v[232:233], v242 offset:0
    ds_read_b64_tr_b16 v[234:235], v242 offset:512
    s_waitcnt lgkmcnt(4)
    s_cmp_lt_u32 s3, 4
    s_cselect_b64 vcc, -1, 0
    s_cbranch_vccnz Lp15
    s_setprio 1
Lp15:
    s_waitcnt vmcnt(6)
    v_mfma_f32_16x16x32_bf16 v[144:147], v[0:3], v[224:227], 0
    ds_read_b64_tr_b16 v[236:237], v243 offset:0
    s_add_u32 s34, s30, 16384
    buffer_load_dwordx4 v[32:35], v245, s[12:15], s34 offen offset:0 sc1
    v_mfma_f32_16x16x32_bf16 v[148:151], v[4:7], v[224:227], 0
    ds_read_b64_tr_b16 v[238:239], v243 offset:512
    s_waitcnt lgkmcnt(4)
    v_mfma_f32_16x16x32_bf16 v[156:159], v[4:7], v[228:231], 0
    ds_read_b64_tr_b16 v[224:225], v240 offset:4096
    buffer_load_dwordx4 v[36:39], v245, s[12:15], s34 offen offset:1024 sc1
    v_mfma_f32_16x16x32_bf16 v[152:155], v[0:3], v[228:231], 0
    ds_read_b64_tr_b16 v[226:227], v240 offset:4608
    s_waitcnt lgkmcnt(4)
    v_mfma_f32_16x16x32_bf16 v[160:163], v[0:3], v[232:235], 0
    ds_read_b64_tr_b16 v[228:229], v241 offset:4096
    s_add_u32 s34, s30, 20480
    buffer_load_dwordx4 v[40:43], v245, s[12:15], s34 offen offset:0 sc1
    v_mfma_f32_16x16x32_bf16 v[164:167], v[4:7], v[232:235], 0
    ds_read_b64_tr_b16 v[230:231], v241 offset:4608
    s_waitcnt lgkmcnt(4)
    v_mfma_f32_16x16x32_bf16 v[172:175], v[4:7], v[236:239], 0
    ds_read_b64_tr_b16 v[232:233], v242 offset:4096
    buffer_load_dwordx4 v[44:47], v245, s[12:15], s34 offen offset:1024 sc1
    v_mfma_f32_16x16x32_bf16 v[168:171], v[0:3], v[236:239], 0
    ds_read_b64_tr_b16 v[234:235], v242 offset:4608
    s_waitcnt lgkmcnt(4)
    s_waitcnt vmcnt(8)
    v_mfma_f32_16x16x32_bf16 v[144:147], v[8:11], v[224:227], v[144:147]
    ds_read_b64_tr_b16 v[236:237], v243 offset:4096
    s_add_u32 s34, s30, 24576
    buffer_load_dwordx4 v[48:51], v245, s[12:15], s34 offen offset:0 sc1
    v_mfma_f32_16x16x32_bf16 v[148:151], v[12:15], v[224:227], v[148:151]
    ds_read_b64_tr_b16 v[238:239], v243 offset:4608
    s_waitcnt lgkmcnt(4)
    v_mfma_f32_16x16x32_bf16 v[156:159], v[12:15], v[228:231], v[156:159]
    ds_read_b64_tr_b16 v[224:225], v240 offset:8192
    buffer_load_dwordx4 v[52:55], v245, s[12:15], s34 offen offset:1024 sc1
    v_mfma_f32_16x16x32_bf16 v[152:155], v[8:11], v[228:231], v[152:155]
    ds_read_b64_tr_b16 v[226:227], v240 offset:8704
    s_waitcnt lgkmcnt(4)
    v_mfma_f32_16x16x32_bf16 v[160:163], v[8:11], v[232:235], v[160:163]
    ds_read_b64_tr_b16 v[228:229], v241 offset:8192
    s_add_u32 s34, s30, 28672
    buffer_load_dwordx4 v[56:59], v245, s[12:15], s34 offen offset:0 sc1
    v_mfma_f32_16x16x32_bf16 v[164:167], v[12:15], v[232:235], v[164:167]
    ds_read_b64_tr_b16 v[230:231], v241 offset:8704
    s_waitcnt lgkmcnt(4)
    v_mfma_f32_16x16x32_bf16 v[172:175], v[12:15], v[236:239], v[172:175]
    ds_read_b64_tr_b16 v[232:233], v242 offset:8192
    buffer_load_dwordx4 v[60:63], v245, s[12:15], s34 offen offset:1024 sc1
    v_mfma_f32_16x16x32_bf16 v[168:171], v[8:11], v[236:239], v[168:171]
    ds_read_b64_tr_b16 v[234:235], v242 offset:8704
    s_waitcnt lgkmcnt(4)
    s_waitcnt vmcnt(10)
    v_mfma_f32_16x16x32_bf16 v[144:147], v[16:19], v[224:227], v[144:147]
    ds_read_b64_tr_b16 v[236:237], v243 offset:8192
    s_add_u32 s34, s30, 32768
    buffer_load_dwordx4 v[64:67], v245, s[12:15], s34 offen offset:0 sc1
    v_mfma_f32_16x16x32_bf16 v[148:151], v[20:23], v[224:227], v[148:151]
    ds_read_b64_tr_b16 v[238:239], v243 offset:8704
    s_waitcnt lgkmcnt(4)
    v_mfma_f32_16x16x32_bf16 v[156:159], v[20:23], v[228:231], v[156:159]
    ds_read_b64_tr_b16 v[224:225], v240 offset:12288
    buffer_load_dwordx4 v[68:71], v245, s[12:15], s34 offen offset:1024 sc1
    v_mfma_f32_16x16x32_bf16 v[152:155], v[16:19], v[228:231], v[152:155]
    ds_read_b64_tr_b16 v[226:227], v240 offset:12800
    s_waitcnt lgkmcnt(4)
    v_mfma_f32_16x16x32_bf16 v[160:163], v[16:19], v[232:235], v[160:163]
    ds_read_b64_tr_b16 v[228:229], v241 offset:12288
    s_add_u32 s34, s30, 36864
    buffer_load_dwordx4 v[72:75], v245, s[12:15], s34 offen offset:0 sc1
    v_mfma_f32_16x16x32_bf16 v[164:167], v[20:23], v[232:235], v[164:167]
    ds_read_b64_tr_b16 v[230:231], v241 offset:12800
    s_waitcnt lgkmcnt(4)
    v_mfma_f32_16x16x32_bf16 v[172:175], v[20:23], v[236:239], v[172:175]
    ds_read_b64_tr_b16 v[232:233], v242 offset:12288
    buffer_load_dwordx4 v[76:79], v245, s[12:15], s34 offen offset:1024 sc1
    v_mfma_f32_16x16x32_bf16 v[168:171], v[16:19], v[236:239], v[168:171]
    ds_read_b64_tr_b16 v[234:235], v242 offset:12800
    s_waitcnt lgkmcnt(4)
    s_waitcnt vmcnt(12)
    v_mfma_f32_16x16x32_bf16 v[144:147], v[24:27], v[224:227], v[144:147]
    ds_read_b64_tr_b16 v[236:237], v243 offset:12288
    s_add_u32 s34, s30, 40960
    buffer_load_dwordx4 v[80:83], v245, s[12:15], s34 offen offset:0 sc1
    v_mfma_f32_16x16x32_bf16 v[148:151], v[28:31], v[224:227], v[148:151]
    ds_read_b64_tr_b16 v[238:239], v243 offset:12800
    s_waitcnt lgkmcnt(4)
    v_mfma_f32_16x16x32_bf16 v[156:159], v[28:31], v[228:231], v[156:159]
    ds_read_b64_tr_b16 v[224:225], v240 offset:16384
    buffer_load_dwordx4 v[84:87], v245, s[12:15], s34 offen offset:1024 sc1
    v_mfma_f32_16x16x32_bf16 v[152:155], v[24:27], v[228:231], v[152:155]
    ds_read_b64_tr_b16 v[226:227], v240 offset:16896
    s_waitcnt lgkmcnt(4)
    v_mfma_f32_16x16x32_bf16 v[160:163], v[24:27], v[232:235], v[160:163]
    ds_read_b64_tr_b16 v[228:229], v241 offset:16384
    s_add_u32 s34, s30, 45056
    buffer_load_dwordx4 v[88:91], v245, s[12:15], s34 offen offset:0 sc1
    v_mfma_f32_16x16x32_bf16 v[164:167], v[28:31], v[232:235], v[164:167]
    ds_read_b64_tr_b16 v[230:231], v241 offset:16896
    s_waitcnt lgkmcnt(4)
    v_mfma_f32_16x16x32_bf16 v[172:175], v[28:31], v[236:239], v[172:175]
    ds_read_b64_tr_b16 v[232:233], v242 offset:16384
    buffer_load_dwordx4 v[92:95], v245, s[12:15], s34 offen offset:1024 sc1
    v_mfma_f32_16x16x32_bf16 v[168:171], v[24:27], v[236:239], v[168:171]
    ds_read_b64_tr_b16 v[234:235], v242 offset:16896
    s_waitcnt lgkmcnt(4)
    s_waitcnt vmcnt(14)
    v_mfma_f32_16x16x32_bf16 v[144:147], v[32:35], v[224:227], v[144:147]
    ds_read_b64_tr_b16 v[236:237], v243 offset:16384
    s_add_u32 s34, s30, 49152
    buffer_load_dwordx4 v[96:99], v245, s[12:15], s34 offen offset:0 sc1
    v_mfma_f32_16x16x32_bf16 v[148:151], v[36:39], v[224:227], v[148:151]
    ds_read_b64_tr_b16 v[238:239], v243 offset:16896
    s_waitcnt lgkmcnt(4)
    v_mfma_f32_16x16x32_bf16 v[156:159], v[36:39], v[228:231], v[156:159]
    ds_read_b64_tr_b16 v[224:225], v240 offset:20480
    buffer_load_dwordx4 v[100:103], v245, s[12:15], s34 offen offset:1024 sc1
    v_mfma_f32_16x16x32_bf16 v[152:155], v[32:35], v[228:231], v[152:155]
    ds_read_b64_tr_b16 v[226:227], v240 offset:20992
    s_waitcnt lgkmcnt(4)
    v_mfma_f32_16x16x32_bf16 v[160:163], v[32:35], v[232:235], v[160:163]
    ds_read_b64_tr_b16 v[228:229], v241 offset:20480
    s_add_u32 s34, s30, 53248
    buffer_load_dwordx4 v[104:107], v245, s[12:15], s34 offen offset:0 sc1
    v_mfma_f32_16x16x32_bf16 v[164:167], v[36:39], v[232:235], v[164:167]
    ds_read_b64_tr_b16 v[230:231], v241 offset:20992
    s_waitcnt lgkmcnt(4)
    v_mfma_f32_16x16x32_bf16 v[172:175], v[36:39], v[236:239], v[172:175]
    ds_read_b64_tr_b16 v[232:233], v242 offset:20480
    buffer_load_dwordx4 v[108:111], v245, s[12:15], s34 offen offset:1024 sc1
    v_mfma_f32_16x16x32_bf16 v[168:171], v[32:35], v[236:239], v[168:171]
    ds_read_b64_tr_b16 v[234:235], v242 offset:20992
    s_waitcnt lgkmcnt(4)
    s_waitcnt vmcnt(16)
    v_mfma_f32_16x16x32_bf16 v[144:147], v[40:43], v[224:227], v[144:147]
    ds_read_b64_tr_b16 v[236:237], v243 offset:20480
    s_add_u32 s34, s30, 57344
    buffer_load_dwordx4 v[112:115], v245, s[12:15], s34 offen offset:0 sc1
    v_mfma_f32_16x16x32_bf16 v[148:151], v[44:47], v[224:227], v[148:151]
    ds_read_b64_tr_b16 v[238:239], v243 offset:20992
    s_waitcnt lgkmcnt(4)
    v_mfma_f32_16x16x32_bf16 v[156:159], v[44:47], v[228:231], v[156:159]
    ds_read_b64_tr_b16 v[224:225], v240 offset:24576
    buffer_load_dwordx4 v[116:119], v245, s[12:15], s34 offen offset:1024 sc1
    v_mfma_f32_16x16x32_bf16 v[152:155], v[40:43], v[228:231], v[152:155]
    ds_read_b64_tr_b16 v[226:227], v240 offset:25088
    s_waitcnt lgkmcnt(4)
    v_mfma_f32_16x16x32_bf16 v[160:163], v[40:43], v[232:235], v[160:163]
    ds_read_b64_tr_b16 v[228:229], v241 offset:24576
    s_add_u32 s34, s30, 61440
    buffer_load_dwordx4 v[120:123], v245, s[12:15], s34 offen offset:0 sc1
    v_mfma_f32_16x16x32_bf16 v[164:167], v[44:47], v[232:235], v[164:167]
    ds_read_b64_tr_b16 v[230:231], v241 offset:25088
    s_waitcnt lgkmcnt(4)
    v_mfma_f32_16x16x32_bf16 v[172:175], v[44:47], v[236:239], v[172:175]
    ds_read_b64_tr_b16 v[232:233], v242 offset:24576
    buffer_load_dwordx4 v[124:127], v245, s[12:15], s34 offen offset:1024 sc1
    v_mfma_f32_16x16x32_bf16 v[168:171], v[40:43], v[236:239], v[168:171]
    ds_read_b64_tr_b16 v[234:235], v242 offset:25088
    s_waitcnt lgkmcnt(4)
    s_waitcnt vmcnt(18)
    v_mfma_f32_16x16x32_bf16 v[144:147], v[48:51], v[224:227], v[144:147]
    ds_read_b64_tr_b16 v[236:237], v243 offset:24576
    s_add_u32 s34, s30, 65536
    buffer_load_dwordx4 v[128:131], v245, s[12:15], s34 offen offset:0 sc1
    v_mfma_f32_16x16x32_bf16 v[148:151], v[52:55], v[224:227], v[148:151]
    ds_read_b64_tr_b16 v[238:239], v243 offset:25088
    s_waitcnt lgkmcnt(4)
    v_mfma_f32_16x16x32_bf16 v[156:159], v[52:55], v[228:231], v[156:159]
    ds_read_b64_tr_b16 v[224:225], v240 offset:28672
    buffer_load_dwordx4 v[132:135], v245, s[12:15], s34 offen offset:1024 sc1
    v_mfma_f32_16x16x32_bf16 v[152:155], v[48:51], v[228:231], v[152:155]
    ds_read_b64_tr_b16 v[226:227], v240 offset:29184
    s_waitcnt lgkmcnt(4)
    v_mfma_f32_16x16x32_bf16 v[160:163], v[48:51], v[232:235], v[160:163]
    ds_read_b64_tr_b16 v[228:229], v241 offset:28672
    s_add_u32 s34, s30, 69632
    buffer_load_dwordx4 v[136:139], v245, s[12:15], s34 offen offset:0 sc1
    v_mfma_f32_16x16x32_bf16 v[164:167], v[52:55], v[232:235], v[164:167]
    ds_read_b64_tr_b16 v[230:231], v241 offset:29184
    s_waitcnt lgkmcnt(4)
    v_mfma_f32_16x16x32_bf16 v[172:175], v[52:55], v[236:239], v[172:175]
    ds_read_b64_tr_b16 v[232:233], v242 offset:28672
    buffer_load_dwordx4 v[140:143], v245, s[12:15], s34 offen offset:1024 sc1
    v_mfma_f32_16x16x32_bf16 v[168:171], v[48:51], v[236:239], v[168:171]
    ds_read_b64_tr_b16 v[234:235], v242 offset:29184
    s_waitcnt lgkmcnt(4)
    s_waitcnt vmcnt(20)
    v_mfma_f32_16x16x32_bf16 v[144:147], v[56:59], v[224:227], v[144:147]
    ds_read_b64_tr_b16 v[236:237], v243 offset:28672
    buffer_load_dword v255, v255, s[60:63], s47 offen
    v_mfma_f32_16x16x32_bf16 v[148:151], v[60:63], v[224:227], v[148:151]
    ds_read_b64_tr_b16 v[238:239], v243 offset:29184
    s_waitcnt lgkmcnt(4)
    v_mfma_f32_16x16x32_bf16 v[156:159], v[60:63], v[228:231], v[156:159]
    ds_read_b64_tr_b16 v[224:225], v240 offset:32768
    buffer_load_dword v254, v254, s[64:67], 0 offen
    v_mfma_f32_16x16x32_bf16 v[152:155], v[56:59], v[228:231], v[152:155]
    ds_read_b64_tr_b16 v[226:227], v240 offset:33280
    s_waitcnt lgkmcnt(4)
    v_add_u32 v240, 0x9000, v240
    v_mfma_f32_16x16x32_bf16 v[160:163], v[56:59], v[232:235], v[160:163]
    ds_read_b64_tr_b16 v[228:229], v241 offset:32768
    v_mfma_f32_16x16x32_bf16 v[164:167], v[60:63], v[232:235], v[164:167]
    ds_read_b64_tr_b16 v[230:231], v241 offset:33280
    s_waitcnt lgkmcnt(4)
    v_add_u32 v241, 0x9000, v241
    v_mfma_f32_16x16x32_bf16 v[172:175], v[60:63], v[236:239], v[172:175]
    ds_read_b64_tr_b16 v[232:233], v242 offset:32768
    v_mfma_f32_16x16x32_bf16 v[168:171], v[56:59], v[236:239], v[168:171]
    ds_read_b64_tr_b16 v[234:235], v242 offset:33280
    s_waitcnt lgkmcnt(4)
    v_add_u32 v242, 0x9000, v242
    s_waitcnt vmcnt(20)
    v_mfma_f32_16x16x32_bf16 v[144:147], v[64:67], v[224:227], v[144:147]
    ds_read_b64_tr_b16 v[236:237], v243 offset:32768
    v_mfma_f32_16x16x32_bf16 v[148:151], v[68:71], v[224:227], v[148:151]
    ds_read_b64_tr_b16 v[238:239], v243 offset:33280
    s_waitcnt lgkmcnt(4)
    v_add_u32 v243, 0x9000, v243
    v_mfma_f32_16x16x32_bf16 v[156:159], v[68:71], v[228:231], v[156:159]
    ds_read_b64_tr_b16 v[224:225], v240 offset:0
    v_mfma_f32_16x16x32_bf16 v[152:155], v[64:67], v[228:231], v[152:155]
    ds_read_b64_tr_b16 v[226:227], v240 offset:512
    s_waitcnt lgkmcnt(4)
    v_mfma_f32_16x16x32_bf16 v[160:163], v[64:67], v[232:235], v[160:163]
    ds_read_b64_tr_b16 v[228:229], v241 offset:0
    v_mfma_f32_16x16x32_bf16 v[164:167], v[68:71], v[232:235], v[164:167]
    ds_read_b64_tr_b16 v[230:231], v241 offset:512
    s_waitcnt lgkmcnt(4)
    v_mfma_f32_16x16x32_bf16 v[172:175], v[68:71], v[236:239], v[172:175]
    ds_read_b64_tr_b16 v[232:233], v242 offset:0
    v_mfma_f32_16x16x32_bf16 v[168:171], v[64:67], v[236:239], v[168:171]
    ds_read_b64_tr_b16 v[234:235], v242 offset:512
    s_waitcnt lgkmcnt(4)
    s_waitcnt vmcnt(18)
    v_mfma_f32_16x16x32_bf16 v[144:147], v[72:75], v[224:227], v[144:147]
    ds_read_b64_tr_b16 v[236:237], v243 offset:0
    v_mfma_f32_16x16x32_bf16 v[148:151], v[76:79], v[224:227], v[148:151]
    ds_read_b64_tr_b16 v[238:239], v243 offset:512
    s_waitcnt lgkmcnt(4)
    v_mfma_f32_16x16x32_bf16 v[156:159], v[76:79], v[228:231], v[156:159]
    ds_read_b64_tr_b16 v[224:225], v240 offset:4096
    v_mfma_f32_16x16x32_bf16 v[152:155], v[72:75], v[228:231], v[152:155]
    ds_read_b64_tr_b16 v[226:227], v240 offset:4608
    s_waitcnt lgkmcnt(4)
    v_mfma_f32_16x16x32_bf16 v[160:163], v[72:75], v[232:235], v[160:163]
    ds_read_b64_tr_b16 v[228:229], v241 offset:4096
    v_mfma_f32_16x16x32_bf16 v[164:167], v[76:79], v[232:235], v[164:167]
    ds_read_b64_tr_b16 v[230:231], v241 offset:4608
    s_waitcnt lgkmcnt(4)
    v_mfma_f32_16x16x32_bf16 v[172:175], v[76:79], v[236:239], v[172:175]
    ds_read_b64_tr_b16 v[232:233], v242 offset:4096
    v_mfma_f32_16x16x32_bf16 v[168:171], v[72:75], v[236:239], v[168:171]
    ds_read_b64_tr_b16 v[234:235], v242 offset:4608
    s_waitcnt lgkmcnt(4)
    s_waitcnt vmcnt(16)
    v_mfma_f32_16x16x32_bf16 v[144:147], v[80:83], v[224:227], v[144:147]
    ds_read_b64_tr_b16 v[236:237], v243 offset:4096
    v_mfma_f32_16x16x32_bf16 v[148:151], v[84:87], v[224:227], v[148:151]
    ds_read_b64_tr_b16 v[238:239], v243 offset:4608
    s_waitcnt lgkmcnt(4)
    v_mfma_f32_16x16x32_bf16 v[156:159], v[84:87], v[228:231], v[156:159]
    ds_read_b64_tr_b16 v[224:225], v240 offset:8192
    v_mfma_f32_16x16x32_bf16 v[152:155], v[80:83], v[228:231], v[152:155]
    ds_read_b64_tr_b16 v[226:227], v240 offset:8704
    s_waitcnt lgkmcnt(4)
    v_mfma_f32_16x16x32_bf16 v[160:163], v[80:83], v[232:235], v[160:163]
    ds_read_b64_tr_b16 v[228:229], v241 offset:8192
    v_mfma_f32_16x16x32_bf16 v[164:167], v[84:87], v[232:235], v[164:167]
    ds_read_b64_tr_b16 v[230:231], v241 offset:8704
    s_waitcnt lgkmcnt(4)
    v_mfma_f32_16x16x32_bf16 v[172:175], v[84:87], v[236:239], v[172:175]
    ds_read_b64_tr_b16 v[232:233], v242 offset:8192
    v_mfma_f32_16x16x32_bf16 v[168:171], v[80:83], v[236:239], v[168:171]
    ds_read_b64_tr_b16 v[234:235], v242 offset:8704
    s_waitcnt lgkmcnt(4)
    s_waitcnt vmcnt(14)
    v_mfma_f32_16x16x32_bf16 v[144:147], v[88:91], v[224:227], v[144:147]
    ds_read_b64_tr_b16 v[236:237], v243 offset:8192
    v_mfma_f32_16x16x32_bf16 v[148:151], v[92:95], v[224:227], v[148:151]
    ds_read_b64_tr_b16 v[238:239], v243 offset:8704
    s_waitcnt lgkmcnt(4)
    v_mfma_f32_16x16x32_bf16 v[156:159], v[92:95], v[228:231], v[156:159]
    ds_read_b64_tr_b16 v[224:225], v240 offset:12288
    v_mfma_f32_16x16x32_bf16 v[152:155], v[88:91], v[228:231], v[152:155]
    ds_read_b64_tr_b16 v[226:227], v240 offset:12800
    s_waitcnt lgkmcnt(4)
    v_mfma_f32_16x16x32_bf16 v[160:163], v[88:91], v[232:235], v[160:163]
    ds_read_b64_tr_b16 v[228:229], v241 offset:12288
    v_mfma_f32_16x16x32_bf16 v[164:167], v[92:95], v[232:235], v[164:167]
    ds_read_b64_tr_b16 v[230:231], v241 offset:12800
    s_waitcnt lgkmcnt(4)
    v_mfma_f32_16x16x32_bf16 v[172:175], v[92:95], v[236:239], v[172:175]
    ds_read_b64_tr_b16 v[232:233], v242 offset:12288
    v_mfma_f32_16x16x32_bf16 v[168:171], v[88:91], v[236:239], v[168:171]
    ds_read_b64_tr_b16 v[234:235], v242 offset:12800
    s_waitcnt lgkmcnt(4)
    s_waitcnt vmcnt(12)
    v_mfma_f32_16x16x32_bf16 v[144:147], v[96:99], v[224:227], v[144:147]
    ds_read_b64_tr_b16 v[236:237], v243 offset:12288
    v_mfma_f32_16x16x32_bf16 v[148:151], v[100:103], v[224:227], v[148:151]
    ds_read_b64_tr_b16 v[238:239], v243 offset:12800
    s_waitcnt lgkmcnt(4)
    v_mfma_f32_16x16x32_bf16 v[156:159], v[100:103], v[228:231], v[156:159]
    ds_read_b64_tr_b16 v[224:225], v240 offset:16384
    v_mfma_f32_16x16x32_bf16 v[152:155], v[96:99], v[228:231], v[152:155]
    ds_read_b64_tr_b16 v[226:227], v240 offset:16896
    s_waitcnt lgkmcnt(4)
    v_mfma_f32_16x16x32_bf16 v[160:163], v[96:99], v[232:235], v[160:163]
    ds_read_b64_tr_b16 v[228:229], v241 offset:16384
    v_mfma_f32_16x16x32_bf16 v[164:167], v[100:103], v[232:235], v[164:167]
    ds_read_b64_tr_b16 v[230:231], v241 offset:16896
    s_waitcnt lgkmcnt(4)
    v_mfma_f32_16x16x32_bf16 v[172:175], v[100:103], v[236:239], v[172:175]
    ds_read_b64_tr_b16 v[232:233], v242 offset:16384
    v_mfma_f32_16x16x32_bf16 v[168:171], v[96:99], v[236:239], v[168:171]
    ds_read_b64_tr_b16 v[234:235], v242 offset:16896
    s_waitcnt lgkmcnt(4)
    s_setprio 0
    s_waitcnt vmcnt(10)
    v_mfma_f32_16x16x32_bf16 v[144:147], v[104:107], v[224:227], v[144:147]
    ds_read_b64_tr_b16 v[236:237], v243 offset:16384
    v_mfma_f32_16x16x32_bf16 v[148:151], v[108:111], v[224:227], v[148:151]
    ds_read_b64_tr_b16 v[238:239], v243 offset:16896
    s_waitcnt lgkmcnt(4)
    v_mfma_f32_16x16x32_bf16 v[156:159], v[108:111], v[228:231], v[156:159]
    ds_read_b64_tr_b16 v[224:225], v240 offset:20480
    v_mfma_f32_16x16x32_bf16 v[152:155], v[104:107], v[228:231], v[152:155]
    ds_read_b64_tr_b16 v[226:227], v240 offset:20992
    s_waitcnt lgkmcnt(4)
    v_mfma_f32_16x16x32_bf16 v[160:163], v[104:107], v[232:235], v[160:163]
    ds_read_b64_tr_b16 v[228:229], v241 offset:20480
    v_mfma_f32_16x16x32_bf16 v[164:167], v[108:111], v[232:235], v[164:167]
    ds_read_b64_tr_b16 v[230:231], v241 offset:20992
    s_waitcnt lgkmcnt(4)
    v_mfma_f32_16x16x32_bf16 v[172:175], v[108:111], v[236:239], v[172:175]
    ds_read_b64_tr_b16 v[232:233], v242 offset:20480
    v_mfma_f32_16x16x32_bf16 v[168:171], v[104:107], v[236:239], v[168:171]
    ds_read_b64_tr_b16 v[234:235], v242 offset:20992
    s_waitcnt lgkmcnt(4)
    s_waitcnt vmcnt(8)
    v_mfma_f32_16x16x32_bf16 v[144:147], v[112:115], v[224:227], v[144:147]
    ds_read_b64_tr_b16 v[236:237], v243 offset:20480
    v_mfma_f32_16x16x32_bf16 v[148:151], v[116:119], v[224:227], v[148:151]
    ds_read_b64_tr_b16 v[238:239], v243 offset:20992
    s_waitcnt lgkmcnt(4)
    v_mfma_f32_16x16x32_bf16 v[156:159], v[116:119], v[228:231], v[156:159]
    ds_read_b64_tr_b16 v[224:225], v240 offset:24576
    v_mfma_f32_16x16x32_bf16 v[152:155], v[112:115], v[228:231], v[152:155]
    ds_read_b64_tr_b16 v[226:227], v240 offset:25088
    s_waitcnt lgkmcnt(4)
    v_mfma_f32_16x16x32_bf16 v[160:163], v[112:115], v[232:235], v[160:163]
    ds_read_b64_tr_b16 v[228:229], v241 offset:24576
    v_mfma_f32_16x16x32_bf16 v[164:167], v[116:119], v[232:235], v[164:167]
    ds_read_b64_tr_b16 v[230:231], v241 offset:25088
    s_waitcnt lgkmcnt(4)
    v_mfma_f32_16x16x32_bf16 v[172:175], v[116:119], v[236:239], v[172:175]
    ds_read_b64_tr_b16 v[232:233], v242 offset:24576
    v_mfma_f32_16x16x32_bf16 v[168:171], v[112:115], v[236:239], v[168:171]
    ds_read_b64_tr_b16 v[234:235], v242 offset:25088
    s_waitcnt lgkmcnt(4)
    s_waitcnt vmcnt(6)
    v_mfma_f32_16x16x32_bf16 v[144:147], v[120:123], v[224:227], v[144:147]
    ds_read_b64_tr_b16 v[236:237], v243 offset:24576
    v_mfma_f32_16x16x32_bf16 v[148:151], v[124:127], v[224:227], v[148:151]
    ds_read_b64_tr_b16 v[238:239], v243 offset:25088
    s_waitcnt lgkmcnt(4)
    v_mfma_f32_16x16x32_bf16 v[156:159], v[124:127], v[228:231], v[156:159]
    ds_read_b64_tr_b16 v[224:225], v240 offset:28672
    v_mfma_f32_16x16x32_bf16 v[152:155], v[120:123], v[228:231], v[152:155]
    ds_read_b64_tr_b16 v[226:227], v240 offset:29184
    s_waitcnt lgkmcnt(4)
    v_mfma_f32_16x16x32_bf16 v[160:163], v[120:123], v[232:235], v[160:163]
    ds_read_b64_tr_b16 v[228:229], v241 offset:28672
    v_mfma_f32_16x16x32_bf16 v[164:167], v[124:127], v[232:235], v[164:167]
    ds_read_b64_tr_b16 v[230:231], v241 offset:29184
    s_waitcnt lgkmcnt(4)
    v_mfma_f32_16x16x32_bf16 v[172:175], v[124:127], v[236:239], v[172:175]
    ds_read_b64_tr_b16 v[232:233], v242 offset:28672
    v_mfma_f32_16x16x32_bf16 v[168:171], v[120:123], v[236:239], v[168:171]
    ds_read_b64_tr_b16 v[234:235], v242 offset:29184
    s_waitcnt lgkmcnt(4)
    s_waitcnt vmcnt(4)
    v_mfma_f32_16x16x32_bf16 v[144:147], v[128:131], v[224:227], v[144:147]
    ds_read_b64_tr_b16 v[236:237], v243 offset:28672
    v_mfma_f32_16x16x32_bf16 v[148:151], v[132:135], v[224:227], v[148:151]
    ds_read_b64_tr_b16 v[238:239], v243 offset:29184
    s_waitcnt lgkmcnt(4)
    v_mfma_f32_16x16x32_bf16 v[156:159], v[132:135], v[228:231], v[156:159]
    ds_read_b64_tr_b16 v[224:225], v240 offset:32768
    v_mfma_f32_16x16x32_bf16 v[152:155], v[128:131], v[228:231], v[152:155]
    ds_read_b64_tr_b16 v[226:227], v240 offset:33280
    s_waitcnt lgkmcnt(4)
    v_add_u32 v240, 0x9000, v240
    v_mfma_f32_16x16x32_bf16 v[160:163], v[128:131], v[232:235], v[160:163]
    ds_read_b64_tr_b16 v[228:229], v241 offset:32768
    v_mfma_f32_16x16x32_bf16 v[164:167], v[132:135], v[232:235], v[164:167]
    ds_read_b64_tr_b16 v[230:231], v241 offset:33280
    s_waitcnt lgkmcnt(4)
    v_add_u32 v241, 0x9000, v241
    v_mfma_f32_16x16x32_bf16 v[172:175], v[132:135], v[236:239], v[172:175]
    ds_read_b64_tr_b16 v[232:233], v242 offset:32768
    v_mfma_f32_16x16x32_bf16 v[168:171], v[128:131], v[236:239], v[168:171]
    ds_read_b64_tr_b16 v[234:235], v242 offset:33280
    s_waitcnt lgkmcnt(4)
    v_add_u32 v242, 0x9000, v242
    s_waitcnt vmcnt(2)
    v_mfma_f32_16x16x32_bf16 v[144:147], v[136:139], v[224:227], v[144:147]
    ds_read_b64_tr_b16 v[236:237], v243 offset:32768
    v_mfma_f32_16x16x32_bf16 v[148:151], v[140:143], v[224:227], v[148:151]
    ds_read_b64_tr_b16 v[238:239], v243 offset:33280
    s_waitcnt lgkmcnt(4)
    v_add_u32 v243, 0x9000, v243
    s_barrier
    v_mfma_f32_16x16x32_bf16 v[156:159], v[140:143], v[228:231], v[156:159]
    ds_read_b64_tr_b16 v[224:225], v240 offset:0
    v_mfma_f32_16x16x32_bf16 v[152:155], v[136:139], v[228:231], v[152:155]
    ds_read_b64_tr_b16 v[226:227], v240 offset:512
    s_waitcnt lgkmcnt(4)
    v_mfma_f32_16x16x32_bf16 v[160:163], v[136:139], v[232:235], v[160:163]
    ds_read_b64_tr_b16 v[228:229], v241 offset:0
    v_mfma_f32_16x16x32_bf16 v[164:167], v[140:143], v[232:235], v[164:167]
    ds_read_b64_tr_b16 v[230:231], v241 offset:512
    s_waitcnt lgkmcnt(4)
    v_mfma_f32_16x16x32_bf16 v[172:175], v[140:143], v[236:239], v[172:175]
    ds_read_b64_tr_b16 v[232:233], v242 offset:0
    v_mfma_f32_16x16x32_bf16 v[168:171], v[136:139], v[236:239], v[168:171]
    ds_read_b64_tr_b16 v[234:235], v242 offset:512
    s_waitcnt lgkmcnt(4)
L1_vr_tail:
    s_setprio 0
    s_nop 7
    s_add_u32 s32, s27, 0
    v_cvt_pk_bf16_f32 v144, v144, v145
    v_cvt_pk_bf16_f32 v145, v146, v147
    buffer_store_dwordx2 v[144:145], v246, s[12:15], s32 offen offset:0 sc1
    v_cvt_pk_bf16_f32 v148, v148, v149
    v_cvt_pk_bf16_f32 v149, v150, v151
    buffer_store_dwordx2 v[148:149], v246, s[12:15], s32 offen offset:640 sc1
    s_add_u32 s32, s27, 655360
    v_cvt_pk_bf16_f32 v152, v152, v153
    v_cvt_pk_bf16_f32 v153, v154, v155
    buffer_store_dwordx2 v[152:153], v246, s[12:15], s32 offen offset:0 sc1
    v_cvt_pk_bf16_f32 v156, v156, v157
    v_cvt_pk_bf16_f32 v157, v158, v159
    buffer_store_dwordx2 v[156:157], v246, s[12:15], s32 offen offset:640 sc1
    s_add_u32 s32, s27, 1310720
    v_cvt_pk_bf16_f32 v160, v160, v161
    v_cvt_pk_bf16_f32 v161, v162, v163
    buffer_store_dwordx2 v[160:161], v246, s[12:15], s32 offen offset:0 sc1
    v_cvt_pk_bf16_f32 v164, v164, v165
    v_cvt_pk_bf16_f32 v165, v166, v167
    buffer_store_dwordx2 v[164:165], v246, s[12:15], s32 offen offset:640 sc1
    s_add_u32 s32, s27, 1966080
    v_cvt_pk_bf16_f32 v168, v168, v169
    v_cvt_pk_bf16_f32 v169, v170, v171
    buffer_store_dwordx2 v[168:169], v246, s[12:15], s32 offen offset:0 sc1
    v_cvt_pk_bf16_f32 v172, v172, v173
    v_cvt_pk_bf16_f32 v173, v174, v175
    buffer_store_dwordx2 v[172:173], v246, s[12:15], s32 offen offset:640 sc1
    s_waitcnt lgkmcnt(0)
    s_branch L1_sp_tail
L1_sp_tail:
    s_lshr_b32 s33, s42, 2
    s_lshl_b32 s35, s33, 3
    s_add_u32 s35, s35, s41
    s_lshl_b32 s35, s35, 4
    s_add_u32 s35, s35, 40396800
    s_cmp_lt_u32 s41, 6
    s_cbranch_scc1 L1_sp_main
    s_waitcnt vmcnt(0)
    s_barrier
    s_cmp_lg_u32 s3, 7
    s_cbranch_scc1 L1_sp_p1
    v_mov_b32 v0, s44
    v_mov_b32 v1, s45
    v_mov_b32 v2, 0
    s_waitcnt vmcnt(0)
    s_mov_b64 exec, 1
    buffer_store_dwordx2 v[0:1], v2, s[12:15], s35 offen sc1
    s_mov_b64 exec, -1
L1_sp_p1:
    s_load_dwordx2 s[48:49], s[0:1], 16
    s_lshr_b32 s34, s42, 2
    s_lshl_b32 s34, s34, 1
    s_add_u32 s34, s34, s41
    s_sub_u32 s34, s34, 6
    s_mov_b32 s50, 663552
    s_mov_b32 s51, 0x20000
    s_waitcnt lgkmcnt(0)
    s_cmp_ge_u32 s3, 4
    s_cbranch_scc1 L1_sp_iwo
    s_mul_i32 s38, s34, 110592
    s_add_u32 s38, s38, 3538944
    s_mul_i32 s39, s3, 27648
    s_add_u32 s38, s38, s39
    s_add_u32 m0, s39, 0
    s_add_u32 s43, s38, 0
    buffer_load_dwordx4 v245, s[64:67], s43 offen lds
    s_add_u32 m0, s39, 1024
    s_add_u32 s43, s38, 1024
    buffer_load_dwordx4 v245, s[64:67], s43 offen lds
    s_add_u32 m0, s39, 2048
    s_add_u32 s43, s38, 2048
    buffer_load_dwordx4 v245, s[64:67], s43 offen lds
    s_add_u32 m0, s39, 3072
    s_add_u32 s43, s38, 3072
    buffer_load_dwordx4 v245, s[64:67], s43 offen lds
    s_add_u32 m0, s39, 4096
    s_add_u32 s43, s38, 4096
    buffer_load_dwordx4 v245, s[64:67], s43 offen lds
    s_add_u32 m0, s39, 5120
    s_add_u32 s43, s38, 5120
    buffer_load_dwordx4 v245, s[64:67], s43 offen lds
    s_add_u32 m0, s39, 6144
    s_add_u32 s43, s38, 6144
    buffer_load_dwordx4 v245, s[64:67], s43 offen lds
    s_add_u32 m0, s39, 7168
    s_add_u32 s43, s38, 7168
    buffer_load_dwordx4 v245, s[64:67], s43 offen lds
    s_add_u32 m0, s39, 8192
    s_add_u32 s43, s38, 8192
    buffer_load_dwordx4 v245, s[64:67], s43 offen lds
    s_add_u32 m0, s39, 9216
    s_add_u32 s43, s38, 9216
    buffer_load_dwordx4 v245, s[64:67], s43 offen lds
    s_add_u32 m0, s39, 10240
    s_add_u32 s43, s38, 10240
    buffer_load_dwordx4 v245, s[64:67], s43 offen lds
    s_add_u32 m0, s39, 11264
    s_add_u32 s43, s38, 11264
    buffer_load_dwordx4 v245, s[64:67], s43 offen lds
    s_add_u32 m0, s39, 12288
    s_add_u32 s43, s38, 12288
    buffer_load_dwordx4 v245, s[64:67], s43 offen lds
    s_add_u32 m0, s39, 13312
    s_add_u32 s43, s38, 13312
    buffer_load_dwordx4 v245, s[64:67], s43 offen lds
    s_add_u32 m0, s39, 14336
    s_add_u32 s43, s38, 14336
    buffer_load_dwordx4 v245, s[64:67], s43 offen lds
    s_add_u32 m0, s39, 15360
    s_add_u32 s43, s38, 15360
    buffer_load_dwordx4 v245, s[64:67], s43 offen lds
    s_add_u32 m0, s39, 16384
    s_add_u32 s43, s38, 16384
    buffer_load_dwordx4 v245, s[64:67], s43 offen lds
    s_add_u32 m0, s39, 17408
    s_add_u32 s43, s38, 17408
    buffer_load_dwordx4 v245, s[64:67], s43 offen lds
    s_add_u32 m0, s39, 18432
    s_add_u32 s43, s38, 18432
    buffer_load_dwordx4 v245, s[64:67], s43 offen lds
    s_add_u32 m0, s39, 19456
    s_add_u32 s43, s38, 19456
    buffer_load_dwordx4 v245, s[64:67], s43 offen lds
    s_add_u32 m0, s39, 20480
    s_add_u32 s43, s38, 20480
    buffer_load_dwordx4 v245, s[64:67], s43 offen lds
    s_add_u32 m0, s39, 21504
    s_add_u32 s43, s38, 21504
    buffer_load_dwordx4 v245, s[64:67], s43 offen lds
    s_add_u32 m0, s39, 22528
    s_add_u32 s43, s38, 22528
    buffer_load_dwordx4 v245, s[64:67], s43 offen lds
    s_add_u32 m0, s39, 23552
    s_add_u32 s43, s38, 23552
    buffer_load_dwordx4 v245, s[64:67], s43 offen lds
    s_add_u32 m0, s39, 24576
    s_add_u32 s43, s38, 24576
    buffer_load_dwordx4 v245, s[64:67], s43 offen lds
    s_add_u32 m0, s39, 25600
    s_add_u32 s43, s38, 25600
    buffer_load_dwordx4 v245, s[64:67], s43 offen lds
    s_add_u32 m0, s39, 26624
    s_add_u32 s43, s38, 26624
    buffer_load_dwordx4 v245, s[64:67], s43 offen lds
    s_branch L1_sp_idone
L1_sp_iwo:
    s_mul_i32 s38, s34, 41472
    s_and_b32 s39, s3, 3
    s_lshl_b32 s39, s39, 10
    s_add_u32 s38, s38, s39
    s_add_u32 s39, s39, 110592
    s_add_u32 m0, s39, 0
    s_add_u32 s43, s38, 0
    buffer_load_dwordx4 v245, s[48:51], s43 offen lds
    s_add_u32 m0, s39, 4096
    s_add_u32 s43, s38, 4096
    buffer_load_dwordx4 v245, s[48:51], s43 offen lds
    s_add_u32 m0, s39, 8192
    s_add_u32 s43, s38, 8192
    buffer_load_dwordx4 v245, s[48:51], s43 offen lds
    s_add_u32 m0, s39, 12288
    s_add_u32 s43, s38, 12288
    buffer_load_dwordx4 v245, s[48:51], s43 offen lds
    s_add_u32 m0, s39, 16384
    s_add_u32 s43, s38, 16384
    buffer_load_dwordx4 v245, s[48:51], s43 offen lds
    s_add_u32 m0, s39, 20480
    s_add_u32 s43, s38, 20480
    buffer_load_dwordx4 v245, s[48:51], s43 offen lds
    s_add_u32 m0, s39, 24576
    s_add_u32 s43, s38, 24576
    buffer_load_dwordx4 v245, s[48:51], s43 offen lds
    s_add_u32 m0, s39, 28672
    s_add_u32 s43, s38, 28672
    buffer_load_dwordx4 v245, s[48:51], s43 offen lds
    s_add_u32 m0, s39, 32768
    s_add_u32 s43, s38, 32768
    buffer_load_dwordx4 v245, s[48:51], s43 offen lds
    s_add_u32 m0, s39, 36864
    s_add_u32 s43, s38, 36864
    buffer_load_dwordx4 v245, s[48:51], s43 offen lds
    s_add_u32 m0, s39, 40960
    s_add_u32 s43, s38, 40960
    buffer_load_dwordx4 v245, s[48:51], s43 offen lds
L1_sp_idone:
    s_waitcnt vmcnt(0)
    s_barrier
    v_lshrrev_b32 v4, 2, v247
    v_mul_u32_u24 v4, 1152, v4
    v_and_b32 v5, 3, v247
    v_lshl_add_u32 v4, v5, 3, v4
    s_and_b32 s38, s3, 3
    s_mul_i32 s39, s38, 288
    v_add_u32 v4, s39, v4
    s_cmp_ge_u32 s3, 4
    s_cbranch_scc1 L1_sp_two
    s_mul_i32 s43, s3, 144
    s_mul_i32 s39, s34, 3
    s_add_u32 s43, s43, s39
    s_add_u32 s43, s43, 96
    s_mul_i32 s43, s43, 9216
    s_add_u32 s43, s43, 3145728
    ds_read_b64_tr_b16 v[16:17], v4 offset:0
    ds_read_b64_tr_b16 v[18:19], v4 offset:18432
    ds_read_b64_tr_b16 v[20:21], v4 offset:32
    ds_read_b64_tr_b16 v[22:23], v4 offset:18464
    ds_read_b64_tr_b16 v[24:25], v4 offset:64
    ds_read_b64_tr_b16 v[26:27], v4 offset:18496
    ds_read_b64_tr_b16 v[28:29], v4 offset:96
    ds_read_b64_tr_b16 v[30:31], v4 offset:18528
    ds_read_b64_tr_b16 v[32:33], v4 offset:128
    ds_read_b64_tr_b16 v[34:35], v4 offset:18560
    ds_read_b64_tr_b16 v[36:37], v4 offset:160
    ds_read_b64_tr_b16 v[38:39], v4 offset:18592
    ds_read_b64_tr_b16 v[40:41], v4 offset:192
    ds_read_b64_tr_b16 v[42:43], v4 offset:18624
    ds_read_b64_tr_b16 v[44:45], v4 offset:224
    ds_read_b64_tr_b16 v[46:47], v4 offset:18656
    ds_read_b64_tr_b16 v[48:49], v4 offset:256
    ds_read_b64_tr_b16 v[50:51], v4 offset:18688
    v_add_u32 v4, 36864, v4
    s_waitcnt lgkmcnt(0)
    buffer_store_dwordx4 v[16:19], v245, s[12:15], s43 offen offset:0 sc1
    buffer_store_dwordx4 v[20:23], v245, s[12:15], s43 offen offset:1024 sc1
    buffer_store_dwordx4 v[24:27], v245, s[12:15], s43 offen offset:2048 sc1
    s_add_u32 s43, s43, 3072
    buffer_store_dwordx4 v[28:31], v245, s[12:15], s43 offen offset:0 sc1
    buffer_store_dwordx4 v[32:35], v245, s[12:15], s43 offen offset:1024 sc1
    buffer_store_dwordx4 v[36:39], v245, s[12:15], s43 offen offset:2048 sc1
    s_add_u32 s43, s43, 3072
    buffer_store_dwordx4 v[40:43], v245, s[12:15], s43 offen offset:0 sc1
    buffer_store_dwordx4 v[44:47], v245, s[12:15], s43 offen offset:1024 sc1
    buffer_store_dwordx4 v[48:51], v245, s[12:15], s43 offen offset:2048 sc1
    s_add_u32 s43, s43, 3072
    ds_read_b64_tr_b16 v[52:53], v4 offset:0
    ds_read_b64_tr_b16 v[54:55], v4 offset:18432
    ds_read_b64_tr_b16 v[56:57], v4 offset:32
    ds_read_b64_tr_b16 v[58:59], v4 offset:18464
    ds_read_b64_tr_b16 v[60:61], v4 offset:64
    ds_read_b64_tr_b16 v[62:63], v4 offset:18496
    ds_read_b64_tr_b16 v[64:65], v4 offset:96
    ds_read_b64_tr_b16 v[66:67], v4 offset:18528
    ds_read_b64_tr_b16 v[68:69], v4 offset:128
    ds_read_b64_tr_b16 v[70:71], v4 offset:18560
    ds_read_b64_tr_b16 v[72:73], v4 offset:160
    ds_read_b64_tr_b16 v[74:75], v4 offset:18592
    ds_read_b64_tr_b16 v[76:77], v4 offset:192
    ds_read_b64_tr_b16 v[78:79], v4 offset:18624
    ds_read_b64_tr_b16 v[80:81], v4 offset:224
    ds_read_b64_tr_b16 v[82:83], v4 offset:18656
    ds_read_b64_tr_b16 v[84:85], v4 offset:256
    ds_read_b64_tr_b16 v[86:87], v4 offset:18688
    v_add_u32 v4, 36864, v4
    s_waitcnt lgkmcnt(0)
    buffer_store_dwordx4 v[52:55], v245, s[12:15], s43 offen offset:0 sc1
    buffer_store_dwordx4 v[56:59], v245, s[12:15], s43 offen offset:1024 sc1
    buffer_store_dwordx4 v[60:63], v245, s[12:15], s43 offen offset:2048 sc1
    s_add_u32 s43, s43, 3072
    buffer_store_dwordx4 v[64:67], v245, s[12:15], s43 offen offset:0 sc1
    buffer_store_dwordx4 v[68:71], v245, s[12:15], s43 offen offset:1024 sc1
    buffer_store_dwordx4 v[72:75], v245, s[12:15], s43 offen offset:2048 sc1
    s_add_u32 s43, s43, 3072
    buffer_store_dwordx4 v[76:79], v245, s[12:15], s43 offen offset:0 sc1
    buffer_store_dwordx4 v[80:83], v245, s[12:15], s43 offen offset:1024 sc1
    buffer_store_dwordx4 v[84:87], v245, s[12:15], s43 offen offset:2048 sc1
    s_add_u32 s43, s43, 3072
    ds_read_b64_tr_b16 v[88:89], v4 offset:0
    ds_read_b64_tr_b16 v[90:91], v4 offset:18432
    ds_read_b64_tr_b16 v[92:93], v4 offset:32
    ds_read_b64_tr_b16 v[94:95], v4 offset:18464
    ds_read_b64_tr_b16 v[96:97], v4 offset:64
    ds_read_b64_tr_b16 v[98:99], v4 offset:18496
    ds_read_b64_tr_b16 v[100:101], v4 offset:96
    ds_read_b64_tr_b16 v[102:103], v4 offset:18528
    ds_read_b64_tr_b16 v[104:105], v4 offset:128
    ds_read_b64_tr_b16 v[106:107], v4 offset:18560
    ds_read_b64_tr_b16 v[108:109], v4 offset:160
    ds_read_b64_tr_b16 v[110:111], v4 offset:18592
    ds_read_b64_tr_b16 v[112:113], v4 offset:192
    ds_read_b64_tr_b16 v[114:115], v4 offset:18624
    ds_read_b64_tr_b16 v[116:117], v4 offset:224
    ds_read_b64_tr_b16 v[118:119], v4 offset:18656
    ds_read_b64_tr_b16 v[120:121], v4 offset:256
    ds_read_b64_tr_b16 v[122:123], v4 offset:18688
    v_add_u32 v4, 36864, v4
    s_waitcnt lgkmcnt(0)
    buffer_store_dwordx4 v[88:91], v245, s[12:15], s43 offen offset:0 sc1
    buffer_store_dwordx4 v[92:95], v245, s[12:15], s43 offen offset:1024 sc1
    buffer_store_dwordx4 v[96:99], v245, s[12:15], s43 offen offset:2048 sc1
    s_add_u32 s43, s43, 3072
    buffer_store_dwordx4 v[100:103], v245, s[12:15], s43 offen offset:0 sc1
    buffer_store_dwordx4 v[104:107], v245, s[12:15], s43 offen offset:1024 sc1
    buffer_store_dwordx4 v[108:111], v245, s[12:15], s43 offen offset:2048 sc1
    s_add_u32 s43, s43, 3072
    buffer_store_dwordx4 v[112:115], v245, s[12:15], s43 offen offset:0 sc1
    buffer_store_dwordx4 v[116:119], v245, s[12:15], s43 offen offset:1024 sc1
    buffer_store_dwordx4 v[120:123], v245, s[12:15], s43 offen offset:2048 sc1
    s_add_u32 s43, s43, 3072
    s_branch L1_sp_tdone
L1_sp_two:
    v_lshrrev_b32 v5, 5, v247
    v_mul_u32_u24 v5, 20, v5
    v_bfe_u32 v6, v247, 2, 3
    v_add_u32 v5, v5, v6
    v_mul_u32_u24 v5, 1152, v5
    v_and_b32 v6, 3, v247
    v_lshl_add_u32 v5, v6, 3, v5
    s_add_u32 s39, s39, 110592
    v_add_u32 v5, s39, v5
    v_bfe_u32 v8, v247, 2, 2
    v_add_u32 v8, 16, v8
    v_mul_u32_u24 v8, 1152, v8
    v_lshl_add_u32 v8, v6, 3, v8
    v_lshrrev_b32 v9, 4, v247
    v_lshl_add_u32 v8, v9, 5, v8
    v_add_u32 v8, s39, v8
    s_lshl_b32 s43, s38, 4
    s_add_u32 s43, s43, s34
    s_mul_i32 s43, s43, 9216
    s_add_u32 s43, s43, 9437184
    s_lshl_b32 s38, s38, 2
    s_lshr_b32 s39, s34, 2
    s_add_u32 s38, s38, s39
    s_mul_i32 s38, s38, 5120
    s_and_b32 s39, s34, 3
    s_lshl_b32 s39, s39, 8
    s_add_u32 s38, s38, s39
    s_add_u32 s38, s38, 10027008
    v_and_b32 v10, 15, v247
    v_lshlrev_b32 v10, 4, v10
    v_and_b32 v11, 1, v9
    v_lshl_add_u32 v10, v11, 3, v10
    v_lshrrev_b32 v11, 1, v9
    v_lshl_add_u32 v10, v11, 10, v10
    ds_read_b64_tr_b16 v[16:17], v5 offset:0
    ds_read_b64_tr_b16 v[18:19], v5 offset:9216
    ds_read_b64_tr_b16 v[20:21], v5 offset:32
    ds_read_b64_tr_b16 v[22:23], v5 offset:9248
    ds_read_b64_tr_b16 v[24:25], v5 offset:64
    ds_read_b64_tr_b16 v[26:27], v5 offset:9280
    ds_read_b64_tr_b16 v[28:29], v5 offset:96
    ds_read_b64_tr_b16 v[30:31], v5 offset:9312
    ds_read_b64_tr_b16 v[32:33], v5 offset:128
    ds_read_b64_tr_b16 v[34:35], v5 offset:9344
    ds_read_b64_tr_b16 v[36:37], v5 offset:160
    ds_read_b64_tr_b16 v[38:39], v5 offset:9376
    ds_read_b64_tr_b16 v[40:41], v5 offset:192
    ds_read_b64_tr_b16 v[42:43], v5 offset:9408
    ds_read_b64_tr_b16 v[44:45], v5 offset:224
    ds_read_b64_tr_b16 v[46:47], v5 offset:9440
    ds_read_b64_tr_b16 v[48:49], v5 offset:256
    ds_read_b64_tr_b16 v[50:51], v5 offset:9472
    ds_read_b64_tr_b16 v[52:53], v8 offset:0
    ds_read_b64_tr_b16 v[54:55], v8 offset:128
    ds_read_b64_tr_b16 v[56:57], v8 offset:256
    s_waitcnt lgkmcnt(0)
    buffer_store_dwordx4 v[16:19], v245, s[12:15], s43 offen offset:0 sc1
    buffer_store_dwordx4 v[20:23], v245, s[12:15], s43 offen offset:1024 sc1
    buffer_store_dwordx4 v[24:27], v245, s[12:15], s43 offen offset:2048 sc1
    s_add_u32 s43, s43, 3072
    buffer_store_dwordx4 v[28:31], v245, s[12:15], s43 offen offset:0 sc1
    buffer_store_dwordx4 v[32:35], v245, s[12:15], s43 offen offset:1024 sc1
    buffer_store_dwordx4 v[36:39], v245, s[12:15], s43 offen offset:2048 sc1
    s_add_u32 s43, s43, 3072
    buffer_store_dwordx4 v[40:43], v245, s[12:15], s43 offen offset:0 sc1
    buffer_store_dwordx4 v[44:47], v245, s[12:15], s43 offen offset:1024 sc1
    buffer_store_dwordx4 v[48:51], v245, s[12:15], s43 offen offset:2048 sc1
    s_add_u32 s43, s43, 3072
    buffer_store_dwordx2 v[52:53], v10, s[12:15], s38 offen sc1
    buffer_store_dwordx2 v[54:55], v10, s[12:15], s38 offen offset:2048 sc1
    s_add_u32 s38, s38, 4096
    s_mov_b64 exec, 0xffff
    buffer_store_dwordx2 v[56:57], v10, s[12:15], s38 offen sc1
    s_mov_b64 exec, -1
L1_sp_tdone:
    s_branch L1_sp_done
L1_sp_main:
    v_lshrrev_b32 v4, 2, v247
    v_mul_u32_u24 v4, 1152, v4
    v_and_b32 v5, 3, v247
    v_lshl_add_u32 v4, v5, 3, v4
    s_and_b32 s38, s3, 3
    s_mul_i32 s39, s38, 288
    v_add_u32 v4, s39, v4
    s_mul_i32 s34, s33, 6
    s_add_u32 s34, s34, s41
    s_lshl_b32 s34, s34, 1
    s_lshr_b32 s24, s3, 2
    s_add_u32 s34, s34, s24
    s_mul_i32 s24, s24, 36864
    v_add_u32 v4, s24, v4
    s_mul_i32 s26, s38, 144
    s_add_u32 s26, s26, s34
    s_mul_i32 s26, s26, 9216
    s_add_u32 s26, s26, 3145728
    ds_read_b64_tr_b16 v[16:17], v4 offset:0
    ds_read_b64_tr_b16 v[18:19], v4 offset:18432
    ds_read_b64_tr_b16 v[20:21], v4 offset:32
    ds_read_b64_tr_b16 v[22:23], v4 offset:18464
    ds_read_b64_tr_b16 v[24:25], v4 offset:64
    ds_read_b64_tr_b16 v[26:27], v4 offset:18496
    ds_read_b64_tr_b16 v[28:29], v4 offset:96
    ds_read_b64_tr_b16 v[30:31], v4 offset:18528
    ds_read_b64_tr_b16 v[32:33], v4 offset:128
    ds_read_b64_tr_b16 v[34:35], v4 offset:18560
    ds_read_b64_tr_b16 v[36:37], v4 offset:160
    ds_read_b64_tr_b16 v[38:39], v4 offset:18592
    ds_read_b64_tr_b16 v[40:41], v4 offset:192
    ds_read_b64_tr_b16 v[42:43], v4 offset:18624
    ds_read_b64_tr_b16 v[44:45], v4 offset:224
    ds_read_b64_tr_b16 v[46:47], v4 offset:18656
    ds_read_b64_tr_b16 v[48:49], v4 offset:256
    ds_read_b64_tr_b16 v[50:51], v4 offset:18688
    v_add_u32 v4, 36864, v4
    s_waitcnt vmcnt(0)
    s_barrier
    s_cmp_lg_u32 s3, 7
    s_cbranch_scc1 L1_sp_p2
    v_mov_b32 v0, s44
    v_mov_b32 v1, s45
    v_mov_b32 v2, 0
    s_waitcnt vmcnt(0)
    s_mov_b64 exec, 1
    buffer_store_dwordx2 v[0:1], v2, s[12:15], s35 offen sc1
    s_mov_b64 exec, -1
L1_sp_p2:
    s_waitcnt lgkmcnt(0)
    buffer_store_dwordx4 v[16:19], v245, s[12:15], s26 offen offset:0 sc1
    buffer_store_dwordx4 v[20:23], v245, s[12:15], s26 offen offset:1024 sc1
    buffer_store_dwordx4 v[24:27], v245, s[12:15], s26 offen offset:2048 sc1
    s_add_u32 s26, s26, 3072
    buffer_store_dwordx4 v[28:31], v245, s[12:15], s26 offen offset:0 sc1
    buffer_store_dwordx4 v[32:35], v245, s[12:15], s26 offen offset:1024 sc1
    buffer_store_dwordx4 v[36:39], v245, s[12:15], s26 offen offset:2048 sc1
    s_add_u32 s26, s26, 3072
    buffer_store_dwordx4 v[40:43], v245, s[12:15], s26 offen offset:0 sc1
    buffer_store_dwordx4 v[44:47], v245, s[12:15], s26 offen offset:1024 sc1
    buffer_store_dwordx4 v[48:51], v245, s[12:15], s26 offen offset:2048 sc1
    s_add_u32 s26, s26, 3072
L1_sp_done:
    s_waitcnt vmcnt(0) lgkmcnt(0)
    s_barrier
    s_add_u32 s35, s35, 8
    s_cmp_lg_u32 s3, 7
    s_cbranch_scc1 L1_sp_nf2
    v_mov_b32 v0, s44
    v_mov_b32 v1, s45
    v_mov_b32 v2, 0
    s_waitcnt vmcnt(0)
    s_mov_b64 exec, 1
    buffer_store_dwordx2 v[0:1], v2, s[12:15], s35 offen sc1
    s_mov_b64 exec, -1
L1_sp_nf2:
    s_mov_b32 s46, 0x40000000
    s_cmp_ge_u32 s3, 4
    s_cbranch_scc1 L2e_sp_g
    s_mov_b32 s47, 40396800
    v_lshlrev_b32 v8, 4, v247
    s_mov_b32 s31, 400000
L2e_sp_pq:
    buffer_load_dwordx2 v[0:1], v8, s[12:15], s47 offen sc1
    s_waitcnt vmcnt(0)
    v_cmp_ne_u64 vcc, s[44:45], v[0:1]
    s_nop 1
    s_and_b64 vcc, vcc, exec
    s_cbranch_scc0 L2e_sp_pq_ok
    s_sleep 4
    s_sub_u32 s31, s31, 1
    s_cmp_lg_u32 s31, 0
    s_cbranch_scc1 L2e_sp_pq
L2e_sp_pq_ok:
    v_mov_b32 v7, v247
    v_lshlrev_b32 v8, 4, v247
    s_lshl_b32 s63, s41, 2
    s_lshr_b32 s30, s42, 3
    s_add_u32 s63, s63, s30
    s_and_b32 s62, s42, 7
    v_and_b32 v1, 31, v7
    v_lshrrev_b32 v2, 5, v7
    v_lshlrev_b32 v10, 2, v1
    v_lshl_add_u32 v10, v2, 30, v10
    s_lshl_b32 s48, s63, 16
    s_lshl_b32 s50, s62, 13
    s_add_u32 s50, s50, s48
    s_add_u32 s50, s50, 10485760
    s_lshl_b32 s49, s63, 13
    s_lshl_b32 s51, s62, 10
    s_add_u32 s51, s51, s49
    s_add_u32 s51, s51, 14680064
    s_add_u32 s20, s48, 12582912
    s_add_u32 s21, s49, 14942208
    buffer_load_dwordx4 v[40:43], v8, s[12:15], s20 offen sc1
    buffer_load_dword v44, v10, s[12:15], s21 offen sc1
    buffer_load_dwordx4 v[48:51], v8, s[12:15], s50 offen offset:0 sc1
    buffer_load_dword v80, v10, s[12:15], s51 offen offset:0 sc1
    buffer_load_dwordx4 v[52:55], v8, s[12:15], s50 offen offset:1024 sc1
    buffer_load_dword v82, v10, s[12:15], s51 offen offset:128 sc1
    buffer_load_dwordx4 v[56:59], v8, s[12:15], s50 offen offset:2048 sc1
    buffer_load_dword v84, v10, s[12:15], s51 offen offset:256 sc1
    buffer_load_dwordx4 v[60:63], v8, s[12:15], s50 offen offset:3072 sc1
    buffer_load_dword v86, v10, s[12:15], s51 offen offset:384 sc1
    s_add_u32 s50, s50, 4096
    buffer_load_dwordx4 v[64:67], v8, s[12:15], s50 offen offset:0 sc1
    buffer_load_dword v88, v10, s[12:15], s51 offen offset:512 sc1
    buffer_load_dwordx4 v[68:71], v8, s[12:15], s50 offen offset:1024 sc1
    buffer_load_dword v90, v10, s[12:15], s51 offen offset:640 sc1
    buffer_load_dwordx4 v[72:75], v8, s[12:15], s50 offen offset:2048 sc1
    buffer_load_dword v92, v10, s[12:15], s51 offen offset:768 sc1
    buffer_load_dwordx4 v[76:79], v8, s[12:15], s50 offen offset:3072 sc1
    buffer_load_dword v94, v10, s[12:15], s51 offen offset:896 sc1
    s_lshl_b32 s36, s3, 14
    s_add_u32 s20, s48, s36
    s_add_u32 s20, s20, 12582912
    s_lshl_b32 s36, s3, 11
    s_add_u32 s21, s49, s36
    s_add_u32 s21, s21, 14942208
    s_mul_i32 s22, s63, 81920
    s_mul_i32 s36, s3, 20480
    s_add_u32 s22, s22, s36
    s_add_u32 s22, s22, 15728640
    buffer_load_dwordx4 v[12:15], v8, s[12:15], s20 offen sc1
    buffer_load_dword v24, v10, s[12:15], s21 offen sc1
    s_add_u32 s20, s20, 1024
    s_add_u32 s21, s21, 128
    v_mul_u32_u24 v9, 320, v2
    v_lshl_add_u32 v9, v1, 4, v9
    s_mov_b32 s60, 0x3ffff
    s_mov_b32 s61, 0x3ffff
    v_cmp_eq_u32 vcc, 18, v1
    v_mov_b32 v3, 0x3f803f80
    s_mov_b32 s24, 0
    s_mov_b32 s25, 0
    v_cndmask_b32 v16, 0, v3, vcc
    v_cndmask_b32 v17, 0, v3, vcc
    v_cndmask_b32 v18, 0, v3, vcc
    v_cndmask_b32 v19, 0, v3, vcc
    v_cndmask_b32 v20, 0, v3, vcc
    v_cndmask_b32 v21, 0, v3, vcc
    v_cndmask_b32 v22, 0, v3, vcc
    v_cndmask_b32 v23, 0, v3, vcc
    v_cndmask_b32 v30, 0, v3, vcc
    v_cndmask_b32 v31, 0, v3, vcc
    v_cndmask_b32 v32, 0, v3, vcc
    v_cndmask_b32 v33, 0, v3, vcc
    v_cndmask_b32 v34, 0, v3, vcc
    v_cndmask_b32 v35, 0, v3, vcc
    v_cndmask_b32 v36, 0, v3, vcc
    v_cndmask_b32 v37, 0, v3, vcc
    s_mov_b64 exec, s[60:61]
    buffer_load_dwordx4 v[16:19], v9, s[12:15], s22 offen sc1
    buffer_load_dwordx4 v[20:23], v9, s[12:15], s22 offen offset:640 sc1
    s_mov_b64 exec, -1
    s_add_u32 s22, s22, 1280
    buffer_load_dwordx4 v[26:29], v8, s[12:15], s20 offen sc1
    buffer_load_dword v38, v10, s[12:15], s21 offen sc1
    s_add_u32 s20, s20, 1024
    s_add_u32 s21, s21, 128
    v_cmp_gt_u32 vcc, 32, v7
    v_mov_b32 v4, 0
    v_mov_b32 v5, 0
    v_mov_b32 v45, 0
    v_cndmask_b32 v25, 0, v3, vcc
    v_cndmask_b32 v39, 0, v3, vcc
    v_mov_b32 v81, 0
    v_mov_b32 v83, 0
    v_mov_b32 v85, 0
    v_mov_b32 v87, 0
    v_mov_b32 v89, 0
    v_mov_b32 v91, 0
    v_mov_b32 v93, 0
    v_mov_b32 v95, 0
    v_mov_b32 v0, s44
    v_mov_b32 v1, s45
    v_mov_b32 v2, 0
    buffer_store_dword v2, v8, s[12:15], s46 offen
    buffer_store_dword v2, v8, s[12:15], s46 offen
    buffer_store_dword v2, v8, s[12:15], s46 offen
    buffer_store_dword v2, v8, s[12:15], s46 offen
    s_branch L2e_sp_done
L2e_sp_g:
    s_setprio 2
    v_mov_b32 v7, v247
    v_lshlrev_b32 v4, 4, v247
L2e_sp_done:
    s_nop 3
    s_cmp_ge_u32 s3, 4
    s_cbranch_scc1 L2_gemm
    s_branch L2_att
L_end:
    s_endpgm
code_end:
.section .rodata,"a"
.p2align 6
.amdhsa_kernel recurrent_scan__softmax_full_mha__glu_gated_glu__prompt_kernel
  .amdhsa_next_free_vgpr 256
  .amdhsa_next_free_sgpr 102
  .amdhsa_accum_offset 256
  .amdhsa_group_segment_fixed_size 0
  .amdhsa_kernarg_size 80
  .amdhsa_user_sgpr_count 2
  .amdhsa_user_sgpr_kernarg_segment_ptr 1
  .amdhsa_system_sgpr_workgroup_id_x 1
  .amdhsa_float_denorm_mode_32 3
  .amdhsa_float_denorm_mode_16_64 3
.end_amdhsa_kernel
```
